```python
import torch

def _softmax(x, axis=-1):
    return torch.softmax(x, dim=axis)

def _gelu(x):
    return torch.nn.functional.gelu(x, approximate='tanh')

def _silu(x):
    return torch.nn.functional.silu(x)

def _sigmoid(x):
    return torch.sigmoid(x)

def _layernorm(x, axis=-1, eps=1e-05):
    m = x.mean(dim=axis, keepdim=True)
    v = x.var(dim=axis, keepdim=True, unbiased=False)
    return (x - m) / torch.sqrt(v + eps)

def _scatter_add(tgt, idx, src, axis=0):
    return tgt.clone().index_add_(axis, idx, src)

def _segment_sum(src, seg, n):
    out = torch.zeros((n,) + src.shape[1:], dtype=src.dtype)
    return out.index_add_(0, seg, src)

def _pad(x, pw):
    flat = tuple((v for pair in reversed(pw) for v in pair))
    return torch.nn.functional.pad(x, flat)
kernel_name = 'recurrent_scan__memory_aug_recurrent_mem_tr__mixer_channel_mlp__prompt'

def setup_inputs():

    _w = lambda a: (lambda t: t.to(torch.bfloat16) if t.is_floating_point() else t)(torch.as_tensor(a))

    def _A_setup():
        B, S, Dm = (1, 2048, 512)
        H, Dh = (32, 128)
        M, seg = (8, 32)
        seg = min(seg, S)
        S = S // seg * seg
        return {'x': _w((lambda *s: torch.randn(*s, dtype=torch.bfloat16) * 0.05)(B, S, Dm)), 'mem0': _w((lambda *s: torch.randn(*s, dtype=torch.bfloat16) * 0.8)(B, M, Dm)), 'Wq': _w((lambda *s: torch.randn(*s, dtype=torch.bfloat16) * 0.8)(Dm, H, Dh) * Dm ** (-0.5)), 'Wk': _w((lambda *s: torch.randn(*s, dtype=torch.bfloat16) * 0.8)(Dm, H, Dh) * Dm ** (-0.5)), 'Wv': _w((lambda *s: torch.randn(*s, dtype=torch.bfloat16) * 0.8)(Dm, H, Dh) * Dm ** (-0.5)), 'Wo': _w((lambda *s: torch.randn(*s, dtype=torch.bfloat16) * 0.8)(H, Dh, Dm) * (H * Dh) ** (-0.5)), 'seg_len': seg}
    _A_in = _A_setup()

    def _B_setup():
        B, S, D, F = (1, 2048, 512, 1792)
        return {'x': _w((lambda *s: torch.randn(*s, dtype=torch.bfloat16) * 0.05)(B, S, D)), 'w1': _w((lambda *s: torch.randn(*s, dtype=torch.bfloat16) * 0.8)(D, F) * D ** (-0.5)), 'b1': _w((lambda *s: torch.randn(*s, dtype=torch.bfloat16) * 0.4)(F)), 'w2': _w((lambda *s: torch.randn(*s, dtype=torch.bfloat16) * 0.2)(F, D) * F ** (-0.5)), 'b2': _w((lambda *s: torch.randn(*s, dtype=torch.bfloat16) * 0.2)(D))}
    _B_in = _B_setup()
    return {'A_x': _A_in['x'], 'A_mem0': _A_in['mem0'], 'A_Wq': _A_in['Wq'], 'A_Wk': _A_in['Wk'], 'A_Wv': _A_in['Wv'], 'A_Wo': _A_in['Wo'], 'A_seg_len': _A_in['seg_len'], 'B_x': _B_in['x'], 'B_w1': _B_in['w1'], 'B_b1': _B_in['b1'], 'B_w2': _B_in['w2'], 'B_b2': _B_in['b2']}

def reference(A_x, A_mem0, A_Wq, A_Wk, A_Wv, A_Wo, A_seg_len, B_x, B_w1, B_b1, B_w2, B_b2):

    def _A_ref(x, mem0, Wq, Wk, Wv, Wo, seg_len):
        B, S, Dm = x.shape
        H, Dh = (Wq.shape[1], Wq.shape[2])
        M = mem0.shape[1]
        scale = Dh ** (-0.5)
        n_seg = S // seg_len
        L = M + seg_len
        idx = torch.arange(L)
        mask = (idx[:, None] < M) | (idx[:, None] >= idx[None, :])
        mem = mem0
        outs = []
        for s in range(n_seg):
            xs = x[:, s * seg_len:(s + 1) * seg_len, :].clone()
            h = torch.concatenate([mem, xs], axis=1)
            q = torch.einsum('btd,dhe->bhte', h, Wq)
            k = torch.einsum('btd,dhe->bhte', h, Wk)
            v = torch.einsum('btd,dhe->bhte', h, Wv)
            scores = torch.einsum('bhqe,bhke->bhqk', q, k) * scale
            scores = torch.where(mask[None, None], scores, -1000000000.0)
            p = _softmax(scores, axis=-1)
            o = torch.einsum('bhqk,bhke->bhqe', p, v)
            o = torch.einsum('bhte,hed->btd', o, Wo)
            mem = o[:, :M, :].clone()
            outs.append(o[:, M:, :])
        return torch.concatenate(outs, axis=1)

    def _B_ref(x, w1, b1, w2, b2):
        y = _layernorm(x, axis=-1)
        h = _gelu(torch.einsum('bsd,df->bsf', y, w1) + b1)
        return torch.einsum('bsf,fd->bsd', h, w2) + b2
    x = A_x
    xn = _layernorm(x, axis=-1)
    s = _A_ref(xn, A_mem0, A_Wq, A_Wk, A_Wv, A_Wo, A_seg_len)
    g = _silu(_B_ref(xn, B_w1, B_b1, B_w2, B_b2))
    return x + s * g
```

```asm
; @launch grid=(256,1,1) block=(256,1,1) lds=163840
.amdgcn_target "amdgcn-amd-amdhsa--gfx950"
.text
.globl recurrent_scan__memory_aug_recurrent_mem_tr__mixer_channel_mlp__prompt_kernel
.p2align 8
.type recurrent_scan__memory_aug_recurrent_mem_tr__mixer_channel_mlp__prompt_kernel,@function
recurrent_scan__memory_aug_recurrent_mem_tr__mixer_channel_mlp__prompt_kernel:
  s_cmp_ge_u32 s2, 256
  s_cbranch_scc1 L_end
  s_load_dwordx4 s[12:15], s[0:1], 32
  s_load_dwordx8 s[4:11], s[0:1], 0
  s_load_dwordx8 s[20:27], s[0:1], 64
  s_load_dwordx4 s[28:31], s[0:1], 96
  s_load_dwordx2 s[32:33], s[0:1], 112
  v_lshrrev_b32 v1, 6, v0
  v_and_b32 v0, 63, v0
  v_readfirstlane_b32 s34, v1
  s_lshr_b32 s35, s2, 3
  s_getreg_b32 s100, hwreg(HW_REG_XCC_ID, 0, 3)
  s_sub_u32 s100, s100, s2
  s_and_b32 s100, s100, 7
  s_or_b32 s100, s100, 8
L_dispatch:
  s_add_u32 s60, s2, s100
  s_lshl_b32 s60, s60, 2
  s_lshr_b32 s60, 0x37260415, s60
  s_and_b32 s60, s60, 7
  s_cbranch_scc1 L_roles
L_chain:
  s_getpc_b64 s[62:63]
L_pc_1:
  s_lshl_b32 s61, s34, 12
  v_lshl_add_u32 v6, v0, 6, s61
  v_min_u32 v7, L_chain_c2-L_pc_1-4, v6
  v_mov_b32 v5, s63
  v_add_co_u32 v4, vcc, s62, v7
  s_nop 1
  v_addc_co_u32 v5, vcc, 0, v5, vcc
  global_load_dword v8, v[4:5], off
  v_lshrrev_b32 v120, 5, v0
  v_lshlrev_b32 v120, 12, v120
  v_bfe_u32 v121, v0, 4, 1
  v_lshl_add_u32 v120, v121, 14, v120
  v_and_b32 v121, 15, v0
  v_lshl_add_u32 v120, v121, 4, v120
  s_lshl_b32 s18, s35, 17
  s_lshl_b32 s19, s34, 8
  s_add_u32 s18, s18, s19
  v_add_u32 v120, s18, v120
  s_waitcnt lgkmcnt(0)
  s_mov_b32 s56, s14
  s_mov_b32 s57, s15
  s_mov_b32 s58, 0x400000
  s_mov_b32 s59, 0x20000
  s_xor_b32 s18, s34, 0
  s_lshl_b32 s18, s18, 15
  s_add_u32 s63, s18, 0x0
  buffer_load_dwordx4 v[52:55], v120, s[56:59], s63 offen offset:0
  buffer_load_dwordx4 v[56:59], v120, s[56:59], s63 offen offset:1024
  buffer_load_dwordx4 v[60:63], v120, s[56:59], s63 offen offset:2048
  buffer_load_dwordx4 v[64:67], v120, s[56:59], s63 offen offset:3072
  s_add_u32 s63, s18, 0x2000
  buffer_load_dwordx4 v[68:71], v120, s[56:59], s63 offen offset:0
  buffer_load_dwordx4 v[72:75], v120, s[56:59], s63 offen offset:1024
  buffer_load_dwordx4 v[76:79], v120, s[56:59], s63 offen offset:2048
  buffer_load_dwordx4 v[80:83], v120, s[56:59], s63 offen offset:3072
  s_mov_b32 s3, 0x80000
  s_mov_b32 s16, 0x05040100
  s_mov_b32 s17, 0x07060302
  s_mov_b32 s36, s32
  s_mov_b32 s37, s33
  s_mov_b32 s38, 0x10000000
  s_mov_b32 s39, 0x20000
  s_mov_b32 s40, s30
  s_mov_b32 s41, s31
  s_mov_b32 s42, 0x100
  s_mov_b32 s43, 0x20000
  s_cmp_lg_u32 s2, 0
  s_cbranch_scc1 L_notwg0_2
  v_mov_b32 v1, s100
  s_mov_b64 exec, 1
  buffer_store_dword v1, off, s[40:43], 0 offset:4 sc1
  s_mov_b64 exec, -1
L_notwg0_2:
  s_lshl_b32 s18, s34, 11
  v_lshl_add_u32 v1, v0, 4, s18
  v_add_u32 v2, 0x10000, v1
  v_add_u32 v3, 0x20000, v1
  s_mul_i32 s64, s34, 31
  s_add_u32 s64, s64, s35
  s_lshl_b32 s64, s64, 11
  s_add_u32 s64, s64, 0x500000
  s_lshl_b32 s18, s34, 1
  s_lshr_b32 s18, 0xe4, s18
  s_and_b32 s18, s18, 3
  s_lshl_b32 s80, s18, 9
  s_lshl_b32 s18, s34, 1
  s_lshr_b32 s18, 0xb1, s18
  s_and_b32 s18, s18, 3
  s_lshl_b32 s81, s18, 9
  s_lshl_b32 s18, s34, 1
  s_lshr_b32 s18, 0x4e, s18
  s_and_b32 s18, s18, 3
  s_lshl_b32 s82, s18, 9
  s_lshl_b32 s18, s34, 1
  s_lshr_b32 s18, 0x1b, s18
  s_and_b32 s18, s18, 3
  s_lshl_b32 s83, s18, 9
  s_mov_b32 s44, s8
  s_mov_b32 s45, s9
  s_mov_b32 s46, 0x400000
  s_mov_b32 s47, 0x20000
  s_mov_b32 s48, s10
  s_mov_b32 s49, s11
  s_mov_b32 s50, 0x400000
  s_mov_b32 s51, 0x20000
  s_mov_b32 s52, s12
  s_mov_b32 s53, s13
  s_mov_b32 s54, 0x400000
  s_mov_b32 s55, 0x20000
  s_and_b32 s18, s34, 1
  s_lshr_b32 s19, s34, 1
  s_lshl_b32 s61, s18, 1
  s_lshl_b32 s62, s19, 3
  s_add_u32 s61, s61, s62
  s_lshl_b32 s62, s61, 10
  s_lshl_b32 s61, s61, 15
  s_lshl_b32 s63, s35, 8
  s_add_u32 s61, s61, s63
  s_lshl_b32 s18, s18, 2
  s_lshl_b32 s19, s19, 3
  s_add_u32 s18, s18, s19
  v_lshrrev_b32 v127, 4, v0
  v_and_b32 v125, 1, v127
  v_lshl_add_u32 v125, v125, 1, s18
  v_and_b32 v126, 15, v0
  v_xor_b32 v125, v125, v126
  v_lshlrev_b32 v125, 4, v125
  v_lshlrev_b32 v124, 13, v127
  v_add3_u32 v124, v124, v125, s61
  s_xor_b32 s18, s34, 1
  s_lshl_b32 s18, s18, 15
  s_add_u32 s63, s18, 0x0
  buffer_load_dwordx4 v[84:87], v120, s[56:59], s63 offen offset:0
  buffer_load_dwordx4 v[88:91], v120, s[56:59], s63 offen offset:1024
  buffer_load_dwordx4 v[92:95], v120, s[56:59], s63 offen offset:2048
  buffer_load_dwordx4 v[96:99], v120, s[56:59], s63 offen offset:3072
  s_add_u32 s63, s18, 0x2000
  buffer_load_dwordx4 v[100:103], v120, s[56:59], s63 offen offset:0
  buffer_load_dwordx4 v[104:107], v120, s[56:59], s63 offen offset:1024
  buffer_load_dwordx4 v[108:111], v120, s[56:59], s63 offen offset:2048
  buffer_load_dwordx4 v[112:115], v120, s[56:59], s63 offen offset:3072
  buffer_load_dword v123, off, s[40:43], 0 offset:4 sc1
  s_xor_b32 s18, s34, 2
  s_lshl_b32 s18, s18, 15
  s_add_u32 s63, s18, 0x0
  buffer_load_dwordx4 a[0:3], v120, s[56:59], s63 offen offset:0
  buffer_load_dwordx4 a[4:7], v120, s[56:59], s63 offen offset:1024
  buffer_load_dwordx4 a[8:11], v120, s[56:59], s63 offen offset:2048
  buffer_load_dwordx4 a[12:15], v120, s[56:59], s63 offen offset:3072
  s_add_u32 s63, s18, 0x2000
  buffer_load_dwordx4 a[16:19], v120, s[56:59], s63 offen offset:0
  buffer_load_dwordx4 a[20:23], v120, s[56:59], s63 offen offset:1024
  buffer_load_dwordx4 a[24:27], v120, s[56:59], s63 offen offset:2048
  buffer_load_dwordx4 a[28:31], v120, s[56:59], s63 offen offset:3072
  s_xor_b32 s18, s34, 3
  s_lshl_b32 s18, s18, 15
  s_add_u32 s63, s18, 0x0
  buffer_load_dwordx4 a[32:35], v120, s[56:59], s63 offen offset:0
  buffer_load_dwordx4 a[36:39], v120, s[56:59], s63 offen offset:1024
  buffer_load_dwordx4 a[40:43], v120, s[56:59], s63 offen offset:2048
  buffer_load_dwordx4 a[44:47], v120, s[56:59], s63 offen offset:3072
  s_add_u32 s63, s18, 0x2000
  buffer_load_dwordx4 a[48:51], v120, s[56:59], s63 offen offset:0
  buffer_load_dwordx4 a[52:55], v120, s[56:59], s63 offen offset:1024
  buffer_load_dwordx4 a[56:59], v120, s[56:59], s63 offen offset:2048
  buffer_load_dwordx4 a[60:63], v120, s[56:59], s63 offen offset:3072
  s_waitcnt vmcnt(16)
  v_readfirstlane_b32 s18, v123
L_rot_3:
  s_cmp_eq_u32 s18, s100
  s_cbranch_scc1 L_rotok_4
  s_cmp_lg_u32 s18, 0
  s_cbranch_scc1 L_restart
  s_sub_u32 s3, s3, 1
  s_cbranch_scc1 L_end
  buffer_load_dword v123, off, s[40:43], 0 offset:4 sc1
  s_waitcnt vmcnt(0)
  v_readfirstlane_b32 s18, v123
  s_branch L_rot_3
L_rotok_4:
  v_mov_b64 v[116:117], 0
  v_mov_b64 v[118:119], 0
  buffer_store_dwordx4 v[116:119], v1, s[36:39], s64 offen sc1
  buffer_store_dwordx4 v[116:119], v1, s[36:39], s64 offen offset:1024 sc1
  s_lshl_b32 s18, s35, 10
  s_lshl_b32 s19, s34, 8
  s_add_u32 s18, s18, s19
  v_lshl_add_u32 v122, v0, 2, s18
  v_mov_b32 v121, -1
  s_mov_b32 s63, 0x480000
  buffer_store_dword v121, v122, s[36:39], s63 offen sc1
  s_add_u32 m0, s62, 0x0
  s_mov_b32 s63, 0x0
  buffer_load_dwordx4 v124, s[52:55], s63 offen lds
  s_add_u32 m0, s62, 0x400
  s_mov_b32 s63, 0x8000
  buffer_load_dwordx4 v124, s[52:55], s63 offen lds
  s_add_u32 m0, s62, 0x1000
  s_mov_b32 s63, 0x20000
  buffer_load_dwordx4 v124, s[52:55], s63 offen lds
  s_add_u32 m0, s62, 0x1400
  s_mov_b32 s63, 0x28000
  buffer_load_dwordx4 v124, s[52:55], s63 offen lds
  s_add_u32 m0, s62, 0x4000
  s_mov_b32 s63, 0x80000
  buffer_load_dwordx4 v124, s[52:55], s63 offen lds
  s_add_u32 m0, s62, 0x4400
  s_mov_b32 s63, 0x88000
  buffer_load_dwordx4 v124, s[52:55], s63 offen lds
  s_add_u32 m0, s62, 0x5000
  s_mov_b32 s63, 0xa0000
  buffer_load_dwordx4 v124, s[52:55], s63 offen lds
  s_add_u32 m0, s62, 0x5400
  s_mov_b32 s63, 0xa8000
  buffer_load_dwordx4 v124, s[52:55], s63 offen lds
  s_add_u32 m0, s62, 0x8000
  s_mov_b32 s63, 0x100000
  buffer_load_dwordx4 v124, s[52:55], s63 offen lds
  s_add_u32 m0, s62, 0x8400
  s_mov_b32 s63, 0x108000
  buffer_load_dwordx4 v124, s[52:55], s63 offen lds
  s_add_u32 m0, s62, 0x9000
  s_mov_b32 s63, 0x120000
  buffer_load_dwordx4 v124, s[52:55], s63 offen lds
  s_add_u32 m0, s62, 0x9400
  s_mov_b32 s63, 0x128000
  buffer_load_dwordx4 v124, s[52:55], s63 offen lds
  s_add_u32 m0, s62, 0xc000
  s_mov_b32 s63, 0x180000
  buffer_load_dwordx4 v124, s[52:55], s63 offen lds
  s_add_u32 m0, s62, 0xc400
  s_mov_b32 s63, 0x188000
  buffer_load_dwordx4 v124, s[52:55], s63 offen lds
  s_add_u32 m0, s62, 0xd000
  s_mov_b32 s63, 0x1a0000
  buffer_load_dwordx4 v124, s[52:55], s63 offen lds
  s_add_u32 m0, s62, 0xd400
  s_mov_b32 s63, 0x1a8000
  buffer_load_dwordx4 v124, s[52:55], s63 offen lds
  v_lshrrev_b32 v127, 4, v0
  v_lshlrev_b32 v125, 13, v127
  v_and_b32 v127, 1, v127
  v_lshlrev_b32 v126, 3, v127
  v_bfe_u32 v127, v0, 3, 1
  v_lshl_add_u32 v125, v127, 11, v125
  v_lshl_add_u32 v126, v127, 2, v126
  v_bfe_u32 v127, v0, 2, 1
  v_lshl_add_u32 v125, v127, 8, v125
  v_lshl_add_u32 v126, v127, 1, v126
  v_bfe_u32 v127, v0, 1, 1
  s_lshl_b32 s18, s34, 2
  v_add_u32 v127, s18, v127
  v_xor_b32 v126, v126, v127
  v_lshl_add_u32 v125, v126, 4, v125
  v_and_b32 v127, 1, v0
  v_lshl_add_u32 v125, v127, 3, v125
L_chain_c0:
  s_waitcnt vmcnt(8)
  s_barrier
  s_getpc_b64 s[96:97]
L_pc_5:
  s_mul_i32 s95, s34, 0
  s_add_u32 s95, s95, L_chain_c2-L_pc_5
  v_lshl_add_u32 v4, v0, 7, s95
  v_min_u32 v4, L_chain_c4-L_pc_5-4, v4
  v_mov_b32 v5, s97
  v_add_co_u32 v4, vcc, s96, v4
  s_nop 1
  v_addc_co_u32 v5, vcc, 0, v5, vcc
  global_load_dword v13, v[4:5], off
  s_add_u32 m0, s62, 0x10000
  s_mov_b32 s63, 0x200000
  buffer_load_dwordx4 v124, s[52:55], s63 offen lds
  s_add_u32 m0, s62, 0x10400
  s_mov_b32 s63, 0x208000
  buffer_load_dwordx4 v124, s[52:55], s63 offen lds
  s_add_u32 m0, s62, 0x11000
  s_mov_b32 s63, 0x220000
  buffer_load_dwordx4 v124, s[52:55], s63 offen lds
  s_add_u32 m0, s62, 0x11400
  s_mov_b32 s63, 0x228000
  buffer_load_dwordx4 v124, s[52:55], s63 offen lds
  s_add_u32 m0, s62, 0x14000
  s_mov_b32 s63, 0x280000
  buffer_load_dwordx4 v124, s[52:55], s63 offen lds
  s_add_u32 m0, s62, 0x14400
  s_mov_b32 s63, 0x288000
  buffer_load_dwordx4 v124, s[52:55], s63 offen lds
  s_add_u32 m0, s62, 0x15000
  s_mov_b32 s63, 0x2a0000
  buffer_load_dwordx4 v124, s[52:55], s63 offen lds
  s_add_u32 m0, s62, 0x15400
  s_mov_b32 s63, 0x2a8000
  buffer_load_dwordx4 v124, s[52:55], s63 offen lds
  s_getreg_b32 s18, hwreg(HW_REG_XCC_ID, 0, 3)
  s_lshl_b32 s18, s18, 2
  s_add_u32 s18, s18, 128
  s_cmp_eq_u32 s34, 0
  s_cselect_b32 s18, s18, 0x1000
  v_mov_b32 v15, 1
  s_mov_b64 exec, 1
  buffer_atomic_add v15, off, s[40:43], s18 sc1
  s_mov_b64 exec, -1
  v_perm_b32 v128, v56, v52, s16
  v_perm_b32 v129, v56, v52, s17
  v_perm_b32 v130, v64, v60, s16
  v_perm_b32 v131, v64, v60, s17
  v_perm_b32 v132, v72, v68, s16
  v_perm_b32 v133, v72, v68, s17
  v_perm_b32 v134, v80, v76, s16
  v_perm_b32 v135, v80, v76, s17
  v_perm_b32 v160, v57, v53, s16
  v_perm_b32 v161, v57, v53, s17
  v_perm_b32 v162, v65, v61, s16
  v_perm_b32 v163, v65, v61, s17
  v_perm_b32 v164, v73, v69, s16
  v_perm_b32 v165, v73, v69, s17
  v_perm_b32 v166, v81, v77, s16
  v_perm_b32 v167, v81, v77, s17
  v_perm_b32 v192, v58, v54, s16
  v_perm_b32 v193, v58, v54, s17
  v_perm_b32 v194, v66, v62, s16
  v_perm_b32 v195, v66, v62, s17
  v_perm_b32 v196, v74, v70, s16
  v_perm_b32 v197, v74, v70, s17
  v_perm_b32 v198, v82, v78, s16
  v_perm_b32 v199, v82, v78, s17
  v_perm_b32 v216, v59, v55, s16
  v_perm_b32 v217, v59, v55, s17
  v_perm_b32 v218, v67, v63, s16
  v_perm_b32 v219, v67, v63, s17
  v_perm_b32 v220, v75, v71, s16
  v_perm_b32 v221, v75, v71, s17
  v_perm_b32 v222, v83, v79, s16
  v_perm_b32 v223, v83, v79, s17
  s_xor_b32 s63, s80, 0x0
  v_xor_b32 v127, s63, v125
  ds_read_b64_tr_b16 v[36:37], v127 offset:0
  ds_read_b64_tr_b16 v[38:39], v127 offset:4096
  s_xor_b32 s63, s80, 0x20
  v_xor_b32 v127, s63, v125
  ds_read_b64_tr_b16 v[20:21], v127 offset:0
  ds_read_b64_tr_b16 v[22:23], v127 offset:4096
  s_xor_b32 s63, s81, 0x0
  v_xor_b32 v127, s63, v125
  ds_read_b64_tr_b16 a[192:193], v127 offset:0
  ds_read_b64_tr_b16 a[194:195], v127 offset:4096
  s_xor_b32 s63, s81, 0x20
  v_xor_b32 v127, s63, v125
  ds_read_b64_tr_b16 a[200:201], v127 offset:0
  ds_read_b64_tr_b16 a[202:203], v127 offset:4096
  s_xor_b32 s63, s82, 0x0
  v_xor_b32 v127, s63, v125
  ds_read_b64_tr_b16 a[224:225], v127 offset:0
  ds_read_b64_tr_b16 a[226:227], v127 offset:4096
  s_xor_b32 s63, s82, 0x20
  v_xor_b32 v127, s63, v125
  ds_read_b64_tr_b16 a[232:233], v127 offset:0
  ds_read_b64_tr_b16 a[234:235], v127 offset:4096
  s_xor_b32 s63, s83, 0x0
  v_xor_b32 v127, s63, v125
  ds_read_b64_tr_b16 v[224:225], v127 offset:0
  ds_read_b64_tr_b16 v[226:227], v127 offset:4096
  s_xor_b32 s63, s83, 0x20
  v_xor_b32 v127, s63, v125
  ds_read_b64_tr_b16 v[232:233], v127 offset:0
  ds_read_b64_tr_b16 v[234:235], v127 offset:4096
  s_waitcnt lgkmcnt(0)
L_chain_c1:
  s_waitcnt vmcnt(10)
  s_barrier
  s_add_u32 m0, s62, 0x18000
  s_mov_b32 s63, 0x300000
  buffer_load_dwordx4 v124, s[52:55], s63 offen lds
  s_add_u32 m0, s62, 0x18400
  s_mov_b32 s63, 0x308000
  buffer_load_dwordx4 v124, s[52:55], s63 offen lds
  s_add_u32 m0, s62, 0x19000
  s_mov_b32 s63, 0x320000
  buffer_load_dwordx4 v124, s[52:55], s63 offen lds
  s_add_u32 m0, s62, 0x19400
  s_mov_b32 s63, 0x328000
  buffer_load_dwordx4 v124, s[52:55], s63 offen lds
  s_add_u32 m0, s62, 0x1c000
  s_mov_b32 s63, 0x380000
  buffer_load_dwordx4 v124, s[52:55], s63 offen lds
  s_add_u32 m0, s62, 0x1c400
  s_mov_b32 s63, 0x388000
  buffer_load_dwordx4 v124, s[52:55], s63 offen lds
  s_add_u32 m0, s62, 0x1d000
  s_mov_b32 s63, 0x3a0000
  buffer_load_dwordx4 v124, s[52:55], s63 offen lds
  s_add_u32 m0, s62, 0x1d400
  s_mov_b32 s63, 0x3a8000
  buffer_load_dwordx4 v124, s[52:55], s63 offen lds
  v_perm_b32 v136, v88, v84, s16
  v_perm_b32 v137, v88, v84, s17
  v_perm_b32 v138, v96, v92, s16
  v_perm_b32 v139, v96, v92, s17
  v_perm_b32 v140, v104, v100, s16
  v_perm_b32 v141, v104, v100, s17
  v_perm_b32 v142, v112, v108, s16
  v_perm_b32 v143, v112, v108, s17
  v_perm_b32 v168, v89, v85, s16
  v_perm_b32 v169, v89, v85, s17
  v_perm_b32 v170, v97, v93, s16
  v_perm_b32 v171, v97, v93, s17
  v_perm_b32 v172, v105, v101, s16
  v_perm_b32 v173, v105, v101, s17
  v_perm_b32 v174, v113, v109, s16
  v_perm_b32 v175, v113, v109, s17
  v_perm_b32 v200, v90, v86, s16
  v_perm_b32 v201, v90, v86, s17
  v_perm_b32 v202, v98, v94, s16
  v_perm_b32 v203, v98, v94, s17
  v_perm_b32 v204, v106, v102, s16
  v_perm_b32 v205, v106, v102, s17
  v_perm_b32 v206, v114, v110, s16
  v_perm_b32 v207, v114, v110, s17
  v_perm_b32 v116, v91, v87, s16
  v_perm_b32 v117, v91, v87, s17
  v_perm_b32 v118, v99, v95, s16
  v_perm_b32 v119, v99, v95, s17
  v_perm_b32 v120, v107, v103, s16
  v_perm_b32 v121, v107, v103, s17
  v_perm_b32 v122, v115, v111, s16
  v_perm_b32 v123, v115, v111, s17
  ds_write_b128 v3, v[116:119] offset:8192
  ds_write_b128 v3, v[120:123] offset:9216
  s_waitcnt lgkmcnt(0)
  s_xor_b32 s63, s80, 0x0
  v_xor_b32 v127, s63, v125
  ds_read_b64_tr_b16 v[40:41], v127 offset:32768
  ds_read_b64_tr_b16 v[42:43], v127 offset:36864
  s_xor_b32 s63, s80, 0x20
  v_xor_b32 v127, s63, v125
  ds_read_b64_tr_b16 v[24:25], v127 offset:32768
  ds_read_b64_tr_b16 v[26:27], v127 offset:36864
  s_xor_b32 s63, s81, 0x0
  v_xor_b32 v127, s63, v125
  ds_read_b64_tr_b16 a[196:197], v127 offset:32768
  ds_read_b64_tr_b16 a[198:199], v127 offset:36864
  s_xor_b32 s63, s81, 0x20
  v_xor_b32 v127, s63, v125
  ds_read_b64_tr_b16 a[204:205], v127 offset:32768
  ds_read_b64_tr_b16 a[206:207], v127 offset:36864
  s_xor_b32 s63, s82, 0x0
  v_xor_b32 v127, s63, v125
  ds_read_b64_tr_b16 a[228:229], v127 offset:32768
  ds_read_b64_tr_b16 a[230:231], v127 offset:36864
  s_xor_b32 s63, s82, 0x20
  v_xor_b32 v127, s63, v125
  ds_read_b64_tr_b16 a[236:237], v127 offset:32768
  ds_read_b64_tr_b16 a[238:239], v127 offset:36864
  s_xor_b32 s63, s83, 0x0
  v_xor_b32 v127, s63, v125
  ds_read_b64_tr_b16 v[228:229], v127 offset:32768
  ds_read_b64_tr_b16 v[230:231], v127 offset:36864
  s_xor_b32 s63, s83, 0x20
  v_xor_b32 v127, s63, v125
  ds_read_b64_tr_b16 v[236:237], v127 offset:32768
  ds_read_b64_tr_b16 v[238:239], v127 offset:36864
  s_waitcnt lgkmcnt(0)
L_chain_c2:
  s_waitcnt vmcnt(9)
  s_barrier
  s_getpc_b64 s[96:97]
L_pc_6:
  s_mul_i32 s95, s34, 0
  s_add_u32 s95, s95, L_chain_c4-L_pc_6
  v_lshl_add_u32 v4, v0, 7, s95
  v_min_u32 v4, L_chain_c6-L_pc_6-4, v4
  v_mov_b32 v5, s97
  v_add_co_u32 v4, vcc, s96, v4
  s_nop 1
  v_addc_co_u32 v5, vcc, 0, v5, vcc
  global_load_dword v13, v[4:5], off
  s_add_u32 m0, s62, 0x0
  s_mov_b32 s63, 0x0
  buffer_load_dwordx4 v124, s[48:51], s63 offen lds
  s_add_u32 m0, s62, 0x400
  s_mov_b32 s63, 0x8000
  buffer_load_dwordx4 v124, s[48:51], s63 offen lds
  s_add_u32 m0, s62, 0x1000
  s_mov_b32 s63, 0x20000
  buffer_load_dwordx4 v124, s[48:51], s63 offen lds
  s_add_u32 m0, s62, 0x1400
  s_mov_b32 s63, 0x28000
  buffer_load_dwordx4 v124, s[48:51], s63 offen lds
  s_add_u32 m0, s62, 0x4000
  s_mov_b32 s63, 0x80000
  buffer_load_dwordx4 v124, s[48:51], s63 offen lds
  s_add_u32 m0, s62, 0x4400
  s_mov_b32 s63, 0x88000
  buffer_load_dwordx4 v124, s[48:51], s63 offen lds
  s_add_u32 m0, s62, 0x5000
  s_mov_b32 s63, 0xa0000
  buffer_load_dwordx4 v124, s[48:51], s63 offen lds
  s_add_u32 m0, s62, 0x5400
  s_mov_b32 s63, 0xa8000
  buffer_load_dwordx4 v124, s[48:51], s63 offen lds
  v_accvgpr_read_b32 v52, a0
  v_accvgpr_read_b32 v53, a1
  v_accvgpr_read_b32 v54, a2
  v_accvgpr_read_b32 v55, a3
  v_accvgpr_read_b32 v56, a4
  v_accvgpr_read_b32 v57, a5
  v_accvgpr_read_b32 v58, a6
  v_accvgpr_read_b32 v59, a7
  v_accvgpr_read_b32 v60, a8
  v_accvgpr_read_b32 v61, a9
  v_accvgpr_read_b32 v62, a10
  v_accvgpr_read_b32 v63, a11
  v_accvgpr_read_b32 v64, a12
  v_accvgpr_read_b32 v65, a13
  v_accvgpr_read_b32 v66, a14
  v_accvgpr_read_b32 v67, a15
  v_accvgpr_read_b32 v68, a16
  v_accvgpr_read_b32 v69, a17
  v_accvgpr_read_b32 v70, a18
  v_accvgpr_read_b32 v71, a19
  v_accvgpr_read_b32 v72, a20
  v_accvgpr_read_b32 v73, a21
  v_accvgpr_read_b32 v74, a22
  v_accvgpr_read_b32 v75, a23
  v_accvgpr_read_b32 v76, a24
  v_accvgpr_read_b32 v77, a25
  v_accvgpr_read_b32 v78, a26
  v_accvgpr_read_b32 v79, a27
  v_accvgpr_read_b32 v80, a28
  v_accvgpr_read_b32 v81, a29
  v_accvgpr_read_b32 v82, a30
  v_accvgpr_read_b32 v83, a31
  v_perm_b32 v144, v56, v52, s16
  v_perm_b32 v145, v56, v52, s17
  v_perm_b32 v146, v64, v60, s16
  v_perm_b32 v147, v64, v60, s17
  v_perm_b32 v148, v72, v68, s16
  v_perm_b32 v149, v72, v68, s17
  v_perm_b32 v150, v80, v76, s16
  v_perm_b32 v151, v80, v76, s17
  v_perm_b32 v176, v57, v53, s16
  v_perm_b32 v177, v57, v53, s17
  v_perm_b32 v178, v65, v61, s16
  v_perm_b32 v179, v65, v61, s17
  v_perm_b32 v180, v73, v69, s16
  v_perm_b32 v181, v73, v69, s17
  v_perm_b32 v182, v81, v77, s16
  v_perm_b32 v183, v81, v77, s17
  v_perm_b32 v208, v58, v54, s16
  v_perm_b32 v209, v58, v54, s17
  v_perm_b32 v210, v66, v62, s16
  v_perm_b32 v211, v66, v62, s17
  v_perm_b32 v212, v74, v70, s16
  v_perm_b32 v213, v74, v70, s17
  v_perm_b32 v214, v82, v78, s16
  v_perm_b32 v215, v82, v78, s17
  v_perm_b32 v116, v59, v55, s16
  v_perm_b32 v117, v59, v55, s17
  v_perm_b32 v118, v67, v63, s16
  v_perm_b32 v119, v67, v63, s17
  v_perm_b32 v120, v75, v71, s16
  v_perm_b32 v121, v75, v71, s17
  v_perm_b32 v122, v83, v79, s16
  v_perm_b32 v123, v83, v79, s17
  ds_write_b128 v3, v[116:119] offset:16384
  ds_write_b128 v3, v[120:123] offset:17408
  s_waitcnt lgkmcnt(0)
  s_xor_b32 s63, s80, 0x10000
  v_xor_b32 v127, s63, v125
  ds_read_b64_tr_b16 v[44:45], v127 offset:0
  ds_read_b64_tr_b16 v[46:47], v127 offset:4096
  s_xor_b32 s63, s80, 0x10020
  v_xor_b32 v127, s63, v125
  ds_read_b64_tr_b16 v[28:29], v127 offset:0
  ds_read_b64_tr_b16 v[30:31], v127 offset:4096
  s_xor_b32 s63, s81, 0x10000
  v_xor_b32 v127, s63, v125
  ds_read_b64_tr_b16 a[208:209], v127 offset:0
  ds_read_b64_tr_b16 a[210:211], v127 offset:4096
  s_xor_b32 s63, s81, 0x10020
  v_xor_b32 v127, s63, v125
  ds_read_b64_tr_b16 a[216:217], v127 offset:0
  ds_read_b64_tr_b16 a[218:219], v127 offset:4096
  s_xor_b32 s63, s82, 0x10000
  v_xor_b32 v127, s63, v125
  ds_read_b64_tr_b16 a[240:241], v127 offset:0
  ds_read_b64_tr_b16 a[242:243], v127 offset:4096
  s_xor_b32 s63, s82, 0x10020
  v_xor_b32 v127, s63, v125
  ds_read_b64_tr_b16 a[248:249], v127 offset:0
  ds_read_b64_tr_b16 a[250:251], v127 offset:4096
  s_xor_b32 s63, s83, 0x10000
  v_xor_b32 v127, s63, v125
  ds_read_b64_tr_b16 v[240:241], v127 offset:0
  ds_read_b64_tr_b16 v[242:243], v127 offset:4096
  s_xor_b32 s63, s83, 0x10020
  v_xor_b32 v127, s63, v125
  ds_read_b64_tr_b16 v[248:249], v127 offset:0
  ds_read_b64_tr_b16 v[250:251], v127 offset:4096
  s_waitcnt lgkmcnt(0)
L_chain_c3:
  s_waitcnt vmcnt(9)
  s_barrier
  s_add_u32 m0, s62, 0x8000
  s_mov_b32 s63, 0x100000
  buffer_load_dwordx4 v124, s[48:51], s63 offen lds
  s_add_u32 m0, s62, 0x8400
  s_mov_b32 s63, 0x108000
  buffer_load_dwordx4 v124, s[48:51], s63 offen lds
  s_add_u32 m0, s62, 0x9000
  s_mov_b32 s63, 0x120000
  buffer_load_dwordx4 v124, s[48:51], s63 offen lds
  s_add_u32 m0, s62, 0x9400
  s_mov_b32 s63, 0x128000
  buffer_load_dwordx4 v124, s[48:51], s63 offen lds
  s_add_u32 m0, s62, 0xc000
  s_mov_b32 s63, 0x180000
  buffer_load_dwordx4 v124, s[48:51], s63 offen lds
  s_add_u32 m0, s62, 0xc400
  s_mov_b32 s63, 0x188000
  buffer_load_dwordx4 v124, s[48:51], s63 offen lds
  s_add_u32 m0, s62, 0xd000
  s_mov_b32 s63, 0x1a0000
  buffer_load_dwordx4 v124, s[48:51], s63 offen lds
  s_add_u32 m0, s62, 0xd400
  s_mov_b32 s63, 0x1a8000
  buffer_load_dwordx4 v124, s[48:51], s63 offen lds
  v_accvgpr_read_b32 v84, a32
  v_accvgpr_read_b32 v85, a33
  v_accvgpr_read_b32 v86, a34
  v_accvgpr_read_b32 v87, a35
  v_accvgpr_read_b32 v88, a36
  v_accvgpr_read_b32 v89, a37
  v_accvgpr_read_b32 v90, a38
  v_accvgpr_read_b32 v91, a39
  v_accvgpr_read_b32 v92, a40
  v_accvgpr_read_b32 v93, a41
  v_accvgpr_read_b32 v94, a42
  v_accvgpr_read_b32 v95, a43
  v_accvgpr_read_b32 v96, a44
  v_accvgpr_read_b32 v97, a45
  v_accvgpr_read_b32 v98, a46
  v_accvgpr_read_b32 v99, a47
  v_accvgpr_read_b32 v100, a48
  v_accvgpr_read_b32 v101, a49
  v_accvgpr_read_b32 v102, a50
  v_accvgpr_read_b32 v103, a51
  v_accvgpr_read_b32 v104, a52
  v_accvgpr_read_b32 v105, a53
  v_accvgpr_read_b32 v106, a54
  v_accvgpr_read_b32 v107, a55
  v_accvgpr_read_b32 v108, a56
  v_accvgpr_read_b32 v109, a57
  v_accvgpr_read_b32 v110, a58
  v_accvgpr_read_b32 v111, a59
  v_accvgpr_read_b32 v112, a60
  v_accvgpr_read_b32 v113, a61
  v_accvgpr_read_b32 v114, a62
  v_accvgpr_read_b32 v115, a63
  v_perm_b32 v152, v88, v84, s16
  v_perm_b32 v153, v88, v84, s17
  v_perm_b32 v154, v96, v92, s16
  v_perm_b32 v155, v96, v92, s17
  v_perm_b32 v156, v104, v100, s16
  v_perm_b32 v157, v104, v100, s17
  v_perm_b32 v158, v112, v108, s16
  v_perm_b32 v159, v112, v108, s17
  v_perm_b32 v184, v89, v85, s16
  v_perm_b32 v185, v89, v85, s17
  v_perm_b32 v186, v97, v93, s16
  v_perm_b32 v187, v97, v93, s17
  v_perm_b32 v188, v105, v101, s16
  v_perm_b32 v189, v105, v101, s17
  v_perm_b32 v190, v113, v109, s16
  v_perm_b32 v191, v113, v109, s17
  v_perm_b32 v116, v90, v86, s16
  v_perm_b32 v117, v90, v86, s17
  v_perm_b32 v118, v98, v94, s16
  v_perm_b32 v119, v98, v94, s17
  v_perm_b32 v120, v106, v102, s16
  v_perm_b32 v121, v106, v102, s17
  v_perm_b32 v122, v114, v110, s16
  v_perm_b32 v123, v114, v110, s17
  ds_write_b128 v3, v[116:119] offset:0
  ds_write_b128 v3, v[120:123] offset:1024
  s_waitcnt lgkmcnt(0)
  v_perm_b32 v116, v91, v87, s16
  v_perm_b32 v117, v91, v87, s17
  v_perm_b32 v118, v99, v95, s16
  v_perm_b32 v119, v99, v95, s17
  v_perm_b32 v120, v107, v103, s16
  v_perm_b32 v121, v107, v103, s17
  v_perm_b32 v122, v115, v111, s16
  v_perm_b32 v123, v115, v111, s17
  ds_write_b128 v3, v[116:119] offset:24576
  ds_write_b128 v3, v[120:123] offset:25600
  s_waitcnt lgkmcnt(0)
  s_xor_b32 s63, s80, 0x10000
  v_xor_b32 v127, s63, v125
  ds_read_b64_tr_b16 v[48:49], v127 offset:32768
  ds_read_b64_tr_b16 v[50:51], v127 offset:36864
  s_xor_b32 s63, s80, 0x10020
  v_xor_b32 v127, s63, v125
  ds_read_b64_tr_b16 v[32:33], v127 offset:32768
  ds_read_b64_tr_b16 v[34:35], v127 offset:36864
  s_xor_b32 s63, s81, 0x10000
  v_xor_b32 v127, s63, v125
  ds_read_b64_tr_b16 a[212:213], v127 offset:32768
  ds_read_b64_tr_b16 a[214:215], v127 offset:36864
  s_xor_b32 s63, s81, 0x10020
  v_xor_b32 v127, s63, v125
  ds_read_b64_tr_b16 a[220:221], v127 offset:32768
  ds_read_b64_tr_b16 a[222:223], v127 offset:36864
  s_xor_b32 s63, s82, 0x10000
  v_xor_b32 v127, s63, v125
  ds_read_b64_tr_b16 a[244:245], v127 offset:32768
  ds_read_b64_tr_b16 a[246:247], v127 offset:36864
  s_xor_b32 s63, s82, 0x10020
  v_xor_b32 v127, s63, v125
  ds_read_b64_tr_b16 a[252:253], v127 offset:32768
  ds_read_b64_tr_b16 a[254:255], v127 offset:36864
  s_xor_b32 s63, s83, 0x10000
  v_xor_b32 v127, s63, v125
  ds_read_b64_tr_b16 v[244:245], v127 offset:32768
  ds_read_b64_tr_b16 v[246:247], v127 offset:36864
  s_xor_b32 s63, s83, 0x10020
  v_xor_b32 v127, s63, v125
  ds_read_b64_tr_b16 v[252:253], v127 offset:32768
  ds_read_b64_tr_b16 v[254:255], v127 offset:36864
  s_waitcnt lgkmcnt(0)
L_chain_c4:
  s_waitcnt vmcnt(8)
  s_barrier
  s_getpc_b64 s[96:97]
L_pc_7:
  s_mul_i32 s95, s34, 0
  s_add_u32 s95, s95, L_chain_c6-L_pc_7
  v_lshl_add_u32 v116, v0, 7, s95
  v_min_u32 v116, L_chain_c8-L_pc_7-4, v116
  v_mov_b32 v117, s97
  v_add_co_u32 v116, vcc, s96, v116
  s_nop 1
  v_addc_co_u32 v117, vcc, 0, v117, vcc
  global_load_dword v13, v[116:117], off
  s_add_u32 m0, s62, 0x10000
  s_mov_b32 s63, 0x200000
  buffer_load_dwordx4 v124, s[48:51], s63 offen lds
  s_add_u32 m0, s62, 0x10400
  s_mov_b32 s63, 0x208000
  buffer_load_dwordx4 v124, s[48:51], s63 offen lds
  s_add_u32 m0, s62, 0x11000
  s_mov_b32 s63, 0x220000
  buffer_load_dwordx4 v124, s[48:51], s63 offen lds
  s_add_u32 m0, s62, 0x11400
  s_mov_b32 s63, 0x228000
  buffer_load_dwordx4 v124, s[48:51], s63 offen lds
  s_add_u32 m0, s62, 0x14000
  s_mov_b32 s63, 0x280000
  buffer_load_dwordx4 v124, s[48:51], s63 offen lds
  s_add_u32 m0, s62, 0x14400
  s_mov_b32 s63, 0x288000
  buffer_load_dwordx4 v124, s[48:51], s63 offen lds
  s_add_u32 m0, s62, 0x15000
  s_mov_b32 s63, 0x2a0000
  buffer_load_dwordx4 v124, s[48:51], s63 offen lds
  s_add_u32 m0, s62, 0x15400
  s_mov_b32 s63, 0x2a8000
  buffer_load_dwordx4 v124, s[48:51], s63 offen lds
  v_lshlrev_b32 v4, 4, v0
  v_add_u32 v4, 0x18000, v4
  s_lshr_b32 s18, s34, 1
  s_lshl_b32 s18, s18, 12
  s_and_b32 s19, s34, 1
  s_lshl_b32 s19, s19, 7
  s_add_u32 s18, s18, s19
  v_lshrrev_b32 v116, 3, v0
  v_lshl_add_u32 v9, v116, 8, s18
  v_and_b32 v116, 7, v0
  v_lshl_add_u32 v9, v116, 4, v9
  v_subrev_u32 v9, s18, v9
  v_lshrrev_b32 v116, 4, v0
  v_and_b32 v117, 15, v0
  v_lshrrev_b32 v118, 3, v117
  v_lshl_add_u32 v118, v116, 1, v118
  s_lshl_b32 s18, s34, 3
  v_add_u32 v118, s18, v118
  v_lshlrev_b32 v5, 11, v118
  v_and_b32 v118, 7, v0
  v_lshl_add_u32 v5, v118, 3, v5
  s_lshl_b32 s18, s35, 6
  s_add_u32 s18, s18, 0x500000
  v_add_u32 v5, s18, v5
  s_lshr_b32 s18, s35, 3
  s_lshl_b32 s18, s18, 10
  s_and_b32 s19, s35, 1
  s_lshl_b32 s19, s19, 9
  s_add_u32 s18, s18, s19
  s_bfe_u32 s19, s35, 0x10002
  s_lshl_b32 s19, s19, 8
  s_add_u32 s18, s18, s19
  s_bfe_u32 s19, s35, 0x10001
  s_lshl_b32 s19, s19, 6
  s_add_u32 s18, s18, s19
  s_lshr_b32 s19, s34, 1
  s_lshl_b32 s19, s19, 12
  s_add_u32 s18, s18, s19
  s_and_b32 s19, s34, 1
  s_lshl_b32 s19, s19, 7
  s_add_u32 s18, s18, s19
  v_and_b32 v6, 48, v0
  v_lshl_add_u32 v6, v117, 2, v6
  v_add_u32 v6, s18, v6
  v_and_b32 v118, 12, v0
  v_cmp_eq_u32 vcc, 0, v118
  v_mov_b32 v118, 0x80000000
  s_nop 0
  v_cndmask_b32 v6, v118, v6, vcc
  v_lshrrev_b32 v118, 2, v117
  v_and_b32 v119, 1, v118
  v_lshlrev_b32 v119, 1, v119
  v_xor_b32 v119, v119, v116
  v_lshlrev_b32 v7, 5, v119
  v_lshl_add_u32 v7, v118, 7, v7
  v_and_b32 v119, 3, v0
  v_lshl_add_u32 v7, v119, 2, v7
  s_lshl_b32 s18, s34, 10
  s_add_u32 s19, s18, 0x1e000
  v_add_u32 v7, s19, v7
  v_and_b32 v120, 1, v116
  v_lshlrev_b32 v120, 2, v120
  v_lshrrev_b32 v119, 1, v117
  v_xor_b32 v119, v119, v120
  v_lshlrev_b32 v119, 4, v119
  v_lshl_add_u32 v119, v116, 7, v119
  v_add_u32 v8, 0x1e000, v119
  s_add_u32 s19, s18, 0x1f000
  v_add_u32 v10, s19, v119
  v_and_b32 v118, 1, v0
  v_lshl_add_u32 v10, v118, 3, v10
  v_mul_u32_u24 v11, 0xaaaa, v118
  v_add_u32 v11, 0x4444, v11
  v_lshlrev_b32 v119, 4, v118
  v_mov_b32 v120, 0x3f80
  v_lshlrev_b32 v119, v119, v120
  v_bfe_u32 v120, v0, 2, 1
  v_bfe_u32 v121, v0, 3, 1
  v_lshl_add_u32 v120, v120, 1, v121
  v_and_b32 v121, 2, v0
  v_cmp_ne_u32 s[66:67], 0, v121
  v_mov_b32 v121, 0x3f803f80
  v_cmp_eq_u32 vcc, 0, v120
  s_nop 1
  v_cndmask_b32 v16, 0, v119, vcc
  v_cndmask_b32 v16, v16, v121, s[66:67]
  v_cmp_eq_u32 vcc, 1, v120
  s_nop 1
  v_cndmask_b32 v17, 0, v119, vcc
  v_cndmask_b32 v17, v17, v121, s[66:67]
  v_cmp_eq_u32 vcc, 2, v120
  s_nop 1
  v_cndmask_b32 v18, 0, v119, vcc
  v_cndmask_b32 v18, v18, v121, s[66:67]
  v_cmp_eq_u32 vcc, 3, v120
  s_nop 1
  v_cndmask_b32 v19, 0, v119, vcc
  v_cndmask_b32 v19, v19, v121, s[66:67]
  s_mov_b32 s68, 2
  s_lshl_b32 s69, s35, 20
  s_add_u32 s69, s69, 0x2008000
  s_lshl_b32 s70, s35, 2
  s_add_u32 s70, s70, 0x580000
  s_add_u32 s77, s70, 0x1f800
  s_add_u32 s70, s70, 6144
  s_mov_b32 s71, 0x484000
  s_mov_b32 s87, 0x482000
  s_mov_b32 s75, 0x484000
  s_add_u32 s92, s75, 0x1000
  s_mov_b32 s93, 0x483000
  s_mov_b32 s72, 0x5b0000
  s_mov_b32 s79, 0x404000
  s_lshl_b32 s91, s35, 2
  s_sub_u32 s91, s91, s34
  s_lshl_b32 s91, s91, 10
  s_add_u32 s91, s91, 0x560000
  s_mov_b32 s73, 0x3e0293ee
  s_mov_b32 s74, 0x10000
  s_mov_b32 s76, 0x20000
  s_mov_b32 s65, 0x30000
  s_mov_b32 s84, 0xaaaaaaaa
  s_mov_b32 s85, 0xaaaaaaaa
  s_mov_b32 s90, 0x40000000
  s_mov_b32 s86, 0x53800000
  s_xor_b32 s63, s80, 0x0
  v_xor_b32 v127, s63, v125
  ds_read_b64_tr_b16 v[68:69], v127 offset:0
  ds_read_b64_tr_b16 v[70:71], v127 offset:4096
  s_xor_b32 s63, s80, 0x20
  v_xor_b32 v127, s63, v125
  ds_read_b64_tr_b16 v[52:53], v127 offset:0
  ds_read_b64_tr_b16 v[54:55], v127 offset:4096
  s_xor_b32 s63, s81, 0x0
  v_xor_b32 v127, s63, v125
  ds_read_b64_tr_b16 v[84:85], v127 offset:0
  ds_read_b64_tr_b16 v[86:87], v127 offset:4096
  s_xor_b32 s63, s81, 0x20
  v_xor_b32 v127, s63, v125
  ds_read_b64_tr_b16 a[128:129], v127 offset:0
  ds_read_b64_tr_b16 a[130:131], v127 offset:4096
  s_xor_b32 s63, s82, 0x0
  v_xor_b32 v127, s63, v125
  ds_read_b64_tr_b16 v[100:101], v127 offset:0
  ds_read_b64_tr_b16 v[102:103], v127 offset:4096
  s_xor_b32 s63, s82, 0x20
  v_xor_b32 v127, s63, v125
  ds_read_b64_tr_b16 a[144:145], v127 offset:0
  ds_read_b64_tr_b16 a[146:147], v127 offset:4096
  s_xor_b32 s63, s83, 0x0
  v_xor_b32 v127, s63, v125
  ds_read_b64_tr_b16 a[160:161], v127 offset:0
  ds_read_b64_tr_b16 a[162:163], v127 offset:4096
  s_xor_b32 s63, s83, 0x20
  v_xor_b32 v127, s63, v125
  ds_read_b64_tr_b16 a[168:169], v127 offset:0
  ds_read_b64_tr_b16 a[170:171], v127 offset:4096
  s_waitcnt lgkmcnt(0)
L_chain_c5:
  s_waitcnt vmcnt(9)
  s_barrier
  s_add_u32 m0, s62, 0x18000
  s_mov_b32 s63, 0x300000
  buffer_load_dwordx4 v124, s[48:51], s63 offen lds
  s_add_u32 m0, s62, 0x18400
  s_mov_b32 s63, 0x308000
  buffer_load_dwordx4 v124, s[48:51], s63 offen lds
  s_add_u32 m0, s62, 0x19000
  s_mov_b32 s63, 0x320000
  buffer_load_dwordx4 v124, s[48:51], s63 offen lds
  s_add_u32 m0, s62, 0x19400
  s_mov_b32 s63, 0x328000
  buffer_load_dwordx4 v124, s[48:51], s63 offen lds
  s_add_u32 m0, s62, 0x1c000
  s_mov_b32 s63, 0x380000
  buffer_load_dwordx4 v124, s[48:51], s63 offen lds
  s_add_u32 m0, s62, 0x1c400
  s_mov_b32 s63, 0x388000
  buffer_load_dwordx4 v124, s[48:51], s63 offen lds
  s_add_u32 m0, s62, 0x1d000
  s_mov_b32 s63, 0x3a0000
  buffer_load_dwordx4 v124, s[48:51], s63 offen lds
  s_add_u32 m0, s62, 0x1d400
  s_mov_b32 s63, 0x3a8000
  buffer_load_dwordx4 v124, s[48:51], s63 offen lds
  s_xor_b32 s63, s80, 0x0
  v_xor_b32 v127, s63, v125
  ds_read_b64_tr_b16 v[72:73], v127 offset:32768
  ds_read_b64_tr_b16 v[74:75], v127 offset:36864
  s_xor_b32 s63, s80, 0x20
  v_xor_b32 v127, s63, v125
  ds_read_b64_tr_b16 v[56:57], v127 offset:32768
  ds_read_b64_tr_b16 v[58:59], v127 offset:36864
  s_xor_b32 s63, s81, 0x0
  v_xor_b32 v127, s63, v125
  ds_read_b64_tr_b16 v[88:89], v127 offset:32768
  ds_read_b64_tr_b16 v[90:91], v127 offset:36864
  s_xor_b32 s63, s81, 0x20
  v_xor_b32 v127, s63, v125
  ds_read_b64_tr_b16 a[132:133], v127 offset:32768
  ds_read_b64_tr_b16 a[134:135], v127 offset:36864
  s_xor_b32 s63, s82, 0x0
  v_xor_b32 v127, s63, v125
  ds_read_b64_tr_b16 v[104:105], v127 offset:32768
  ds_read_b64_tr_b16 v[106:107], v127 offset:36864
  s_xor_b32 s63, s82, 0x20
  v_xor_b32 v127, s63, v125
  ds_read_b64_tr_b16 a[148:149], v127 offset:32768
  ds_read_b64_tr_b16 a[150:151], v127 offset:36864
  s_xor_b32 s63, s83, 0x0
  v_xor_b32 v127, s63, v125
  ds_read_b64_tr_b16 a[164:165], v127 offset:32768
  ds_read_b64_tr_b16 a[166:167], v127 offset:36864
  s_xor_b32 s63, s83, 0x20
  v_xor_b32 v127, s63, v125
  ds_read_b64_tr_b16 a[172:173], v127 offset:32768
  ds_read_b64_tr_b16 a[174:175], v127 offset:36864
  s_waitcnt lgkmcnt(0)
L_chain_c6:
  s_waitcnt vmcnt(8)
  s_barrier
  s_getpc_b64 s[96:97]
L_pc_8:
  s_mul_i32 s95, s34, 0
  s_add_u32 s95, s95, L_chain_c8-L_pc_8
  v_lshl_add_u32 v116, v0, 7, s95
  v_min_u32 v116, L_chain_c10-L_pc_8-4, v116
  v_mov_b32 v117, s97
  v_add_co_u32 v116, vcc, s96, v116
  s_nop 1
  v_addc_co_u32 v117, vcc, 0, v117, vcc
  global_load_dword v13, v[116:117], off
  s_add_u32 m0, s62, 0x0
  s_mov_b32 s63, 0x0
  buffer_load_dwordx4 v124, s[44:47], s63 offen lds
  s_add_u32 m0, s62, 0x400
  s_mov_b32 s63, 0x8000
  buffer_load_dwordx4 v124, s[44:47], s63 offen lds
  s_add_u32 m0, s62, 0x1000
  s_mov_b32 s63, 0x20000
  buffer_load_dwordx4 v124, s[44:47], s63 offen lds
  s_add_u32 m0, s62, 0x1400
  s_mov_b32 s63, 0x28000
  buffer_load_dwordx4 v124, s[44:47], s63 offen lds
  s_add_u32 m0, s62, 0x4000
  s_mov_b32 s63, 0x80000
  buffer_load_dwordx4 v124, s[44:47], s63 offen lds
  s_add_u32 m0, s62, 0x4400
  s_mov_b32 s63, 0x88000
  buffer_load_dwordx4 v124, s[44:47], s63 offen lds
  s_add_u32 m0, s62, 0x5000
  s_mov_b32 s63, 0xa0000
  buffer_load_dwordx4 v124, s[44:47], s63 offen lds
  s_add_u32 m0, s62, 0x5400
  s_mov_b32 s63, 0xa8000
  buffer_load_dwordx4 v124, s[44:47], s63 offen lds
  s_xor_b32 s63, s80, 0x10000
  v_xor_b32 v127, s63, v125
  ds_read_b64_tr_b16 v[76:77], v127 offset:0
  ds_read_b64_tr_b16 v[78:79], v127 offset:4096
  s_xor_b32 s63, s80, 0x10020
  v_xor_b32 v127, s63, v125
  ds_read_b64_tr_b16 v[60:61], v127 offset:0
  ds_read_b64_tr_b16 v[62:63], v127 offset:4096
  s_xor_b32 s63, s81, 0x10000
  v_xor_b32 v127, s63, v125
  ds_read_b64_tr_b16 v[92:93], v127 offset:0
  ds_read_b64_tr_b16 v[94:95], v127 offset:4096
  s_xor_b32 s63, s81, 0x10020
  v_xor_b32 v127, s63, v125
  ds_read_b64_tr_b16 a[136:137], v127 offset:0
  ds_read_b64_tr_b16 a[138:139], v127 offset:4096
  s_xor_b32 s63, s82, 0x10000
  v_xor_b32 v127, s63, v125
  ds_read_b64_tr_b16 v[108:109], v127 offset:0
  ds_read_b64_tr_b16 v[110:111], v127 offset:4096
  s_xor_b32 s63, s82, 0x10020
  v_xor_b32 v127, s63, v125
  ds_read_b64_tr_b16 a[152:153], v127 offset:0
  ds_read_b64_tr_b16 a[154:155], v127 offset:4096
  s_xor_b32 s63, s83, 0x10000
  v_xor_b32 v127, s63, v125
  ds_read_b64_tr_b16 a[176:177], v127 offset:0
  ds_read_b64_tr_b16 a[178:179], v127 offset:4096
  s_xor_b32 s63, s83, 0x10020
  v_xor_b32 v127, s63, v125
  ds_read_b64_tr_b16 a[184:185], v127 offset:0
  ds_read_b64_tr_b16 a[186:187], v127 offset:4096
  s_waitcnt lgkmcnt(0)
L_chain_c7:
  s_waitcnt vmcnt(9)
  s_barrier
  s_add_u32 m0, s62, 0x8000
  s_mov_b32 s63, 0x100000
  buffer_load_dwordx4 v124, s[44:47], s63 offen lds
  s_add_u32 m0, s62, 0x8400
  s_mov_b32 s63, 0x108000
  buffer_load_dwordx4 v124, s[44:47], s63 offen lds
  s_add_u32 m0, s62, 0x9000
  s_mov_b32 s63, 0x120000
  buffer_load_dwordx4 v124, s[44:47], s63 offen lds
  s_add_u32 m0, s62, 0x9400
  s_mov_b32 s63, 0x128000
  buffer_load_dwordx4 v124, s[44:47], s63 offen lds
  s_add_u32 m0, s62, 0xc000
  s_mov_b32 s63, 0x180000
  buffer_load_dwordx4 v124, s[44:47], s63 offen lds
  s_add_u32 m0, s62, 0xc400
  s_mov_b32 s63, 0x188000
  buffer_load_dwordx4 v124, s[44:47], s63 offen lds
  s_add_u32 m0, s62, 0xd000
  s_mov_b32 s63, 0x1a0000
  buffer_load_dwordx4 v124, s[44:47], s63 offen lds
  s_add_u32 m0, s62, 0xd400
  s_mov_b32 s63, 0x1a8000
  buffer_load_dwordx4 v124, s[44:47], s63 offen lds
  s_xor_b32 s63, s80, 0x10000
  v_xor_b32 v127, s63, v125
  ds_read_b64_tr_b16 v[80:81], v127 offset:32768
  ds_read_b64_tr_b16 v[82:83], v127 offset:36864
  s_xor_b32 s63, s80, 0x10020
  v_xor_b32 v127, s63, v125
  ds_read_b64_tr_b16 v[64:65], v127 offset:32768
  ds_read_b64_tr_b16 v[66:67], v127 offset:36864
  s_xor_b32 s63, s81, 0x10000
  v_xor_b32 v127, s63, v125
  ds_read_b64_tr_b16 v[96:97], v127 offset:32768
  ds_read_b64_tr_b16 v[98:99], v127 offset:36864
  s_xor_b32 s63, s81, 0x10020
  v_xor_b32 v127, s63, v125
  ds_read_b64_tr_b16 a[140:141], v127 offset:32768
  ds_read_b64_tr_b16 a[142:143], v127 offset:36864
  s_xor_b32 s63, s82, 0x10000
  v_xor_b32 v127, s63, v125
  ds_read_b64_tr_b16 v[112:113], v127 offset:32768
  ds_read_b64_tr_b16 v[114:115], v127 offset:36864
  s_xor_b32 s63, s82, 0x10020
  v_xor_b32 v127, s63, v125
  ds_read_b64_tr_b16 a[156:157], v127 offset:32768
  ds_read_b64_tr_b16 a[158:159], v127 offset:36864
  s_xor_b32 s63, s83, 0x10000
  v_xor_b32 v127, s63, v125
  ds_read_b64_tr_b16 a[180:181], v127 offset:32768
  ds_read_b64_tr_b16 a[182:183], v127 offset:36864
  s_xor_b32 s63, s83, 0x10020
  v_xor_b32 v127, s63, v125
  ds_read_b64_tr_b16 a[188:189], v127 offset:32768
  ds_read_b64_tr_b16 a[190:191], v127 offset:36864
  s_waitcnt lgkmcnt(0)
L_chain_c8:
  s_waitcnt vmcnt(8)
  s_barrier
  s_getpc_b64 s[96:97]
L_pc_9:
  s_mul_i32 s95, s34, 0
  s_add_u32 s95, s95, L_chain_c10-L_pc_9
  v_lshl_add_u32 v116, v0, 7, s95
  v_min_u32 v116, L_chain_ready-L_pc_9-4, v116
  v_mov_b32 v117, s97
  v_add_co_u32 v116, vcc, s96, v116
  s_nop 1
  v_addc_co_u32 v117, vcc, 0, v117, vcc
  global_load_dword v13, v[116:117], off
  s_add_u32 m0, s62, 0x10000
  s_mov_b32 s63, 0x200000
  buffer_load_dwordx4 v124, s[44:47], s63 offen lds
  s_add_u32 m0, s62, 0x10400
  s_mov_b32 s63, 0x208000
  buffer_load_dwordx4 v124, s[44:47], s63 offen lds
  s_add_u32 m0, s62, 0x11000
  s_mov_b32 s63, 0x220000
  buffer_load_dwordx4 v124, s[44:47], s63 offen lds
  s_add_u32 m0, s62, 0x11400
  s_mov_b32 s63, 0x228000
  buffer_load_dwordx4 v124, s[44:47], s63 offen lds
  s_add_u32 m0, s62, 0x14000
  s_mov_b32 s63, 0x280000
  buffer_load_dwordx4 v124, s[44:47], s63 offen lds
  s_add_u32 m0, s62, 0x14400
  s_mov_b32 s63, 0x288000
  buffer_load_dwordx4 v124, s[44:47], s63 offen lds
  s_add_u32 m0, s62, 0x15000
  s_mov_b32 s63, 0x2a0000
  buffer_load_dwordx4 v124, s[44:47], s63 offen lds
  s_add_u32 m0, s62, 0x15400
  s_mov_b32 s63, 0x2a8000
  buffer_load_dwordx4 v124, s[44:47], s63 offen lds
  s_xor_b32 s63, s80, 0x0
  v_xor_b32 v127, s63, v125
  ds_read_b64_tr_b16 a[0:1], v127 offset:0
  ds_read_b64_tr_b16 a[2:3], v127 offset:4096
  s_xor_b32 s63, s80, 0x20
  v_xor_b32 v127, s63, v125
  ds_read_b64_tr_b16 a[8:9], v127 offset:0
  ds_read_b64_tr_b16 a[10:11], v127 offset:4096
  s_xor_b32 s63, s81, 0x0
  v_xor_b32 v127, s63, v125
  ds_read_b64_tr_b16 a[32:33], v127 offset:0
  ds_read_b64_tr_b16 a[34:35], v127 offset:4096
  s_xor_b32 s63, s81, 0x20
  v_xor_b32 v127, s63, v125
  ds_read_b64_tr_b16 a[40:41], v127 offset:0
  ds_read_b64_tr_b16 a[42:43], v127 offset:4096
  s_xor_b32 s63, s82, 0x0
  v_xor_b32 v127, s63, v125
  ds_read_b64_tr_b16 a[64:65], v127 offset:0
  ds_read_b64_tr_b16 a[66:67], v127 offset:4096
  s_xor_b32 s63, s82, 0x20
  v_xor_b32 v127, s63, v125
  ds_read_b64_tr_b16 a[72:73], v127 offset:0
  ds_read_b64_tr_b16 a[74:75], v127 offset:4096
  s_xor_b32 s63, s83, 0x0
  v_xor_b32 v127, s63, v125
  ds_read_b64_tr_b16 a[96:97], v127 offset:0
  ds_read_b64_tr_b16 a[98:99], v127 offset:4096
  s_xor_b32 s63, s83, 0x20
  v_xor_b32 v127, s63, v125
  ds_read_b64_tr_b16 a[104:105], v127 offset:0
  ds_read_b64_tr_b16 a[106:107], v127 offset:4096
  s_waitcnt lgkmcnt(0)
L_chain_c9:
  s_waitcnt vmcnt(9)
  s_barrier
  v_and_b32 v15, 15, v0
  v_lshlrev_b32 v15, 2, v15
  buffer_load_dword v12, v15, s[40:43], 0 offen offset:128 sc1
  s_add_u32 m0, s62, 0x18000
  s_mov_b32 s63, 0x300000
  buffer_load_dwordx4 v124, s[44:47], s63 offen lds
  s_add_u32 m0, s62, 0x18400
  s_mov_b32 s63, 0x308000
  buffer_load_dwordx4 v124, s[44:47], s63 offen lds
  s_add_u32 m0, s62, 0x19000
  s_mov_b32 s63, 0x320000
  buffer_load_dwordx4 v124, s[44:47], s63 offen lds
  s_add_u32 m0, s62, 0x19400
  s_mov_b32 s63, 0x328000
  buffer_load_dwordx4 v124, s[44:47], s63 offen lds
  s_add_u32 m0, s62, 0x1c000
  s_mov_b32 s63, 0x380000
  buffer_load_dwordx4 v124, s[44:47], s63 offen lds
  s_add_u32 m0, s62, 0x1c400
  s_mov_b32 s63, 0x388000
  buffer_load_dwordx4 v124, s[44:47], s63 offen lds
  s_add_u32 m0, s62, 0x1d000
  s_mov_b32 s63, 0x3a0000
  buffer_load_dwordx4 v124, s[44:47], s63 offen lds
  s_add_u32 m0, s62, 0x1d400
  s_mov_b32 s63, 0x3a8000
  buffer_load_dwordx4 v124, s[44:47], s63 offen lds
  s_getpc_b64 s[96:97]
L_pc_10:
  s_mul_i32 s95, s34, L_step_f1_0-L_step_f0_0
  s_add_u32 s95, s95, L_step_f0_0-L_pc_10
  v_lshl_add_u32 v116, v0, 7, s95
  v_min_u32 v116, L_step_s0_0-L_pc_10-4, v116
  v_mov_b32 v117, s97
  v_add_co_u32 v116, vcc, s96, v116
  s_nop 1
  v_addc_co_u32 v117, vcc, 0, v117, vcc
  global_load_dword v13, v[116:117], off
  ds_write_b128 v1, v[20:23] offset:0
  ds_write_b128 v1, v[24:27] offset:1024
  ds_write_b128 v1, v[28:31] offset:8192
  ds_write_b128 v1, v[32:35] offset:9216
  ds_write_b128 v1, v[36:39] offset:16384
  ds_write_b128 v1, v[40:43] offset:17408
  ds_write_b128 v1, v[44:47] offset:24576
  ds_write_b128 v1, v[48:51] offset:25600
  s_xor_b32 s63, s80, 0x0
  v_xor_b32 v127, s63, v125
  ds_read_b64_tr_b16 a[4:5], v127 offset:32768
  ds_read_b64_tr_b16 a[6:7], v127 offset:36864
  s_xor_b32 s63, s80, 0x20
  v_xor_b32 v127, s63, v125
  ds_read_b64_tr_b16 a[12:13], v127 offset:32768
  ds_read_b64_tr_b16 a[14:15], v127 offset:36864
  s_xor_b32 s63, s81, 0x0
  v_xor_b32 v127, s63, v125
  ds_read_b64_tr_b16 a[36:37], v127 offset:32768
  ds_read_b64_tr_b16 a[38:39], v127 offset:36864
  s_xor_b32 s63, s81, 0x20
  v_xor_b32 v127, s63, v125
  ds_read_b64_tr_b16 a[44:45], v127 offset:32768
  ds_read_b64_tr_b16 a[46:47], v127 offset:36864
  s_xor_b32 s63, s82, 0x0
  v_xor_b32 v127, s63, v125
  ds_read_b64_tr_b16 a[68:69], v127 offset:32768
  ds_read_b64_tr_b16 a[70:71], v127 offset:36864
  s_xor_b32 s63, s82, 0x20
  v_xor_b32 v127, s63, v125
  ds_read_b64_tr_b16 a[76:77], v127 offset:32768
  ds_read_b64_tr_b16 a[78:79], v127 offset:36864
  s_xor_b32 s63, s83, 0x0
  v_xor_b32 v127, s63, v125
  ds_read_b64_tr_b16 a[100:101], v127 offset:32768
  ds_read_b64_tr_b16 a[102:103], v127 offset:36864
  s_xor_b32 s63, s83, 0x20
  v_xor_b32 v127, s63, v125
  ds_read_b64_tr_b16 a[108:109], v127 offset:32768
  ds_read_b64_tr_b16 a[110:111], v127 offset:36864
  s_waitcnt lgkmcnt(0)
L_chain_c10:
  s_waitcnt vmcnt(10)
  s_barrier
  s_waitcnt vmcnt(9)
  v_cmp_eq_u32 s[66:67], 32, v12
  v_add_u32_dpp v12, v12, v12 row_ror:8 row_mask:0xf bank_mask:0xf
  s_nop 1
  v_add_u32_dpp v12, v12, v12 row_ror:4 row_mask:0xf bank_mask:0xf
  s_nop 1
  v_add_u32_dpp v12, v12, v12 row_ror:2 row_mask:0xf bank_mask:0xf
  s_nop 1
  v_add_u32_dpp v12, v12, v12 row_ror:1 row_mask:0xf bank_mask:0xf
  s_and_b64 s[66:67], s[66:67], 0xff
  v_cmp_ne_u32 vcc, 64, v12
  s_mov_b64 s[88:89], vcc
  s_mov_b32 s94, s69
  s_cmp_eq_u64 vcc, 0
  s_cselect_b32 s69, s69, s90
  s_add_u32 s78, s69, 8192
  buffer_load_dwordx4 v[20:23], v1, s[36:39], s69 offen offset:0 sc1
  buffer_load_dwordx4 v[24:27], v1, s[36:39], s69 offen offset:1024 sc1
  buffer_load_dwordx4 v[28:31], v1, s[36:39], s78 offen offset:0 sc1
  buffer_load_dwordx4 v[32:35], v1, s[36:39], s78 offen offset:1024 sc1
  s_mov_b32 s69, s94
  ds_write_b128 v1, v[52:55] offset:32768
  ds_write_b128 v1, v[56:59] offset:33792
  ds_write_b128 v1, v[60:63] offset:40960
  ds_write_b128 v1, v[64:67] offset:41984
  ds_write_b128 v1, v[68:71] offset:49152
  ds_write_b128 v1, v[72:75] offset:50176
  ds_write_b128 v1, v[76:79] offset:57344
  ds_write_b128 v1, v[80:83] offset:58368
  s_xor_b32 s63, s80, 0x10000
  v_xor_b32 v127, s63, v125
  ds_read_b64_tr_b16 a[16:17], v127 offset:0
  ds_read_b64_tr_b16 a[18:19], v127 offset:4096
  s_xor_b32 s63, s80, 0x10020
  v_xor_b32 v127, s63, v125
  ds_read_b64_tr_b16 a[24:25], v127 offset:0
  ds_read_b64_tr_b16 a[26:27], v127 offset:4096
  s_xor_b32 s63, s81, 0x10000
  v_xor_b32 v127, s63, v125
  ds_read_b64_tr_b16 a[48:49], v127 offset:0
  ds_read_b64_tr_b16 a[50:51], v127 offset:4096
  s_xor_b32 s63, s81, 0x10020
  v_xor_b32 v127, s63, v125
  ds_read_b64_tr_b16 a[56:57], v127 offset:0
  ds_read_b64_tr_b16 a[58:59], v127 offset:4096
  s_xor_b32 s63, s82, 0x10000
  v_xor_b32 v127, s63, v125
  ds_read_b64_tr_b16 a[80:81], v127 offset:0
  ds_read_b64_tr_b16 a[82:83], v127 offset:4096
  s_xor_b32 s63, s82, 0x10020
  v_xor_b32 v127, s63, v125
  ds_read_b64_tr_b16 a[88:89], v127 offset:0
  ds_read_b64_tr_b16 a[90:91], v127 offset:4096
  s_xor_b32 s63, s83, 0x10000
  v_xor_b32 v127, s63, v125
  ds_read_b64_tr_b16 a[112:113], v127 offset:0
  ds_read_b64_tr_b16 a[114:115], v127 offset:4096
  s_xor_b32 s63, s83, 0x10020
  v_xor_b32 v127, s63, v125
  ds_read_b64_tr_b16 a[120:121], v127 offset:0
  ds_read_b64_tr_b16 a[122:123], v127 offset:4096
  s_waitcnt lgkmcnt(0)
  v_and_b32 v116, 15, v0
  s_lshl_b32 s18, s34, 11
  v_lshl_add_u32 v116, v116, 7, s18
  v_and_b32 v117, 1, v0
  s_lshl_b32 s18, s35, 10
  s_lshl_b32 s19, s34, 8
  s_add_u32 s18, s18, s19
  v_lshl_add_u32 v117, v117, 7, s18
  buffer_load_dword v13, v116, s[36:39], s64 offen sc1
  s_mov_b32 s18, 0x480000
  buffer_load_dword v13, v117, s[36:39], s18 offen sc1
  s_barrier
  ds_write_b128 v2, v[84:87] offset:0
  ds_write_b128 v2, v[88:91] offset:1024
  ds_write_b128 v2, v[92:95] offset:8192
  ds_write_b128 v2, v[96:99] offset:9216
  ds_write_b128 v2, v[100:103] offset:16384
  ds_write_b128 v2, v[104:107] offset:17408
  ds_write_b128 v2, v[108:111] offset:24576
  ds_write_b128 v2, v[112:115] offset:25600
  v_mov_b64 v[76:77], 0
  v_mov_b64 v[78:79], 0
  v_mov_b64 v[80:81], 0
  v_mov_b64 v[82:83], 0
  v_mov_b64 v[44:45], 0
  v_mov_b64 v[46:47], 0
  v_mov_b64 v[48:49], 0
  v_mov_b64 v[50:51], 0
L_chain_c11:
  s_waitcnt vmcnt(7)
  s_barrier
  buffer_load_dword v14, off, s[36:39], s70 sc1
  buffer_load_dwordx4 v[36:39], v1, s[36:39], s91 offen sc1
  s_xor_b32 s63, s80, 0x10000
  v_xor_b32 v127, s63, v125
  ds_read_b64_tr_b16 a[20:21], v127 offset:32768
  ds_read_b64_tr_b16 a[22:23], v127 offset:36864
  s_xor_b32 s63, s80, 0x10020
  v_xor_b32 v127, s63, v125
  ds_read_b64_tr_b16 a[28:29], v127 offset:32768
  ds_read_b64_tr_b16 a[30:31], v127 offset:36864
  s_xor_b32 s63, s81, 0x10000
  v_xor_b32 v127, s63, v125
  ds_read_b64_tr_b16 a[52:53], v127 offset:32768
  ds_read_b64_tr_b16 a[54:55], v127 offset:36864
  s_xor_b32 s63, s81, 0x10020
  v_xor_b32 v127, s63, v125
  ds_read_b64_tr_b16 a[60:61], v127 offset:32768
  ds_read_b64_tr_b16 a[62:63], v127 offset:36864
  s_xor_b32 s63, s82, 0x10000
  v_xor_b32 v127, s63, v125
  ds_read_b64_tr_b16 a[84:85], v127 offset:32768
  ds_read_b64_tr_b16 a[86:87], v127 offset:36864
  s_xor_b32 s63, s82, 0x10020
  v_xor_b32 v127, s63, v125
  ds_read_b64_tr_b16 a[92:93], v127 offset:32768
  ds_read_b64_tr_b16 a[94:95], v127 offset:36864
  s_xor_b32 s63, s83, 0x10000
  v_xor_b32 v127, s63, v125
  ds_read_b64_tr_b16 a[116:117], v127 offset:32768
  ds_read_b64_tr_b16 a[118:119], v127 offset:36864
  s_xor_b32 s63, s83, 0x10020
  v_xor_b32 v127, s63, v125
  ds_read_b64_tr_b16 a[124:125], v127 offset:32768
  ds_read_b64_tr_b16 a[126:127], v127 offset:36864
  s_waitcnt lgkmcnt(0)
  s_barrier
  s_cmp_eq_u64 s[88:89], 0
  s_cbranch_scc1 L_xccok_12
  buffer_load_dword v12, v15, s[40:43], 0 offen offset:128 sc1
L_xcc_11:
  s_waitcnt vmcnt(0)
  v_cmp_eq_u32 s[66:67], 32, v12
  v_add_u32_dpp v12, v12, v12 row_ror:8 row_mask:0xf bank_mask:0xf
  s_nop 1
  v_add_u32_dpp v12, v12, v12 row_ror:4 row_mask:0xf bank_mask:0xf
  s_nop 1
  v_add_u32_dpp v12, v12, v12 row_ror:2 row_mask:0xf bank_mask:0xf
  s_nop 1
  v_add_u32_dpp v12, v12, v12 row_ror:1 row_mask:0xf bank_mask:0xf
  s_and_b64 s[66:67], s[66:67], 0xff
  v_cmp_ne_u32 vcc, 64, v12
  s_cbranch_vccz L_xccre_13
  s_sub_u32 s3, s3, 1
  s_cbranch_scc1 L_end
  buffer_load_dword v12, v15, s[40:43], 0 offen offset:128 sc1
  s_waitcnt vmcnt(0)
  s_branch L_xcc_11
L_xccre_13:
  s_add_u32 s78, s69, 8192
  buffer_load_dwordx4 v[20:23], v1, s[36:39], s69 offen offset:0 sc1
  buffer_load_dwordx4 v[24:27], v1, s[36:39], s69 offen offset:1024 sc1
  buffer_load_dwordx4 v[28:31], v1, s[36:39], s78 offen offset:0 sc1
  buffer_load_dwordx4 v[32:35], v1, s[36:39], s78 offen offset:1024 sc1
  buffer_load_dword v14, off, s[36:39], s70 sc1
  buffer_load_dwordx4 v[36:39], v1, s[36:39], s91 offen sc1
  s_waitcnt vmcnt(0)
L_xccok_12:
  s_waitcnt vmcnt(0)
  v_cmp_eq_u32 vcc, -1, v36
  s_cbranch_vccz L_have_14
L_spin_15:
  buffer_load_dword v14, off, s[36:39], s70 sc1
  buffer_load_dwordx4 v[36:39], v1, s[36:39], s91 offen sc1
  s_waitcnt vmcnt(0)
  v_cmp_eq_u32 vcc, -1, v36
  s_cbranch_vccz L_ok_16
  s_sub_u32 s3, s3, 1
  s_cbranch_scc1 L_end
  s_branch L_spin_15
L_ok_16:
L_have_14:
  v_and_b32 v15, -9, v10
  ds_write_b128 v15, v[36:39]
  v_mov_b64 v[100:101], v[36:37]
  v_mov_b64 v[102:103], v[38:39]
  v_mov_b32 v12, v14
  s_waitcnt lgkmcnt(0)
  s_cmp_eq_u64 s[66:67], 0
  s_cselect_b32 s61, 4, 0
  s_add_u32 s61, s61, s34
  s_cmp_eq_u32 s61, 1
  s_cbranch_scc1 L_sm_f1_1
  s_cmp_eq_u32 s61, 2
  s_cbranch_scc1 L_sm_f2_1
  s_cmp_eq_u32 s61, 3
  s_cbranch_scc1 L_sm_f3_1
  s_cmp_eq_u32 s61, 4
  s_cbranch_scc1 L_sm_s0_1
  s_cmp_eq_u32 s61, 5
  s_cbranch_scc1 L_sm_s1_1
  s_cmp_eq_u32 s61, 6
  s_cbranch_scc1 L_sm_s2_1
  s_cmp_eq_u32 s61, 7
  s_cbranch_scc1 L_sm_s3_1
  s_branch L_sm_f0_1
L_chain_ready:
L_helper:
  s_getpc_b64 s[62:63]
L_pc_17:
  s_lshl_b32 s61, s34, 12
  v_lshl_add_u32 v6, v0, 6, s61
  v_min_u32 v7, L_step_f0_0-L_pc_17-4, v6
  v_mov_b32 v5, s63
  v_add_co_u32 v4, vcc, s62, v7
  s_nop 1
  v_addc_co_u32 v5, vcc, 0, v5, vcc
  global_load_dword v8, v[4:5], off
  v_lshrrev_b32 v120, 5, v0
  v_lshlrev_b32 v120, 12, v120
  v_bfe_u32 v121, v0, 4, 1
  v_lshl_add_u32 v120, v121, 14, v120
  v_and_b32 v121, 15, v0
  v_lshl_add_u32 v120, v121, 4, v120
  s_lshl_b32 s18, s35, 17
  s_lshl_b32 s19, s34, 8
  s_add_u32 s18, s18, s19
  v_add_u32 v120, s18, v120
  s_mov_b32 s56, s14
  s_mov_b32 s57, s15
  s_mov_b32 s58, 0x400000
  s_mov_b32 s59, 0x20000
  s_xor_b32 s18, s34, 0
  s_lshl_b32 s18, s18, 15
  s_add_u32 s63, s18, 0x0
  buffer_load_dwordx4 v[52:55], v120, s[56:59], s63 offen offset:0
  buffer_load_dwordx4 v[56:59], v120, s[56:59], s63 offen offset:1024
  buffer_load_dwordx4 v[60:63], v120, s[56:59], s63 offen offset:2048
  buffer_load_dwordx4 v[64:67], v120, s[56:59], s63 offen offset:3072
  s_add_u32 s63, s18, 0x2000
  buffer_load_dwordx4 v[68:71], v120, s[56:59], s63 offen offset:0
  buffer_load_dwordx4 v[72:75], v120, s[56:59], s63 offen offset:1024
  buffer_load_dwordx4 v[76:79], v120, s[56:59], s63 offen offset:2048
  buffer_load_dwordx4 v[80:83], v120, s[56:59], s63 offen offset:3072
  s_xor_b32 s18, s34, 1
  s_lshl_b32 s18, s18, 15
  s_add_u32 s63, s18, 0x0
  buffer_load_dwordx4 v[84:87], v120, s[56:59], s63 offen offset:0
  buffer_load_dwordx4 v[88:91], v120, s[56:59], s63 offen offset:1024
  buffer_load_dwordx4 v[92:95], v120, s[56:59], s63 offen offset:2048
  buffer_load_dwordx4 v[96:99], v120, s[56:59], s63 offen offset:3072
  s_add_u32 s63, s18, 0x2000
  buffer_load_dwordx4 v[100:103], v120, s[56:59], s63 offen offset:0
  buffer_load_dwordx4 v[104:107], v120, s[56:59], s63 offen offset:1024
  buffer_load_dwordx4 v[108:111], v120, s[56:59], s63 offen offset:2048
  buffer_load_dwordx4 v[112:115], v120, s[56:59], s63 offen offset:3072
  buffer_load_dword v123, off, s[40:43], 0 offset:4 sc1
  s_xor_b32 s18, s34, 2
  s_lshl_b32 s18, s18, 15
  s_add_u32 s63, s18, 0x0
  buffer_load_dwordx4 a[0:3], v120, s[56:59], s63 offen offset:0
  buffer_load_dwordx4 a[4:7], v120, s[56:59], s63 offen offset:1024
  buffer_load_dwordx4 a[8:11], v120, s[56:59], s63 offen offset:2048
  buffer_load_dwordx4 a[12:15], v120, s[56:59], s63 offen offset:3072
  s_add_u32 s63, s18, 0x2000
  buffer_load_dwordx4 a[16:19], v120, s[56:59], s63 offen offset:0
  buffer_load_dwordx4 a[20:23], v120, s[56:59], s63 offen offset:1024
  buffer_load_dwordx4 a[24:27], v120, s[56:59], s63 offen offset:2048
  buffer_load_dwordx4 a[28:31], v120, s[56:59], s63 offen offset:3072
  s_xor_b32 s18, s34, 3
  s_lshl_b32 s18, s18, 15
  s_add_u32 s63, s18, 0x0
  buffer_load_dwordx4 a[32:35], v120, s[56:59], s63 offen offset:0
  buffer_load_dwordx4 a[36:39], v120, s[56:59], s63 offen offset:1024
  buffer_load_dwordx4 a[40:43], v120, s[56:59], s63 offen offset:2048
  buffer_load_dwordx4 a[44:47], v120, s[56:59], s63 offen offset:3072
  s_add_u32 s63, s18, 0x2000
  buffer_load_dwordx4 a[48:51], v120, s[56:59], s63 offen offset:0
  buffer_load_dwordx4 a[52:55], v120, s[56:59], s63 offen offset:1024
  buffer_load_dwordx4 a[56:59], v120, s[56:59], s63 offen offset:2048
  buffer_load_dwordx4 a[60:63], v120, s[56:59], s63 offen offset:3072
  s_lshl_b32 s18, s34, 11
  v_lshl_add_u32 v1, v0, 4, s18
  v_add_u32 v2, 0x10000, v1
  v_add_u32 v3, 0x20000, v1
  s_mul_i32 s64, s34, 31
  s_add_u32 s64, s64, s35
  s_lshl_b32 s64, s64, 11
  s_add_u32 s64, s64, 0xe00000
  s_waitcnt vmcnt(16)
  v_readfirstlane_b32 s18, v123
L_rot_18:
  s_cmp_eq_u32 s18, s100
  s_cbranch_scc1 L_rotok_19
  s_cmp_lg_u32 s18, 0
  s_cbranch_scc1 L_restart
  s_sub_u32 s3, s3, 1
  s_cbranch_scc1 L_end
  buffer_load_dword v123, off, s[40:43], 0 offset:4 sc1
  s_waitcnt vmcnt(0)
  v_readfirstlane_b32 s18, v123
  s_branch L_rot_18
L_rotok_19:
  v_mov_b64 v[116:117], -1
  v_mov_b64 v[118:119], -1
  buffer_store_dwordx4 v[116:119], v1, s[36:39], s64 offen sc1
  buffer_store_dwordx4 v[116:119], v1, s[36:39], s64 offen offset:1024 sc1
  v_lshlrev_b32 v4, 4, v0
  v_add_u32 v4, 0x18000, v4
  s_lshr_b32 s18, s34, 1
  s_lshl_b32 s18, s18, 12
  s_and_b32 s19, s34, 1
  s_lshl_b32 s19, s19, 7
  s_add_u32 s18, s18, s19
  v_lshrrev_b32 v116, 3, v0
  v_lshl_add_u32 v9, v116, 8, s18
  v_and_b32 v116, 7, v0
  v_lshl_add_u32 v9, v116, 4, v9
  v_subrev_u32 v9, s18, v9
  v_lshrrev_b32 v116, 4, v0
  v_and_b32 v117, 15, v0
  v_lshrrev_b32 v118, 3, v117
  v_lshl_add_u32 v118, v116, 1, v118
  s_lshl_b32 s18, s34, 3
  v_add_u32 v118, s18, v118
  v_lshlrev_b32 v5, 11, v118
  v_and_b32 v118, 7, v0
  v_lshl_add_u32 v5, v118, 3, v5
  s_lshl_b32 s18, s35, 6
  s_add_u32 s18, s18, 0xe00000
  v_add_u32 v5, s18, v5
  s_lshr_b32 s18, s35, 3
  s_lshl_b32 s18, s18, 10
  s_and_b32 s19, s35, 1
  s_lshl_b32 s19, s19, 9
  s_add_u32 s18, s18, s19
  s_bfe_u32 s19, s35, 0x10002
  s_lshl_b32 s19, s19, 8
  s_add_u32 s18, s18, s19
  s_bfe_u32 s19, s35, 0x10001
  s_lshl_b32 s19, s19, 6
  s_add_u32 s18, s18, s19
  s_lshr_b32 s19, s34, 1
  s_lshl_b32 s19, s19, 12
  s_add_u32 s18, s18, s19
  s_and_b32 s19, s34, 1
  s_lshl_b32 s19, s19, 7
  s_add_u32 s18, s18, s19
  v_and_b32 v6, 48, v0
  v_lshl_add_u32 v6, v117, 2, v6
  v_add_u32 v6, s18, v6
  v_and_b32 v118, 12, v0
  v_cmp_eq_u32 vcc, 0, v118
  v_mov_b32 v118, 0x80000000
  s_nop 0
  v_cndmask_b32 v6, v118, v6, vcc
  v_lshrrev_b32 v118, 2, v117
  v_and_b32 v119, 1, v118
  v_lshlrev_b32 v119, 1, v119
  v_xor_b32 v119, v119, v116
  v_lshlrev_b32 v7, 5, v119
  v_lshl_add_u32 v7, v118, 7, v7
  v_and_b32 v119, 3, v0
  v_lshl_add_u32 v7, v119, 2, v7
  s_lshl_b32 s18, s34, 10
  s_add_u32 s19, s18, 0x1e000
  v_add_u32 v7, s19, v7
  v_and_b32 v120, 1, v116
  v_lshlrev_b32 v120, 2, v120
  v_lshrrev_b32 v119, 1, v117
  v_xor_b32 v119, v119, v120
  v_lshlrev_b32 v119, 4, v119
  v_lshl_add_u32 v119, v116, 7, v119
  v_add_u32 v8, 0x1e000, v119
  s_add_u32 s19, s18, 0x1f000
  v_add_u32 v10, s19, v119
  v_and_b32 v118, 1, v0
  v_lshl_add_u32 v10, v118, 3, v10
  v_mul_u32_u24 v11, 0xaaaa, v118
  v_add_u32 v11, 0x4444, v11
  v_lshlrev_b32 v119, 4, v118
  v_mov_b32 v120, 0x3f80
  v_lshlrev_b32 v119, v119, v120
  v_bfe_u32 v120, v0, 2, 1
  v_bfe_u32 v121, v0, 3, 1
  v_lshl_add_u32 v120, v120, 1, v121
  v_and_b32 v121, 2, v0
  v_cmp_ne_u32 s[66:67], 0, v121
  v_mov_b32 v121, 0x3f803f80
  v_cmp_eq_u32 vcc, 0, v120
  s_nop 1
  v_cndmask_b32 v16, 0, v119, vcc
  v_cndmask_b32 v16, v16, v121, s[66:67]
  v_cmp_eq_u32 vcc, 1, v120
  s_nop 1
  v_cndmask_b32 v17, 0, v119, vcc
  v_cndmask_b32 v17, v17, v121, s[66:67]
  v_cmp_eq_u32 vcc, 2, v120
  s_nop 1
  v_cndmask_b32 v18, 0, v119, vcc
  v_cndmask_b32 v18, v18, v121, s[66:67]
  v_cmp_eq_u32 vcc, 3, v120
  s_nop 1
  v_cndmask_b32 v19, 0, v119, vcc
  v_cndmask_b32 v19, v19, v121, s[66:67]
  s_mov_b32 s68, 62
  s_lshl_b32 s69, s35, 20
  s_add_u32 s69, s69, 0x2008000
  s_lshl_b32 s70, s35, 2
  s_add_u32 s70, s70, 0x580000
  s_add_u32 s77, s70, 0x1f800
  s_add_u32 s70, s70, 6144
  s_mov_b32 s71, 0xd80000
  s_mov_b32 s87, 0xd82000
  s_mov_b32 s75, 0x400000
  s_add_u32 s92, s75, 0x1000
  s_mov_b32 s93, 0xd83000
  s_mov_b32 s72, 0x5b0000
  s_mov_b32 s79, 0x402000
  s_lshl_b32 s91, s35, 2
  s_sub_u32 s91, s91, s34
  s_lshl_b32 s91, s91, 10
  s_add_u32 s91, s91, 0x540000
  s_mov_b32 s73, 0x3e0293ee
  s_mov_b32 s74, 0x10000
  s_mov_b32 s76, 0x20000
  s_mov_b32 s65, 0x30000
  s_mov_b32 s84, 0xaaaaaaaa
  s_mov_b32 s85, 0xaaaaaaaa
  s_mov_b32 s90, 0x40000000
  s_mov_b32 s86, 0x53800000
  s_waitcnt vmcnt(0)
  s_barrier
  s_getreg_b32 s18, hwreg(HW_REG_XCC_ID, 0, 3)
  s_lshl_b32 s18, s18, 2
  s_add_u32 s18, s18, 192
  s_cmp_eq_u32 s34, 0
  s_cselect_b32 s18, s18, 0x1000
  v_mov_b32 v15, 1
  s_mov_b64 exec, 1
  buffer_atomic_add v15, off, s[40:43], s18 sc1
  s_mov_b64 exec, -1
  v_perm_b32 v128, v56, v52, s16
  v_perm_b32 v129, v56, v52, s17
  v_perm_b32 v130, v64, v60, s16
  v_perm_b32 v131, v64, v60, s17
  v_perm_b32 v132, v72, v68, s16
  v_perm_b32 v133, v72, v68, s17
  v_perm_b32 v134, v80, v76, s16
  v_perm_b32 v135, v80, v76, s17
  v_perm_b32 v160, v57, v53, s16
  v_perm_b32 v161, v57, v53, s17
  v_perm_b32 v162, v65, v61, s16
  v_perm_b32 v163, v65, v61, s17
  v_perm_b32 v164, v73, v69, s16
  v_perm_b32 v165, v73, v69, s17
  v_perm_b32 v166, v81, v77, s16
  v_perm_b32 v167, v81, v77, s17
  v_perm_b32 v192, v58, v54, s16
  v_perm_b32 v193, v58, v54, s17
  v_perm_b32 v194, v66, v62, s16
  v_perm_b32 v195, v66, v62, s17
  v_perm_b32 v196, v74, v70, s16
  v_perm_b32 v197, v74, v70, s17
  v_perm_b32 v198, v82, v78, s16
  v_perm_b32 v199, v82, v78, s17
  v_perm_b32 v216, v59, v55, s16
  v_perm_b32 v217, v59, v55, s17
  v_perm_b32 v218, v67, v63, s16
  v_perm_b32 v219, v67, v63, s17
  v_perm_b32 v220, v75, v71, s16
  v_perm_b32 v221, v75, v71, s17
  v_perm_b32 v222, v83, v79, s16
  v_perm_b32 v223, v83, v79, s17
  v_perm_b32 v136, v88, v84, s16
  v_perm_b32 v137, v88, v84, s17
  v_perm_b32 v138, v96, v92, s16
  v_perm_b32 v139, v96, v92, s17
  v_perm_b32 v140, v104, v100, s16
  v_perm_b32 v141, v104, v100, s17
  v_perm_b32 v142, v112, v108, s16
  v_perm_b32 v143, v112, v108, s17
  v_perm_b32 v168, v89, v85, s16
  v_perm_b32 v169, v89, v85, s17
  v_perm_b32 v170, v97, v93, s16
  v_perm_b32 v171, v97, v93, s17
  v_perm_b32 v172, v105, v101, s16
  v_perm_b32 v173, v105, v101, s17
  v_perm_b32 v174, v113, v109, s16
  v_perm_b32 v175, v113, v109, s17
  v_perm_b32 v200, v90, v86, s16
  v_perm_b32 v201, v90, v86, s17
  v_perm_b32 v202, v98, v94, s16
  v_perm_b32 v203, v98, v94, s17
  v_perm_b32 v204, v106, v102, s16
  v_perm_b32 v205, v106, v102, s17
  v_perm_b32 v206, v114, v110, s16
  v_perm_b32 v207, v114, v110, s17
  v_perm_b32 v116, v91, v87, s16
  v_perm_b32 v117, v91, v87, s17
  v_perm_b32 v118, v99, v95, s16
  v_perm_b32 v119, v99, v95, s17
  v_perm_b32 v120, v107, v103, s16
  v_perm_b32 v121, v107, v103, s17
  v_perm_b32 v122, v115, v111, s16
  v_perm_b32 v123, v115, v111, s17
  ds_write_b128 v3, v[116:119] offset:8192
  ds_write_b128 v3, v[120:123] offset:9216
  s_waitcnt lgkmcnt(0)
  v_accvgpr_read_b32 v52, a0
  v_accvgpr_read_b32 v53, a1
  v_accvgpr_read_b32 v54, a2
  v_accvgpr_read_b32 v55, a3
  v_accvgpr_read_b32 v56, a4
  v_accvgpr_read_b32 v57, a5
  v_accvgpr_read_b32 v58, a6
  v_accvgpr_read_b32 v59, a7
  v_accvgpr_read_b32 v60, a8
  v_accvgpr_read_b32 v61, a9
  v_accvgpr_read_b32 v62, a10
  v_accvgpr_read_b32 v63, a11
  v_accvgpr_read_b32 v64, a12
  v_accvgpr_read_b32 v65, a13
  v_accvgpr_read_b32 v66, a14
  v_accvgpr_read_b32 v67, a15
  v_accvgpr_read_b32 v68, a16
  v_accvgpr_read_b32 v69, a17
  v_accvgpr_read_b32 v70, a18
  v_accvgpr_read_b32 v71, a19
  v_accvgpr_read_b32 v72, a20
  v_accvgpr_read_b32 v73, a21
  v_accvgpr_read_b32 v74, a22
  v_accvgpr_read_b32 v75, a23
  v_accvgpr_read_b32 v76, a24
  v_accvgpr_read_b32 v77, a25
  v_accvgpr_read_b32 v78, a26
  v_accvgpr_read_b32 v79, a27
  v_accvgpr_read_b32 v80, a28
  v_accvgpr_read_b32 v81, a29
  v_accvgpr_read_b32 v82, a30
  v_accvgpr_read_b32 v83, a31
  v_perm_b32 v144, v56, v52, s16
  v_perm_b32 v145, v56, v52, s17
  v_perm_b32 v146, v64, v60, s16
  v_perm_b32 v147, v64, v60, s17
  v_perm_b32 v148, v72, v68, s16
  v_perm_b32 v149, v72, v68, s17
  v_perm_b32 v150, v80, v76, s16
  v_perm_b32 v151, v80, v76, s17
  v_perm_b32 v176, v57, v53, s16
  v_perm_b32 v177, v57, v53, s17
  v_perm_b32 v178, v65, v61, s16
  v_perm_b32 v179, v65, v61, s17
  v_perm_b32 v180, v73, v69, s16
  v_perm_b32 v181, v73, v69, s17
  v_perm_b32 v182, v81, v77, s16
  v_perm_b32 v183, v81, v77, s17
  v_perm_b32 v208, v58, v54, s16
  v_perm_b32 v209, v58, v54, s17
  v_perm_b32 v210, v66, v62, s16
  v_perm_b32 v211, v66, v62, s17
  v_perm_b32 v212, v74, v70, s16
  v_perm_b32 v213, v74, v70, s17
  v_perm_b32 v214, v82, v78, s16
  v_perm_b32 v215, v82, v78, s17
  v_perm_b32 v116, v59, v55, s16
  v_perm_b32 v117, v59, v55, s17
  v_perm_b32 v118, v67, v63, s16
  v_perm_b32 v119, v67, v63, s17
  v_perm_b32 v120, v75, v71, s16
  v_perm_b32 v121, v75, v71, s17
  v_perm_b32 v122, v83, v79, s16
  v_perm_b32 v123, v83, v79, s17
  ds_write_b128 v3, v[116:119] offset:16384
  ds_write_b128 v3, v[120:123] offset:17408
  s_waitcnt lgkmcnt(0)
  v_accvgpr_read_b32 v84, a32
  v_accvgpr_read_b32 v85, a33
  v_accvgpr_read_b32 v86, a34
  v_accvgpr_read_b32 v87, a35
  v_accvgpr_read_b32 v88, a36
  v_accvgpr_read_b32 v89, a37
  v_accvgpr_read_b32 v90, a38
  v_accvgpr_read_b32 v91, a39
  v_accvgpr_read_b32 v92, a40
  v_accvgpr_read_b32 v93, a41
  v_accvgpr_read_b32 v94, a42
  v_accvgpr_read_b32 v95, a43
  v_accvgpr_read_b32 v96, a44
  v_accvgpr_read_b32 v97, a45
  v_accvgpr_read_b32 v98, a46
  v_accvgpr_read_b32 v99, a47
  v_accvgpr_read_b32 v100, a48
  v_accvgpr_read_b32 v101, a49
  v_accvgpr_read_b32 v102, a50
  v_accvgpr_read_b32 v103, a51
  v_accvgpr_read_b32 v104, a52
  v_accvgpr_read_b32 v105, a53
  v_accvgpr_read_b32 v106, a54
  v_accvgpr_read_b32 v107, a55
  v_accvgpr_read_b32 v108, a56
  v_accvgpr_read_b32 v109, a57
  v_accvgpr_read_b32 v110, a58
  v_accvgpr_read_b32 v111, a59
  v_accvgpr_read_b32 v112, a60
  v_accvgpr_read_b32 v113, a61
  v_accvgpr_read_b32 v114, a62
  v_accvgpr_read_b32 v115, a63
  v_perm_b32 v152, v88, v84, s16
  v_perm_b32 v153, v88, v84, s17
  v_perm_b32 v154, v96, v92, s16
  v_perm_b32 v155, v96, v92, s17
  v_perm_b32 v156, v104, v100, s16
  v_perm_b32 v157, v104, v100, s17
  v_perm_b32 v158, v112, v108, s16
  v_perm_b32 v159, v112, v108, s17
  v_perm_b32 v184, v89, v85, s16
  v_perm_b32 v185, v89, v85, s17
  v_perm_b32 v186, v97, v93, s16
  v_perm_b32 v187, v97, v93, s17
  v_perm_b32 v188, v105, v101, s16
  v_perm_b32 v189, v105, v101, s17
  v_perm_b32 v190, v113, v109, s16
  v_perm_b32 v191, v113, v109, s17
  v_perm_b32 v116, v90, v86, s16
  v_perm_b32 v117, v90, v86, s17
  v_perm_b32 v118, v98, v94, s16
  v_perm_b32 v119, v98, v94, s17
  v_perm_b32 v120, v106, v102, s16
  v_perm_b32 v121, v106, v102, s17
  v_perm_b32 v122, v114, v110, s16
  v_perm_b32 v123, v114, v110, s17
  ds_write_b128 v3, v[116:119] offset:0
  ds_write_b128 v3, v[120:123] offset:1024
  s_waitcnt lgkmcnt(0)
  v_perm_b32 v116, v91, v87, s16
  v_perm_b32 v117, v91, v87, s17
  v_perm_b32 v118, v99, v95, s16
  v_perm_b32 v119, v99, v95, s17
  v_perm_b32 v120, v107, v103, s16
  v_perm_b32 v121, v107, v103, s17
  v_perm_b32 v122, v115, v111, s16
  v_perm_b32 v123, v115, v111, s17
  ds_write_b128 v3, v[116:119] offset:24576
  ds_write_b128 v3, v[120:123] offset:25600
  s_waitcnt lgkmcnt(0)
  v_mov_b64 v[76:77], 0
  v_mov_b64 v[78:79], 0
  v_mov_b64 v[80:81], 0
  v_mov_b64 v[82:83], 0
  v_mov_b64 v[44:45], 0
  v_mov_b64 v[46:47], 0
  v_mov_b64 v[48:49], 0
  v_mov_b64 v[50:51], 0
  buffer_load_dwordx4 v[116:119], v1, s[36:39], s64 offen offset:0 sc1
  buffer_load_dwordx4 v[116:119], v1, s[36:39], s64 offen offset:1024 sc1
  s_getpc_b64 s[96:97]
L_pc_20:
  s_mul_i32 s95, s34, L_step_f1_0-L_step_f0_0
  s_add_u32 s95, s95, L_step_f0_0-L_pc_20
  v_lshl_add_u32 v120, v0, 7, s95
  v_min_u32 v120, L_step_s0_0-L_pc_20-4, v120
  v_mov_b32 v121, s97
  v_add_co_u32 v120, vcc, s96, v120
  s_nop 1
  v_addc_co_u32 v121, vcc, 0, v121, vcc
  global_load_dword v13, v[120:121], off
L_spin_21:
  buffer_load_dword v12, off, s[40:43], 0 offset:0 sc1
  s_waitcnt vmcnt(0)
  v_cmp_ne_u32 vcc, 64, v12
  s_cbranch_vccz L_ok_22
  s_sub_u32 s3, s3, 1
  s_cbranch_scc1 L_end
  s_sleep 8
  s_branch L_spin_21
L_ok_22:
  v_and_b32 v15, 7, v0
  v_lshlrev_b32 v15, 2, v15
L_xcc_23:
  buffer_load_dword v12, v15, s[40:43], 0 offen offset:192 sc1
  s_waitcnt vmcnt(0)
  v_cmp_eq_u32 s[66:67], 32, v12
  v_add_u32_dpp v12, v12, v12 row_ror:8 row_mask:0xf bank_mask:0xf
  s_nop 1
  v_add_u32_dpp v12, v12, v12 row_ror:4 row_mask:0xf bank_mask:0xf
  s_nop 1
  v_add_u32_dpp v12, v12, v12 row_ror:2 row_mask:0xf bank_mask:0xf
  s_nop 1
  v_add_u32_dpp v12, v12, v12 row_ror:1 row_mask:0xf bank_mask:0xf
  s_and_b64 s[66:67], s[66:67], 0xff
  v_cmp_ne_u32 vcc, 64, v12
  s_cbranch_vccz L_xccok_24
  s_sub_u32 s3, s3, 1
  s_cbranch_scc1 L_end
  s_branch L_xcc_23
L_xccok_24:
L_spin_25:
  buffer_load_dwordx4 v[36:39], v1, s[36:39], s91 offen sc1
  s_waitcnt vmcnt(0)
  v_cmp_eq_u32 vcc, -1, v36
  s_cbranch_vccz L_ok_26
  s_sub_u32 s3, s3, 1
  s_cbranch_scc1 L_end
  s_branch L_spin_25
L_ok_26:
  v_and_b32 v15, -9, v10
  ds_write_b128 v15, v[36:39]
  v_mov_b64 v[100:101], v[36:37]
  v_mov_b64 v[102:103], v[38:39]
  s_cmp_eq_u64 s[66:67], 0
  s_cselect_b32 s61, 4, 0
  s_add_u32 s61, s61, s34
  s_cmp_eq_u32 s61, 1
  s_cbranch_scc1 L_sm_f1_0
  s_cmp_eq_u32 s61, 2
  s_cbranch_scc1 L_sm_f2_0
  s_cmp_eq_u32 s61, 3
  s_cbranch_scc1 L_sm_f3_0
  s_cmp_eq_u32 s61, 4
  s_cbranch_scc1 L_sm_s0_0
  s_cmp_eq_u32 s61, 5
  s_cbranch_scc1 L_sm_s1_0
  s_cmp_eq_u32 s61, 6
  s_cbranch_scc1 L_sm_s2_0
  s_cmp_eq_u32 s61, 7
  s_cbranch_scc1 L_sm_s3_0
  s_branch L_sm_f0_0
.p2align 5
  s_nop 0
  s_nop 0
  s_nop 0
  s_nop 0
L_step_f0_0:
  s_waitcnt lgkmcnt(0)
  s_waitcnt vmcnt(0)
  v_max_u32 v15, v39, v43
  v_cmp_eq_u32 vcc, -1, v15
  ds_write_b64 v2, v[36:37] offset:32768
  s_cbranch_vccnz L_er0_f0_0
L_eb0_f0_0:
  v_smfmac_f32_16x16x64_bf16 v[88:91], v[36:39], v[44:51], v11
  ds_write_b64 v2, v[38:39] offset:32776
  v_smfmac_f32_16x16x64_bf16 v[88:91], v[40:43], v[52:59], v11
  ds_write_b64 v2, v[40:41] offset:33792
  v_smfmac_f32_16x16x64_bf16 v[84:87], v[36:39], v[60:67], v11
  ds_write_b64 v2, v[42:43] offset:33800
  v_smfmac_f32_16x16x64_bf16 v[84:87], v[40:43], v[92:99], v11
  s_add_u32 s69, s69, 16384
  s_add_u32 s78, s69, 8192
  v_smfmac_f32_16x16x64_bf16 v[80:83], v[36:39], v[100:107], v11
  s_add_u32 s70, s70, 2048
  s_min_u32 s70, s70, s77
  v_smfmac_f32_16x16x64_bf16 v[80:83], v[40:43], v[116:123], v11
  v_smfmac_f32_16x16x64_bf16 v[76:79], v[36:39], v[20:27], v11
  s_waitcnt lgkmcnt(0)
  s_barrier
  ds_read_b128 v[44:47], v4 offset:2048
  v_smfmac_f32_16x16x64_bf16 v[76:79], v[40:43], v[28:35], v11
  ds_read_b128 v[48:51], v4 offset:3072
  v_smfmac_f32_16x16x64_bf16 v[72:75], v[36:39], a[8:15], v11
  ds_read_b128 v[52:55], v4 offset:4096
  v_smfmac_f32_16x16x64_bf16 v[72:75], v[40:43], a[24:31], v11
  ds_read_b128 v[56:59], v4 offset:5120
  v_smfmac_f32_16x16x64_bf16 v[68:71], v[36:39], a[0:7], v11
  ds_read_b128 v[60:63], v4 offset:6144
  v_smfmac_f32_16x16x64_bf16 v[68:71], v[40:43], a[16:23], v11
  ds_read_b128 v[64:67], v4 offset:7168
  s_waitcnt lgkmcnt(5)
  v_smfmac_f32_16x16x64_bf16 v[68:71], v[44:47], a[32:39], v11
  s_waitcnt lgkmcnt(4)
  buffer_store_dword v14, v6, s[36:39], s72 offen sc1
  v_smfmac_f32_16x16x64_bf16 v[68:71], v[48:51], a[48:55], v11
  ds_read_b128 v[92:95], v2 offset:8192
  s_waitcnt lgkmcnt(4)
  v_smfmac_f32_16x16x64_bf16 v[68:71], v[52:55], a[64:71], v11
  ds_read_b128 v[96:99], v2 offset:9216
  s_waitcnt lgkmcnt(4)
  v_smfmac_f32_16x16x64_bf16 v[68:71], v[56:59], a[80:87], v11
  ds_read_b128 v[100:103], v2 offset:16384
  s_waitcnt lgkmcnt(4)
  v_smfmac_f32_16x16x64_bf16 v[68:71], v[60:63], a[96:103], v11
  buffer_load_dwordx4 v[20:23], v1, s[36:39], s69 offen offset:0 sc1
  s_waitcnt lgkmcnt(3)
  v_smfmac_f32_16x16x64_bf16 v[68:71], v[64:67], a[112:119], v11
  ds_read_b128 v[104:107], v2 offset:17408
  v_smfmac_f32_16x16x64_bf16 v[72:75], v[44:47], a[40:47], v11
  ds_read_b128 v[116:119], v2 offset:24576
  v_smfmac_f32_16x16x64_bf16 v[72:75], v[48:51], a[56:63], v11
  ds_read_b128 v[120:123], v2 offset:25600
  v_add_f32 v124, v68, v69
  v_smfmac_f32_16x16x64_bf16 v[72:75], v[52:55], a[72:79], v11
  buffer_load_dwordx4 v[24:27], v1, s[36:39], s69 offen offset:1024 sc1
  v_add_f32 v126, v70, v71
  v_smfmac_f32_16x16x64_bf16 v[72:75], v[56:59], a[88:95], v11
  v_mul_f32 v124, s73, v124
  v_smfmac_f32_16x16x64_bf16 v[72:75], v[60:63], a[104:111], v11
  v_mul_f32 v126, s73, v126
  v_smfmac_f32_16x16x64_bf16 v[72:75], v[64:67], a[120:127], v11
  s_waitcnt lgkmcnt(0) vmcnt(3)
  v_smfmac_f32_16x16x64_bf16 v[76:79], v[44:47], v[108:115], v11
  buffer_load_dwordx4 v[28:31], v1, s[36:39], s78 offen offset:0 sc1
  v_smfmac_f32_16x16x64_bf16 v[76:79], v[48:51], v[92:99], v11
  ds_read_b128 v[92:95], v4 offset:8192
  v_add_f32 v125, v72, v73
  v_smfmac_f32_16x16x64_bf16 v[76:79], v[52:55], v[100:107], v11
  ds_read_b128 v[96:99], v4 offset:10240
  v_add_f32 v127, v74, v75
  v_smfmac_f32_16x16x64_bf16 v[76:79], v[56:59], v[116:123], v11
  ds_read_b128 v[100:103], v4 offset:12288
  v_mul_f32 v125, s73, v125
  v_smfmac_f32_16x16x64_bf16 v[76:79], v[60:63], a[160:167], v11
  ds_read_b128 v[104:107], v4 offset:14336
  v_mul_f32 v127, s73, v127
  v_smfmac_f32_16x16x64_bf16 v[76:79], v[64:67], a[176:183], v11
  ds_read_b128 v[108:111], v4 offset:9216
  v_cvt_pk_bf16_f32 v124, v124, v125
  v_smfmac_f32_16x16x64_bf16 v[80:83], v[44:47], a[128:135], v11
  ds_read_b128 v[112:115], v4 offset:11264
  v_cvt_pk_bf16_f32 v125, v126, v127
  v_smfmac_f32_16x16x64_bf16 v[80:83], v[48:51], a[136:143], v11
  ds_write2_b32 v7, v124, v125 offset0:0 offset1:4
  v_smfmac_f32_16x16x64_bf16 v[80:83], v[52:55], a[144:151], v11
  ds_read_b128 v[36:39], v4 offset:13312
  v_add_f32 v120, v76, v77
  v_smfmac_f32_16x16x64_bf16 v[80:83], v[56:59], a[152:159], v11
  ds_read_b128 v[40:43], v4 offset:15360
  v_add_f32 v122, v78, v79
  v_smfmac_f32_16x16x64_bf16 v[80:83], v[60:63], a[168:175], v11
  buffer_load_dword v12, off, s[36:39], s70 sc1
  v_smfmac_f32_16x16x64_bf16 v[80:83], v[64:67], a[184:191], v11
  s_waitcnt lgkmcnt(2)
  s_barrier
  v_smfmac_f32_16x16x64_bf16 v[84:87], v[44:47], a[192:199], v11
  ds_read_b128 v[68:71], v8 offset:0
  v_smfmac_f32_16x16x64_bf16 v[84:87], v[48:51], a[208:215], v11
  ds_read_b128 v[72:75], v8 offset:1024
  v_add_f32 v121, v80, v81
  v_smfmac_f32_16x16x64_bf16 v[84:87], v[52:55], a[224:231], v11
  ds_read_b128 v[76:79], v8 offset:2048
  v_add_f32 v123, v82, v83
  v_smfmac_f32_16x16x64_bf16 v[84:87], v[56:59], a[240:247], v11
  ds_read_b128 v[80:83], v8 offset:3072
  v_cvt_pk_bf16_f32 v120, v120, v121
  v_smfmac_f32_16x16x64_bf16 v[84:87], v[60:63], v[224:231], v11
  buffer_load_dwordx4 v[32:35], v1, s[36:39], s78 offen offset:1024 sc1
  v_cvt_pk_bf16_f32 v121, v122, v123
  v_smfmac_f32_16x16x64_bf16 v[84:87], v[64:67], v[240:247], v11
  ds_write2_b32 v7, v120, v121 offset0:128 offset1:132
  v_smfmac_f32_16x16x64_bf16 v[88:91], v[44:47], a[200:207], v11
  v_smfmac_f32_16x16x64_bf16 v[88:91], v[48:51], a[216:223], v11
  v_cvt_pk_bf16_f32 v84, v84, v85
  v_smfmac_f32_16x16x64_bf16 v[88:91], v[52:55], a[232:239], v11
  v_cvt_pk_bf16_f32 v85, v86, v87
  v_smfmac_f32_16x16x64_bf16 v[88:91], v[56:59], a[248:255], v11
  v_smfmac_f32_16x16x64_bf16 v[88:91], v[60:63], v[232:239], v11
  s_waitcnt lgkmcnt(0)
  s_barrier
  v_smfmac_f32_16x16x64_bf16 v[88:91], v[64:67], v[248:255], v11
  ds_read_b128 v[44:47], v8 offset:512
  v_mfma_f32_16x16x32_bf16 v[116:119], v[92:95], v[68:71], 0
  ds_read_b128 v[92:95], v2 offset:49152
  v_mfma_f32_16x16x32_bf16 v[116:119], v[96:99], v[72:75], v[116:119]
  ds_read_b128 v[48:51], v8 offset:1536
  v_cvt_pk_bf16_f32 v88, v88, v89
  v_mfma_f32_16x16x32_bf16 v[116:119], v[100:103], v[76:79], v[116:119]
  ds_read_b128 v[52:55], v8 offset:2560
  v_cvt_pk_bf16_f32 v89, v90, v91
  v_mfma_f32_16x16x32_bf16 v[116:119], v[104:107], v[80:83], v[116:119]
  ds_read_b128 v[56:59], v8 offset:3584
  v_mfma_f32_16x16x32_bf16 v[120:123], v[108:111], v[68:71], 0
  ds_read_b128 v[96:99], v2 offset:50176
  v_mfma_f32_16x16x32_bf16 v[120:123], v[112:115], v[72:75], v[120:123]
  v_exp_f32 v60, v116
  v_mfma_f32_16x16x32_bf16 v[120:123], v[36:39], v[76:79], v[120:123]
  v_exp_f32 v61, v117
  v_mfma_f32_16x16x32_bf16 v[120:123], v[40:43], v[80:83], v[120:123]
  s_waitcnt lgkmcnt(5)
  v_exp_f32 v62, v118
  v_mfma_f32_16x16x32_bf16 v[124:127], v[44:47], v[68:71], 0
  s_waitcnt lgkmcnt(3)
  v_exp_f32 v63, v119
  v_mfma_f32_16x16x32_bf16 v[124:127], v[48:51], v[72:75], v[124:127]
  s_waitcnt lgkmcnt(2)
  v_exp_f32 v64, v120
  v_mfma_f32_16x16x32_bf16 v[124:127], v[52:55], v[76:79], v[124:127]
  s_waitcnt lgkmcnt(1)
  v_exp_f32 v65, v121
  v_mfma_f32_16x16x32_bf16 v[124:127], v[56:59], v[80:83], v[124:127]
  s_waitcnt lgkmcnt(0)
  v_exp_f32 v66, v122
  v_exp_f32 v67, v123
  v_cvt_pk_bf16_f32 v100, v60, v64
  v_cvt_pk_bf16_f32 v101, v61, v65
  v_cvt_pk_bf16_f32 v102, v62, v66
  v_cvt_pk_bf16_f32 v103, v63, v67
  v_exp_f32 v86, v124
  v_mov_b64 v[76:77], 0
  v_mfma_f32_16x16x32_bf16 v[104:107], v[16:19], v[100:103], 0
  v_exp_f32 v87, v126
  v_mfma_f32_16x16x32_bf16 v[108:111], v[92:95], v[100:103], 0
  v_cvt_pk_bf16_f32 v90, v86, v86
  v_cvt_pk_bf16_f32 v91, v87, v87
  v_mfma_f32_16x16x32_bf16 v[112:115], v[96:99], v[100:103], 0
  v_mov_b64 v[78:79], 0
  v_mov_b64 v[80:81], 0
  v_mfma_f32_16x16x16_bf16 v[36:39], v[16:17], v[90:91], 0
  v_mov_b64 v[82:83], 0
  v_mfma_f32_16x16x16_bf16 v[108:111], v[84:85], v[90:91], v[108:111]
  v_mfma_f32_16x16x16_bf16 v[112:115], v[88:89], v[90:91], v[112:115]
  v_fma_f32 v106, v38, 0.5, v106
  v_rcp_f32 v107, v106
  v_mov_b32 v13, 0
  v_mul_f32 v108, v108, v107
  v_mul_f32 v109, v109, v107
  v_mul_f32 v110, v110, v107
  v_mul_f32 v111, v111, v107
  v_cvt_pk_bf16_f32 v100, v108, v109
  v_cvt_pk_bf16_f32 v101, v110, v111
  v_mul_f32 v112, v112, v107
  v_mul_f32 v113, v113, v107
  v_mul_f32 v114, v114, v107
  v_mul_f32 v115, v115, v107
  v_cvt_pk_bf16_f32 v102, v112, v113
  v_cvt_pk_bf16_f32 v103, v114, v115
  v_cndmask_b32 v36, v100, v102, s[84:85]
  v_cndmask_b32 v37, v101, v103, s[84:85]
  ds_write_b64 v10, v[36:37]
  v_max_f32 v104, v106, v107
  v_cmp_nge_f32 vcc, s86, v104
  v_mov_b64 v[44:45], 0
  v_mov_b64 v[46:47], 0
  v_mov_b64 v[48:49], 0
  v_mov_b64 v[50:51], 0
  s_cbranch_vccnz L_smr_f0_0
L_sm_f0_0:
  v_smfmac_f32_16x16x64_bf16 v[76:79], v[100:103], v[128:135], v11
  s_waitcnt lgkmcnt(0)
  s_barrier
  ds_read_b128 v[60:63], v8 offset:5120
  v_smfmac_f32_16x16x64_bf16 v[80:83], v[100:103], v[160:167], v11
  ds_read_b128 v[64:67], v8 offset:6144
  v_mov_b64 v[84:85], 0
  v_smfmac_f32_16x16x64_bf16 v[44:47], v[100:103], v[192:199], v11
  ds_read_b128 v[40:43], v8 offset:7168
  v_mov_b64 v[86:87], 0
  v_smfmac_f32_16x16x64_bf16 v[48:51], v[100:103], v[216:223], v11
  ds_read_b128 v[92:95], v3 offset:0
  s_waitcnt lgkmcnt(3)
  v_smfmac_f32_16x16x64_bf16 v[76:79], v[60:63], v[136:143], v11
  ds_read_b128 v[96:99], v3 offset:1024
  s_waitcnt lgkmcnt(3)
  v_smfmac_f32_16x16x64_bf16 v[76:79], v[64:67], v[144:151], v11
  ds_read_b128 v[52:55], v3 offset:8192
  s_waitcnt lgkmcnt(3)
  v_smfmac_f32_16x16x64_bf16 v[76:79], v[40:43], v[152:159], v11
  ds_read_b128 v[56:59], v3 offset:9216
  v_mov_b64 v[88:89], 0
  v_smfmac_f32_16x16x64_bf16 v[80:83], v[60:63], v[168:175], v11
  ds_read_b128 v[68:71], v3 offset:16384
  v_mov_b64 v[90:91], 0
  v_smfmac_f32_16x16x64_bf16 v[80:83], v[64:67], v[176:183], v11
  ds_read_b128 v[72:75], v3 offset:17408
  v_cvt_pk_bf16_f32 v76, v76, v77
  v_cvt_pk_bf16_f32 v77, v78, v79
  v_and_b32 v76, -2, v76
  v_smfmac_f32_16x16x64_bf16 v[80:83], v[40:43], v[184:191], v11
  s_waitcnt lgkmcnt(2)
  buffer_store_dwordx2 v[76:77], v5, s[36:39], 0 offen
  v_smfmac_f32_16x16x64_bf16 v[44:47], v[60:63], v[200:207], v11
  ds_read_b128 v[116:119], v3 offset:24576
  v_mov_b64 v[76:77], 0
  v_mov_b64 v[78:79], 0
  v_smfmac_f32_16x16x64_bf16 v[44:47], v[64:67], v[208:215], v11
  ds_read_b128 v[120:123], v3 offset:25600
  v_cvt_pk_bf16_f32 v80, v80, v81
  v_cvt_pk_bf16_f32 v81, v82, v83
  v_and_b32 v80, -2, v80
  v_smfmac_f32_16x16x64_bf16 v[44:47], v[40:43], v[92:99], v11
  buffer_store_dwordx2 v[80:81], v5, s[36:39], s74 offen
  v_smfmac_f32_16x16x64_bf16 v[48:51], v[60:63], v[52:59], v11
  s_waitcnt lgkmcnt(2)
  v_mov_b64 v[80:81], 0
  v_mov_b64 v[82:83], 0
  v_smfmac_f32_16x16x64_bf16 v[48:51], v[64:67], v[68:75], v11
  s_waitcnt lgkmcnt(0)
  v_cvt_pk_bf16_f32 v44, v44, v45
  v_cvt_pk_bf16_f32 v45, v46, v47
  v_and_b32 v44, -2, v44
  v_smfmac_f32_16x16x64_bf16 v[48:51], v[40:43], v[116:123], v11
  buffer_store_dwordx2 v[44:45], v5, s[36:39], s76 offen
  v_mov_b64 v[68:69], 0
  v_mov_b64 v[70:71], 0
  v_mov_b32 v13, 0
  v_mov_b32 v13, 0
  v_cvt_pk_bf16_f32 v48, v48, v49
  v_cvt_pk_bf16_f32 v49, v50, v51
  v_and_b32 v48, -2, v48
  buffer_store_dwordx2 v[48:49], v5, s[36:39], s65 offen
  v_mov_b64 v[72:73], 0
  v_mov_b64 v[74:75], 0
L_gap_gp00_6_27:
  s_nop 5
  s_nop 5
  s_nop 5
  s_nop 5
  s_nop 5
  s_nop 4
  buffer_load_dwordx4 v[108:111], v1, s[36:39], s64 offen offset:0 sc1
  buffer_load_dwordx4 v[112:115], v1, s[36:39], s64 offen offset:1024 sc1
  s_waitcnt vmcnt(10)
  ds_write_b128 v2, v[20:23] offset:40960
  s_waitcnt vmcnt(9)
  ds_write_b128 v2, v[24:27] offset:41984
  s_waitcnt vmcnt(8)
  ds_write_b128 v2, v[28:31] offset:49152
  s_waitcnt vmcnt(6)
  ds_write_b128 v2, v[32:35] offset:50176
  ds_read_b128 v[44:47], v1 offset:0
  ds_read_b128 v[48:51], v1 offset:1024
  ds_read_b128 v[52:55], v1 offset:8192
  ds_read_b128 v[56:59], v1 offset:9216
.p2align 5
  s_nop 0
  s_nop 0
  s_nop 0
  s_nop 0
  s_waitcnt vmcnt(1)
  v_mfma_f32_16x16x32_bf16 v[124:127], v[16:19], v[108:111], 0
  v_bitop3_b32 v15, v108, v110, 1 bitop3:0xa8
  v_lshlrev_b32 v15, 1, v15
  s_waitcnt vmcnt(0)
  v_mfma_f32_16x16x32_bf16 v[124:127], v[16:19], v[112:115], v[124:127]
  v_bitop3_b32 v13, v112, v114, 1 bitop3:0xa8
  v_cmp_ne_u32 vcc, v13, v15
  s_cbranch_vccnz L_pb_f0_0r
L_pb_f0_0:
  v_add_f32_dpp v124, v124, v124 row_ror:4 row_mask:0xf bank_mask:0xf
  v_add_f32_dpp v125, v125, v125 row_ror:4 row_mask:0xf bank_mask:0xf
  s_nop 0
  v_add_f32_dpp v124, v124, v124 row_ror:8 row_mask:0xf bank_mask:0xf
  v_add_f32_dpp v125, v125, v125 row_ror:8 row_mask:0xf bank_mask:0xf
  v_cvt_pk_bf16_f32 v14, v124, v125
  v_min_u32 v14, -2, v14
  buffer_store_dword v14, v6, s[36:39], s87 offen
  s_mov_b32 s72, s79
  s_add_u32 s79, s79, 8192
  s_cmp_eq_u32 s68, 62
  s_cbranch_scc1 L_chain_done
  s_add_u32 s68, s68, 2
  v_cmp_ne_u32 vcc, 1, v12
  v_mov_b32 v124, -1
  buffer_store_dword v124, v6, s[36:39], s71 offen
  s_cbranch_vccnz L_flr_f0_0
L_fl_f0_0:
  s_xor_b32 s71, s71, 0x4000
  s_mov_b32 s75, s71
  s_add_u32 s92, s75, 0x1000
  ds_read_b128 v[60:63], v1 offset:16384
  ds_read_b128 v[64:67], v1 offset:17408
  ds_read_b128 v[92:95], v1 offset:24576
  ds_read_b128 v[96:99], v1 offset:25600
  ds_read_b128 v[100:103], v1 offset:32768
  ds_read_b128 v[104:107], v1 offset:33792
L_gap_gp01_3_28:
  s_nop 10
  s_nop 10
  s_nop 9
  buffer_load_dwordx4 v[36:39], v9, s[36:39], s87 offen offset:0 sc1
  buffer_load_dwordx4 v[40:43], v9, s[36:39], s87 offen offset:2048 sc1
  ds_read_b128 v[116:119], v1 offset:40960
  ds_read_b128 v[120:123], v1 offset:41984
  ds_read_b128 v[20:23], v1 offset:49152
  ds_read_b128 v[24:27], v1 offset:50176
  ds_read_b128 v[28:31], v1 offset:57344
  ds_read_b128 v[32:35], v1 offset:58368
  s_waitcnt vmcnt(4)
  ds_read_b128 v[108:111], v2 offset:0
  ds_read_b128 v[112:115], v2 offset:1024
.p2align 5
  s_nop 0
  s_nop 0
  s_nop 0
  s_nop 0
L_step_f0_1:
  s_waitcnt lgkmcnt(0)
  s_waitcnt vmcnt(0)
  v_max_u32 v15, v39, v43
  v_cmp_eq_u32 vcc, -1, v15
  ds_write_b64 v2, v[36:37] offset:32768
  s_cbranch_vccnz L_er0_f0_1
L_eb0_f0_1:
  v_smfmac_f32_16x16x64_bf16 v[88:91], v[36:39], v[44:51], v11
  ds_write_b64 v2, v[38:39] offset:32776
  v_smfmac_f32_16x16x64_bf16 v[88:91], v[40:43], v[52:59], v11
  ds_write_b64 v2, v[40:41] offset:33792
  v_smfmac_f32_16x16x64_bf16 v[84:87], v[36:39], v[60:67], v11
  ds_write_b64 v2, v[42:43] offset:33800
  v_smfmac_f32_16x16x64_bf16 v[84:87], v[40:43], v[92:99], v11
  s_add_u32 s69, s69, 16384
  s_add_u32 s78, s69, 8192
  v_smfmac_f32_16x16x64_bf16 v[80:83], v[36:39], v[100:107], v11
  s_add_u32 s70, s70, 2048
  s_min_u32 s70, s70, s77
  v_smfmac_f32_16x16x64_bf16 v[80:83], v[40:43], v[116:123], v11
  v_smfmac_f32_16x16x64_bf16 v[76:79], v[36:39], v[20:27], v11
  s_waitcnt lgkmcnt(0)
  s_barrier
  ds_read_b128 v[44:47], v4 offset:2048
  v_smfmac_f32_16x16x64_bf16 v[76:79], v[40:43], v[28:35], v11
  ds_read_b128 v[48:51], v4 offset:3072
  v_smfmac_f32_16x16x64_bf16 v[72:75], v[36:39], a[8:15], v11
  ds_read_b128 v[52:55], v4 offset:4096
  v_smfmac_f32_16x16x64_bf16 v[72:75], v[40:43], a[24:31], v11
  ds_read_b128 v[56:59], v4 offset:5120
  v_smfmac_f32_16x16x64_bf16 v[68:71], v[36:39], a[0:7], v11
  ds_read_b128 v[60:63], v4 offset:6144
  v_smfmac_f32_16x16x64_bf16 v[68:71], v[40:43], a[16:23], v11
  ds_read_b128 v[64:67], v4 offset:7168
  s_waitcnt lgkmcnt(5)
  v_smfmac_f32_16x16x64_bf16 v[68:71], v[44:47], a[32:39], v11
  s_waitcnt lgkmcnt(4)
  buffer_store_dword v14, v6, s[36:39], s72 offen sc1
  v_smfmac_f32_16x16x64_bf16 v[68:71], v[48:51], a[48:55], v11
  ds_read_b128 v[92:95], v2 offset:8192
  s_waitcnt lgkmcnt(4)
  v_smfmac_f32_16x16x64_bf16 v[68:71], v[52:55], a[64:71], v11
  ds_read_b128 v[96:99], v2 offset:9216
  s_waitcnt lgkmcnt(4)
  v_smfmac_f32_16x16x64_bf16 v[68:71], v[56:59], a[80:87], v11
  ds_read_b128 v[100:103], v2 offset:16384
  s_waitcnt lgkmcnt(4)
  v_smfmac_f32_16x16x64_bf16 v[68:71], v[60:63], a[96:103], v11
  buffer_load_dwordx4 v[20:23], v1, s[36:39], s69 offen offset:0 sc1
  s_waitcnt lgkmcnt(3)
  v_smfmac_f32_16x16x64_bf16 v[68:71], v[64:67], a[112:119], v11
  ds_read_b128 v[104:107], v2 offset:17408
  v_smfmac_f32_16x16x64_bf16 v[72:75], v[44:47], a[40:47], v11
  ds_read_b128 v[116:119], v2 offset:24576
  v_smfmac_f32_16x16x64_bf16 v[72:75], v[48:51], a[56:63], v11
  ds_read_b128 v[120:123], v2 offset:25600
  v_add_f32 v124, v68, v69
  v_smfmac_f32_16x16x64_bf16 v[72:75], v[52:55], a[72:79], v11
  buffer_load_dwordx4 v[24:27], v1, s[36:39], s69 offen offset:1024 sc1
  v_add_f32 v126, v70, v71
  v_smfmac_f32_16x16x64_bf16 v[72:75], v[56:59], a[88:95], v11
  v_mul_f32 v124, s73, v124
  v_smfmac_f32_16x16x64_bf16 v[72:75], v[60:63], a[104:111], v11
  v_mul_f32 v126, s73, v126
  v_smfmac_f32_16x16x64_bf16 v[72:75], v[64:67], a[120:127], v11
  s_waitcnt lgkmcnt(0) vmcnt(3)
  v_smfmac_f32_16x16x64_bf16 v[76:79], v[44:47], v[108:115], v11
  buffer_load_dwordx4 v[28:31], v1, s[36:39], s78 offen offset:0 sc1
  v_smfmac_f32_16x16x64_bf16 v[76:79], v[48:51], v[92:99], v11
  ds_read_b128 v[92:95], v4 offset:8192
  v_add_f32 v125, v72, v73
  v_smfmac_f32_16x16x64_bf16 v[76:79], v[52:55], v[100:107], v11
  ds_read_b128 v[96:99], v4 offset:10240
  v_add_f32 v127, v74, v75
  v_smfmac_f32_16x16x64_bf16 v[76:79], v[56:59], v[116:123], v11
  ds_read_b128 v[100:103], v4 offset:12288
  v_mul_f32 v125, s73, v125
  v_smfmac_f32_16x16x64_bf16 v[76:79], v[60:63], a[160:167], v11
  ds_read_b128 v[104:107], v4 offset:14336
  v_mul_f32 v127, s73, v127
  v_smfmac_f32_16x16x64_bf16 v[76:79], v[64:67], a[176:183], v11
  ds_read_b128 v[108:111], v4 offset:9216
  v_cvt_pk_bf16_f32 v124, v124, v125
  v_smfmac_f32_16x16x64_bf16 v[80:83], v[44:47], a[128:135], v11
  ds_read_b128 v[112:115], v4 offset:11264
  v_cvt_pk_bf16_f32 v125, v126, v127
  v_smfmac_f32_16x16x64_bf16 v[80:83], v[48:51], a[136:143], v11
  ds_write2_b32 v7, v124, v125 offset0:0 offset1:4
  v_smfmac_f32_16x16x64_bf16 v[80:83], v[52:55], a[144:151], v11
  ds_read_b128 v[36:39], v4 offset:13312
  v_add_f32 v120, v76, v77
  v_smfmac_f32_16x16x64_bf16 v[80:83], v[56:59], a[152:159], v11
  ds_read_b128 v[40:43], v4 offset:15360
  v_add_f32 v122, v78, v79
  v_smfmac_f32_16x16x64_bf16 v[80:83], v[60:63], a[168:175], v11
  buffer_load_dword v12, off, s[36:39], s70 sc1
  v_smfmac_f32_16x16x64_bf16 v[80:83], v[64:67], a[184:191], v11
  s_waitcnt lgkmcnt(2)
  s_barrier
  v_smfmac_f32_16x16x64_bf16 v[84:87], v[44:47], a[192:199], v11
  ds_read_b128 v[68:71], v8 offset:0
  v_smfmac_f32_16x16x64_bf16 v[84:87], v[48:51], a[208:215], v11
  ds_read_b128 v[72:75], v8 offset:1024
  v_add_f32 v121, v80, v81
  v_smfmac_f32_16x16x64_bf16 v[84:87], v[52:55], a[224:231], v11
  ds_read_b128 v[76:79], v8 offset:2048
  v_add_f32 v123, v82, v83
  v_smfmac_f32_16x16x64_bf16 v[84:87], v[56:59], a[240:247], v11
  ds_read_b128 v[80:83], v8 offset:3072
  v_cvt_pk_bf16_f32 v120, v120, v121
  v_smfmac_f32_16x16x64_bf16 v[84:87], v[60:63], v[224:231], v11
  buffer_load_dwordx4 v[32:35], v1, s[36:39], s78 offen offset:1024 sc1
  v_cvt_pk_bf16_f32 v121, v122, v123
  v_smfmac_f32_16x16x64_bf16 v[84:87], v[64:67], v[240:247], v11
  ds_write2_b32 v7, v120, v121 offset0:128 offset1:132
  v_smfmac_f32_16x16x64_bf16 v[88:91], v[44:47], a[200:207], v11
  v_smfmac_f32_16x16x64_bf16 v[88:91], v[48:51], a[216:223], v11
  v_cvt_pk_bf16_f32 v84, v84, v85
  v_smfmac_f32_16x16x64_bf16 v[88:91], v[52:55], a[232:239], v11
  v_cvt_pk_bf16_f32 v85, v86, v87
  v_smfmac_f32_16x16x64_bf16 v[88:91], v[56:59], a[248:255], v11
  v_smfmac_f32_16x16x64_bf16 v[88:91], v[60:63], v[232:239], v11
  s_waitcnt lgkmcnt(0)
  s_barrier
  v_smfmac_f32_16x16x64_bf16 v[88:91], v[64:67], v[248:255], v11
  ds_read_b128 v[44:47], v8 offset:512
  v_mfma_f32_16x16x32_bf16 v[116:119], v[92:95], v[68:71], 0
  ds_read_b128 v[92:95], v2 offset:49152
  v_mfma_f32_16x16x32_bf16 v[116:119], v[96:99], v[72:75], v[116:119]
  ds_read_b128 v[48:51], v8 offset:1536
  v_cvt_pk_bf16_f32 v88, v88, v89
  v_mfma_f32_16x16x32_bf16 v[116:119], v[100:103], v[76:79], v[116:119]
  ds_read_b128 v[52:55], v8 offset:2560
  v_cvt_pk_bf16_f32 v89, v90, v91
  v_mfma_f32_16x16x32_bf16 v[116:119], v[104:107], v[80:83], v[116:119]
  ds_read_b128 v[56:59], v8 offset:3584
  v_mfma_f32_16x16x32_bf16 v[120:123], v[108:111], v[68:71], 0
  ds_read_b128 v[96:99], v2 offset:50176
  v_mfma_f32_16x16x32_bf16 v[120:123], v[112:115], v[72:75], v[120:123]
  v_exp_f32 v60, v116
  v_mfma_f32_16x16x32_bf16 v[120:123], v[36:39], v[76:79], v[120:123]
  v_exp_f32 v61, v117
  v_mfma_f32_16x16x32_bf16 v[120:123], v[40:43], v[80:83], v[120:123]
  s_waitcnt lgkmcnt(5)
  v_exp_f32 v62, v118
  v_mfma_f32_16x16x32_bf16 v[124:127], v[44:47], v[68:71], 0
  s_waitcnt lgkmcnt(3)
  v_exp_f32 v63, v119
  v_mfma_f32_16x16x32_bf16 v[124:127], v[48:51], v[72:75], v[124:127]
  s_waitcnt lgkmcnt(2)
  v_exp_f32 v64, v120
  v_mfma_f32_16x16x32_bf16 v[124:127], v[52:55], v[76:79], v[124:127]
  s_waitcnt lgkmcnt(1)
  v_exp_f32 v65, v121
  v_mfma_f32_16x16x32_bf16 v[124:127], v[56:59], v[80:83], v[124:127]
  s_waitcnt lgkmcnt(0)
  v_exp_f32 v66, v122
  v_exp_f32 v67, v123
  v_cvt_pk_bf16_f32 v100, v60, v64
  v_cvt_pk_bf16_f32 v101, v61, v65
  v_cvt_pk_bf16_f32 v102, v62, v66
  v_cvt_pk_bf16_f32 v103, v63, v67
  v_exp_f32 v86, v124
  v_mov_b64 v[76:77], 0
  v_mfma_f32_16x16x32_bf16 v[104:107], v[16:19], v[100:103], 0
  v_exp_f32 v87, v126
  v_mfma_f32_16x16x32_bf16 v[108:111], v[92:95], v[100:103], 0
  v_cvt_pk_bf16_f32 v90, v86, v86
  v_cvt_pk_bf16_f32 v91, v87, v87
  v_mfma_f32_16x16x32_bf16 v[112:115], v[96:99], v[100:103], 0
  v_mov_b64 v[78:79], 0
  v_mov_b64 v[80:81], 0
  v_mfma_f32_16x16x16_bf16 v[36:39], v[16:17], v[90:91], 0
  v_mov_b64 v[82:83], 0
  v_mfma_f32_16x16x16_bf16 v[108:111], v[84:85], v[90:91], v[108:111]
  v_mfma_f32_16x16x16_bf16 v[112:115], v[88:89], v[90:91], v[112:115]
  v_fma_f32 v106, v38, 0.5, v106
  v_rcp_f32 v107, v106
  v_mov_b32 v13, 0
  v_mul_f32 v108, v108, v107
  v_mul_f32 v109, v109, v107
  v_mul_f32 v110, v110, v107
  v_mul_f32 v111, v111, v107
  v_cvt_pk_bf16_f32 v100, v108, v109
  v_cvt_pk_bf16_f32 v101, v110, v111
  v_mul_f32 v112, v112, v107
  v_mul_f32 v113, v113, v107
  v_mul_f32 v114, v114, v107
  v_mul_f32 v115, v115, v107
  v_cvt_pk_bf16_f32 v102, v112, v113
  v_cvt_pk_bf16_f32 v103, v114, v115
  v_cndmask_b32 v36, v100, v102, s[84:85]
  v_cndmask_b32 v37, v101, v103, s[84:85]
  ds_write_b64 v10, v[36:37]
  v_max_f32 v104, v106, v107
  v_cmp_nge_f32 vcc, s86, v104
  v_mov_b64 v[44:45], 0
  v_mov_b64 v[46:47], 0
  v_mov_b64 v[48:49], 0
  v_mov_b64 v[50:51], 0
  s_cbranch_vccnz L_smr_f0_1
L_sm_f0_1:
  v_smfmac_f32_16x16x64_bf16 v[76:79], v[100:103], v[128:135], v11
  s_waitcnt lgkmcnt(0)
  s_barrier
  ds_read_b128 v[60:63], v8 offset:5120
  v_smfmac_f32_16x16x64_bf16 v[80:83], v[100:103], v[160:167], v11
  ds_read_b128 v[64:67], v8 offset:6144
  v_mov_b64 v[84:85], 0
  v_smfmac_f32_16x16x64_bf16 v[44:47], v[100:103], v[192:199], v11
  ds_read_b128 v[40:43], v8 offset:7168
  v_mov_b64 v[86:87], 0
  v_smfmac_f32_16x16x64_bf16 v[48:51], v[100:103], v[216:223], v11
  ds_read_b128 v[92:95], v3 offset:0
  s_waitcnt lgkmcnt(3)
  v_smfmac_f32_16x16x64_bf16 v[76:79], v[60:63], v[136:143], v11
  ds_read_b128 v[96:99], v3 offset:1024
  s_waitcnt lgkmcnt(3)
  v_smfmac_f32_16x16x64_bf16 v[76:79], v[64:67], v[144:151], v11
  ds_read_b128 v[52:55], v3 offset:8192
  s_waitcnt lgkmcnt(3)
  v_smfmac_f32_16x16x64_bf16 v[76:79], v[40:43], v[152:159], v11
  ds_read_b128 v[56:59], v3 offset:9216
  v_mov_b64 v[88:89], 0
  v_smfmac_f32_16x16x64_bf16 v[80:83], v[60:63], v[168:175], v11
  ds_read_b128 v[68:71], v3 offset:16384
  v_mov_b64 v[90:91], 0
  v_smfmac_f32_16x16x64_bf16 v[80:83], v[64:67], v[176:183], v11
  ds_read_b128 v[72:75], v3 offset:17408
  v_cvt_pk_bf16_f32 v76, v76, v77
  v_cvt_pk_bf16_f32 v77, v78, v79
  v_or_b32 v76, 1, v76
  v_smfmac_f32_16x16x64_bf16 v[80:83], v[40:43], v[184:191], v11
  s_waitcnt lgkmcnt(2)
  buffer_store_dwordx2 v[76:77], v5, s[36:39], 0 offen
  v_smfmac_f32_16x16x64_bf16 v[44:47], v[60:63], v[200:207], v11
  ds_read_b128 v[116:119], v3 offset:24576
  v_mov_b64 v[76:77], 0
  v_mov_b64 v[78:79], 0
  v_smfmac_f32_16x16x64_bf16 v[44:47], v[64:67], v[208:215], v11
  ds_read_b128 v[120:123], v3 offset:25600
  v_cvt_pk_bf16_f32 v80, v80, v81
  v_cvt_pk_bf16_f32 v81, v82, v83
  v_or_b32 v80, 1, v80
  v_smfmac_f32_16x16x64_bf16 v[44:47], v[40:43], v[92:99], v11
  buffer_store_dwordx2 v[80:81], v5, s[36:39], s74 offen
  v_smfmac_f32_16x16x64_bf16 v[48:51], v[60:63], v[52:59], v11
  s_waitcnt lgkmcnt(2)
  v_mov_b64 v[80:81], 0
  v_mov_b64 v[82:83], 0
  v_smfmac_f32_16x16x64_bf16 v[48:51], v[64:67], v[68:75], v11
  s_waitcnt lgkmcnt(0)
  v_cvt_pk_bf16_f32 v44, v44, v45
  v_cvt_pk_bf16_f32 v45, v46, v47
  v_or_b32 v44, 1, v44
  v_smfmac_f32_16x16x64_bf16 v[48:51], v[40:43], v[116:123], v11
  buffer_store_dwordx2 v[44:45], v5, s[36:39], s76 offen
  v_mov_b64 v[68:69], 0
  v_mov_b64 v[70:71], 0
  v_mov_b32 v13, 0
  v_mov_b32 v13, 0
  v_cvt_pk_bf16_f32 v48, v48, v49
  v_cvt_pk_bf16_f32 v49, v50, v51
  v_or_b32 v48, 1, v48
  buffer_store_dwordx2 v[48:49], v5, s[36:39], s65 offen
  v_mov_b64 v[72:73], 0
  v_mov_b64 v[74:75], 0
L_gap_gp00_6_29:
  s_nop 5
  s_nop 5
  s_nop 5
  s_nop 5
  s_nop 5
  s_nop 4
  buffer_load_dwordx4 v[108:111], v1, s[36:39], s64 offen offset:0 sc1
  buffer_load_dwordx4 v[112:115], v1, s[36:39], s64 offen offset:1024 sc1
  s_waitcnt vmcnt(10)
  ds_write_b128 v2, v[20:23] offset:40960
  s_waitcnt vmcnt(9)
  ds_write_b128 v2, v[24:27] offset:41984
  s_waitcnt vmcnt(8)
  ds_write_b128 v2, v[28:31] offset:49152
  s_waitcnt vmcnt(6)
  ds_write_b128 v2, v[32:35] offset:50176
  ds_read_b128 v[44:47], v1 offset:0
  ds_read_b128 v[48:51], v1 offset:1024
  ds_read_b128 v[52:55], v1 offset:8192
  ds_read_b128 v[56:59], v1 offset:9216
.p2align 5
  s_nop 0
  s_nop 0
  s_nop 0
  s_nop 0
  s_waitcnt vmcnt(1)
  v_mfma_f32_16x16x32_bf16 v[124:127], v[16:19], v[108:111], 0
  v_bitop3_b32 v15, v108, v110, 1 bitop3:0x80
  v_sub_u32 v15, 2, v15
  s_waitcnt vmcnt(0)
  v_mfma_f32_16x16x32_bf16 v[124:127], v[16:19], v[112:115], v[124:127]
  v_bitop3_b32 v13, v112, v114, 1 bitop3:0x80
  v_cmp_ne_u32 vcc, v13, v15
  s_cbranch_vccnz L_pb_f0_1r
L_pb_f0_1:
  v_add_f32_dpp v124, v124, v124 row_ror:4 row_mask:0xf bank_mask:0xf
  v_add_f32_dpp v125, v125, v125 row_ror:4 row_mask:0xf bank_mask:0xf
  s_nop 0
  v_add_f32_dpp v124, v124, v124 row_ror:8 row_mask:0xf bank_mask:0xf
  v_add_f32_dpp v125, v125, v125 row_ror:8 row_mask:0xf bank_mask:0xf
  v_cvt_pk_bf16_f32 v14, v124, v125
  v_min_u32 v14, -2, v14
  buffer_store_dword v14, v6, s[36:39], s71 offen
  s_mov_b32 s72, s79
  s_add_u32 s79, s79, 8192
  v_cmp_ne_u32 vcc, 1, v12
  v_mov_b32 v124, -1
  buffer_store_dword v124, v6, s[36:39], s87 offen
  s_cbranch_vccnz L_flr_f0_1
L_fl_f0_1:
  s_xor_b32 s87, s87, 0x4000
  s_xor_b32 s93, s93, 0x4000
  ds_read_b128 v[60:63], v1 offset:16384
  ds_read_b128 v[64:67], v1 offset:17408
  ds_read_b128 v[92:95], v1 offset:24576
  ds_read_b128 v[96:99], v1 offset:25600
  ds_read_b128 v[100:103], v1 offset:32768
  ds_read_b128 v[104:107], v1 offset:33792
L_gap_gp01_3_30:
  s_nop 10
  s_nop 10
  s_nop 9
  buffer_load_dwordx4 v[36:39], v9, s[36:39], s75 offen offset:0 sc1
  buffer_load_dwordx4 v[40:43], v9, s[36:39], s75 offen offset:2048 sc1
  ds_read_b128 v[116:119], v1 offset:40960
  ds_read_b128 v[120:123], v1 offset:41984
  ds_read_b128 v[20:23], v1 offset:49152
  ds_read_b128 v[24:27], v1 offset:50176
  ds_read_b128 v[28:31], v1 offset:57344
  ds_read_b128 v[32:35], v1 offset:58368
  s_waitcnt vmcnt(4)
  ds_read_b128 v[108:111], v2 offset:0
  ds_read_b128 v[112:115], v2 offset:1024
  s_branch L_step_f0_0
L_er0_f0_0:
  buffer_load_dwordx4 v[36:39], v9, s[36:39], s75 offen offset:0 sc1
  buffer_load_dwordx4 v[40:43], v9, s[36:39], s75 offen offset:2048 sc1
  s_nop 15
  s_nop 7
L_er0_f0_0s:
  buffer_load_dwordx4 v[36:39], v9, s[36:39], s75 offen offset:0 sc1
  buffer_load_dwordx4 v[40:43], v9, s[36:39], s75 offen offset:2048 sc1
  s_waitcnt vmcnt(2)
  v_max_u32 v15, v39, v43
  v_cmp_eq_u32 vcc, -1, v15
  s_cbranch_vccz L_eb0_f0_0o
  s_sub_u32 s3, s3, 1
  s_cbranch_scc1 L_end
  s_branch L_er0_f0_0s
L_eb0_f0_0o:
  ds_write_b64 v2, v[36:37] offset:32768
  s_branch L_eb0_f0_0
L_smr_f0_0:
  v_max_f32 v86, v116, v120
  v_max3_f32 v86, v86, v117, v121
  v_max3_f32 v86, v86, v118, v122
  v_max3_f32 v86, v86, v119, v123
  v_max3_f32 v86, v86, v124, v126
  v_mov_b32 v87, v86
  s_nop 1
  v_permlane32_swap_b32 v86, v87
  v_max_f32 v86, v86, v87
  v_mov_b32 v87, v86
  s_nop 1
  v_permlane16_swap_b32 v86, v87
  v_max_f32 v86, v86, v87
  v_sub_f32 v116, v116, v86
  v_sub_f32 v120, v120, v86
  v_sub_f32 v117, v117, v86
  v_sub_f32 v121, v121, v86
  v_sub_f32 v118, v118, v86
  v_sub_f32 v122, v122, v86
  v_sub_f32 v119, v119, v86
  v_sub_f32 v123, v123, v86
  v_sub_f32 v124, v124, v86
  v_sub_f32 v126, v126, v86
  v_exp_f32 v116, v116
  v_exp_f32 v120, v120
  v_exp_f32 v117, v117
  v_exp_f32 v121, v121
  v_exp_f32 v118, v118
  v_exp_f32 v122, v122
  v_exp_f32 v119, v119
  v_exp_f32 v123, v123
  v_exp_f32 v124, v124
  v_exp_f32 v126, v126
  v_cvt_pk_bf16_f32 v100, v116, v120
  v_cvt_pk_bf16_f32 v101, v117, v121
  v_cvt_pk_bf16_f32 v102, v118, v122
  v_cvt_pk_bf16_f32 v103, v119, v123
  v_cvt_pk_bf16_f32 v90, v124, v124
  v_cvt_pk_bf16_f32 v91, v126, v126
  s_waitcnt lgkmcnt(0)
  v_mov_b64 v[76:77], 0
  v_mov_b64 v[78:79], 0
  v_mfma_f32_16x16x32_bf16 v[104:107], v[16:19], v[100:103], 0
  v_mfma_f32_16x16x32_bf16 v[108:111], v[92:95], v[100:103], 0
  v_mfma_f32_16x16x32_bf16 v[112:115], v[96:99], v[100:103], 0
  v_mfma_f32_16x16x16_bf16 v[36:39], v[16:17], v[90:91], 0
  v_mfma_f32_16x16x16_bf16 v[108:111], v[84:85], v[90:91], v[108:111]
  v_mfma_f32_16x16x16_bf16 v[112:115], v[88:89], v[90:91], v[112:115]
  v_fma_f32 v106, v38, 0.5, v106
  v_rcp_f32 v107, v106
  s_nop 0
  v_mul_f32 v108, v108, v107
  v_mul_f32 v109, v109, v107
  v_mul_f32 v110, v110, v107
  v_mul_f32 v111, v111, v107
  v_cvt_pk_bf16_f32 v100, v108, v109
  v_cvt_pk_bf16_f32 v101, v110, v111
  v_mul_f32 v112, v112, v107
  v_mul_f32 v113, v113, v107
  v_mul_f32 v114, v114, v107
  v_mul_f32 v115, v115, v107
  v_cvt_pk_bf16_f32 v102, v112, v113
  v_cvt_pk_bf16_f32 v103, v114, v115
  v_cndmask_b32 v36, v100, v102, s[84:85]
  v_cndmask_b32 v37, v101, v103, s[84:85]
  ds_write_b64 v10, v[36:37]
  s_branch L_sm_f0_0
L_pb_f0_0r:
  buffer_load_dwordx4 v[108:111], v1, s[36:39], s64 offen offset:0 sc1
  buffer_load_dwordx4 v[112:115], v1, s[36:39], s64 offen offset:1024 sc1
  s_nop 15
  s_nop 7
L_pb_f0_0s:
  buffer_load_dwordx4 v[36:39], v1, s[36:39], s64 offen offset:0 sc1
  buffer_load_dwordx4 v[40:43], v1, s[36:39], s64 offen offset:1024 sc1
  s_waitcnt vmcnt(3)
  v_mfma_f32_16x16x32_bf16 v[124:127], v[16:19], v[108:111], 0
  v_bitop3_b32 v15, v108, v110, 1 bitop3:0xa8
  v_lshlrev_b32 v15, 1, v15
  s_waitcnt vmcnt(2)
  v_mfma_f32_16x16x32_bf16 v[124:127], v[16:19], v[112:115], v[124:127]
  v_bitop3_b32 v13, v112, v114, 1 bitop3:0xa8
  v_cmp_ne_u32 vcc, v13, v15
  s_cbranch_vccz L_pb_f0_0
  buffer_load_dwordx4 v[108:111], v1, s[36:39], s64 offen offset:0 sc1
  buffer_load_dwordx4 v[112:115], v1, s[36:39], s64 offen offset:1024 sc1
  s_waitcnt vmcnt(3)
  v_mfma_f32_16x16x32_bf16 v[124:127], v[16:19], v[36:39], 0
  v_bitop3_b32 v15, v36, v38, 1 bitop3:0xa8
  v_lshlrev_b32 v15, 1, v15
  s_waitcnt vmcnt(2)
  v_mfma_f32_16x16x32_bf16 v[124:127], v[16:19], v[40:43], v[124:127]
  v_bitop3_b32 v13, v40, v42, 1 bitop3:0xa8
  v_cmp_ne_u32 vcc, v13, v15
  s_cbranch_vccz L_pb_f0_0
  s_sub_u32 s3, s3, 1
  s_cbranch_scc1 L_end
  s_branch L_pb_f0_0s
L_flr_f0_0:
L_spin_31:
  buffer_load_dword v12, off, s[36:39], s70 sc1
  s_waitcnt vmcnt(0)
  v_cmp_ne_u32 vcc, 1, v12
  s_cbranch_vccz L_ok_32
  s_sub_u32 s3, s3, 1
  s_cbranch_scc1 L_end
  s_sleep 2
  s_branch L_spin_31
L_ok_32:
  s_branch L_fl_f0_0
L_er0_f0_1:
  buffer_load_dwordx4 v[36:39], v9, s[36:39], s87 offen offset:0 sc1
  buffer_load_dwordx4 v[40:43], v9, s[36:39], s87 offen offset:2048 sc1
  s_nop 15
  s_nop 7
L_er0_f0_1s:
  buffer_load_dwordx4 v[36:39], v9, s[36:39], s87 offen offset:0 sc1
  buffer_load_dwordx4 v[40:43], v9, s[36:39], s87 offen offset:2048 sc1
  s_waitcnt vmcnt(2)
  v_max_u32 v15, v39, v43
  v_cmp_eq_u32 vcc, -1, v15
  s_cbranch_vccz L_eb0_f0_1o
  s_sub_u32 s3, s3, 1
  s_cbranch_scc1 L_end
  s_branch L_er0_f0_1s
L_eb0_f0_1o:
  ds_write_b64 v2, v[36:37] offset:32768
  s_branch L_eb0_f0_1
L_smr_f0_1:
  v_max_f32 v86, v116, v120
  v_max3_f32 v86, v86, v117, v121
  v_max3_f32 v86, v86, v118, v122
  v_max3_f32 v86, v86, v119, v123
  v_max3_f32 v86, v86, v124, v126
  v_mov_b32 v87, v86
  s_nop 1
  v_permlane32_swap_b32 v86, v87
  v_max_f32 v86, v86, v87
  v_mov_b32 v87, v86
  s_nop 1
  v_permlane16_swap_b32 v86, v87
  v_max_f32 v86, v86, v87
  v_sub_f32 v116, v116, v86
  v_sub_f32 v120, v120, v86
  v_sub_f32 v117, v117, v86
  v_sub_f32 v121, v121, v86
  v_sub_f32 v118, v118, v86
  v_sub_f32 v122, v122, v86
  v_sub_f32 v119, v119, v86
  v_sub_f32 v123, v123, v86
  v_sub_f32 v124, v124, v86
  v_sub_f32 v126, v126, v86
  v_exp_f32 v116, v116
  v_exp_f32 v120, v120
  v_exp_f32 v117, v117
  v_exp_f32 v121, v121
  v_exp_f32 v118, v118
  v_exp_f32 v122, v122
  v_exp_f32 v119, v119
  v_exp_f32 v123, v123
  v_exp_f32 v124, v124
  v_exp_f32 v126, v126
  v_cvt_pk_bf16_f32 v100, v116, v120
  v_cvt_pk_bf16_f32 v101, v117, v121
  v_cvt_pk_bf16_f32 v102, v118, v122
  v_cvt_pk_bf16_f32 v103, v119, v123
  v_cvt_pk_bf16_f32 v90, v124, v124
  v_cvt_pk_bf16_f32 v91, v126, v126
  s_waitcnt lgkmcnt(0)
  v_mov_b64 v[76:77], 0
  v_mov_b64 v[78:79], 0
  v_mfma_f32_16x16x32_bf16 v[104:107], v[16:19], v[100:103], 0
  v_mfma_f32_16x16x32_bf16 v[108:111], v[92:95], v[100:103], 0
  v_mfma_f32_16x16x32_bf16 v[112:115], v[96:99], v[100:103], 0
  v_mfma_f32_16x16x16_bf16 v[36:39], v[16:17], v[90:91], 0
  v_mfma_f32_16x16x16_bf16 v[108:111], v[84:85], v[90:91], v[108:111]
  v_mfma_f32_16x16x16_bf16 v[112:115], v[88:89], v[90:91], v[112:115]
  v_fma_f32 v106, v38, 0.5, v106
  v_rcp_f32 v107, v106
  s_nop 0
  v_mul_f32 v108, v108, v107
  v_mul_f32 v109, v109, v107
  v_mul_f32 v110, v110, v107
  v_mul_f32 v111, v111, v107
  v_cvt_pk_bf16_f32 v100, v108, v109
  v_cvt_pk_bf16_f32 v101, v110, v111
  v_mul_f32 v112, v112, v107
  v_mul_f32 v113, v113, v107
  v_mul_f32 v114, v114, v107
  v_mul_f32 v115, v115, v107
  v_cvt_pk_bf16_f32 v102, v112, v113
  v_cvt_pk_bf16_f32 v103, v114, v115
  v_cndmask_b32 v36, v100, v102, s[84:85]
  v_cndmask_b32 v37, v101, v103, s[84:85]
  ds_write_b64 v10, v[36:37]
  s_branch L_sm_f0_1
L_pb_f0_1r:
  buffer_load_dwordx4 v[108:111], v1, s[36:39], s64 offen offset:0 sc1
  buffer_load_dwordx4 v[112:115], v1, s[36:39], s64 offen offset:1024 sc1
  s_nop 15
  s_nop 7
L_pb_f0_1s:
  buffer_load_dwordx4 v[36:39], v1, s[36:39], s64 offen offset:0 sc1
  buffer_load_dwordx4 v[40:43], v1, s[36:39], s64 offen offset:1024 sc1
  s_waitcnt vmcnt(3)
  v_mfma_f32_16x16x32_bf16 v[124:127], v[16:19], v[108:111], 0
  v_bitop3_b32 v15, v108, v110, 1 bitop3:0x80
  v_sub_u32 v15, 2, v15
  s_waitcnt vmcnt(2)
  v_mfma_f32_16x16x32_bf16 v[124:127], v[16:19], v[112:115], v[124:127]
  v_bitop3_b32 v13, v112, v114, 1 bitop3:0x80
  v_cmp_ne_u32 vcc, v13, v15
  s_cbranch_vccz L_pb_f0_1
  buffer_load_dwordx4 v[108:111], v1, s[36:39], s64 offen offset:0 sc1
  buffer_load_dwordx4 v[112:115], v1, s[36:39], s64 offen offset:1024 sc1
  s_waitcnt vmcnt(3)
  v_mfma_f32_16x16x32_bf16 v[124:127], v[16:19], v[36:39], 0
  v_bitop3_b32 v15, v36, v38, 1 bitop3:0x80
  v_sub_u32 v15, 2, v15
  s_waitcnt vmcnt(2)
  v_mfma_f32_16x16x32_bf16 v[124:127], v[16:19], v[40:43], v[124:127]
  v_bitop3_b32 v13, v40, v42, 1 bitop3:0x80
  v_cmp_ne_u32 vcc, v13, v15
  s_cbranch_vccz L_pb_f0_1
  s_sub_u32 s3, s3, 1
  s_cbranch_scc1 L_end
  s_branch L_pb_f0_1s
L_flr_f0_1:
L_spin_33:
  buffer_load_dword v12, off, s[36:39], s70 sc1
  s_waitcnt vmcnt(0)
  v_cmp_ne_u32 vcc, 1, v12
  s_cbranch_vccz L_ok_34
  s_sub_u32 s3, s3, 1
  s_cbranch_scc1 L_end
  s_sleep 2
  s_branch L_spin_33
L_ok_34:
  s_branch L_fl_f0_1
.p2align 5
  s_nop 0
  s_nop 0
  s_nop 0
  s_nop 0
L_step_f1_0:
  s_waitcnt lgkmcnt(0)
  s_waitcnt vmcnt(2)
  v_max_u32 v15, v39, v43
  v_cmp_eq_u32 vcc, -1, v15
  ds_write_b64 v2, v[36:37] offset:32768
  s_cbranch_vccnz L_er0_f1_0
L_eb0_f1_0:
  v_smfmac_f32_16x16x64_bf16 v[88:91], v[36:39], v[44:51], v11
  ds_write_b64 v2, v[38:39] offset:32776
  v_smfmac_f32_16x16x64_bf16 v[88:91], v[40:43], v[52:59], v11
  ds_write_b64 v2, v[40:41] offset:33792
  v_smfmac_f32_16x16x64_bf16 v[84:87], v[36:39], v[60:67], v11
  ds_write_b64 v2, v[42:43] offset:33800
  v_smfmac_f32_16x16x64_bf16 v[84:87], v[40:43], v[92:99], v11
  s_add_u32 s69, s69, 16384
  s_add_u32 s78, s69, 8192
  v_smfmac_f32_16x16x64_bf16 v[80:83], v[36:39], v[100:107], v11
  s_add_u32 s70, s70, 2048
  s_min_u32 s70, s70, s77
  v_smfmac_f32_16x16x64_bf16 v[80:83], v[40:43], v[116:123], v11
  v_smfmac_f32_16x16x64_bf16 v[76:79], v[36:39], v[20:27], v11
  s_waitcnt lgkmcnt(0)
  s_barrier
  ds_read_b128 v[44:47], v4 offset:0
  v_smfmac_f32_16x16x64_bf16 v[76:79], v[40:43], v[28:35], v11
  ds_read_b128 v[48:51], v4 offset:1024
  v_smfmac_f32_16x16x64_bf16 v[72:75], v[36:39], a[8:15], v11
  ds_read_b128 v[52:55], v4 offset:6144
  v_smfmac_f32_16x16x64_bf16 v[72:75], v[40:43], a[24:31], v11
  ds_read_b128 v[56:59], v4 offset:7168
  v_smfmac_f32_16x16x64_bf16 v[68:71], v[36:39], a[0:7], v11
  ds_read_b128 v[60:63], v4 offset:4096
  v_smfmac_f32_16x16x64_bf16 v[68:71], v[40:43], a[16:23], v11
  ds_read_b128 v[64:67], v4 offset:5120
  s_waitcnt lgkmcnt(5)
  v_smfmac_f32_16x16x64_bf16 v[68:71], v[44:47], a[32:39], v11
  ds_read_b128 v[92:95], v2 offset:8192
  s_waitcnt lgkmcnt(5)
  v_smfmac_f32_16x16x64_bf16 v[68:71], v[48:51], a[48:55], v11
  s_waitcnt lgkmcnt(4)
  buffer_store_dword v14, v6, s[36:39], s72 offen sc1
  v_smfmac_f32_16x16x64_bf16 v[68:71], v[52:55], a[64:71], v11
  ds_read_b128 v[96:99], v2 offset:9216
  s_waitcnt lgkmcnt(4)
  v_smfmac_f32_16x16x64_bf16 v[68:71], v[56:59], a[80:87], v11
  ds_read_b128 v[100:103], v2 offset:16384
  s_waitcnt lgkmcnt(4)
  v_smfmac_f32_16x16x64_bf16 v[68:71], v[60:63], a[96:103], v11
  ds_read_b128 v[104:107], v2 offset:17408
  s_waitcnt lgkmcnt(4)
  v_smfmac_f32_16x16x64_bf16 v[68:71], v[64:67], a[112:119], v11
  buffer_load_dwordx4 v[20:23], v1, s[36:39], s69 offen offset:0 sc1
  v_smfmac_f32_16x16x64_bf16 v[72:75], v[44:47], a[40:47], v11
  ds_read_b128 v[116:119], v2 offset:24576
  v_smfmac_f32_16x16x64_bf16 v[72:75], v[48:51], a[56:63], v11
  ds_read_b128 v[120:123], v2 offset:25600
  v_add_f32 v124, v68, v69
  v_smfmac_f32_16x16x64_bf16 v[72:75], v[52:55], a[72:79], v11
  v_add_f32 v126, v70, v71
  v_smfmac_f32_16x16x64_bf16 v[72:75], v[56:59], a[88:95], v11
  buffer_load_dwordx4 v[24:27], v1, s[36:39], s69 offen offset:1024 sc1
  v_mul_f32 v124, s73, v124
  v_smfmac_f32_16x16x64_bf16 v[72:75], v[60:63], a[104:111], v11
  v_mul_f32 v126, s73, v126
  v_smfmac_f32_16x16x64_bf16 v[72:75], v[64:67], a[120:127], v11
  s_waitcnt lgkmcnt(0) vmcnt(3)
  v_smfmac_f32_16x16x64_bf16 v[76:79], v[44:47], v[108:115], v11
  ds_read_b128 v[108:111], v4 offset:9216
  v_smfmac_f32_16x16x64_bf16 v[76:79], v[48:51], v[92:99], v11
  buffer_load_dwordx4 v[28:31], v1, s[36:39], s78 offen offset:0 sc1
  v_add_f32 v125, v72, v73
  v_smfmac_f32_16x16x64_bf16 v[76:79], v[52:55], v[100:107], v11
  ds_read_b128 v[92:95], v4 offset:8192
  v_add_f32 v127, v74, v75
  v_smfmac_f32_16x16x64_bf16 v[76:79], v[56:59], v[116:123], v11
  ds_read_b128 v[96:99], v4 offset:10240
  v_mul_f32 v125, s73, v125
  v_smfmac_f32_16x16x64_bf16 v[76:79], v[60:63], a[160:167], v11
  ds_read_b128 v[100:103], v4 offset:12288
  v_mul_f32 v127, s73, v127
  v_smfmac_f32_16x16x64_bf16 v[76:79], v[64:67], a[176:183], v11
  ds_read_b128 v[104:107], v4 offset:14336
  v_cvt_pk_bf16_f32 v124, v124, v125
  v_smfmac_f32_16x16x64_bf16 v[80:83], v[44:47], a[128:135], v11
  ds_read_b128 v[112:115], v4 offset:11264
  v_cvt_pk_bf16_f32 v125, v126, v127
  v_smfmac_f32_16x16x64_bf16 v[80:83], v[48:51], a[136:143], v11
  ds_write2_b32 v7, v124, v125 offset0:0 offset1:4
  v_smfmac_f32_16x16x64_bf16 v[80:83], v[52:55], a[144:151], v11
  ds_read_b128 v[36:39], v4 offset:13312
  v_add_f32 v120, v76, v77
  v_smfmac_f32_16x16x64_bf16 v[80:83], v[56:59], a[152:159], v11
  ds_read_b128 v[40:43], v4 offset:15360
  v_add_f32 v122, v78, v79
  v_smfmac_f32_16x16x64_bf16 v[80:83], v[60:63], a[168:175], v11
  buffer_load_dword v12, off, s[36:39], s70 sc1
  v_smfmac_f32_16x16x64_bf16 v[80:83], v[64:67], a[184:191], v11
  s_waitcnt lgkmcnt(2)
  s_barrier
  v_smfmac_f32_16x16x64_bf16 v[84:87], v[44:47], a[192:199], v11
  ds_read_b128 v[68:71], v8 offset:0
  v_smfmac_f32_16x16x64_bf16 v[84:87], v[48:51], a[208:215], v11
  ds_read_b128 v[72:75], v8 offset:1024
  v_add_f32 v121, v80, v81
  v_smfmac_f32_16x16x64_bf16 v[84:87], v[52:55], a[224:231], v11
  ds_read_b128 v[76:79], v8 offset:2048
  v_add_f32 v123, v82, v83
  v_smfmac_f32_16x16x64_bf16 v[84:87], v[56:59], a[240:247], v11
  ds_read_b128 v[80:83], v8 offset:3072
  v_cvt_pk_bf16_f32 v120, v120, v121
  v_smfmac_f32_16x16x64_bf16 v[84:87], v[60:63], v[224:231], v11
  v_cvt_pk_bf16_f32 v121, v122, v123
  v_smfmac_f32_16x16x64_bf16 v[84:87], v[64:67], v[240:247], v11
  ds_write2_b32 v7, v120, v121 offset0:128 offset1:132
  v_smfmac_f32_16x16x64_bf16 v[88:91], v[44:47], a[200:207], v11
  buffer_load_dwordx4 v[32:35], v1, s[36:39], s78 offen offset:1024 sc1
  v_smfmac_f32_16x16x64_bf16 v[88:91], v[48:51], a[216:223], v11
  v_cvt_pk_bf16_f32 v84, v84, v85
  v_smfmac_f32_16x16x64_bf16 v[88:91], v[52:55], a[232:239], v11
  v_cvt_pk_bf16_f32 v85, v86, v87
  v_smfmac_f32_16x16x64_bf16 v[88:91], v[56:59], a[248:255], v11
  v_smfmac_f32_16x16x64_bf16 v[88:91], v[60:63], v[232:239], v11
  s_waitcnt lgkmcnt(0)
  s_barrier
  v_smfmac_f32_16x16x64_bf16 v[88:91], v[64:67], v[248:255], v11
  ds_read_b128 v[44:47], v8 offset:512
  v_mfma_f32_16x16x32_bf16 v[116:119], v[92:95], v[68:71], 0
  ds_read_b128 v[92:95], v2 offset:49152
  v_mfma_f32_16x16x32_bf16 v[116:119], v[96:99], v[72:75], v[116:119]
  ds_read_b128 v[48:51], v8 offset:1536
  v_cvt_pk_bf16_f32 v88, v88, v89
  v_mfma_f32_16x16x32_bf16 v[116:119], v[100:103], v[76:79], v[116:119]
  ds_read_b128 v[52:55], v8 offset:2560
  v_cvt_pk_bf16_f32 v89, v90, v91
  v_mfma_f32_16x16x32_bf16 v[116:119], v[104:107], v[80:83], v[116:119]
  ds_read_b128 v[56:59], v8 offset:3584
  v_mfma_f32_16x16x32_bf16 v[120:123], v[108:111], v[68:71], 0
  ds_read_b128 v[96:99], v2 offset:50176
  v_mfma_f32_16x16x32_bf16 v[120:123], v[112:115], v[72:75], v[120:123]
  v_exp_f32 v60, v116
  v_mfma_f32_16x16x32_bf16 v[120:123], v[36:39], v[76:79], v[120:123]
  v_exp_f32 v61, v117
  v_mfma_f32_16x16x32_bf16 v[120:123], v[40:43], v[80:83], v[120:123]
  s_waitcnt lgkmcnt(5)
  v_exp_f32 v62, v118
  v_mfma_f32_16x16x32_bf16 v[124:127], v[44:47], v[68:71], 0
  s_waitcnt lgkmcnt(3)
  v_exp_f32 v63, v119
  v_mfma_f32_16x16x32_bf16 v[124:127], v[48:51], v[72:75], v[124:127]
  s_waitcnt lgkmcnt(2)
  v_exp_f32 v64, v120
  v_mfma_f32_16x16x32_bf16 v[124:127], v[52:55], v[76:79], v[124:127]
  s_waitcnt lgkmcnt(1)
  v_exp_f32 v65, v121
  v_mfma_f32_16x16x32_bf16 v[124:127], v[56:59], v[80:83], v[124:127]
  s_waitcnt lgkmcnt(0)
  v_exp_f32 v66, v122
  v_exp_f32 v67, v123
  v_cvt_pk_bf16_f32 v100, v60, v64
  v_cvt_pk_bf16_f32 v101, v61, v65
  v_cvt_pk_bf16_f32 v102, v62, v66
  v_cvt_pk_bf16_f32 v103, v63, v67
  v_exp_f32 v86, v124
  v_mov_b64 v[76:77], 0
  v_mfma_f32_16x16x32_bf16 v[104:107], v[16:19], v[100:103], 0
  v_exp_f32 v87, v126
  v_mfma_f32_16x16x32_bf16 v[108:111], v[92:95], v[100:103], 0
  v_cvt_pk_bf16_f32 v90, v86, v86
  v_cvt_pk_bf16_f32 v91, v87, v87
  v_mfma_f32_16x16x32_bf16 v[112:115], v[96:99], v[100:103], 0
  v_mov_b64 v[78:79], 0
  v_mov_b64 v[80:81], 0
  v_mfma_f32_16x16x16_bf16 v[36:39], v[16:17], v[90:91], 0
  v_mov_b64 v[82:83], 0
  v_mfma_f32_16x16x16_bf16 v[108:111], v[84:85], v[90:91], v[108:111]
  v_mfma_f32_16x16x16_bf16 v[112:115], v[88:89], v[90:91], v[112:115]
  v_fma_f32 v106, v38, 0.5, v106
  v_rcp_f32 v107, v106
  v_mov_b32 v13, 0
  v_mul_f32 v108, v108, v107
  v_mul_f32 v109, v109, v107
  v_mul_f32 v110, v110, v107
  v_mul_f32 v111, v111, v107
  v_cvt_pk_bf16_f32 v100, v108, v109
  v_cvt_pk_bf16_f32 v101, v110, v111
  v_mul_f32 v112, v112, v107
  v_mul_f32 v113, v113, v107
  v_mul_f32 v114, v114, v107
  v_mul_f32 v115, v115, v107
  v_cvt_pk_bf16_f32 v102, v112, v113
  v_cvt_pk_bf16_f32 v103, v114, v115
  v_cndmask_b32 v36, v100, v102, s[84:85]
  v_cndmask_b32 v37, v101, v103, s[84:85]
  ds_write_b64 v10, v[36:37]
  v_max_f32 v104, v106, v107
  v_cmp_nge_f32 vcc, s86, v104
  v_mov_b64 v[44:45], 0
  v_mov_b64 v[46:47], 0
  v_mov_b64 v[48:49], 0
  v_mov_b64 v[50:51], 0
  s_cbranch_vccnz L_smr_f1_0
L_sm_f1_0:
  v_smfmac_f32_16x16x64_bf16 v[76:79], v[100:103], v[128:135], v11
  s_waitcnt lgkmcnt(0)
  s_barrier
  ds_read_b128 v[60:63], v8 offset:4096
  v_smfmac_f32_16x16x64_bf16 v[80:83], v[100:103], v[160:167], v11
  ds_read_b128 v[64:67], v8 offset:7168
  v_mov_b64 v[84:85], 0
  v_smfmac_f32_16x16x64_bf16 v[44:47], v[100:103], v[192:199], v11
  ds_read_b128 v[40:43], v8 offset:6144
  v_mov_b64 v[86:87], 0
  v_smfmac_f32_16x16x64_bf16 v[48:51], v[100:103], v[216:223], v11
  ds_read_b128 v[92:95], v3 offset:0
  s_waitcnt lgkmcnt(3)
  v_smfmac_f32_16x16x64_bf16 v[76:79], v[60:63], v[136:143], v11
  ds_read_b128 v[96:99], v3 offset:1024
  s_waitcnt lgkmcnt(3)
  v_smfmac_f32_16x16x64_bf16 v[76:79], v[64:67], v[144:151], v11
  ds_read_b128 v[52:55], v3 offset:8192
  s_waitcnt lgkmcnt(3)
  v_smfmac_f32_16x16x64_bf16 v[76:79], v[40:43], v[152:159], v11
  ds_read_b128 v[56:59], v3 offset:9216
  v_mov_b64 v[88:89], 0
  v_smfmac_f32_16x16x64_bf16 v[80:83], v[60:63], v[168:175], v11
  ds_read_b128 v[68:71], v3 offset:16384
  v_mov_b64 v[90:91], 0
  v_smfmac_f32_16x16x64_bf16 v[80:83], v[64:67], v[176:183], v11
  ds_read_b128 v[72:75], v3 offset:17408
  v_cvt_pk_bf16_f32 v76, v76, v77
  v_cvt_pk_bf16_f32 v77, v78, v79
  v_and_b32 v76, -2, v76
  v_smfmac_f32_16x16x64_bf16 v[80:83], v[40:43], v[184:191], v11
  s_waitcnt lgkmcnt(2)
  buffer_store_dwordx2 v[76:77], v5, s[36:39], 0 offen
  v_smfmac_f32_16x16x64_bf16 v[44:47], v[60:63], v[200:207], v11
  ds_read_b128 v[116:119], v3 offset:24576
  v_mov_b64 v[76:77], 0
  v_mov_b64 v[78:79], 0
  v_smfmac_f32_16x16x64_bf16 v[44:47], v[64:67], v[208:215], v11
  ds_read_b128 v[120:123], v3 offset:25600
  v_cvt_pk_bf16_f32 v80, v80, v81
  v_cvt_pk_bf16_f32 v81, v82, v83
  v_and_b32 v80, -2, v80
  v_smfmac_f32_16x16x64_bf16 v[44:47], v[40:43], v[92:99], v11
  buffer_store_dwordx2 v[80:81], v5, s[36:39], s74 offen
  v_smfmac_f32_16x16x64_bf16 v[48:51], v[60:63], v[52:59], v11
  s_waitcnt lgkmcnt(2)
  v_mov_b64 v[80:81], 0
  v_mov_b64 v[82:83], 0
  v_smfmac_f32_16x16x64_bf16 v[48:51], v[64:67], v[68:75], v11
  s_waitcnt lgkmcnt(0)
  v_cvt_pk_bf16_f32 v44, v44, v45
  v_cvt_pk_bf16_f32 v45, v46, v47
  v_and_b32 v44, -2, v44
  v_smfmac_f32_16x16x64_bf16 v[48:51], v[40:43], v[116:123], v11
  buffer_store_dwordx2 v[44:45], v5, s[36:39], s76 offen
  v_mov_b64 v[68:69], 0
  v_mov_b64 v[70:71], 0
  v_mov_b32 v13, 0
  v_mov_b32 v13, 0
  v_cvt_pk_bf16_f32 v48, v48, v49
  v_cvt_pk_bf16_f32 v49, v50, v51
  v_and_b32 v48, -2, v48
  buffer_store_dwordx2 v[48:49], v5, s[36:39], s65 offen
  v_mov_b64 v[72:73], 0
  v_mov_b64 v[74:75], 0
L_gap_gp10_6_35:
  s_nop 7
  s_nop 7
  s_nop 6
  s_nop 6
  s_nop 6
  s_nop 6
  buffer_load_dwordx4 v[108:111], v1, s[36:39], s64 offen offset:0 sc1
  buffer_load_dwordx4 v[112:115], v1, s[36:39], s64 offen offset:1024 sc1
  s_waitcnt vmcnt(10)
  ds_write_b128 v2, v[20:23] offset:40960
  s_waitcnt vmcnt(9)
  ds_write_b128 v2, v[24:27] offset:41984
  s_waitcnt vmcnt(8)
  ds_write_b128 v2, v[28:31] offset:49152
  s_waitcnt vmcnt(6)
  ds_write_b128 v2, v[32:35] offset:50176
  ds_read_b128 v[44:47], v1 offset:0
  ds_read_b128 v[48:51], v1 offset:1024
  ds_read_b128 v[52:55], v1 offset:8192
  ds_read_b128 v[56:59], v1 offset:9216
.p2align 5
  s_nop 0
  s_nop 0
  s_nop 0
  s_nop 0
  s_waitcnt vmcnt(1)
  v_mfma_f32_16x16x32_bf16 v[124:127], v[16:19], v[108:111], 0
  v_bitop3_b32 v15, v108, v110, 1 bitop3:0xa8
  v_lshlrev_b32 v15, 1, v15
  s_waitcnt vmcnt(0)
  v_mfma_f32_16x16x32_bf16 v[124:127], v[16:19], v[112:115], v[124:127]
  v_bitop3_b32 v13, v112, v114, 1 bitop3:0xa8
  v_cmp_ne_u32 vcc, v13, v15
  s_cbranch_vccnz L_pb_f1_0r
L_pb_f1_0:
  v_add_f32_dpp v124, v124, v124 row_ror:4 row_mask:0xf bank_mask:0xf
  v_add_f32_dpp v125, v125, v125 row_ror:4 row_mask:0xf bank_mask:0xf
  s_nop 0
  v_add_f32_dpp v124, v124, v124 row_ror:8 row_mask:0xf bank_mask:0xf
  v_add_f32_dpp v125, v125, v125 row_ror:8 row_mask:0xf bank_mask:0xf
  v_cvt_pk_bf16_f32 v14, v124, v125
  v_min_u32 v14, -2, v14
  buffer_store_dword v14, v6, s[36:39], s87 offen
  s_mov_b32 s72, s79
  s_add_u32 s79, s79, 8192
  s_cmp_eq_u32 s68, 62
  s_cbranch_scc1 L_chain_done
  s_add_u32 s68, s68, 2
  v_cmp_ne_u32 vcc, 1, v12
  v_mov_b32 v124, -1
  buffer_store_dword v124, v6, s[36:39], s71 offen
  s_cbranch_vccnz L_flr_f1_0
L_fl_f1_0:
  s_xor_b32 s71, s71, 0x4000
  s_mov_b32 s75, s71
  s_add_u32 s92, s75, 0x1000
  ds_read_b128 v[60:63], v1 offset:16384
  ds_read_b128 v[64:67], v1 offset:17408
  ds_read_b128 v[92:95], v1 offset:24576
  ds_read_b128 v[96:99], v1 offset:25600
  ds_read_b128 v[100:103], v1 offset:32768
  ds_read_b128 v[104:107], v1 offset:33792
L_gap_gp11_3_36:
  s_nop 3
  s_nop 3
  s_nop 3
  buffer_load_dwordx4 v[36:39], v9, s[36:39], s87 offen offset:128 sc1
  buffer_load_dwordx4 v[40:43], v9, s[36:39], s87 offen offset:2176 sc1
  ds_read_b128 v[116:119], v1 offset:40960
  ds_read_b128 v[120:123], v1 offset:41984
  ds_read_b128 v[20:23], v1 offset:49152
  ds_read_b128 v[24:27], v1 offset:50176
  ds_read_b128 v[28:31], v1 offset:57344
  ds_read_b128 v[32:35], v1 offset:58368
  s_waitcnt vmcnt(4)
  ds_read_b128 v[108:111], v2 offset:0
  ds_read_b128 v[112:115], v2 offset:1024
L_gap_gp12_3_37:
  s_nop 9
  s_nop 8
  s_nop 8
  buffer_load_dwordx4 v[36:39], v9, s[36:39], s87 offen offset:128 sc1
  buffer_load_dwordx4 v[40:43], v9, s[36:39], s87 offen offset:2176 sc1
.p2align 5
  s_nop 0
  s_nop 0
  s_nop 0
  s_nop 0
L_step_f1_1:
  s_waitcnt lgkmcnt(0)
  s_waitcnt vmcnt(2)
  v_max_u32 v15, v39, v43
  v_cmp_eq_u32 vcc, -1, v15
  ds_write_b64 v2, v[36:37] offset:32768
  s_cbranch_vccnz L_er0_f1_1
L_eb0_f1_1:
  v_smfmac_f32_16x16x64_bf16 v[88:91], v[36:39], v[44:51], v11
  ds_write_b64 v2, v[38:39] offset:32776
  v_smfmac_f32_16x16x64_bf16 v[88:91], v[40:43], v[52:59], v11
  ds_write_b64 v2, v[40:41] offset:33792
  v_smfmac_f32_16x16x64_bf16 v[84:87], v[36:39], v[60:67], v11
  ds_write_b64 v2, v[42:43] offset:33800
  v_smfmac_f32_16x16x64_bf16 v[84:87], v[40:43], v[92:99], v11
  s_add_u32 s69, s69, 16384
  s_add_u32 s78, s69, 8192
  v_smfmac_f32_16x16x64_bf16 v[80:83], v[36:39], v[100:107], v11
  s_add_u32 s70, s70, 2048
  s_min_u32 s70, s70, s77
  v_smfmac_f32_16x16x64_bf16 v[80:83], v[40:43], v[116:123], v11
  v_smfmac_f32_16x16x64_bf16 v[76:79], v[36:39], v[20:27], v11
  s_waitcnt lgkmcnt(0)
  s_barrier
  ds_read_b128 v[44:47], v4 offset:0
  v_smfmac_f32_16x16x64_bf16 v[76:79], v[40:43], v[28:35], v11
  ds_read_b128 v[48:51], v4 offset:1024
  v_smfmac_f32_16x16x64_bf16 v[72:75], v[36:39], a[8:15], v11
  ds_read_b128 v[52:55], v4 offset:6144
  v_smfmac_f32_16x16x64_bf16 v[72:75], v[40:43], a[24:31], v11
  ds_read_b128 v[56:59], v4 offset:7168
  v_smfmac_f32_16x16x64_bf16 v[68:71], v[36:39], a[0:7], v11
  ds_read_b128 v[60:63], v4 offset:4096
  v_smfmac_f32_16x16x64_bf16 v[68:71], v[40:43], a[16:23], v11
  ds_read_b128 v[64:67], v4 offset:5120
  s_waitcnt lgkmcnt(5)
  v_smfmac_f32_16x16x64_bf16 v[68:71], v[44:47], a[32:39], v11
  ds_read_b128 v[92:95], v2 offset:8192
  s_waitcnt lgkmcnt(5)
  v_smfmac_f32_16x16x64_bf16 v[68:71], v[48:51], a[48:55], v11
  s_waitcnt lgkmcnt(4)
  buffer_store_dword v14, v6, s[36:39], s72 offen sc1
  v_smfmac_f32_16x16x64_bf16 v[68:71], v[52:55], a[64:71], v11
  ds_read_b128 v[96:99], v2 offset:9216
  s_waitcnt lgkmcnt(4)
  v_smfmac_f32_16x16x64_bf16 v[68:71], v[56:59], a[80:87], v11
  ds_read_b128 v[100:103], v2 offset:16384
  s_waitcnt lgkmcnt(4)
  v_smfmac_f32_16x16x64_bf16 v[68:71], v[60:63], a[96:103], v11
  ds_read_b128 v[104:107], v2 offset:17408
  s_waitcnt lgkmcnt(4)
  v_smfmac_f32_16x16x64_bf16 v[68:71], v[64:67], a[112:119], v11
  buffer_load_dwordx4 v[20:23], v1, s[36:39], s69 offen offset:0 sc1
  v_smfmac_f32_16x16x64_bf16 v[72:75], v[44:47], a[40:47], v11
  ds_read_b128 v[116:119], v2 offset:24576
  v_smfmac_f32_16x16x64_bf16 v[72:75], v[48:51], a[56:63], v11
  ds_read_b128 v[120:123], v2 offset:25600
  v_add_f32 v124, v68, v69
  v_smfmac_f32_16x16x64_bf16 v[72:75], v[52:55], a[72:79], v11
  v_add_f32 v126, v70, v71
  v_smfmac_f32_16x16x64_bf16 v[72:75], v[56:59], a[88:95], v11
  buffer_load_dwordx4 v[24:27], v1, s[36:39], s69 offen offset:1024 sc1
  v_mul_f32 v124, s73, v124
  v_smfmac_f32_16x16x64_bf16 v[72:75], v[60:63], a[104:111], v11
  v_mul_f32 v126, s73, v126
  v_smfmac_f32_16x16x64_bf16 v[72:75], v[64:67], a[120:127], v11
  s_waitcnt lgkmcnt(0) vmcnt(3)
  v_smfmac_f32_16x16x64_bf16 v[76:79], v[44:47], v[108:115], v11
  ds_read_b128 v[108:111], v4 offset:9216
  v_smfmac_f32_16x16x64_bf16 v[76:79], v[48:51], v[92:99], v11
  buffer_load_dwordx4 v[28:31], v1, s[36:39], s78 offen offset:0 sc1
  v_add_f32 v125, v72, v73
  v_smfmac_f32_16x16x64_bf16 v[76:79], v[52:55], v[100:107], v11
  ds_read_b128 v[92:95], v4 offset:8192
  v_add_f32 v127, v74, v75
  v_smfmac_f32_16x16x64_bf16 v[76:79], v[56:59], v[116:123], v11
  ds_read_b128 v[96:99], v4 offset:10240
  v_mul_f32 v125, s73, v125
  v_smfmac_f32_16x16x64_bf16 v[76:79], v[60:63], a[160:167], v11
  ds_read_b128 v[100:103], v4 offset:12288
  v_mul_f32 v127, s73, v127
  v_smfmac_f32_16x16x64_bf16 v[76:79], v[64:67], a[176:183], v11
  ds_read_b128 v[104:107], v4 offset:14336
  v_cvt_pk_bf16_f32 v124, v124, v125
  v_smfmac_f32_16x16x64_bf16 v[80:83], v[44:47], a[128:135], v11
  ds_read_b128 v[112:115], v4 offset:11264
  v_cvt_pk_bf16_f32 v125, v126, v127
  v_smfmac_f32_16x16x64_bf16 v[80:83], v[48:51], a[136:143], v11
  ds_write2_b32 v7, v124, v125 offset0:0 offset1:4
  v_smfmac_f32_16x16x64_bf16 v[80:83], v[52:55], a[144:151], v11
  ds_read_b128 v[36:39], v4 offset:13312
  v_add_f32 v120, v76, v77
  v_smfmac_f32_16x16x64_bf16 v[80:83], v[56:59], a[152:159], v11
  ds_read_b128 v[40:43], v4 offset:15360
  v_add_f32 v122, v78, v79
  v_smfmac_f32_16x16x64_bf16 v[80:83], v[60:63], a[168:175], v11
  buffer_load_dword v12, off, s[36:39], s70 sc1
  v_smfmac_f32_16x16x64_bf16 v[80:83], v[64:67], a[184:191], v11
  s_waitcnt lgkmcnt(2)
  s_barrier
  v_smfmac_f32_16x16x64_bf16 v[84:87], v[44:47], a[192:199], v11
  ds_read_b128 v[68:71], v8 offset:0
  v_smfmac_f32_16x16x64_bf16 v[84:87], v[48:51], a[208:215], v11
  ds_read_b128 v[72:75], v8 offset:1024
  v_add_f32 v121, v80, v81
  v_smfmac_f32_16x16x64_bf16 v[84:87], v[52:55], a[224:231], v11
  ds_read_b128 v[76:79], v8 offset:2048
  v_add_f32 v123, v82, v83
  v_smfmac_f32_16x16x64_bf16 v[84:87], v[56:59], a[240:247], v11
  ds_read_b128 v[80:83], v8 offset:3072
  v_cvt_pk_bf16_f32 v120, v120, v121
  v_smfmac_f32_16x16x64_bf16 v[84:87], v[60:63], v[224:231], v11
  v_cvt_pk_bf16_f32 v121, v122, v123
  v_smfmac_f32_16x16x64_bf16 v[84:87], v[64:67], v[240:247], v11
  ds_write2_b32 v7, v120, v121 offset0:128 offset1:132
  v_smfmac_f32_16x16x64_bf16 v[88:91], v[44:47], a[200:207], v11
  buffer_load_dwordx4 v[32:35], v1, s[36:39], s78 offen offset:1024 sc1
  v_smfmac_f32_16x16x64_bf16 v[88:91], v[48:51], a[216:223], v11
  v_cvt_pk_bf16_f32 v84, v84, v85
  v_smfmac_f32_16x16x64_bf16 v[88:91], v[52:55], a[232:239], v11
  v_cvt_pk_bf16_f32 v85, v86, v87
  v_smfmac_f32_16x16x64_bf16 v[88:91], v[56:59], a[248:255], v11
  v_smfmac_f32_16x16x64_bf16 v[88:91], v[60:63], v[232:239], v11
  s_waitcnt lgkmcnt(0)
  s_barrier
  v_smfmac_f32_16x16x64_bf16 v[88:91], v[64:67], v[248:255], v11
  ds_read_b128 v[44:47], v8 offset:512
  v_mfma_f32_16x16x32_bf16 v[116:119], v[92:95], v[68:71], 0
  ds_read_b128 v[92:95], v2 offset:49152
  v_mfma_f32_16x16x32_bf16 v[116:119], v[96:99], v[72:75], v[116:119]
  ds_read_b128 v[48:51], v8 offset:1536
  v_cvt_pk_bf16_f32 v88, v88, v89
  v_mfma_f32_16x16x32_bf16 v[116:119], v[100:103], v[76:79], v[116:119]
  ds_read_b128 v[52:55], v8 offset:2560
  v_cvt_pk_bf16_f32 v89, v90, v91
  v_mfma_f32_16x16x32_bf16 v[116:119], v[104:107], v[80:83], v[116:119]
  ds_read_b128 v[56:59], v8 offset:3584
  v_mfma_f32_16x16x32_bf16 v[120:123], v[108:111], v[68:71], 0
  ds_read_b128 v[96:99], v2 offset:50176
  v_mfma_f32_16x16x32_bf16 v[120:123], v[112:115], v[72:75], v[120:123]
  v_exp_f32 v60, v116
  v_mfma_f32_16x16x32_bf16 v[120:123], v[36:39], v[76:79], v[120:123]
  v_exp_f32 v61, v117
  v_mfma_f32_16x16x32_bf16 v[120:123], v[40:43], v[80:83], v[120:123]
  s_waitcnt lgkmcnt(5)
  v_exp_f32 v62, v118
  v_mfma_f32_16x16x32_bf16 v[124:127], v[44:47], v[68:71], 0
  s_waitcnt lgkmcnt(3)
  v_exp_f32 v63, v119
  v_mfma_f32_16x16x32_bf16 v[124:127], v[48:51], v[72:75], v[124:127]
  s_waitcnt lgkmcnt(2)
  v_exp_f32 v64, v120
  v_mfma_f32_16x16x32_bf16 v[124:127], v[52:55], v[76:79], v[124:127]
  s_waitcnt lgkmcnt(1)
  v_exp_f32 v65, v121
  v_mfma_f32_16x16x32_bf16 v[124:127], v[56:59], v[80:83], v[124:127]
  s_waitcnt lgkmcnt(0)
  v_exp_f32 v66, v122
  v_exp_f32 v67, v123
  v_cvt_pk_bf16_f32 v100, v60, v64
  v_cvt_pk_bf16_f32 v101, v61, v65
  v_cvt_pk_bf16_f32 v102, v62, v66
  v_cvt_pk_bf16_f32 v103, v63, v67
  v_exp_f32 v86, v124
  v_mov_b64 v[76:77], 0
  v_mfma_f32_16x16x32_bf16 v[104:107], v[16:19], v[100:103], 0
  v_exp_f32 v87, v126
  v_mfma_f32_16x16x32_bf16 v[108:111], v[92:95], v[100:103], 0
  v_cvt_pk_bf16_f32 v90, v86, v86
  v_cvt_pk_bf16_f32 v91, v87, v87
  v_mfma_f32_16x16x32_bf16 v[112:115], v[96:99], v[100:103], 0
  v_mov_b64 v[78:79], 0
  v_mov_b64 v[80:81], 0
  v_mfma_f32_16x16x16_bf16 v[36:39], v[16:17], v[90:91], 0
  v_mov_b64 v[82:83], 0
  v_mfma_f32_16x16x16_bf16 v[108:111], v[84:85], v[90:91], v[108:111]
  v_mfma_f32_16x16x16_bf16 v[112:115], v[88:89], v[90:91], v[112:115]
  v_fma_f32 v106, v38, 0.5, v106
  v_rcp_f32 v107, v106
  v_mov_b32 v13, 0
  v_mul_f32 v108, v108, v107
  v_mul_f32 v109, v109, v107
  v_mul_f32 v110, v110, v107
  v_mul_f32 v111, v111, v107
  v_cvt_pk_bf16_f32 v100, v108, v109
  v_cvt_pk_bf16_f32 v101, v110, v111
  v_mul_f32 v112, v112, v107
  v_mul_f32 v113, v113, v107
  v_mul_f32 v114, v114, v107
  v_mul_f32 v115, v115, v107
  v_cvt_pk_bf16_f32 v102, v112, v113
  v_cvt_pk_bf16_f32 v103, v114, v115
  v_cndmask_b32 v36, v100, v102, s[84:85]
  v_cndmask_b32 v37, v101, v103, s[84:85]
  ds_write_b64 v10, v[36:37]
  v_max_f32 v104, v106, v107
  v_cmp_nge_f32 vcc, s86, v104
  v_mov_b64 v[44:45], 0
  v_mov_b64 v[46:47], 0
  v_mov_b64 v[48:49], 0
  v_mov_b64 v[50:51], 0
  s_cbranch_vccnz L_smr_f1_1
L_sm_f1_1:
  v_smfmac_f32_16x16x64_bf16 v[76:79], v[100:103], v[128:135], v11
  s_waitcnt lgkmcnt(0)
  s_barrier
  ds_read_b128 v[60:63], v8 offset:4096
  v_smfmac_f32_16x16x64_bf16 v[80:83], v[100:103], v[160:167], v11
  ds_read_b128 v[64:67], v8 offset:7168
  v_mov_b64 v[84:85], 0
  v_smfmac_f32_16x16x64_bf16 v[44:47], v[100:103], v[192:199], v11
  ds_read_b128 v[40:43], v8 offset:6144
  v_mov_b64 v[86:87], 0
  v_smfmac_f32_16x16x64_bf16 v[48:51], v[100:103], v[216:223], v11
  ds_read_b128 v[92:95], v3 offset:0
  s_waitcnt lgkmcnt(3)
  v_smfmac_f32_16x16x64_bf16 v[76:79], v[60:63], v[136:143], v11
  ds_read_b128 v[96:99], v3 offset:1024
  s_waitcnt lgkmcnt(3)
  v_smfmac_f32_16x16x64_bf16 v[76:79], v[64:67], v[144:151], v11
  ds_read_b128 v[52:55], v3 offset:8192
  s_waitcnt lgkmcnt(3)
  v_smfmac_f32_16x16x64_bf16 v[76:79], v[40:43], v[152:159], v11
  ds_read_b128 v[56:59], v3 offset:9216
  v_mov_b64 v[88:89], 0
  v_smfmac_f32_16x16x64_bf16 v[80:83], v[60:63], v[168:175], v11
  ds_read_b128 v[68:71], v3 offset:16384
  v_mov_b64 v[90:91], 0
  v_smfmac_f32_16x16x64_bf16 v[80:83], v[64:67], v[176:183], v11
  ds_read_b128 v[72:75], v3 offset:17408
  v_cvt_pk_bf16_f32 v76, v76, v77
  v_cvt_pk_bf16_f32 v77, v78, v79
  v_or_b32 v76, 1, v76
  v_smfmac_f32_16x16x64_bf16 v[80:83], v[40:43], v[184:191], v11
  s_waitcnt lgkmcnt(2)
  buffer_store_dwordx2 v[76:77], v5, s[36:39], 0 offen
  v_smfmac_f32_16x16x64_bf16 v[44:47], v[60:63], v[200:207], v11
  ds_read_b128 v[116:119], v3 offset:24576
  v_mov_b64 v[76:77], 0
  v_mov_b64 v[78:79], 0
  v_smfmac_f32_16x16x64_bf16 v[44:47], v[64:67], v[208:215], v11
  ds_read_b128 v[120:123], v3 offset:25600
  v_cvt_pk_bf16_f32 v80, v80, v81
  v_cvt_pk_bf16_f32 v81, v82, v83
  v_or_b32 v80, 1, v80
  v_smfmac_f32_16x16x64_bf16 v[44:47], v[40:43], v[92:99], v11
  buffer_store_dwordx2 v[80:81], v5, s[36:39], s74 offen
  v_smfmac_f32_16x16x64_bf16 v[48:51], v[60:63], v[52:59], v11
  s_waitcnt lgkmcnt(2)
  v_mov_b64 v[80:81], 0
  v_mov_b64 v[82:83], 0
  v_smfmac_f32_16x16x64_bf16 v[48:51], v[64:67], v[68:75], v11
  s_waitcnt lgkmcnt(0)
  v_cvt_pk_bf16_f32 v44, v44, v45
  v_cvt_pk_bf16_f32 v45, v46, v47
  v_or_b32 v44, 1, v44
  v_smfmac_f32_16x16x64_bf16 v[48:51], v[40:43], v[116:123], v11
  buffer_store_dwordx2 v[44:45], v5, s[36:39], s76 offen
  v_mov_b64 v[68:69], 0
  v_mov_b64 v[70:71], 0
  v_mov_b32 v13, 0
  v_mov_b32 v13, 0
  v_cvt_pk_bf16_f32 v48, v48, v49
  v_cvt_pk_bf16_f32 v49, v50, v51
  v_or_b32 v48, 1, v48
  buffer_store_dwordx2 v[48:49], v5, s[36:39], s65 offen
  v_mov_b64 v[72:73], 0
  v_mov_b64 v[74:75], 0
L_gap_gp10_6_38:
  s_nop 7
  s_nop 7
  s_nop 6
  s_nop 6
  s_nop 6
  s_nop 6
  buffer_load_dwordx4 v[108:111], v1, s[36:39], s64 offen offset:0 sc1
  buffer_load_dwordx4 v[112:115], v1, s[36:39], s64 offen offset:1024 sc1
  s_waitcnt vmcnt(10)
  ds_write_b128 v2, v[20:23] offset:40960
  s_waitcnt vmcnt(9)
  ds_write_b128 v2, v[24:27] offset:41984
  s_waitcnt vmcnt(8)
  ds_write_b128 v2, v[28:31] offset:49152
  s_waitcnt vmcnt(6)
  ds_write_b128 v2, v[32:35] offset:50176
  ds_read_b128 v[44:47], v1 offset:0
  ds_read_b128 v[48:51], v1 offset:1024
  ds_read_b128 v[52:55], v1 offset:8192
  ds_read_b128 v[56:59], v1 offset:9216
.p2align 5
  s_nop 0
  s_nop 0
  s_nop 0
  s_nop 0
  s_waitcnt vmcnt(1)
  v_mfma_f32_16x16x32_bf16 v[124:127], v[16:19], v[108:111], 0
  v_bitop3_b32 v15, v108, v110, 1 bitop3:0x80
  v_sub_u32 v15, 2, v15
  s_waitcnt vmcnt(0)
  v_mfma_f32_16x16x32_bf16 v[124:127], v[16:19], v[112:115], v[124:127]
  v_bitop3_b32 v13, v112, v114, 1 bitop3:0x80
  v_cmp_ne_u32 vcc, v13, v15
  s_cbranch_vccnz L_pb_f1_1r
L_pb_f1_1:
  v_add_f32_dpp v124, v124, v124 row_ror:4 row_mask:0xf bank_mask:0xf
  v_add_f32_dpp v125, v125, v125 row_ror:4 row_mask:0xf bank_mask:0xf
  s_nop 0
  v_add_f32_dpp v124, v124, v124 row_ror:8 row_mask:0xf bank_mask:0xf
  v_add_f32_dpp v125, v125, v125 row_ror:8 row_mask:0xf bank_mask:0xf
  v_cvt_pk_bf16_f32 v14, v124, v125
  v_min_u32 v14, -2, v14
  buffer_store_dword v14, v6, s[36:39], s71 offen
  s_mov_b32 s72, s79
  s_add_u32 s79, s79, 8192
  v_cmp_ne_u32 vcc, 1, v12
  v_mov_b32 v124, -1
  buffer_store_dword v124, v6, s[36:39], s87 offen
  s_cbranch_vccnz L_flr_f1_1
L_fl_f1_1:
  s_xor_b32 s87, s87, 0x4000
  s_xor_b32 s93, s93, 0x4000
  ds_read_b128 v[60:63], v1 offset:16384
  ds_read_b128 v[64:67], v1 offset:17408
  ds_read_b128 v[92:95], v1 offset:24576
  ds_read_b128 v[96:99], v1 offset:25600
  ds_read_b128 v[100:103], v1 offset:32768
  ds_read_b128 v[104:107], v1 offset:33792
L_gap_gp11_3_39:
  s_nop 3
  s_nop 3
  s_nop 3
  buffer_load_dwordx4 v[36:39], v9, s[36:39], s75 offen offset:128 sc1
  buffer_load_dwordx4 v[40:43], v9, s[36:39], s75 offen offset:2176 sc1
  ds_read_b128 v[116:119], v1 offset:40960
  ds_read_b128 v[120:123], v1 offset:41984
  ds_read_b128 v[20:23], v1 offset:49152
  ds_read_b128 v[24:27], v1 offset:50176
  ds_read_b128 v[28:31], v1 offset:57344
  ds_read_b128 v[32:35], v1 offset:58368
  s_waitcnt vmcnt(4)
  ds_read_b128 v[108:111], v2 offset:0
  ds_read_b128 v[112:115], v2 offset:1024
L_gap_gp12_3_40:
  s_nop 9
  s_nop 8
  s_nop 8
  buffer_load_dwordx4 v[36:39], v9, s[36:39], s75 offen offset:128 sc1
  buffer_load_dwordx4 v[40:43], v9, s[36:39], s75 offen offset:2176 sc1
  s_branch L_step_f1_0
L_er0_f1_0:
  buffer_load_dwordx4 v[36:39], v9, s[36:39], s75 offen offset:128 sc1
  buffer_load_dwordx4 v[40:43], v9, s[36:39], s75 offen offset:2176 sc1
  s_waitcnt vmcnt(2)
  v_max_u32 v15, v39, v43
  v_cmp_eq_u32 vcc, -1, v15
  s_cbranch_vccz L_eb0_f1_0o
L_er0_f1_0s:
  buffer_load_dwordx4 v[36:39], v9, s[36:39], s75 offen offset:128 sc1
  buffer_load_dwordx4 v[40:43], v9, s[36:39], s75 offen offset:2176 sc1
  s_waitcnt vmcnt(2)
  v_max_u32 v15, v39, v43
  v_cmp_eq_u32 vcc, -1, v15
  s_cbranch_vccz L_eb0_f1_0o
  s_sub_u32 s3, s3, 1
  s_cbranch_scc1 L_end
  s_branch L_er0_f1_0s
L_eb0_f1_0o:
  ds_write_b64 v2, v[36:37] offset:32768
  s_branch L_eb0_f1_0
L_smr_f1_0:
  v_max_f32 v86, v116, v120
  v_max3_f32 v86, v86, v117, v121
  v_max3_f32 v86, v86, v118, v122
  v_max3_f32 v86, v86, v119, v123
  v_max3_f32 v86, v86, v124, v126
  v_mov_b32 v87, v86
  s_nop 1
  v_permlane32_swap_b32 v86, v87
  v_max_f32 v86, v86, v87
  v_mov_b32 v87, v86
  s_nop 1
  v_permlane16_swap_b32 v86, v87
  v_max_f32 v86, v86, v87
  v_sub_f32 v116, v116, v86
  v_sub_f32 v120, v120, v86
  v_sub_f32 v117, v117, v86
  v_sub_f32 v121, v121, v86
  v_sub_f32 v118, v118, v86
  v_sub_f32 v122, v122, v86
  v_sub_f32 v119, v119, v86
  v_sub_f32 v123, v123, v86
  v_sub_f32 v124, v124, v86
  v_sub_f32 v126, v126, v86
  v_exp_f32 v116, v116
  v_exp_f32 v120, v120
  v_exp_f32 v117, v117
  v_exp_f32 v121, v121
  v_exp_f32 v118, v118
  v_exp_f32 v122, v122
  v_exp_f32 v119, v119
  v_exp_f32 v123, v123
  v_exp_f32 v124, v124
  v_exp_f32 v126, v126
  v_cvt_pk_bf16_f32 v100, v116, v120
  v_cvt_pk_bf16_f32 v101, v117, v121
  v_cvt_pk_bf16_f32 v102, v118, v122
  v_cvt_pk_bf16_f32 v103, v119, v123
  v_cvt_pk_bf16_f32 v90, v124, v124
  v_cvt_pk_bf16_f32 v91, v126, v126
  s_waitcnt lgkmcnt(0)
  v_mov_b64 v[76:77], 0
  v_mov_b64 v[78:79], 0
  v_mfma_f32_16x16x32_bf16 v[104:107], v[16:19], v[100:103], 0
  v_mfma_f32_16x16x32_bf16 v[108:111], v[92:95], v[100:103], 0
  v_mfma_f32_16x16x32_bf16 v[112:115], v[96:99], v[100:103], 0
  v_mfma_f32_16x16x16_bf16 v[36:39], v[16:17], v[90:91], 0
  v_mfma_f32_16x16x16_bf16 v[108:111], v[84:85], v[90:91], v[108:111]
  v_mfma_f32_16x16x16_bf16 v[112:115], v[88:89], v[90:91], v[112:115]
  v_fma_f32 v106, v38, 0.5, v106
  v_rcp_f32 v107, v106
  s_nop 0
  v_mul_f32 v108, v108, v107
  v_mul_f32 v109, v109, v107
  v_mul_f32 v110, v110, v107
  v_mul_f32 v111, v111, v107
  v_cvt_pk_bf16_f32 v100, v108, v109
  v_cvt_pk_bf16_f32 v101, v110, v111
  v_mul_f32 v112, v112, v107
  v_mul_f32 v113, v113, v107
  v_mul_f32 v114, v114, v107
  v_mul_f32 v115, v115, v107
  v_cvt_pk_bf16_f32 v102, v112, v113
  v_cvt_pk_bf16_f32 v103, v114, v115
  v_cndmask_b32 v36, v100, v102, s[84:85]
  v_cndmask_b32 v37, v101, v103, s[84:85]
  ds_write_b64 v10, v[36:37]
  s_branch L_sm_f1_0
L_pb_f1_0r:
  buffer_load_dwordx4 v[108:111], v1, s[36:39], s64 offen offset:0 sc1
  buffer_load_dwordx4 v[112:115], v1, s[36:39], s64 offen offset:1024 sc1
  s_nop 15
  s_nop 7
L_pb_f1_0s:
  buffer_load_dwordx4 v[36:39], v1, s[36:39], s64 offen offset:0 sc1
  buffer_load_dwordx4 v[40:43], v1, s[36:39], s64 offen offset:1024 sc1
  s_waitcnt vmcnt(3)
  v_mfma_f32_16x16x32_bf16 v[124:127], v[16:19], v[108:111], 0
  v_bitop3_b32 v15, v108, v110, 1 bitop3:0xa8
  v_lshlrev_b32 v15, 1, v15
  s_waitcnt vmcnt(2)
  v_mfma_f32_16x16x32_bf16 v[124:127], v[16:19], v[112:115], v[124:127]
  v_bitop3_b32 v13, v112, v114, 1 bitop3:0xa8
  v_cmp_ne_u32 vcc, v13, v15
  s_cbranch_vccz L_pb_f1_0
  buffer_load_dwordx4 v[108:111], v1, s[36:39], s64 offen offset:0 sc1
  buffer_load_dwordx4 v[112:115], v1, s[36:39], s64 offen offset:1024 sc1
  s_waitcnt vmcnt(3)
  v_mfma_f32_16x16x32_bf16 v[124:127], v[16:19], v[36:39], 0
  v_bitop3_b32 v15, v36, v38, 1 bitop3:0xa8
  v_lshlrev_b32 v15, 1, v15
  s_waitcnt vmcnt(2)
  v_mfma_f32_16x16x32_bf16 v[124:127], v[16:19], v[40:43], v[124:127]
  v_bitop3_b32 v13, v40, v42, 1 bitop3:0xa8
  v_cmp_ne_u32 vcc, v13, v15
  s_cbranch_vccz L_pb_f1_0
  s_sub_u32 s3, s3, 1
  s_cbranch_scc1 L_end
  s_branch L_pb_f1_0s
L_flr_f1_0:
L_spin_41:
  buffer_load_dword v12, off, s[36:39], s70 sc1
  s_waitcnt vmcnt(0)
  v_cmp_ne_u32 vcc, 1, v12
  s_cbranch_vccz L_ok_42
  s_sub_u32 s3, s3, 1
  s_cbranch_scc1 L_end
  s_sleep 2
  s_branch L_spin_41
L_ok_42:
  s_branch L_fl_f1_0
L_er0_f1_1:
  buffer_load_dwordx4 v[36:39], v9, s[36:39], s87 offen offset:128 sc1
  buffer_load_dwordx4 v[40:43], v9, s[36:39], s87 offen offset:2176 sc1
  s_waitcnt vmcnt(2)
  v_max_u32 v15, v39, v43
  v_cmp_eq_u32 vcc, -1, v15
  s_cbranch_vccz L_eb0_f1_1o
L_er0_f1_1s:
  buffer_load_dwordx4 v[36:39], v9, s[36:39], s87 offen offset:128 sc1
  buffer_load_dwordx4 v[40:43], v9, s[36:39], s87 offen offset:2176 sc1
  s_waitcnt vmcnt(2)
  v_max_u32 v15, v39, v43
  v_cmp_eq_u32 vcc, -1, v15
  s_cbranch_vccz L_eb0_f1_1o
  s_sub_u32 s3, s3, 1
  s_cbranch_scc1 L_end
  s_branch L_er0_f1_1s
L_eb0_f1_1o:
  ds_write_b64 v2, v[36:37] offset:32768
  s_branch L_eb0_f1_1
L_smr_f1_1:
  v_max_f32 v86, v116, v120
  v_max3_f32 v86, v86, v117, v121
  v_max3_f32 v86, v86, v118, v122
  v_max3_f32 v86, v86, v119, v123
  v_max3_f32 v86, v86, v124, v126
  v_mov_b32 v87, v86
  s_nop 1
  v_permlane32_swap_b32 v86, v87
  v_max_f32 v86, v86, v87
  v_mov_b32 v87, v86
  s_nop 1
  v_permlane16_swap_b32 v86, v87
  v_max_f32 v86, v86, v87
  v_sub_f32 v116, v116, v86
  v_sub_f32 v120, v120, v86
  v_sub_f32 v117, v117, v86
  v_sub_f32 v121, v121, v86
  v_sub_f32 v118, v118, v86
  v_sub_f32 v122, v122, v86
  v_sub_f32 v119, v119, v86
  v_sub_f32 v123, v123, v86
  v_sub_f32 v124, v124, v86
  v_sub_f32 v126, v126, v86
  v_exp_f32 v116, v116
  v_exp_f32 v120, v120
  v_exp_f32 v117, v117
  v_exp_f32 v121, v121
  v_exp_f32 v118, v118
  v_exp_f32 v122, v122
  v_exp_f32 v119, v119
  v_exp_f32 v123, v123
  v_exp_f32 v124, v124
  v_exp_f32 v126, v126
  v_cvt_pk_bf16_f32 v100, v116, v120
  v_cvt_pk_bf16_f32 v101, v117, v121
  v_cvt_pk_bf16_f32 v102, v118, v122
  v_cvt_pk_bf16_f32 v103, v119, v123
  v_cvt_pk_bf16_f32 v90, v124, v124
  v_cvt_pk_bf16_f32 v91, v126, v126
  s_waitcnt lgkmcnt(0)
  v_mov_b64 v[76:77], 0
  v_mov_b64 v[78:79], 0
  v_mfma_f32_16x16x32_bf16 v[104:107], v[16:19], v[100:103], 0
  v_mfma_f32_16x16x32_bf16 v[108:111], v[92:95], v[100:103], 0
  v_mfma_f32_16x16x32_bf16 v[112:115], v[96:99], v[100:103], 0
  v_mfma_f32_16x16x16_bf16 v[36:39], v[16:17], v[90:91], 0
  v_mfma_f32_16x16x16_bf16 v[108:111], v[84:85], v[90:91], v[108:111]
  v_mfma_f32_16x16x16_bf16 v[112:115], v[88:89], v[90:91], v[112:115]
  v_fma_f32 v106, v38, 0.5, v106
  v_rcp_f32 v107, v106
  s_nop 0
  v_mul_f32 v108, v108, v107
  v_mul_f32 v109, v109, v107
  v_mul_f32 v110, v110, v107
  v_mul_f32 v111, v111, v107
  v_cvt_pk_bf16_f32 v100, v108, v109
  v_cvt_pk_bf16_f32 v101, v110, v111
  v_mul_f32 v112, v112, v107
  v_mul_f32 v113, v113, v107
  v_mul_f32 v114, v114, v107
  v_mul_f32 v115, v115, v107
  v_cvt_pk_bf16_f32 v102, v112, v113
  v_cvt_pk_bf16_f32 v103, v114, v115
  v_cndmask_b32 v36, v100, v102, s[84:85]
  v_cndmask_b32 v37, v101, v103, s[84:85]
  ds_write_b64 v10, v[36:37]
  s_branch L_sm_f1_1
L_pb_f1_1r:
  buffer_load_dwordx4 v[108:111], v1, s[36:39], s64 offen offset:0 sc1
  buffer_load_dwordx4 v[112:115], v1, s[36:39], s64 offen offset:1024 sc1
  s_nop 15
  s_nop 7
L_pb_f1_1s:
  buffer_load_dwordx4 v[36:39], v1, s[36:39], s64 offen offset:0 sc1
  buffer_load_dwordx4 v[40:43], v1, s[36:39], s64 offen offset:1024 sc1
  s_waitcnt vmcnt(3)
  v_mfma_f32_16x16x32_bf16 v[124:127], v[16:19], v[108:111], 0
  v_bitop3_b32 v15, v108, v110, 1 bitop3:0x80
  v_sub_u32 v15, 2, v15
  s_waitcnt vmcnt(2)
  v_mfma_f32_16x16x32_bf16 v[124:127], v[16:19], v[112:115], v[124:127]
  v_bitop3_b32 v13, v112, v114, 1 bitop3:0x80
  v_cmp_ne_u32 vcc, v13, v15
  s_cbranch_vccz L_pb_f1_1
  buffer_load_dwordx4 v[108:111], v1, s[36:39], s64 offen offset:0 sc1
  buffer_load_dwordx4 v[112:115], v1, s[36:39], s64 offen offset:1024 sc1
  s_waitcnt vmcnt(3)
  v_mfma_f32_16x16x32_bf16 v[124:127], v[16:19], v[36:39], 0
  v_bitop3_b32 v15, v36, v38, 1 bitop3:0x80
  v_sub_u32 v15, 2, v15
  s_waitcnt vmcnt(2)
  v_mfma_f32_16x16x32_bf16 v[124:127], v[16:19], v[40:43], v[124:127]
  v_bitop3_b32 v13, v40, v42, 1 bitop3:0x80
  v_cmp_ne_u32 vcc, v13, v15
  s_cbranch_vccz L_pb_f1_1
  s_sub_u32 s3, s3, 1
  s_cbranch_scc1 L_end
  s_branch L_pb_f1_1s
L_flr_f1_1:
L_spin_43:
  buffer_load_dword v12, off, s[36:39], s70 sc1
  s_waitcnt vmcnt(0)
  v_cmp_ne_u32 vcc, 1, v12
  s_cbranch_vccz L_ok_44
  s_sub_u32 s3, s3, 1
  s_cbranch_scc1 L_end
  s_sleep 2
  s_branch L_spin_43
L_ok_44:
  s_branch L_fl_f1_1
.p2align 5
  s_nop 0
  s_nop 0
  s_nop 0
  s_nop 0
L_step_f2_0:
  s_waitcnt lgkmcnt(0)
  s_waitcnt vmcnt(2)
  v_max_u32 v15, v39, v43
  v_cmp_eq_u32 vcc, -1, v15
  ds_write_b64 v2, v[36:37] offset:32768
  s_cbranch_vccnz L_er0_f2_0
L_eb0_f2_0:
  v_smfmac_f32_16x16x64_bf16 v[88:91], v[36:39], v[44:51], v11
  ds_write_b64 v2, v[38:39] offset:32776
  v_smfmac_f32_16x16x64_bf16 v[88:91], v[40:43], v[52:59], v11
  ds_write_b64 v2, v[40:41] offset:33792
  v_smfmac_f32_16x16x64_bf16 v[84:87], v[36:39], v[60:67], v11
  ds_write_b64 v2, v[42:43] offset:33800
  v_smfmac_f32_16x16x64_bf16 v[84:87], v[40:43], v[92:99], v11
  s_add_u32 s69, s69, 16384
  s_add_u32 s78, s69, 8192
  v_smfmac_f32_16x16x64_bf16 v[80:83], v[36:39], v[100:107], v11
  s_add_u32 s70, s70, 2048
  s_min_u32 s70, s70, s77
  v_smfmac_f32_16x16x64_bf16 v[80:83], v[40:43], v[116:123], v11
  v_smfmac_f32_16x16x64_bf16 v[76:79], v[36:39], v[20:27], v11
  s_waitcnt lgkmcnt(0)
  s_barrier
  ds_read_b128 v[44:47], v4 offset:6144
  v_smfmac_f32_16x16x64_bf16 v[76:79], v[40:43], v[28:35], v11
  ds_read_b128 v[48:51], v4 offset:7168
  v_smfmac_f32_16x16x64_bf16 v[72:75], v[36:39], a[8:15], v11
  ds_read_b128 v[52:55], v4 offset:0
  v_smfmac_f32_16x16x64_bf16 v[72:75], v[40:43], a[24:31], v11
  ds_read_b128 v[56:59], v4 offset:1024
  v_smfmac_f32_16x16x64_bf16 v[68:71], v[36:39], a[0:7], v11
  ds_read_b128 v[60:63], v4 offset:2048
  v_smfmac_f32_16x16x64_bf16 v[68:71], v[40:43], a[16:23], v11
  ds_read_b128 v[64:67], v4 offset:3072
  s_waitcnt lgkmcnt(5)
  v_smfmac_f32_16x16x64_bf16 v[68:71], v[44:47], a[32:39], v11
  ds_read_b128 v[92:95], v2 offset:8192
  s_waitcnt lgkmcnt(5)
  v_smfmac_f32_16x16x64_bf16 v[68:71], v[48:51], a[48:55], v11
  ds_read_b128 v[96:99], v2 offset:9216
  s_waitcnt lgkmcnt(5)
  v_smfmac_f32_16x16x64_bf16 v[68:71], v[52:55], a[64:71], v11
  s_waitcnt lgkmcnt(4)
  buffer_store_dword v14, v6, s[36:39], s72 offen sc1
  v_smfmac_f32_16x16x64_bf16 v[68:71], v[56:59], a[80:87], v11
  ds_read_b128 v[100:103], v2 offset:16384
  s_waitcnt lgkmcnt(4)
  v_smfmac_f32_16x16x64_bf16 v[68:71], v[60:63], a[96:103], v11
  ds_read_b128 v[104:107], v2 offset:17408
  s_waitcnt lgkmcnt(4)
  v_smfmac_f32_16x16x64_bf16 v[68:71], v[64:67], a[112:119], v11
  ds_read_b128 v[116:119], v2 offset:24576
  v_smfmac_f32_16x16x64_bf16 v[72:75], v[44:47], a[40:47], v11
  buffer_load_dwordx4 v[20:23], v1, s[36:39], s69 offen offset:0 sc1
  v_smfmac_f32_16x16x64_bf16 v[72:75], v[48:51], a[56:63], v11
  ds_read_b128 v[120:123], v2 offset:25600
  v_add_f32 v124, v68, v69
  v_smfmac_f32_16x16x64_bf16 v[72:75], v[52:55], a[72:79], v11
  v_add_f32 v126, v70, v71
  v_smfmac_f32_16x16x64_bf16 v[72:75], v[56:59], a[88:95], v11
  v_mul_f32 v124, s73, v124
  v_smfmac_f32_16x16x64_bf16 v[72:75], v[60:63], a[104:111], v11
  buffer_load_dwordx4 v[24:27], v1, s[36:39], s69 offen offset:1024 sc1
  v_mul_f32 v126, s73, v126
  v_smfmac_f32_16x16x64_bf16 v[72:75], v[64:67], a[120:127], v11
  s_waitcnt lgkmcnt(0) vmcnt(3)
  v_smfmac_f32_16x16x64_bf16 v[76:79], v[44:47], v[108:115], v11
  ds_read_b128 v[108:111], v4 offset:9216
  v_smfmac_f32_16x16x64_bf16 v[76:79], v[48:51], v[92:99], v11
  ds_read_b128 v[92:95], v4 offset:8192
  v_add_f32 v125, v72, v73
  v_smfmac_f32_16x16x64_bf16 v[76:79], v[52:55], v[100:107], v11
  buffer_load_dwordx4 v[28:31], v1, s[36:39], s78 offen offset:0 sc1
  v_add_f32 v127, v74, v75
  v_smfmac_f32_16x16x64_bf16 v[76:79], v[56:59], v[116:123], v11
  ds_read_b128 v[96:99], v4 offset:10240
  v_mul_f32 v125, s73, v125
  v_smfmac_f32_16x16x64_bf16 v[76:79], v[60:63], a[160:167], v11
  ds_read_b128 v[100:103], v4 offset:12288
  v_mul_f32 v127, s73, v127
  v_smfmac_f32_16x16x64_bf16 v[76:79], v[64:67], a[176:183], v11
  ds_read_b128 v[104:107], v4 offset:14336
  v_cvt_pk_bf16_f32 v124, v124, v125
  v_smfmac_f32_16x16x64_bf16 v[80:83], v[44:47], a[128:135], v11
  ds_read_b128 v[112:115], v4 offset:11264
  v_cvt_pk_bf16_f32 v125, v126, v127
  v_smfmac_f32_16x16x64_bf16 v[80:83], v[48:51], a[136:143], v11
  ds_write2_b32 v7, v124, v125 offset0:0 offset1:4
  v_smfmac_f32_16x16x64_bf16 v[80:83], v[52:55], a[144:151], v11
  ds_read_b128 v[36:39], v4 offset:13312
  v_add_f32 v120, v76, v77
  v_smfmac_f32_16x16x64_bf16 v[80:83], v[56:59], a[152:159], v11
  ds_read_b128 v[40:43], v4 offset:15360
  v_add_f32 v122, v78, v79
  v_smfmac_f32_16x16x64_bf16 v[80:83], v[60:63], a[168:175], v11
  buffer_load_dword v12, off, s[36:39], s70 sc1
  v_smfmac_f32_16x16x64_bf16 v[80:83], v[64:67], a[184:191], v11
  s_waitcnt lgkmcnt(2)
  s_barrier
  v_smfmac_f32_16x16x64_bf16 v[84:87], v[44:47], a[192:199], v11
  ds_read_b128 v[68:71], v8 offset:0
  v_smfmac_f32_16x16x64_bf16 v[84:87], v[48:51], a[208:215], v11
  ds_read_b128 v[72:75], v8 offset:1024
  v_add_f32 v121, v80, v81
  v_smfmac_f32_16x16x64_bf16 v[84:87], v[52:55], a[224:231], v11
  ds_read_b128 v[76:79], v8 offset:2048
  v_add_f32 v123, v82, v83
  v_smfmac_f32_16x16x64_bf16 v[84:87], v[56:59], a[240:247], v11
  ds_read_b128 v[80:83], v8 offset:3072
  v_cvt_pk_bf16_f32 v120, v120, v121
  v_smfmac_f32_16x16x64_bf16 v[84:87], v[60:63], v[224:231], v11
  v_cvt_pk_bf16_f32 v121, v122, v123
  v_smfmac_f32_16x16x64_bf16 v[84:87], v[64:67], v[240:247], v11
  ds_write2_b32 v7, v120, v121 offset0:128 offset1:132
  v_smfmac_f32_16x16x64_bf16 v[88:91], v[44:47], a[200:207], v11
  v_smfmac_f32_16x16x64_bf16 v[88:91], v[48:51], a[216:223], v11
  buffer_load_dwordx4 v[32:35], v1, s[36:39], s78 offen offset:1024 sc1
  v_cvt_pk_bf16_f32 v84, v84, v85
  v_smfmac_f32_16x16x64_bf16 v[88:91], v[52:55], a[232:239], v11
  v_cvt_pk_bf16_f32 v85, v86, v87
  v_smfmac_f32_16x16x64_bf16 v[88:91], v[56:59], a[248:255], v11
  v_smfmac_f32_16x16x64_bf16 v[88:91], v[60:63], v[232:239], v11
  s_waitcnt lgkmcnt(0)
  s_barrier
  v_smfmac_f32_16x16x64_bf16 v[88:91], v[64:67], v[248:255], v11
  ds_read_b128 v[44:47], v8 offset:512
  v_mfma_f32_16x16x32_bf16 v[116:119], v[92:95], v[68:71], 0
  ds_read_b128 v[92:95], v2 offset:49152
  v_mfma_f32_16x16x32_bf16 v[116:119], v[96:99], v[72:75], v[116:119]
  ds_read_b128 v[48:51], v8 offset:1536
  v_cvt_pk_bf16_f32 v88, v88, v89
  v_mfma_f32_16x16x32_bf16 v[116:119], v[100:103], v[76:79], v[116:119]
  ds_read_b128 v[52:55], v8 offset:2560
  v_cvt_pk_bf16_f32 v89, v90, v91
  v_mfma_f32_16x16x32_bf16 v[116:119], v[104:107], v[80:83], v[116:119]
  ds_read_b128 v[56:59], v8 offset:3584
  v_mfma_f32_16x16x32_bf16 v[120:123], v[108:111], v[68:71], 0
  ds_read_b128 v[96:99], v2 offset:50176
  v_mfma_f32_16x16x32_bf16 v[120:123], v[112:115], v[72:75], v[120:123]
  v_exp_f32 v60, v116
  v_mfma_f32_16x16x32_bf16 v[120:123], v[36:39], v[76:79], v[120:123]
  v_exp_f32 v61, v117
  v_mfma_f32_16x16x32_bf16 v[120:123], v[40:43], v[80:83], v[120:123]
  s_waitcnt lgkmcnt(5)
  v_exp_f32 v62, v118
  v_mfma_f32_16x16x32_bf16 v[124:127], v[44:47], v[68:71], 0
  s_waitcnt lgkmcnt(3)
  v_exp_f32 v63, v119
  v_mfma_f32_16x16x32_bf16 v[124:127], v[48:51], v[72:75], v[124:127]
  s_waitcnt lgkmcnt(2)
  v_exp_f32 v64, v120
  v_mfma_f32_16x16x32_bf16 v[124:127], v[52:55], v[76:79], v[124:127]
  s_waitcnt lgkmcnt(1)
  v_exp_f32 v65, v121
  v_mfma_f32_16x16x32_bf16 v[124:127], v[56:59], v[80:83], v[124:127]
  s_waitcnt lgkmcnt(0)
  v_exp_f32 v66, v122
  v_exp_f32 v67, v123
  v_cvt_pk_bf16_f32 v100, v60, v64
  v_cvt_pk_bf16_f32 v101, v61, v65
  v_cvt_pk_bf16_f32 v102, v62, v66
  v_cvt_pk_bf16_f32 v103, v63, v67
  v_exp_f32 v86, v124
  v_mov_b64 v[76:77], 0
  v_mfma_f32_16x16x32_bf16 v[104:107], v[16:19], v[100:103], 0
  v_exp_f32 v87, v126
  v_mfma_f32_16x16x32_bf16 v[108:111], v[92:95], v[100:103], 0
  v_cvt_pk_bf16_f32 v90, v86, v86
  v_cvt_pk_bf16_f32 v91, v87, v87
  v_mfma_f32_16x16x32_bf16 v[112:115], v[96:99], v[100:103], 0
  v_mov_b64 v[78:79], 0
  v_mov_b64 v[80:81], 0
  v_mfma_f32_16x16x16_bf16 v[36:39], v[16:17], v[90:91], 0
  v_mov_b64 v[82:83], 0
  v_mfma_f32_16x16x16_bf16 v[108:111], v[84:85], v[90:91], v[108:111]
  v_mfma_f32_16x16x16_bf16 v[112:115], v[88:89], v[90:91], v[112:115]
  v_fma_f32 v106, v38, 0.5, v106
  v_rcp_f32 v107, v106
  v_mov_b32 v13, 0
  v_mul_f32 v108, v108, v107
  v_mul_f32 v109, v109, v107
  v_mul_f32 v110, v110, v107
  v_mul_f32 v111, v111, v107
  v_cvt_pk_bf16_f32 v100, v108, v109
  v_cvt_pk_bf16_f32 v101, v110, v111
  v_mul_f32 v112, v112, v107
  v_mul_f32 v113, v113, v107
  v_mul_f32 v114, v114, v107
  v_mul_f32 v115, v115, v107
  v_cvt_pk_bf16_f32 v102, v112, v113
  v_cvt_pk_bf16_f32 v103, v114, v115
  v_cndmask_b32 v36, v100, v102, s[84:85]
  v_cndmask_b32 v37, v101, v103, s[84:85]
  ds_write_b64 v10, v[36:37]
  v_max_f32 v104, v106, v107
  v_cmp_nge_f32 vcc, s86, v104
  v_mov_b64 v[44:45], 0
  v_mov_b64 v[46:47], 0
  v_mov_b64 v[48:49], 0
  v_mov_b64 v[50:51], 0
  s_cbranch_vccnz L_smr_f2_0
L_sm_f2_0:
  v_smfmac_f32_16x16x64_bf16 v[76:79], v[100:103], v[128:135], v11
  s_waitcnt lgkmcnt(0)
  s_barrier
  ds_read_b128 v[60:63], v8 offset:7168
  v_smfmac_f32_16x16x64_bf16 v[80:83], v[100:103], v[160:167], v11
  ds_read_b128 v[64:67], v8 offset:4096
  v_mov_b64 v[84:85], 0
  v_smfmac_f32_16x16x64_bf16 v[44:47], v[100:103], v[192:199], v11
  ds_read_b128 v[40:43], v8 offset:5120
  v_mov_b64 v[86:87], 0
  v_smfmac_f32_16x16x64_bf16 v[48:51], v[100:103], v[216:223], v11
  ds_read_b128 v[92:95], v3 offset:0
  s_waitcnt lgkmcnt(3)
  v_smfmac_f32_16x16x64_bf16 v[76:79], v[60:63], v[136:143], v11
  ds_read_b128 v[96:99], v3 offset:1024
  s_waitcnt lgkmcnt(3)
  v_smfmac_f32_16x16x64_bf16 v[76:79], v[64:67], v[144:151], v11
  ds_read_b128 v[52:55], v3 offset:8192
  s_waitcnt lgkmcnt(3)
  v_smfmac_f32_16x16x64_bf16 v[76:79], v[40:43], v[152:159], v11
  ds_read_b128 v[56:59], v3 offset:9216
  v_mov_b64 v[88:89], 0
  v_smfmac_f32_16x16x64_bf16 v[80:83], v[60:63], v[168:175], v11
  ds_read_b128 v[68:71], v3 offset:16384
  v_mov_b64 v[90:91], 0
  v_smfmac_f32_16x16x64_bf16 v[80:83], v[64:67], v[176:183], v11
  ds_read_b128 v[72:75], v3 offset:17408
  v_cvt_pk_bf16_f32 v76, v76, v77
  v_cvt_pk_bf16_f32 v77, v78, v79
  v_and_b32 v76, -2, v76
  v_smfmac_f32_16x16x64_bf16 v[80:83], v[40:43], v[184:191], v11
  s_waitcnt lgkmcnt(2)
  buffer_store_dwordx2 v[76:77], v5, s[36:39], 0 offen
  v_smfmac_f32_16x16x64_bf16 v[44:47], v[60:63], v[200:207], v11
  ds_read_b128 v[116:119], v3 offset:24576
  v_mov_b64 v[76:77], 0
  v_mov_b64 v[78:79], 0
  v_smfmac_f32_16x16x64_bf16 v[44:47], v[64:67], v[208:215], v11
  ds_read_b128 v[120:123], v3 offset:25600
  v_cvt_pk_bf16_f32 v80, v80, v81
  v_cvt_pk_bf16_f32 v81, v82, v83
  v_and_b32 v80, -2, v80
  v_smfmac_f32_16x16x64_bf16 v[44:47], v[40:43], v[92:99], v11
  buffer_store_dwordx2 v[80:81], v5, s[36:39], s74 offen
  v_smfmac_f32_16x16x64_bf16 v[48:51], v[60:63], v[52:59], v11
  s_waitcnt lgkmcnt(2)
  v_mov_b64 v[80:81], 0
  v_mov_b64 v[82:83], 0
  v_smfmac_f32_16x16x64_bf16 v[48:51], v[64:67], v[68:75], v11
  s_waitcnt lgkmcnt(0)
  v_cvt_pk_bf16_f32 v44, v44, v45
  v_cvt_pk_bf16_f32 v45, v46, v47
  v_and_b32 v44, -2, v44
  v_smfmac_f32_16x16x64_bf16 v[48:51], v[40:43], v[116:123], v11
  buffer_store_dwordx2 v[44:45], v5, s[36:39], s76 offen
  v_mov_b64 v[68:69], 0
  v_mov_b64 v[70:71], 0
  v_mov_b32 v13, 0
  v_mov_b32 v13, 0
  v_cvt_pk_bf16_f32 v48, v48, v49
  v_cvt_pk_bf16_f32 v49, v50, v51
  v_and_b32 v48, -2, v48
  buffer_store_dwordx2 v[48:49], v5, s[36:39], s65 offen
  v_mov_b64 v[72:73], 0
  v_mov_b64 v[74:75], 0
  s_waitcnt vmcnt(8)
  ds_write_b128 v2, v[20:23] offset:40960
  s_waitcnt vmcnt(7)
  ds_write_b128 v2, v[24:27] offset:41984
  s_waitcnt vmcnt(6)
  ds_write_b128 v2, v[28:31] offset:49152
  s_waitcnt vmcnt(4)
  ds_write_b128 v2, v[32:35] offset:50176
L_gap_gp20_6_45:
  s_nop 5
  s_nop 4
  s_nop 4
  s_nop 4
  s_nop 4
  s_nop 4
  buffer_load_dwordx4 v[108:111], v1, s[36:39], s64 offen offset:0 sc1
  buffer_load_dwordx4 v[112:115], v1, s[36:39], s64 offen offset:1024 sc1
  ds_read_b128 v[44:47], v1 offset:0
  ds_read_b128 v[48:51], v1 offset:1024
  ds_read_b128 v[52:55], v1 offset:8192
  ds_read_b128 v[56:59], v1 offset:9216
  ds_read_b128 v[60:63], v1 offset:16384
  ds_read_b128 v[64:67], v1 offset:17408
  ds_read_b128 v[92:95], v1 offset:24576
  ds_read_b128 v[96:99], v1 offset:25600
  ds_read_b128 v[100:103], v1 offset:32768
  ds_read_b128 v[104:107], v1 offset:33792
L_gap_gp21_3_46:
  s_nop 4
  s_nop 4
  s_nop 4
  buffer_load_dwordx4 v[36:39], v1, s[36:39], s64 offen offset:0 sc1
  buffer_load_dwordx4 v[40:43], v1, s[36:39], s64 offen offset:1024 sc1
.p2align 5
  s_nop 0
  s_nop 0
  s_nop 0
  s_nop 0
  s_waitcnt vmcnt(3)
  v_mfma_f32_16x16x32_bf16 v[124:127], v[16:19], v[108:111], 0
  v_bitop3_b32 v15, v108, v110, 1 bitop3:0xa8
  v_lshlrev_b32 v15, 1, v15
  s_waitcnt vmcnt(2)
  v_mfma_f32_16x16x32_bf16 v[124:127], v[16:19], v[112:115], v[124:127]
  v_bitop3_b32 v13, v112, v114, 1 bitop3:0xa8
  v_cmp_ne_u32 vcc, v13, v15
  s_cbranch_vccnz L_pb_f2_0r
L_pb_f2_0:
  v_add_f32_dpp v124, v124, v124 row_ror:4 row_mask:0xf bank_mask:0xf
  v_add_f32_dpp v125, v125, v125 row_ror:4 row_mask:0xf bank_mask:0xf
  s_nop 0
  v_add_f32_dpp v124, v124, v124 row_ror:8 row_mask:0xf bank_mask:0xf
  v_add_f32_dpp v125, v125, v125 row_ror:8 row_mask:0xf bank_mask:0xf
  v_cvt_pk_bf16_f32 v14, v124, v125
  v_min_u32 v14, -2, v14
  buffer_store_dword v14, v6, s[36:39], s87 offen
  s_mov_b32 s72, s79
  s_add_u32 s79, s79, 8192
  s_cmp_eq_u32 s68, 62
  s_cbranch_scc1 L_chain_done
  s_add_u32 s68, s68, 2
  v_cmp_ne_u32 vcc, 1, v12
  v_mov_b32 v124, -1
  buffer_store_dword v124, v6, s[36:39], s71 offen
  s_cbranch_vccnz L_flr_f2_0
L_fl_f2_0:
  s_xor_b32 s71, s71, 0x4000
  s_mov_b32 s75, s71
  s_add_u32 s92, s75, 0x1000
L_gap_gp22_3_47:
  s_nop 8
  s_nop 8
  s_nop 8
  buffer_load_dwordx4 v[36:39], v9, s[36:39], s93 offen offset:0 sc1
  buffer_load_dwordx4 v[40:43], v9, s[36:39], s93 offen offset:2048 sc1
  ds_read_b128 v[116:119], v1 offset:40960
  ds_read_b128 v[120:123], v1 offset:41984
  ds_read_b128 v[20:23], v1 offset:49152
  ds_read_b128 v[24:27], v1 offset:50176
  ds_read_b128 v[28:31], v1 offset:57344
  ds_read_b128 v[32:35], v1 offset:58368
  s_waitcnt vmcnt(4)
  ds_read_b128 v[108:111], v2 offset:0
  ds_read_b128 v[112:115], v2 offset:1024
L_gap_gp23_3_48:
  s_nop 5
  s_nop 5
  s_nop 5
  buffer_load_dwordx4 v[36:39], v9, s[36:39], s93 offen offset:0 sc1
  buffer_load_dwordx4 v[40:43], v9, s[36:39], s93 offen offset:2048 sc1
.p2align 5
  s_nop 0
  s_nop 0
  s_nop 0
  s_nop 0
L_step_f2_1:
  s_waitcnt lgkmcnt(0)
  s_waitcnt vmcnt(2)
  v_max_u32 v15, v39, v43
  v_cmp_eq_u32 vcc, -1, v15
  ds_write_b64 v2, v[36:37] offset:32768
  s_cbranch_vccnz L_er0_f2_1
L_eb0_f2_1:
  v_smfmac_f32_16x16x64_bf16 v[88:91], v[36:39], v[44:51], v11
  ds_write_b64 v2, v[38:39] offset:32776
  v_smfmac_f32_16x16x64_bf16 v[88:91], v[40:43], v[52:59], v11
  ds_write_b64 v2, v[40:41] offset:33792
  v_smfmac_f32_16x16x64_bf16 v[84:87], v[36:39], v[60:67], v11
  ds_write_b64 v2, v[42:43] offset:33800
  v_smfmac_f32_16x16x64_bf16 v[84:87], v[40:43], v[92:99], v11
  s_add_u32 s69, s69, 16384
  s_add_u32 s78, s69, 8192
  v_smfmac_f32_16x16x64_bf16 v[80:83], v[36:39], v[100:107], v11
  s_add_u32 s70, s70, 2048
  s_min_u32 s70, s70, s77
  v_smfmac_f32_16x16x64_bf16 v[80:83], v[40:43], v[116:123], v11
  v_smfmac_f32_16x16x64_bf16 v[76:79], v[36:39], v[20:27], v11
  s_waitcnt lgkmcnt(0)
  s_barrier
  ds_read_b128 v[44:47], v4 offset:6144
  v_smfmac_f32_16x16x64_bf16 v[76:79], v[40:43], v[28:35], v11
  ds_read_b128 v[48:51], v4 offset:7168
  v_smfmac_f32_16x16x64_bf16 v[72:75], v[36:39], a[8:15], v11
  ds_read_b128 v[52:55], v4 offset:0
  v_smfmac_f32_16x16x64_bf16 v[72:75], v[40:43], a[24:31], v11
  ds_read_b128 v[56:59], v4 offset:1024
  v_smfmac_f32_16x16x64_bf16 v[68:71], v[36:39], a[0:7], v11
  ds_read_b128 v[60:63], v4 offset:2048
  v_smfmac_f32_16x16x64_bf16 v[68:71], v[40:43], a[16:23], v11
  ds_read_b128 v[64:67], v4 offset:3072
  s_waitcnt lgkmcnt(5)
  v_smfmac_f32_16x16x64_bf16 v[68:71], v[44:47], a[32:39], v11
  ds_read_b128 v[92:95], v2 offset:8192
  s_waitcnt lgkmcnt(5)
  v_smfmac_f32_16x16x64_bf16 v[68:71], v[48:51], a[48:55], v11
  ds_read_b128 v[96:99], v2 offset:9216
  s_waitcnt lgkmcnt(5)
  v_smfmac_f32_16x16x64_bf16 v[68:71], v[52:55], a[64:71], v11
  s_waitcnt lgkmcnt(4)
  buffer_store_dword v14, v6, s[36:39], s72 offen sc1
  v_smfmac_f32_16x16x64_bf16 v[68:71], v[56:59], a[80:87], v11
  ds_read_b128 v[100:103], v2 offset:16384
  s_waitcnt lgkmcnt(4)
  v_smfmac_f32_16x16x64_bf16 v[68:71], v[60:63], a[96:103], v11
  ds_read_b128 v[104:107], v2 offset:17408
  s_waitcnt lgkmcnt(4)
  v_smfmac_f32_16x16x64_bf16 v[68:71], v[64:67], a[112:119], v11
  ds_read_b128 v[116:119], v2 offset:24576
  v_smfmac_f32_16x16x64_bf16 v[72:75], v[44:47], a[40:47], v11
  buffer_load_dwordx4 v[20:23], v1, s[36:39], s69 offen offset:0 sc1
  v_smfmac_f32_16x16x64_bf16 v[72:75], v[48:51], a[56:63], v11
  ds_read_b128 v[120:123], v2 offset:25600
  v_add_f32 v124, v68, v69
  v_smfmac_f32_16x16x64_bf16 v[72:75], v[52:55], a[72:79], v11
  v_add_f32 v126, v70, v71
  v_smfmac_f32_16x16x64_bf16 v[72:75], v[56:59], a[88:95], v11
  v_mul_f32 v124, s73, v124
  v_smfmac_f32_16x16x64_bf16 v[72:75], v[60:63], a[104:111], v11
  buffer_load_dwordx4 v[24:27], v1, s[36:39], s69 offen offset:1024 sc1
  v_mul_f32 v126, s73, v126
  v_smfmac_f32_16x16x64_bf16 v[72:75], v[64:67], a[120:127], v11
  s_waitcnt lgkmcnt(0) vmcnt(3)
  v_smfmac_f32_16x16x64_bf16 v[76:79], v[44:47], v[108:115], v11
  ds_read_b128 v[108:111], v4 offset:9216
  v_smfmac_f32_16x16x64_bf16 v[76:79], v[48:51], v[92:99], v11
  ds_read_b128 v[92:95], v4 offset:8192
  v_add_f32 v125, v72, v73
  v_smfmac_f32_16x16x64_bf16 v[76:79], v[52:55], v[100:107], v11
  buffer_load_dwordx4 v[28:31], v1, s[36:39], s78 offen offset:0 sc1
  v_add_f32 v127, v74, v75
  v_smfmac_f32_16x16x64_bf16 v[76:79], v[56:59], v[116:123], v11
  ds_read_b128 v[96:99], v4 offset:10240
  v_mul_f32 v125, s73, v125
  v_smfmac_f32_16x16x64_bf16 v[76:79], v[60:63], a[160:167], v11
  ds_read_b128 v[100:103], v4 offset:12288
  v_mul_f32 v127, s73, v127
  v_smfmac_f32_16x16x64_bf16 v[76:79], v[64:67], a[176:183], v11
  ds_read_b128 v[104:107], v4 offset:14336
  v_cvt_pk_bf16_f32 v124, v124, v125
  v_smfmac_f32_16x16x64_bf16 v[80:83], v[44:47], a[128:135], v11
  ds_read_b128 v[112:115], v4 offset:11264
  v_cvt_pk_bf16_f32 v125, v126, v127
  v_smfmac_f32_16x16x64_bf16 v[80:83], v[48:51], a[136:143], v11
  ds_write2_b32 v7, v124, v125 offset0:0 offset1:4
  v_smfmac_f32_16x16x64_bf16 v[80:83], v[52:55], a[144:151], v11
  ds_read_b128 v[36:39], v4 offset:13312
  v_add_f32 v120, v76, v77
  v_smfmac_f32_16x16x64_bf16 v[80:83], v[56:59], a[152:159], v11
  ds_read_b128 v[40:43], v4 offset:15360
  v_add_f32 v122, v78, v79
  v_smfmac_f32_16x16x64_bf16 v[80:83], v[60:63], a[168:175], v11
  buffer_load_dword v12, off, s[36:39], s70 sc1
  v_smfmac_f32_16x16x64_bf16 v[80:83], v[64:67], a[184:191], v11
  s_waitcnt lgkmcnt(2)
  s_barrier
  v_smfmac_f32_16x16x64_bf16 v[84:87], v[44:47], a[192:199], v11
  ds_read_b128 v[68:71], v8 offset:0
  v_smfmac_f32_16x16x64_bf16 v[84:87], v[48:51], a[208:215], v11
  ds_read_b128 v[72:75], v8 offset:1024
  v_add_f32 v121, v80, v81
  v_smfmac_f32_16x16x64_bf16 v[84:87], v[52:55], a[224:231], v11
  ds_read_b128 v[76:79], v8 offset:2048
  v_add_f32 v123, v82, v83
  v_smfmac_f32_16x16x64_bf16 v[84:87], v[56:59], a[240:247], v11
  ds_read_b128 v[80:83], v8 offset:3072
  v_cvt_pk_bf16_f32 v120, v120, v121
  v_smfmac_f32_16x16x64_bf16 v[84:87], v[60:63], v[224:231], v11
  v_cvt_pk_bf16_f32 v121, v122, v123
  v_smfmac_f32_16x16x64_bf16 v[84:87], v[64:67], v[240:247], v11
  ds_write2_b32 v7, v120, v121 offset0:128 offset1:132
  v_smfmac_f32_16x16x64_bf16 v[88:91], v[44:47], a[200:207], v11
  v_smfmac_f32_16x16x64_bf16 v[88:91], v[48:51], a[216:223], v11
  buffer_load_dwordx4 v[32:35], v1, s[36:39], s78 offen offset:1024 sc1
  v_cvt_pk_bf16_f32 v84, v84, v85
  v_smfmac_f32_16x16x64_bf16 v[88:91], v[52:55], a[232:239], v11
  v_cvt_pk_bf16_f32 v85, v86, v87
  v_smfmac_f32_16x16x64_bf16 v[88:91], v[56:59], a[248:255], v11
  v_smfmac_f32_16x16x64_bf16 v[88:91], v[60:63], v[232:239], v11
  s_waitcnt lgkmcnt(0)
  s_barrier
  v_smfmac_f32_16x16x64_bf16 v[88:91], v[64:67], v[248:255], v11
  ds_read_b128 v[44:47], v8 offset:512
  v_mfma_f32_16x16x32_bf16 v[116:119], v[92:95], v[68:71], 0
  ds_read_b128 v[92:95], v2 offset:49152
  v_mfma_f32_16x16x32_bf16 v[116:119], v[96:99], v[72:75], v[116:119]
  ds_read_b128 v[48:51], v8 offset:1536
  v_cvt_pk_bf16_f32 v88, v88, v89
  v_mfma_f32_16x16x32_bf16 v[116:119], v[100:103], v[76:79], v[116:119]
  ds_read_b128 v[52:55], v8 offset:2560
  v_cvt_pk_bf16_f32 v89, v90, v91
  v_mfma_f32_16x16x32_bf16 v[116:119], v[104:107], v[80:83], v[116:119]
  ds_read_b128 v[56:59], v8 offset:3584
  v_mfma_f32_16x16x32_bf16 v[120:123], v[108:111], v[68:71], 0
  ds_read_b128 v[96:99], v2 offset:50176
  v_mfma_f32_16x16x32_bf16 v[120:123], v[112:115], v[72:75], v[120:123]
  v_exp_f32 v60, v116
  v_mfma_f32_16x16x32_bf16 v[120:123], v[36:39], v[76:79], v[120:123]
  v_exp_f32 v61, v117
  v_mfma_f32_16x16x32_bf16 v[120:123], v[40:43], v[80:83], v[120:123]
  s_waitcnt lgkmcnt(5)
  v_exp_f32 v62, v118
  v_mfma_f32_16x16x32_bf16 v[124:127], v[44:47], v[68:71], 0
  s_waitcnt lgkmcnt(3)
  v_exp_f32 v63, v119
  v_mfma_f32_16x16x32_bf16 v[124:127], v[48:51], v[72:75], v[124:127]
  s_waitcnt lgkmcnt(2)
  v_exp_f32 v64, v120
  v_mfma_f32_16x16x32_bf16 v[124:127], v[52:55], v[76:79], v[124:127]
  s_waitcnt lgkmcnt(1)
  v_exp_f32 v65, v121
  v_mfma_f32_16x16x32_bf16 v[124:127], v[56:59], v[80:83], v[124:127]
  s_waitcnt lgkmcnt(0)
  v_exp_f32 v66, v122
  v_exp_f32 v67, v123
  v_cvt_pk_bf16_f32 v100, v60, v64
  v_cvt_pk_bf16_f32 v101, v61, v65
  v_cvt_pk_bf16_f32 v102, v62, v66
  v_cvt_pk_bf16_f32 v103, v63, v67
  v_exp_f32 v86, v124
  v_mov_b64 v[76:77], 0
  v_mfma_f32_16x16x32_bf16 v[104:107], v[16:19], v[100:103], 0
  v_exp_f32 v87, v126
  v_mfma_f32_16x16x32_bf16 v[108:111], v[92:95], v[100:103], 0
  v_cvt_pk_bf16_f32 v90, v86, v86
  v_cvt_pk_bf16_f32 v91, v87, v87
  v_mfma_f32_16x16x32_bf16 v[112:115], v[96:99], v[100:103], 0
  v_mov_b64 v[78:79], 0
  v_mov_b64 v[80:81], 0
  v_mfma_f32_16x16x16_bf16 v[36:39], v[16:17], v[90:91], 0
  v_mov_b64 v[82:83], 0
  v_mfma_f32_16x16x16_bf16 v[108:111], v[84:85], v[90:91], v[108:111]
  v_mfma_f32_16x16x16_bf16 v[112:115], v[88:89], v[90:91], v[112:115]
  v_fma_f32 v106, v38, 0.5, v106
  v_rcp_f32 v107, v106
  v_mov_b32 v13, 0
  v_mul_f32 v108, v108, v107
  v_mul_f32 v109, v109, v107
  v_mul_f32 v110, v110, v107
  v_mul_f32 v111, v111, v107
  v_cvt_pk_bf16_f32 v100, v108, v109
  v_cvt_pk_bf16_f32 v101, v110, v111
  v_mul_f32 v112, v112, v107
  v_mul_f32 v113, v113, v107
  v_mul_f32 v114, v114, v107
  v_mul_f32 v115, v115, v107
  v_cvt_pk_bf16_f32 v102, v112, v113
  v_cvt_pk_bf16_f32 v103, v114, v115
  v_cndmask_b32 v36, v100, v102, s[84:85]
  v_cndmask_b32 v37, v101, v103, s[84:85]
  ds_write_b64 v10, v[36:37]
  v_max_f32 v104, v106, v107
  v_cmp_nge_f32 vcc, s86, v104
  v_mov_b64 v[44:45], 0
  v_mov_b64 v[46:47], 0
  v_mov_b64 v[48:49], 0
  v_mov_b64 v[50:51], 0
  s_cbranch_vccnz L_smr_f2_1
L_sm_f2_1:
  v_smfmac_f32_16x16x64_bf16 v[76:79], v[100:103], v[128:135], v11
  s_waitcnt lgkmcnt(0)
  s_barrier
  ds_read_b128 v[60:63], v8 offset:7168
  v_smfmac_f32_16x16x64_bf16 v[80:83], v[100:103], v[160:167], v11
  ds_read_b128 v[64:67], v8 offset:4096
  v_mov_b64 v[84:85], 0
  v_smfmac_f32_16x16x64_bf16 v[44:47], v[100:103], v[192:199], v11
  ds_read_b128 v[40:43], v8 offset:5120
  v_mov_b64 v[86:87], 0
  v_smfmac_f32_16x16x64_bf16 v[48:51], v[100:103], v[216:223], v11
  ds_read_b128 v[92:95], v3 offset:0
  s_waitcnt lgkmcnt(3)
  v_smfmac_f32_16x16x64_bf16 v[76:79], v[60:63], v[136:143], v11
  ds_read_b128 v[96:99], v3 offset:1024
  s_waitcnt lgkmcnt(3)
  v_smfmac_f32_16x16x64_bf16 v[76:79], v[64:67], v[144:151], v11
  ds_read_b128 v[52:55], v3 offset:8192
  s_waitcnt lgkmcnt(3)
  v_smfmac_f32_16x16x64_bf16 v[76:79], v[40:43], v[152:159], v11
  ds_read_b128 v[56:59], v3 offset:9216
  v_mov_b64 v[88:89], 0
  v_smfmac_f32_16x16x64_bf16 v[80:83], v[60:63], v[168:175], v11
  ds_read_b128 v[68:71], v3 offset:16384
  v_mov_b64 v[90:91], 0
  v_smfmac_f32_16x16x64_bf16 v[80:83], v[64:67], v[176:183], v11
  ds_read_b128 v[72:75], v3 offset:17408
  v_cvt_pk_bf16_f32 v76, v76, v77
  v_cvt_pk_bf16_f32 v77, v78, v79
  v_or_b32 v76, 1, v76
  v_smfmac_f32_16x16x64_bf16 v[80:83], v[40:43], v[184:191], v11
  s_waitcnt lgkmcnt(2)
  buffer_store_dwordx2 v[76:77], v5, s[36:39], 0 offen
  v_smfmac_f32_16x16x64_bf16 v[44:47], v[60:63], v[200:207], v11
  ds_read_b128 v[116:119], v3 offset:24576
  v_mov_b64 v[76:77], 0
  v_mov_b64 v[78:79], 0
  v_smfmac_f32_16x16x64_bf16 v[44:47], v[64:67], v[208:215], v11
  ds_read_b128 v[120:123], v3 offset:25600
  v_cvt_pk_bf16_f32 v80, v80, v81
  v_cvt_pk_bf16_f32 v81, v82, v83
  v_or_b32 v80, 1, v80
  v_smfmac_f32_16x16x64_bf16 v[44:47], v[40:43], v[92:99], v11
  buffer_store_dwordx2 v[80:81], v5, s[36:39], s74 offen
  v_smfmac_f32_16x16x64_bf16 v[48:51], v[60:63], v[52:59], v11
  s_waitcnt lgkmcnt(2)
  v_mov_b64 v[80:81], 0
  v_mov_b64 v[82:83], 0
  v_smfmac_f32_16x16x64_bf16 v[48:51], v[64:67], v[68:75], v11
  s_waitcnt lgkmcnt(0)
  v_cvt_pk_bf16_f32 v44, v44, v45
  v_cvt_pk_bf16_f32 v45, v46, v47
  v_or_b32 v44, 1, v44
  v_smfmac_f32_16x16x64_bf16 v[48:51], v[40:43], v[116:123], v11
  buffer_store_dwordx2 v[44:45], v5, s[36:39], s76 offen
  v_mov_b64 v[68:69], 0
  v_mov_b64 v[70:71], 0
  v_mov_b32 v13, 0
  v_mov_b32 v13, 0
  v_cvt_pk_bf16_f32 v48, v48, v49
  v_cvt_pk_bf16_f32 v49, v50, v51
  v_or_b32 v48, 1, v48
  buffer_store_dwordx2 v[48:49], v5, s[36:39], s65 offen
  v_mov_b64 v[72:73], 0
  v_mov_b64 v[74:75], 0
  s_waitcnt vmcnt(8)
  ds_write_b128 v2, v[20:23] offset:40960
  s_waitcnt vmcnt(7)
  ds_write_b128 v2, v[24:27] offset:41984
  s_waitcnt vmcnt(6)
  ds_write_b128 v2, v[28:31] offset:49152
  s_waitcnt vmcnt(4)
  ds_write_b128 v2, v[32:35] offset:50176
L_gap_gp20_6_49:
  s_nop 5
  s_nop 4
  s_nop 4
  s_nop 4
  s_nop 4
  s_nop 4
  buffer_load_dwordx4 v[108:111], v1, s[36:39], s64 offen offset:0 sc1
  buffer_load_dwordx4 v[112:115], v1, s[36:39], s64 offen offset:1024 sc1
  ds_read_b128 v[44:47], v1 offset:0
  ds_read_b128 v[48:51], v1 offset:1024
  ds_read_b128 v[52:55], v1 offset:8192
  ds_read_b128 v[56:59], v1 offset:9216
  ds_read_b128 v[60:63], v1 offset:16384
  ds_read_b128 v[64:67], v1 offset:17408
  ds_read_b128 v[92:95], v1 offset:24576
  ds_read_b128 v[96:99], v1 offset:25600
  ds_read_b128 v[100:103], v1 offset:32768
  ds_read_b128 v[104:107], v1 offset:33792
L_gap_gp21_3_50:
  s_nop 4
  s_nop 4
  s_nop 4
  buffer_load_dwordx4 v[36:39], v1, s[36:39], s64 offen offset:0 sc1
  buffer_load_dwordx4 v[40:43], v1, s[36:39], s64 offen offset:1024 sc1
.p2align 5
  s_nop 0
  s_nop 0
  s_nop 0
  s_nop 0
  s_waitcnt vmcnt(3)
  v_mfma_f32_16x16x32_bf16 v[124:127], v[16:19], v[108:111], 0
  v_bitop3_b32 v15, v108, v110, 1 bitop3:0x80
  v_sub_u32 v15, 2, v15
  s_waitcnt vmcnt(2)
  v_mfma_f32_16x16x32_bf16 v[124:127], v[16:19], v[112:115], v[124:127]
  v_bitop3_b32 v13, v112, v114, 1 bitop3:0x80
  v_cmp_ne_u32 vcc, v13, v15
  s_cbranch_vccnz L_pb_f2_1r
L_pb_f2_1:
  v_add_f32_dpp v124, v124, v124 row_ror:4 row_mask:0xf bank_mask:0xf
  v_add_f32_dpp v125, v125, v125 row_ror:4 row_mask:0xf bank_mask:0xf
  s_nop 0
  v_add_f32_dpp v124, v124, v124 row_ror:8 row_mask:0xf bank_mask:0xf
  v_add_f32_dpp v125, v125, v125 row_ror:8 row_mask:0xf bank_mask:0xf
  v_cvt_pk_bf16_f32 v14, v124, v125
  v_min_u32 v14, -2, v14
  buffer_store_dword v14, v6, s[36:39], s71 offen
  s_mov_b32 s72, s79
  s_add_u32 s79, s79, 8192
  v_cmp_ne_u32 vcc, 1, v12
  v_mov_b32 v124, -1
  buffer_store_dword v124, v6, s[36:39], s87 offen
  s_cbranch_vccnz L_flr_f2_1
L_fl_f2_1:
  s_xor_b32 s87, s87, 0x4000
  s_xor_b32 s93, s93, 0x4000
L_gap_gp22_3_51:
  s_nop 8
  s_nop 8
  s_nop 8
  buffer_load_dwordx4 v[36:39], v9, s[36:39], s92 offen offset:0 sc1
  buffer_load_dwordx4 v[40:43], v9, s[36:39], s92 offen offset:2048 sc1
  ds_read_b128 v[116:119], v1 offset:40960
  ds_read_b128 v[120:123], v1 offset:41984
  ds_read_b128 v[20:23], v1 offset:49152
  ds_read_b128 v[24:27], v1 offset:50176
  ds_read_b128 v[28:31], v1 offset:57344
  ds_read_b128 v[32:35], v1 offset:58368
  s_waitcnt vmcnt(4)
  ds_read_b128 v[108:111], v2 offset:0
  ds_read_b128 v[112:115], v2 offset:1024
L_gap_gp23_3_52:
  s_nop 5
  s_nop 5
  s_nop 5
  buffer_load_dwordx4 v[36:39], v9, s[36:39], s92 offen offset:0 sc1
  buffer_load_dwordx4 v[40:43], v9, s[36:39], s92 offen offset:2048 sc1
  s_branch L_step_f2_0
L_er0_f2_0:
  buffer_load_dwordx4 v[36:39], v9, s[36:39], s92 offen offset:0 sc1
  buffer_load_dwordx4 v[40:43], v9, s[36:39], s92 offen offset:2048 sc1
  s_waitcnt vmcnt(2)
  v_max_u32 v15, v39, v43
  v_cmp_eq_u32 vcc, -1, v15
  s_cbranch_vccz L_eb0_f2_0o
L_er0_f2_0s:
  buffer_load_dwordx4 v[36:39], v9, s[36:39], s92 offen offset:0 sc1
  buffer_load_dwordx4 v[40:43], v9, s[36:39], s92 offen offset:2048 sc1
  s_waitcnt vmcnt(2)
  v_max_u32 v15, v39, v43
  v_cmp_eq_u32 vcc, -1, v15
  s_cbranch_vccz L_eb0_f2_0o
  s_sub_u32 s3, s3, 1
  s_cbranch_scc1 L_end
  s_branch L_er0_f2_0s
L_eb0_f2_0o:
  ds_write_b64 v2, v[36:37] offset:32768
  s_branch L_eb0_f2_0
L_smr_f2_0:
  v_max_f32 v86, v116, v120
  v_max3_f32 v86, v86, v117, v121
  v_max3_f32 v86, v86, v118, v122
  v_max3_f32 v86, v86, v119, v123
  v_max3_f32 v86, v86, v124, v126
  v_mov_b32 v87, v86
  s_nop 1
  v_permlane32_swap_b32 v86, v87
  v_max_f32 v86, v86, v87
  v_mov_b32 v87, v86
  s_nop 1
  v_permlane16_swap_b32 v86, v87
  v_max_f32 v86, v86, v87
  v_sub_f32 v116, v116, v86
  v_sub_f32 v120, v120, v86
  v_sub_f32 v117, v117, v86
  v_sub_f32 v121, v121, v86
  v_sub_f32 v118, v118, v86
  v_sub_f32 v122, v122, v86
  v_sub_f32 v119, v119, v86
  v_sub_f32 v123, v123, v86
  v_sub_f32 v124, v124, v86
  v_sub_f32 v126, v126, v86
  v_exp_f32 v116, v116
  v_exp_f32 v120, v120
  v_exp_f32 v117, v117
  v_exp_f32 v121, v121
  v_exp_f32 v118, v118
  v_exp_f32 v122, v122
  v_exp_f32 v119, v119
  v_exp_f32 v123, v123
  v_exp_f32 v124, v124
  v_exp_f32 v126, v126
  v_cvt_pk_bf16_f32 v100, v116, v120
  v_cvt_pk_bf16_f32 v101, v117, v121
  v_cvt_pk_bf16_f32 v102, v118, v122
  v_cvt_pk_bf16_f32 v103, v119, v123
  v_cvt_pk_bf16_f32 v90, v124, v124
  v_cvt_pk_bf16_f32 v91, v126, v126
  s_waitcnt lgkmcnt(0)
  v_mov_b64 v[76:77], 0
  v_mov_b64 v[78:79], 0
  v_mfma_f32_16x16x32_bf16 v[104:107], v[16:19], v[100:103], 0
  v_mfma_f32_16x16x32_bf16 v[108:111], v[92:95], v[100:103], 0
  v_mfma_f32_16x16x32_bf16 v[112:115], v[96:99], v[100:103], 0
  v_mfma_f32_16x16x16_bf16 v[36:39], v[16:17], v[90:91], 0
  v_mfma_f32_16x16x16_bf16 v[108:111], v[84:85], v[90:91], v[108:111]
  v_mfma_f32_16x16x16_bf16 v[112:115], v[88:89], v[90:91], v[112:115]
  v_fma_f32 v106, v38, 0.5, v106
  v_rcp_f32 v107, v106
  s_nop 0
  v_mul_f32 v108, v108, v107
  v_mul_f32 v109, v109, v107
  v_mul_f32 v110, v110, v107
  v_mul_f32 v111, v111, v107
  v_cvt_pk_bf16_f32 v100, v108, v109
  v_cvt_pk_bf16_f32 v101, v110, v111
  v_mul_f32 v112, v112, v107
  v_mul_f32 v113, v113, v107
  v_mul_f32 v114, v114, v107
  v_mul_f32 v115, v115, v107
  v_cvt_pk_bf16_f32 v102, v112, v113
  v_cvt_pk_bf16_f32 v103, v114, v115
  v_cndmask_b32 v36, v100, v102, s[84:85]
  v_cndmask_b32 v37, v101, v103, s[84:85]
  ds_write_b64 v10, v[36:37]
  s_branch L_sm_f2_0
L_pb_f2_0r:
  buffer_load_dwordx4 v[108:111], v1, s[36:39], s64 offen offset:0 sc1
  buffer_load_dwordx4 v[112:115], v1, s[36:39], s64 offen offset:1024 sc1
  s_waitcnt vmcnt(3)
  v_mfma_f32_16x16x32_bf16 v[124:127], v[16:19], v[36:39], 0
  v_bitop3_b32 v15, v36, v38, 1 bitop3:0xa8
  v_lshlrev_b32 v15, 1, v15
  s_waitcnt vmcnt(2)
  v_mfma_f32_16x16x32_bf16 v[124:127], v[16:19], v[40:43], v[124:127]
  v_bitop3_b32 v13, v40, v42, 1 bitop3:0xa8
  v_cmp_ne_u32 vcc, v13, v15
  s_cbranch_vccz L_pb_f2_0
L_pb_f2_0s:
  buffer_load_dwordx4 v[36:39], v1, s[36:39], s64 offen offset:0 sc1
  buffer_load_dwordx4 v[40:43], v1, s[36:39], s64 offen offset:1024 sc1
  s_waitcnt vmcnt(3)
  v_mfma_f32_16x16x32_bf16 v[124:127], v[16:19], v[108:111], 0
  v_bitop3_b32 v15, v108, v110, 1 bitop3:0xa8
  v_lshlrev_b32 v15, 1, v15
  s_waitcnt vmcnt(2)
  v_mfma_f32_16x16x32_bf16 v[124:127], v[16:19], v[112:115], v[124:127]
  v_bitop3_b32 v13, v112, v114, 1 bitop3:0xa8
  v_cmp_ne_u32 vcc, v13, v15
  s_cbranch_vccz L_pb_f2_0
  buffer_load_dwordx4 v[108:111], v1, s[36:39], s64 offen offset:0 sc1
  buffer_load_dwordx4 v[112:115], v1, s[36:39], s64 offen offset:1024 sc1
  s_waitcnt vmcnt(3)
  v_mfma_f32_16x16x32_bf16 v[124:127], v[16:19], v[36:39], 0
  v_bitop3_b32 v15, v36, v38, 1 bitop3:0xa8
  v_lshlrev_b32 v15, 1, v15
  s_waitcnt vmcnt(2)
  v_mfma_f32_16x16x32_bf16 v[124:127], v[16:19], v[40:43], v[124:127]
  v_bitop3_b32 v13, v40, v42, 1 bitop3:0xa8
  v_cmp_ne_u32 vcc, v13, v15
  s_cbranch_vccz L_pb_f2_0
  s_sub_u32 s3, s3, 1
  s_cbranch_scc1 L_end
  s_branch L_pb_f2_0s
L_flr_f2_0:
L_spin_53:
  buffer_load_dword v12, off, s[36:39], s70 sc1
  s_waitcnt vmcnt(0)
  v_cmp_ne_u32 vcc, 1, v12
  s_cbranch_vccz L_ok_54
  s_sub_u32 s3, s3, 1
  s_cbranch_scc1 L_end
  s_sleep 2
  s_branch L_spin_53
L_ok_54:
  s_branch L_fl_f2_0
L_er0_f2_1:
  buffer_load_dwordx4 v[36:39], v9, s[36:39], s93 offen offset:0 sc1
  buffer_load_dwordx4 v[40:43], v9, s[36:39], s93 offen offset:2048 sc1
  s_waitcnt vmcnt(2)
  v_max_u32 v15, v39, v43
  v_cmp_eq_u32 vcc, -1, v15
  s_cbranch_vccz L_eb0_f2_1o
L_er0_f2_1s:
  buffer_load_dwordx4 v[36:39], v9, s[36:39], s93 offen offset:0 sc1
  buffer_load_dwordx4 v[40:43], v9, s[36:39], s93 offen offset:2048 sc1
  s_waitcnt vmcnt(2)
  v_max_u32 v15, v39, v43
  v_cmp_eq_u32 vcc, -1, v15
  s_cbranch_vccz L_eb0_f2_1o
  s_sub_u32 s3, s3, 1
  s_cbranch_scc1 L_end
  s_branch L_er0_f2_1s
L_eb0_f2_1o:
  ds_write_b64 v2, v[36:37] offset:32768
  s_branch L_eb0_f2_1
L_smr_f2_1:
  v_max_f32 v86, v116, v120
  v_max3_f32 v86, v86, v117, v121
  v_max3_f32 v86, v86, v118, v122
  v_max3_f32 v86, v86, v119, v123
  v_max3_f32 v86, v86, v124, v126
  v_mov_b32 v87, v86
  s_nop 1
  v_permlane32_swap_b32 v86, v87
  v_max_f32 v86, v86, v87
  v_mov_b32 v87, v86
  s_nop 1
  v_permlane16_swap_b32 v86, v87
  v_max_f32 v86, v86, v87
  v_sub_f32 v116, v116, v86
  v_sub_f32 v120, v120, v86
  v_sub_f32 v117, v117, v86
  v_sub_f32 v121, v121, v86
  v_sub_f32 v118, v118, v86
  v_sub_f32 v122, v122, v86
  v_sub_f32 v119, v119, v86
  v_sub_f32 v123, v123, v86
  v_sub_f32 v124, v124, v86
  v_sub_f32 v126, v126, v86
  v_exp_f32 v116, v116
  v_exp_f32 v120, v120
  v_exp_f32 v117, v117
  v_exp_f32 v121, v121
  v_exp_f32 v118, v118
  v_exp_f32 v122, v122
  v_exp_f32 v119, v119
  v_exp_f32 v123, v123
  v_exp_f32 v124, v124
  v_exp_f32 v126, v126
  v_cvt_pk_bf16_f32 v100, v116, v120
  v_cvt_pk_bf16_f32 v101, v117, v121
  v_cvt_pk_bf16_f32 v102, v118, v122
  v_cvt_pk_bf16_f32 v103, v119, v123
  v_cvt_pk_bf16_f32 v90, v124, v124
  v_cvt_pk_bf16_f32 v91, v126, v126
  s_waitcnt lgkmcnt(0)
  v_mov_b64 v[76:77], 0
  v_mov_b64 v[78:79], 0
  v_mfma_f32_16x16x32_bf16 v[104:107], v[16:19], v[100:103], 0
  v_mfma_f32_16x16x32_bf16 v[108:111], v[92:95], v[100:103], 0
  v_mfma_f32_16x16x32_bf16 v[112:115], v[96:99], v[100:103], 0
  v_mfma_f32_16x16x16_bf16 v[36:39], v[16:17], v[90:91], 0
  v_mfma_f32_16x16x16_bf16 v[108:111], v[84:85], v[90:91], v[108:111]
  v_mfma_f32_16x16x16_bf16 v[112:115], v[88:89], v[90:91], v[112:115]
  v_fma_f32 v106, v38, 0.5, v106
  v_rcp_f32 v107, v106
  s_nop 0
  v_mul_f32 v108, v108, v107
  v_mul_f32 v109, v109, v107
  v_mul_f32 v110, v110, v107
  v_mul_f32 v111, v111, v107
  v_cvt_pk_bf16_f32 v100, v108, v109
  v_cvt_pk_bf16_f32 v101, v110, v111
  v_mul_f32 v112, v112, v107
  v_mul_f32 v113, v113, v107
  v_mul_f32 v114, v114, v107
  v_mul_f32 v115, v115, v107
  v_cvt_pk_bf16_f32 v102, v112, v113
  v_cvt_pk_bf16_f32 v103, v114, v115
  v_cndmask_b32 v36, v100, v102, s[84:85]
  v_cndmask_b32 v37, v101, v103, s[84:85]
  ds_write_b64 v10, v[36:37]
  s_branch L_sm_f2_1
L_pb_f2_1r:
  buffer_load_dwordx4 v[108:111], v1, s[36:39], s64 offen offset:0 sc1
  buffer_load_dwordx4 v[112:115], v1, s[36:39], s64 offen offset:1024 sc1
  s_waitcnt vmcnt(3)
  v_mfma_f32_16x16x32_bf16 v[124:127], v[16:19], v[36:39], 0
  v_bitop3_b32 v15, v36, v38, 1 bitop3:0x80
  v_sub_u32 v15, 2, v15
  s_waitcnt vmcnt(2)
  v_mfma_f32_16x16x32_bf16 v[124:127], v[16:19], v[40:43], v[124:127]
  v_bitop3_b32 v13, v40, v42, 1 bitop3:0x80
  v_cmp_ne_u32 vcc, v13, v15
  s_cbranch_vccz L_pb_f2_1
L_pb_f2_1s:
  buffer_load_dwordx4 v[36:39], v1, s[36:39], s64 offen offset:0 sc1
  buffer_load_dwordx4 v[40:43], v1, s[36:39], s64 offen offset:1024 sc1
  s_waitcnt vmcnt(3)
  v_mfma_f32_16x16x32_bf16 v[124:127], v[16:19], v[108:111], 0
  v_bitop3_b32 v15, v108, v110, 1 bitop3:0x80
  v_sub_u32 v15, 2, v15
  s_waitcnt vmcnt(2)
  v_mfma_f32_16x16x32_bf16 v[124:127], v[16:19], v[112:115], v[124:127]
  v_bitop3_b32 v13, v112, v114, 1 bitop3:0x80
  v_cmp_ne_u32 vcc, v13, v15
  s_cbranch_vccz L_pb_f2_1
  buffer_load_dwordx4 v[108:111], v1, s[36:39], s64 offen offset:0 sc1
  buffer_load_dwordx4 v[112:115], v1, s[36:39], s64 offen offset:1024 sc1
  s_waitcnt vmcnt(3)
  v_mfma_f32_16x16x32_bf16 v[124:127], v[16:19], v[36:39], 0
  v_bitop3_b32 v15, v36, v38, 1 bitop3:0x80
  v_sub_u32 v15, 2, v15
  s_waitcnt vmcnt(2)
  v_mfma_f32_16x16x32_bf16 v[124:127], v[16:19], v[40:43], v[124:127]
  v_bitop3_b32 v13, v40, v42, 1 bitop3:0x80
  v_cmp_ne_u32 vcc, v13, v15
  s_cbranch_vccz L_pb_f2_1
  s_sub_u32 s3, s3, 1
  s_cbranch_scc1 L_end
  s_branch L_pb_f2_1s
L_flr_f2_1:
L_spin_55:
  buffer_load_dword v12, off, s[36:39], s70 sc1
  s_waitcnt vmcnt(0)
  v_cmp_ne_u32 vcc, 1, v12
  s_cbranch_vccz L_ok_56
  s_sub_u32 s3, s3, 1
  s_cbranch_scc1 L_end
  s_sleep 2
  s_branch L_spin_55
L_ok_56:
  s_branch L_fl_f2_1
.p2align 5
  s_nop 0
  s_nop 0
  s_nop 0
  s_nop 0
L_step_f3_0:
  s_waitcnt lgkmcnt(0)
  s_waitcnt vmcnt(2)
  v_max_u32 v15, v39, v43
  v_cmp_eq_u32 vcc, -1, v15
  ds_write_b64 v2, v[36:37] offset:32768
  s_cbranch_vccnz L_er0_f3_0
L_eb0_f3_0:
  v_smfmac_f32_16x16x64_bf16 v[88:91], v[36:39], v[44:51], v11
  ds_write_b64 v2, v[38:39] offset:32776
  v_smfmac_f32_16x16x64_bf16 v[88:91], v[40:43], v[52:59], v11
  ds_write_b64 v2, v[40:41] offset:33792
  v_smfmac_f32_16x16x64_bf16 v[84:87], v[36:39], v[60:67], v11
  ds_write_b64 v2, v[42:43] offset:33800
  v_smfmac_f32_16x16x64_bf16 v[84:87], v[40:43], v[92:99], v11
  s_add_u32 s69, s69, 16384
  s_add_u32 s78, s69, 8192
  v_smfmac_f32_16x16x64_bf16 v[80:83], v[36:39], v[100:107], v11
  s_add_u32 s70, s70, 2048
  s_min_u32 s70, s70, s77
  v_smfmac_f32_16x16x64_bf16 v[80:83], v[40:43], v[116:123], v11
  v_smfmac_f32_16x16x64_bf16 v[76:79], v[36:39], v[20:27], v11
  s_waitcnt lgkmcnt(0)
  s_barrier
  ds_read_b128 v[44:47], v4 offset:4096
  v_smfmac_f32_16x16x64_bf16 v[76:79], v[40:43], v[28:35], v11
  ds_read_b128 v[48:51], v4 offset:5120
  v_smfmac_f32_16x16x64_bf16 v[72:75], v[36:39], a[8:15], v11
  ds_read_b128 v[52:55], v4 offset:2048
  v_smfmac_f32_16x16x64_bf16 v[72:75], v[40:43], a[24:31], v11
  ds_read_b128 v[56:59], v4 offset:3072
  v_smfmac_f32_16x16x64_bf16 v[68:71], v[36:39], a[0:7], v11
  ds_read_b128 v[60:63], v4 offset:0
  v_smfmac_f32_16x16x64_bf16 v[68:71], v[40:43], a[16:23], v11
  ds_read_b128 v[64:67], v4 offset:1024
  s_waitcnt lgkmcnt(5)
  v_smfmac_f32_16x16x64_bf16 v[68:71], v[44:47], a[32:39], v11
  ds_read_b128 v[92:95], v2 offset:8192
  s_waitcnt lgkmcnt(5)
  v_smfmac_f32_16x16x64_bf16 v[68:71], v[48:51], a[48:55], v11
  ds_read_b128 v[96:99], v2 offset:9216
  s_waitcnt lgkmcnt(5)
  v_smfmac_f32_16x16x64_bf16 v[68:71], v[52:55], a[64:71], v11
  ds_read_b128 v[100:103], v2 offset:16384
  s_waitcnt lgkmcnt(5)
  v_smfmac_f32_16x16x64_bf16 v[68:71], v[56:59], a[80:87], v11
  s_waitcnt lgkmcnt(4)
  buffer_store_dword v14, v6, s[36:39], s72 offen sc1
  v_smfmac_f32_16x16x64_bf16 v[68:71], v[60:63], a[96:103], v11
  ds_read_b128 v[104:107], v2 offset:17408
  s_waitcnt lgkmcnt(4)
  v_smfmac_f32_16x16x64_bf16 v[68:71], v[64:67], a[112:119], v11
  ds_read_b128 v[116:119], v2 offset:24576
  v_smfmac_f32_16x16x64_bf16 v[72:75], v[44:47], a[40:47], v11
  ds_read_b128 v[120:123], v2 offset:25600
  v_smfmac_f32_16x16x64_bf16 v[72:75], v[48:51], a[56:63], v11
  buffer_load_dwordx4 v[20:23], v1, s[36:39], s69 offen offset:0 sc1
  v_add_f32 v124, v68, v69
  v_smfmac_f32_16x16x64_bf16 v[72:75], v[52:55], a[72:79], v11
  v_add_f32 v126, v70, v71
  v_smfmac_f32_16x16x64_bf16 v[72:75], v[56:59], a[88:95], v11
  v_mul_f32 v124, s73, v124
  v_smfmac_f32_16x16x64_bf16 v[72:75], v[60:63], a[104:111], v11
  v_mul_f32 v126, s73, v126
  v_smfmac_f32_16x16x64_bf16 v[72:75], v[64:67], a[120:127], v11
  buffer_load_dwordx4 v[24:27], v1, s[36:39], s69 offen offset:1024 sc1
  s_waitcnt lgkmcnt(0) vmcnt(3)
  v_smfmac_f32_16x16x64_bf16 v[76:79], v[44:47], v[108:115], v11
  ds_read_b128 v[108:111], v4 offset:9216
  v_smfmac_f32_16x16x64_bf16 v[76:79], v[48:51], v[92:99], v11
  ds_read_b128 v[92:95], v4 offset:8192
  v_add_f32 v125, v72, v73
  v_smfmac_f32_16x16x64_bf16 v[76:79], v[52:55], v[100:107], v11
  ds_read_b128 v[96:99], v4 offset:10240
  v_add_f32 v127, v74, v75
  v_smfmac_f32_16x16x64_bf16 v[76:79], v[56:59], v[116:123], v11
  buffer_load_dwordx4 v[28:31], v1, s[36:39], s78 offen offset:0 sc1
  v_mul_f32 v125, s73, v125
  v_smfmac_f32_16x16x64_bf16 v[76:79], v[60:63], a[160:167], v11
  ds_read_b128 v[100:103], v4 offset:12288
  v_mul_f32 v127, s73, v127
  v_smfmac_f32_16x16x64_bf16 v[76:79], v[64:67], a[176:183], v11
  ds_read_b128 v[104:107], v4 offset:14336
  v_cvt_pk_bf16_f32 v124, v124, v125
  v_smfmac_f32_16x16x64_bf16 v[80:83], v[44:47], a[128:135], v11
  ds_read_b128 v[112:115], v4 offset:11264
  v_cvt_pk_bf16_f32 v125, v126, v127
  v_smfmac_f32_16x16x64_bf16 v[80:83], v[48:51], a[136:143], v11
  ds_write2_b32 v7, v124, v125 offset0:0 offset1:4
  v_smfmac_f32_16x16x64_bf16 v[80:83], v[52:55], a[144:151], v11
  ds_read_b128 v[36:39], v4 offset:13312
  v_add_f32 v120, v76, v77
  v_smfmac_f32_16x16x64_bf16 v[80:83], v[56:59], a[152:159], v11
  ds_read_b128 v[40:43], v4 offset:15360
  v_add_f32 v122, v78, v79
  v_smfmac_f32_16x16x64_bf16 v[80:83], v[60:63], a[168:175], v11
  buffer_load_dword v12, off, s[36:39], s70 sc1
  v_smfmac_f32_16x16x64_bf16 v[80:83], v[64:67], a[184:191], v11
  s_waitcnt lgkmcnt(2)
  s_barrier
  v_smfmac_f32_16x16x64_bf16 v[84:87], v[44:47], a[192:199], v11
  ds_read_b128 v[68:71], v8 offset:0
  v_smfmac_f32_16x16x64_bf16 v[84:87], v[48:51], a[208:215], v11
  ds_read_b128 v[72:75], v8 offset:1024
  v_add_f32 v121, v80, v81
  v_smfmac_f32_16x16x64_bf16 v[84:87], v[52:55], a[224:231], v11
  ds_read_b128 v[76:79], v8 offset:2048
  v_add_f32 v123, v82, v83
  v_smfmac_f32_16x16x64_bf16 v[84:87], v[56:59], a[240:247], v11
  ds_read_b128 v[80:83], v8 offset:3072
  v_cvt_pk_bf16_f32 v120, v120, v121
  v_smfmac_f32_16x16x64_bf16 v[84:87], v[60:63], v[224:231], v11
  v_cvt_pk_bf16_f32 v121, v122, v123
  v_smfmac_f32_16x16x64_bf16 v[84:87], v[64:67], v[240:247], v11
  ds_write2_b32 v7, v120, v121 offset0:128 offset1:132
  v_smfmac_f32_16x16x64_bf16 v[88:91], v[44:47], a[200:207], v11
  v_smfmac_f32_16x16x64_bf16 v[88:91], v[48:51], a[216:223], v11
  v_cvt_pk_bf16_f32 v84, v84, v85
  v_smfmac_f32_16x16x64_bf16 v[88:91], v[52:55], a[232:239], v11
  buffer_load_dwordx4 v[32:35], v1, s[36:39], s78 offen offset:1024 sc1
  v_cvt_pk_bf16_f32 v85, v86, v87
  v_smfmac_f32_16x16x64_bf16 v[88:91], v[56:59], a[248:255], v11
  v_smfmac_f32_16x16x64_bf16 v[88:91], v[60:63], v[232:239], v11
  s_waitcnt lgkmcnt(0)
  s_barrier
  v_smfmac_f32_16x16x64_bf16 v[88:91], v[64:67], v[248:255], v11
  ds_read_b128 v[44:47], v8 offset:512
  v_mfma_f32_16x16x32_bf16 v[116:119], v[92:95], v[68:71], 0
  ds_read_b128 v[92:95], v2 offset:49152
  v_mfma_f32_16x16x32_bf16 v[116:119], v[96:99], v[72:75], v[116:119]
  ds_read_b128 v[48:51], v8 offset:1536
  v_cvt_pk_bf16_f32 v88, v88, v89
  v_mfma_f32_16x16x32_bf16 v[116:119], v[100:103], v[76:79], v[116:119]
  ds_read_b128 v[52:55], v8 offset:2560
  v_cvt_pk_bf16_f32 v89, v90, v91
  v_mfma_f32_16x16x32_bf16 v[116:119], v[104:107], v[80:83], v[116:119]
  ds_read_b128 v[56:59], v8 offset:3584
  v_mfma_f32_16x16x32_bf16 v[120:123], v[108:111], v[68:71], 0
  ds_read_b128 v[96:99], v2 offset:50176
  v_mfma_f32_16x16x32_bf16 v[120:123], v[112:115], v[72:75], v[120:123]
  v_exp_f32 v60, v116
  v_mfma_f32_16x16x32_bf16 v[120:123], v[36:39], v[76:79], v[120:123]
  v_exp_f32 v61, v117
  v_mfma_f32_16x16x32_bf16 v[120:123], v[40:43], v[80:83], v[120:123]
  s_waitcnt lgkmcnt(5)
  v_exp_f32 v62, v118
  v_mfma_f32_16x16x32_bf16 v[124:127], v[44:47], v[68:71], 0
  s_waitcnt lgkmcnt(3)
  v_exp_f32 v63, v119
  v_mfma_f32_16x16x32_bf16 v[124:127], v[48:51], v[72:75], v[124:127]
  s_waitcnt lgkmcnt(2)
  v_exp_f32 v64, v120
  v_mfma_f32_16x16x32_bf16 v[124:127], v[52:55], v[76:79], v[124:127]
  s_waitcnt lgkmcnt(1)
  v_exp_f32 v65, v121
  v_mfma_f32_16x16x32_bf16 v[124:127], v[56:59], v[80:83], v[124:127]
  s_waitcnt lgkmcnt(0)
  v_exp_f32 v66, v122
  v_exp_f32 v67, v123
  v_cvt_pk_bf16_f32 v100, v60, v64
  v_cvt_pk_bf16_f32 v101, v61, v65
  v_cvt_pk_bf16_f32 v102, v62, v66
  v_cvt_pk_bf16_f32 v103, v63, v67
  v_exp_f32 v86, v124
  v_mov_b64 v[76:77], 0
  v_mfma_f32_16x16x32_bf16 v[104:107], v[16:19], v[100:103], 0
  v_exp_f32 v87, v126
  v_mfma_f32_16x16x32_bf16 v[108:111], v[92:95], v[100:103], 0
  v_cvt_pk_bf16_f32 v90, v86, v86
  v_cvt_pk_bf16_f32 v91, v87, v87
  v_mfma_f32_16x16x32_bf16 v[112:115], v[96:99], v[100:103], 0
  v_mov_b64 v[78:79], 0
  v_mov_b64 v[80:81], 0
  v_mfma_f32_16x16x16_bf16 v[36:39], v[16:17], v[90:91], 0
  v_mov_b64 v[82:83], 0
  v_mfma_f32_16x16x16_bf16 v[108:111], v[84:85], v[90:91], v[108:111]
  v_mfma_f32_16x16x16_bf16 v[112:115], v[88:89], v[90:91], v[112:115]
  v_fma_f32 v106, v38, 0.5, v106
  v_rcp_f32 v107, v106
  v_mov_b32 v13, 0
  v_mul_f32 v108, v108, v107
  v_mul_f32 v109, v109, v107
  v_mul_f32 v110, v110, v107
  v_mul_f32 v111, v111, v107
  v_cvt_pk_bf16_f32 v100, v108, v109
  v_cvt_pk_bf16_f32 v101, v110, v111
  v_mul_f32 v112, v112, v107
  v_mul_f32 v113, v113, v107
  v_mul_f32 v114, v114, v107
  v_mul_f32 v115, v115, v107
  v_cvt_pk_bf16_f32 v102, v112, v113
  v_cvt_pk_bf16_f32 v103, v114, v115
  v_cndmask_b32 v36, v100, v102, s[84:85]
  v_cndmask_b32 v37, v101, v103, s[84:85]
  ds_write_b64 v10, v[36:37]
  v_max_f32 v104, v106, v107
  v_cmp_nge_f32 vcc, s86, v104
  v_mov_b64 v[44:45], 0
  v_mov_b64 v[46:47], 0
  v_mov_b64 v[48:49], 0
  v_mov_b64 v[50:51], 0
  s_cbranch_vccnz L_smr_f3_0
L_sm_f3_0:
  v_smfmac_f32_16x16x64_bf16 v[76:79], v[100:103], v[128:135], v11
  s_waitcnt lgkmcnt(0)
  s_barrier
  ds_read_b128 v[60:63], v8 offset:6144
  v_smfmac_f32_16x16x64_bf16 v[80:83], v[100:103], v[160:167], v11
  ds_read_b128 v[64:67], v8 offset:5120
  v_mov_b64 v[84:85], 0
  v_smfmac_f32_16x16x64_bf16 v[44:47], v[100:103], v[192:199], v11
  ds_read_b128 v[40:43], v8 offset:4096
  v_mov_b64 v[86:87], 0
  v_smfmac_f32_16x16x64_bf16 v[48:51], v[100:103], v[216:223], v11
  ds_read_b128 v[92:95], v3 offset:0
  s_waitcnt lgkmcnt(3)
  v_smfmac_f32_16x16x64_bf16 v[76:79], v[60:63], v[136:143], v11
  ds_read_b128 v[96:99], v3 offset:1024
  s_waitcnt lgkmcnt(3)
  v_smfmac_f32_16x16x64_bf16 v[76:79], v[64:67], v[144:151], v11
  ds_read_b128 v[52:55], v3 offset:8192
  s_waitcnt lgkmcnt(3)
  v_smfmac_f32_16x16x64_bf16 v[76:79], v[40:43], v[152:159], v11
  ds_read_b128 v[56:59], v3 offset:9216
  v_mov_b64 v[88:89], 0
  v_smfmac_f32_16x16x64_bf16 v[80:83], v[60:63], v[168:175], v11
  ds_read_b128 v[68:71], v3 offset:16384
  v_mov_b64 v[90:91], 0
  v_smfmac_f32_16x16x64_bf16 v[80:83], v[64:67], v[176:183], v11
  ds_read_b128 v[72:75], v3 offset:17408
  v_cvt_pk_bf16_f32 v76, v76, v77
  v_cvt_pk_bf16_f32 v77, v78, v79
  v_and_b32 v76, -2, v76
  v_smfmac_f32_16x16x64_bf16 v[80:83], v[40:43], v[184:191], v11
  s_waitcnt lgkmcnt(2)
  buffer_store_dwordx2 v[76:77], v5, s[36:39], 0 offen
  v_smfmac_f32_16x16x64_bf16 v[44:47], v[60:63], v[200:207], v11
  ds_read_b128 v[116:119], v3 offset:24576
  v_mov_b64 v[76:77], 0
  v_mov_b64 v[78:79], 0
  v_smfmac_f32_16x16x64_bf16 v[44:47], v[64:67], v[208:215], v11
  ds_read_b128 v[120:123], v3 offset:25600
  v_cvt_pk_bf16_f32 v80, v80, v81
  v_cvt_pk_bf16_f32 v81, v82, v83
  v_and_b32 v80, -2, v80
  v_smfmac_f32_16x16x64_bf16 v[44:47], v[40:43], v[92:99], v11
  buffer_store_dwordx2 v[80:81], v5, s[36:39], s74 offen
  v_smfmac_f32_16x16x64_bf16 v[48:51], v[60:63], v[52:59], v11
  s_waitcnt lgkmcnt(2)
  v_mov_b64 v[80:81], 0
  v_mov_b64 v[82:83], 0
  v_smfmac_f32_16x16x64_bf16 v[48:51], v[64:67], v[68:75], v11
  s_waitcnt lgkmcnt(0)
  v_cvt_pk_bf16_f32 v44, v44, v45
  v_cvt_pk_bf16_f32 v45, v46, v47
  v_and_b32 v44, -2, v44
  v_smfmac_f32_16x16x64_bf16 v[48:51], v[40:43], v[116:123], v11
  buffer_store_dwordx2 v[44:45], v5, s[36:39], s76 offen
  v_mov_b64 v[68:69], 0
  v_mov_b64 v[70:71], 0
  v_mov_b32 v13, 0
  v_mov_b32 v13, 0
  v_cvt_pk_bf16_f32 v48, v48, v49
  v_cvt_pk_bf16_f32 v49, v50, v51
  v_and_b32 v48, -2, v48
  buffer_store_dwordx2 v[48:49], v5, s[36:39], s65 offen
  v_mov_b64 v[72:73], 0
  v_mov_b64 v[74:75], 0
  s_waitcnt vmcnt(8)
  ds_write_b128 v2, v[20:23] offset:40960
  s_waitcnt vmcnt(7)
  ds_write_b128 v2, v[24:27] offset:41984
  s_waitcnt vmcnt(6)
  ds_write_b128 v2, v[28:31] offset:49152
  s_waitcnt vmcnt(4)
  ds_write_b128 v2, v[32:35] offset:50176
L_gap_gp30_6_57:
  s_nop 6
  s_nop 6
  s_nop 6
  s_nop 6
  s_nop 6
  s_nop 5
  buffer_load_dwordx4 v[108:111], v1, s[36:39], s64 offen offset:0 sc1
  buffer_load_dwordx4 v[112:115], v1, s[36:39], s64 offen offset:1024 sc1
  ds_read_b128 v[44:47], v1 offset:0
  ds_read_b128 v[48:51], v1 offset:1024
  ds_read_b128 v[52:55], v1 offset:8192
  ds_read_b128 v[56:59], v1 offset:9216
  ds_read_b128 v[60:63], v1 offset:16384
  ds_read_b128 v[64:67], v1 offset:17408
  ds_read_b128 v[92:95], v1 offset:24576
  ds_read_b128 v[96:99], v1 offset:25600
  ds_read_b128 v[100:103], v1 offset:32768
  ds_read_b128 v[104:107], v1 offset:33792
L_gap_gp31_3_58:
  s_nop 4
  s_nop 3
  s_nop 3
  buffer_load_dwordx4 v[36:39], v1, s[36:39], s64 offen offset:0 sc1
  buffer_load_dwordx4 v[40:43], v1, s[36:39], s64 offen offset:1024 sc1
.p2align 5
  s_nop 0
  s_nop 0
  s_nop 0
  s_nop 0
  s_waitcnt vmcnt(3)
  v_mfma_f32_16x16x32_bf16 v[124:127], v[16:19], v[108:111], 0
  v_bitop3_b32 v15, v108, v110, 1 bitop3:0xa8
  v_lshlrev_b32 v15, 1, v15
  s_waitcnt vmcnt(2)
  v_mfma_f32_16x16x32_bf16 v[124:127], v[16:19], v[112:115], v[124:127]
  v_bitop3_b32 v13, v112, v114, 1 bitop3:0xa8
  v_cmp_ne_u32 vcc, v13, v15
  s_cbranch_vccnz L_pb_f3_0r
L_pb_f3_0:
  v_add_f32_dpp v124, v124, v124 row_ror:4 row_mask:0xf bank_mask:0xf
  v_add_f32_dpp v125, v125, v125 row_ror:4 row_mask:0xf bank_mask:0xf
  s_nop 0
  v_add_f32_dpp v124, v124, v124 row_ror:8 row_mask:0xf bank_mask:0xf
  v_add_f32_dpp v125, v125, v125 row_ror:8 row_mask:0xf bank_mask:0xf
  v_cvt_pk_bf16_f32 v14, v124, v125
  v_min_u32 v14, -2, v14
  buffer_store_dword v14, v6, s[36:39], s87 offen
  s_mov_b32 s72, s79
  s_add_u32 s79, s79, 8192
  s_cmp_eq_u32 s68, 62
  s_cbranch_scc1 L_chain_done
  s_add_u32 s68, s68, 2
  v_cmp_ne_u32 vcc, 1, v12
  v_mov_b32 v124, -1
  buffer_store_dword v124, v6, s[36:39], s71 offen
  s_cbranch_vccnz L_flr_f3_0
L_fl_f3_0:
  s_xor_b32 s71, s71, 0x4000
  s_mov_b32 s75, s71
  s_add_u32 s92, s75, 0x1000
L_gap_gp32_3_59:
  s_nop 8
  s_nop 8
  s_nop 8
  buffer_load_dwordx4 v[36:39], v9, s[36:39], s93 offen offset:128 sc1
  buffer_load_dwordx4 v[40:43], v9, s[36:39], s93 offen offset:2176 sc1
  ds_read_b128 v[116:119], v1 offset:40960
  ds_read_b128 v[120:123], v1 offset:41984
  ds_read_b128 v[20:23], v1 offset:49152
  ds_read_b128 v[24:27], v1 offset:50176
  ds_read_b128 v[28:31], v1 offset:57344
  ds_read_b128 v[32:35], v1 offset:58368
  s_waitcnt vmcnt(4)
  ds_read_b128 v[108:111], v2 offset:0
  ds_read_b128 v[112:115], v2 offset:1024
L_gap_gp33_3_60:
  s_nop 3
  s_nop 3
  s_nop 3
  buffer_load_dwordx4 v[36:39], v9, s[36:39], s93 offen offset:128 sc1
  buffer_load_dwordx4 v[40:43], v9, s[36:39], s93 offen offset:2176 sc1
.p2align 5
  s_nop 0
  s_nop 0
  s_nop 0
  s_nop 0
L_step_f3_1:
  s_waitcnt lgkmcnt(0)
  s_waitcnt vmcnt(2)
  v_max_u32 v15, v39, v43
  v_cmp_eq_u32 vcc, -1, v15
  ds_write_b64 v2, v[36:37] offset:32768
  s_cbranch_vccnz L_er0_f3_1
L_eb0_f3_1:
  v_smfmac_f32_16x16x64_bf16 v[88:91], v[36:39], v[44:51], v11
  ds_write_b64 v2, v[38:39] offset:32776
  v_smfmac_f32_16x16x64_bf16 v[88:91], v[40:43], v[52:59], v11
  ds_write_b64 v2, v[40:41] offset:33792
  v_smfmac_f32_16x16x64_bf16 v[84:87], v[36:39], v[60:67], v11
  ds_write_b64 v2, v[42:43] offset:33800
  v_smfmac_f32_16x16x64_bf16 v[84:87], v[40:43], v[92:99], v11
  s_add_u32 s69, s69, 16384
  s_add_u32 s78, s69, 8192
  v_smfmac_f32_16x16x64_bf16 v[80:83], v[36:39], v[100:107], v11
  s_add_u32 s70, s70, 2048
  s_min_u32 s70, s70, s77
  v_smfmac_f32_16x16x64_bf16 v[80:83], v[40:43], v[116:123], v11
  v_smfmac_f32_16x16x64_bf16 v[76:79], v[36:39], v[20:27], v11
  s_waitcnt lgkmcnt(0)
  s_barrier
  ds_read_b128 v[44:47], v4 offset:4096
  v_smfmac_f32_16x16x64_bf16 v[76:79], v[40:43], v[28:35], v11
  ds_read_b128 v[48:51], v4 offset:5120
  v_smfmac_f32_16x16x64_bf16 v[72:75], v[36:39], a[8:15], v11
  ds_read_b128 v[52:55], v4 offset:2048
  v_smfmac_f32_16x16x64_bf16 v[72:75], v[40:43], a[24:31], v11
  ds_read_b128 v[56:59], v4 offset:3072
  v_smfmac_f32_16x16x64_bf16 v[68:71], v[36:39], a[0:7], v11
  ds_read_b128 v[60:63], v4 offset:0
  v_smfmac_f32_16x16x64_bf16 v[68:71], v[40:43], a[16:23], v11
  ds_read_b128 v[64:67], v4 offset:1024
  s_waitcnt lgkmcnt(5)
  v_smfmac_f32_16x16x64_bf16 v[68:71], v[44:47], a[32:39], v11
  ds_read_b128 v[92:95], v2 offset:8192
  s_waitcnt lgkmcnt(5)
  v_smfmac_f32_16x16x64_bf16 v[68:71], v[48:51], a[48:55], v11
  ds_read_b128 v[96:99], v2 offset:9216
  s_waitcnt lgkmcnt(5)
  v_smfmac_f32_16x16x64_bf16 v[68:71], v[52:55], a[64:71], v11
  ds_read_b128 v[100:103], v2 offset:16384
  s_waitcnt lgkmcnt(5)
  v_smfmac_f32_16x16x64_bf16 v[68:71], v[56:59], a[80:87], v11
  s_waitcnt lgkmcnt(4)
  buffer_store_dword v14, v6, s[36:39], s72 offen sc1
  v_smfmac_f32_16x16x64_bf16 v[68:71], v[60:63], a[96:103], v11
  ds_read_b128 v[104:107], v2 offset:17408
  s_waitcnt lgkmcnt(4)
  v_smfmac_f32_16x16x64_bf16 v[68:71], v[64:67], a[112:119], v11
  ds_read_b128 v[116:119], v2 offset:24576
  v_smfmac_f32_16x16x64_bf16 v[72:75], v[44:47], a[40:47], v11
  ds_read_b128 v[120:123], v2 offset:25600
  v_smfmac_f32_16x16x64_bf16 v[72:75], v[48:51], a[56:63], v11
  buffer_load_dwordx4 v[20:23], v1, s[36:39], s69 offen offset:0 sc1
  v_add_f32 v124, v68, v69
  v_smfmac_f32_16x16x64_bf16 v[72:75], v[52:55], a[72:79], v11
  v_add_f32 v126, v70, v71
  v_smfmac_f32_16x16x64_bf16 v[72:75], v[56:59], a[88:95], v11
  v_mul_f32 v124, s73, v124
  v_smfmac_f32_16x16x64_bf16 v[72:75], v[60:63], a[104:111], v11
  v_mul_f32 v126, s73, v126
  v_smfmac_f32_16x16x64_bf16 v[72:75], v[64:67], a[120:127], v11
  buffer_load_dwordx4 v[24:27], v1, s[36:39], s69 offen offset:1024 sc1
  s_waitcnt lgkmcnt(0) vmcnt(3)
  v_smfmac_f32_16x16x64_bf16 v[76:79], v[44:47], v[108:115], v11
  ds_read_b128 v[108:111], v4 offset:9216
  v_smfmac_f32_16x16x64_bf16 v[76:79], v[48:51], v[92:99], v11
  ds_read_b128 v[92:95], v4 offset:8192
  v_add_f32 v125, v72, v73
  v_smfmac_f32_16x16x64_bf16 v[76:79], v[52:55], v[100:107], v11
  ds_read_b128 v[96:99], v4 offset:10240
  v_add_f32 v127, v74, v75
  v_smfmac_f32_16x16x64_bf16 v[76:79], v[56:59], v[116:123], v11
  buffer_load_dwordx4 v[28:31], v1, s[36:39], s78 offen offset:0 sc1
  v_mul_f32 v125, s73, v125
  v_smfmac_f32_16x16x64_bf16 v[76:79], v[60:63], a[160:167], v11
  ds_read_b128 v[100:103], v4 offset:12288
  v_mul_f32 v127, s73, v127
  v_smfmac_f32_16x16x64_bf16 v[76:79], v[64:67], a[176:183], v11
  ds_read_b128 v[104:107], v4 offset:14336
  v_cvt_pk_bf16_f32 v124, v124, v125
  v_smfmac_f32_16x16x64_bf16 v[80:83], v[44:47], a[128:135], v11
  ds_read_b128 v[112:115], v4 offset:11264
  v_cvt_pk_bf16_f32 v125, v126, v127
  v_smfmac_f32_16x16x64_bf16 v[80:83], v[48:51], a[136:143], v11
  ds_write2_b32 v7, v124, v125 offset0:0 offset1:4
  v_smfmac_f32_16x16x64_bf16 v[80:83], v[52:55], a[144:151], v11
  ds_read_b128 v[36:39], v4 offset:13312
  v_add_f32 v120, v76, v77
  v_smfmac_f32_16x16x64_bf16 v[80:83], v[56:59], a[152:159], v11
  ds_read_b128 v[40:43], v4 offset:15360
  v_add_f32 v122, v78, v79
  v_smfmac_f32_16x16x64_bf16 v[80:83], v[60:63], a[168:175], v11
  buffer_load_dword v12, off, s[36:39], s70 sc1
  v_smfmac_f32_16x16x64_bf16 v[80:83], v[64:67], a[184:191], v11
  s_waitcnt lgkmcnt(2)
  s_barrier
  v_smfmac_f32_16x16x64_bf16 v[84:87], v[44:47], a[192:199], v11
  ds_read_b128 v[68:71], v8 offset:0
  v_smfmac_f32_16x16x64_bf16 v[84:87], v[48:51], a[208:215], v11
  ds_read_b128 v[72:75], v8 offset:1024
  v_add_f32 v121, v80, v81
  v_smfmac_f32_16x16x64_bf16 v[84:87], v[52:55], a[224:231], v11
  ds_read_b128 v[76:79], v8 offset:2048
  v_add_f32 v123, v82, v83
  v_smfmac_f32_16x16x64_bf16 v[84:87], v[56:59], a[240:247], v11
  ds_read_b128 v[80:83], v8 offset:3072
  v_cvt_pk_bf16_f32 v120, v120, v121
  v_smfmac_f32_16x16x64_bf16 v[84:87], v[60:63], v[224:231], v11
  v_cvt_pk_bf16_f32 v121, v122, v123
  v_smfmac_f32_16x16x64_bf16 v[84:87], v[64:67], v[240:247], v11
  ds_write2_b32 v7, v120, v121 offset0:128 offset1:132
  v_smfmac_f32_16x16x64_bf16 v[88:91], v[44:47], a[200:207], v11
  v_smfmac_f32_16x16x64_bf16 v[88:91], v[48:51], a[216:223], v11
  v_cvt_pk_bf16_f32 v84, v84, v85
  v_smfmac_f32_16x16x64_bf16 v[88:91], v[52:55], a[232:239], v11
  buffer_load_dwordx4 v[32:35], v1, s[36:39], s78 offen offset:1024 sc1
  v_cvt_pk_bf16_f32 v85, v86, v87
  v_smfmac_f32_16x16x64_bf16 v[88:91], v[56:59], a[248:255], v11
  v_smfmac_f32_16x16x64_bf16 v[88:91], v[60:63], v[232:239], v11
  s_waitcnt lgkmcnt(0)
  s_barrier
  v_smfmac_f32_16x16x64_bf16 v[88:91], v[64:67], v[248:255], v11
  ds_read_b128 v[44:47], v8 offset:512
  v_mfma_f32_16x16x32_bf16 v[116:119], v[92:95], v[68:71], 0
  ds_read_b128 v[92:95], v2 offset:49152
  v_mfma_f32_16x16x32_bf16 v[116:119], v[96:99], v[72:75], v[116:119]
  ds_read_b128 v[48:51], v8 offset:1536
  v_cvt_pk_bf16_f32 v88, v88, v89
  v_mfma_f32_16x16x32_bf16 v[116:119], v[100:103], v[76:79], v[116:119]
  ds_read_b128 v[52:55], v8 offset:2560
  v_cvt_pk_bf16_f32 v89, v90, v91
  v_mfma_f32_16x16x32_bf16 v[116:119], v[104:107], v[80:83], v[116:119]
  ds_read_b128 v[56:59], v8 offset:3584
  v_mfma_f32_16x16x32_bf16 v[120:123], v[108:111], v[68:71], 0
  ds_read_b128 v[96:99], v2 offset:50176
  v_mfma_f32_16x16x32_bf16 v[120:123], v[112:115], v[72:75], v[120:123]
  v_exp_f32 v60, v116
  v_mfma_f32_16x16x32_bf16 v[120:123], v[36:39], v[76:79], v[120:123]
  v_exp_f32 v61, v117
  v_mfma_f32_16x16x32_bf16 v[120:123], v[40:43], v[80:83], v[120:123]
  s_waitcnt lgkmcnt(5)
  v_exp_f32 v62, v118
  v_mfma_f32_16x16x32_bf16 v[124:127], v[44:47], v[68:71], 0
  s_waitcnt lgkmcnt(3)
  v_exp_f32 v63, v119
  v_mfma_f32_16x16x32_bf16 v[124:127], v[48:51], v[72:75], v[124:127]
  s_waitcnt lgkmcnt(2)
  v_exp_f32 v64, v120
  v_mfma_f32_16x16x32_bf16 v[124:127], v[52:55], v[76:79], v[124:127]
  s_waitcnt lgkmcnt(1)
  v_exp_f32 v65, v121
  v_mfma_f32_16x16x32_bf16 v[124:127], v[56:59], v[80:83], v[124:127]
  s_waitcnt lgkmcnt(0)
  v_exp_f32 v66, v122
  v_exp_f32 v67, v123
  v_cvt_pk_bf16_f32 v100, v60, v64
  v_cvt_pk_bf16_f32 v101, v61, v65
  v_cvt_pk_bf16_f32 v102, v62, v66
  v_cvt_pk_bf16_f32 v103, v63, v67
  v_exp_f32 v86, v124
  v_mov_b64 v[76:77], 0
  v_mfma_f32_16x16x32_bf16 v[104:107], v[16:19], v[100:103], 0
  v_exp_f32 v87, v126
  v_mfma_f32_16x16x32_bf16 v[108:111], v[92:95], v[100:103], 0
  v_cvt_pk_bf16_f32 v90, v86, v86
  v_cvt_pk_bf16_f32 v91, v87, v87
  v_mfma_f32_16x16x32_bf16 v[112:115], v[96:99], v[100:103], 0
  v_mov_b64 v[78:79], 0
  v_mov_b64 v[80:81], 0
  v_mfma_f32_16x16x16_bf16 v[36:39], v[16:17], v[90:91], 0
  v_mov_b64 v[82:83], 0
  v_mfma_f32_16x16x16_bf16 v[108:111], v[84:85], v[90:91], v[108:111]
  v_mfma_f32_16x16x16_bf16 v[112:115], v[88:89], v[90:91], v[112:115]
  v_fma_f32 v106, v38, 0.5, v106
  v_rcp_f32 v107, v106
  v_mov_b32 v13, 0
  v_mul_f32 v108, v108, v107
  v_mul_f32 v109, v109, v107
  v_mul_f32 v110, v110, v107
  v_mul_f32 v111, v111, v107
  v_cvt_pk_bf16_f32 v100, v108, v109
  v_cvt_pk_bf16_f32 v101, v110, v111
  v_mul_f32 v112, v112, v107
  v_mul_f32 v113, v113, v107
  v_mul_f32 v114, v114, v107
  v_mul_f32 v115, v115, v107
  v_cvt_pk_bf16_f32 v102, v112, v113
  v_cvt_pk_bf16_f32 v103, v114, v115
  v_cndmask_b32 v36, v100, v102, s[84:85]
  v_cndmask_b32 v37, v101, v103, s[84:85]
  ds_write_b64 v10, v[36:37]
  v_max_f32 v104, v106, v107
  v_cmp_nge_f32 vcc, s86, v104
  v_mov_b64 v[44:45], 0
  v_mov_b64 v[46:47], 0
  v_mov_b64 v[48:49], 0
  v_mov_b64 v[50:51], 0
  s_cbranch_vccnz L_smr_f3_1
L_sm_f3_1:
  v_smfmac_f32_16x16x64_bf16 v[76:79], v[100:103], v[128:135], v11
  s_waitcnt lgkmcnt(0)
  s_barrier
  ds_read_b128 v[60:63], v8 offset:6144
  v_smfmac_f32_16x16x64_bf16 v[80:83], v[100:103], v[160:167], v11
  ds_read_b128 v[64:67], v8 offset:5120
  v_mov_b64 v[84:85], 0
  v_smfmac_f32_16x16x64_bf16 v[44:47], v[100:103], v[192:199], v11
  ds_read_b128 v[40:43], v8 offset:4096
  v_mov_b64 v[86:87], 0
  v_smfmac_f32_16x16x64_bf16 v[48:51], v[100:103], v[216:223], v11
  ds_read_b128 v[92:95], v3 offset:0
  s_waitcnt lgkmcnt(3)
  v_smfmac_f32_16x16x64_bf16 v[76:79], v[60:63], v[136:143], v11
  ds_read_b128 v[96:99], v3 offset:1024
  s_waitcnt lgkmcnt(3)
  v_smfmac_f32_16x16x64_bf16 v[76:79], v[64:67], v[144:151], v11
  ds_read_b128 v[52:55], v3 offset:8192
  s_waitcnt lgkmcnt(3)
  v_smfmac_f32_16x16x64_bf16 v[76:79], v[40:43], v[152:159], v11
  ds_read_b128 v[56:59], v3 offset:9216
  v_mov_b64 v[88:89], 0
  v_smfmac_f32_16x16x64_bf16 v[80:83], v[60:63], v[168:175], v11
  ds_read_b128 v[68:71], v3 offset:16384
  v_mov_b64 v[90:91], 0
  v_smfmac_f32_16x16x64_bf16 v[80:83], v[64:67], v[176:183], v11
  ds_read_b128 v[72:75], v3 offset:17408
  v_cvt_pk_bf16_f32 v76, v76, v77
  v_cvt_pk_bf16_f32 v77, v78, v79
  v_or_b32 v76, 1, v76
  v_smfmac_f32_16x16x64_bf16 v[80:83], v[40:43], v[184:191], v11
  s_waitcnt lgkmcnt(2)
  buffer_store_dwordx2 v[76:77], v5, s[36:39], 0 offen
  v_smfmac_f32_16x16x64_bf16 v[44:47], v[60:63], v[200:207], v11
  ds_read_b128 v[116:119], v3 offset:24576
  v_mov_b64 v[76:77], 0
  v_mov_b64 v[78:79], 0
  v_smfmac_f32_16x16x64_bf16 v[44:47], v[64:67], v[208:215], v11
  ds_read_b128 v[120:123], v3 offset:25600
  v_cvt_pk_bf16_f32 v80, v80, v81
  v_cvt_pk_bf16_f32 v81, v82, v83
  v_or_b32 v80, 1, v80
  v_smfmac_f32_16x16x64_bf16 v[44:47], v[40:43], v[92:99], v11
  buffer_store_dwordx2 v[80:81], v5, s[36:39], s74 offen
  v_smfmac_f32_16x16x64_bf16 v[48:51], v[60:63], v[52:59], v11
  s_waitcnt lgkmcnt(2)
  v_mov_b64 v[80:81], 0
  v_mov_b64 v[82:83], 0
  v_smfmac_f32_16x16x64_bf16 v[48:51], v[64:67], v[68:75], v11
  s_waitcnt lgkmcnt(0)
  v_cvt_pk_bf16_f32 v44, v44, v45
  v_cvt_pk_bf16_f32 v45, v46, v47
  v_or_b32 v44, 1, v44
  v_smfmac_f32_16x16x64_bf16 v[48:51], v[40:43], v[116:123], v11
  buffer_store_dwordx2 v[44:45], v5, s[36:39], s76 offen
  v_mov_b64 v[68:69], 0
  v_mov_b64 v[70:71], 0
  v_mov_b32 v13, 0
  v_mov_b32 v13, 0
  v_cvt_pk_bf16_f32 v48, v48, v49
  v_cvt_pk_bf16_f32 v49, v50, v51
  v_or_b32 v48, 1, v48
  buffer_store_dwordx2 v[48:49], v5, s[36:39], s65 offen
  v_mov_b64 v[72:73], 0
  v_mov_b64 v[74:75], 0
  s_waitcnt vmcnt(8)
  ds_write_b128 v2, v[20:23] offset:40960
  s_waitcnt vmcnt(7)
  ds_write_b128 v2, v[24:27] offset:41984
  s_waitcnt vmcnt(6)
  ds_write_b128 v2, v[28:31] offset:49152
  s_waitcnt vmcnt(4)
  ds_write_b128 v2, v[32:35] offset:50176
L_gap_gp30_6_61:
  s_nop 6
  s_nop 6
  s_nop 6
  s_nop 6
  s_nop 6
  s_nop 5
  buffer_load_dwordx4 v[108:111], v1, s[36:39], s64 offen offset:0 sc1
  buffer_load_dwordx4 v[112:115], v1, s[36:39], s64 offen offset:1024 sc1
  ds_read_b128 v[44:47], v1 offset:0
  ds_read_b128 v[48:51], v1 offset:1024
  ds_read_b128 v[52:55], v1 offset:8192
  ds_read_b128 v[56:59], v1 offset:9216
  ds_read_b128 v[60:63], v1 offset:16384
  ds_read_b128 v[64:67], v1 offset:17408
  ds_read_b128 v[92:95], v1 offset:24576
  ds_read_b128 v[96:99], v1 offset:25600
  ds_read_b128 v[100:103], v1 offset:32768
  ds_read_b128 v[104:107], v1 offset:33792
L_gap_gp31_3_62:
  s_nop 4
  s_nop 3
  s_nop 3
  buffer_load_dwordx4 v[36:39], v1, s[36:39], s64 offen offset:0 sc1
  buffer_load_dwordx4 v[40:43], v1, s[36:39], s64 offen offset:1024 sc1
.p2align 5
  s_nop 0
  s_nop 0
  s_nop 0
  s_nop 0
  s_waitcnt vmcnt(3)
  v_mfma_f32_16x16x32_bf16 v[124:127], v[16:19], v[108:111], 0
  v_bitop3_b32 v15, v108, v110, 1 bitop3:0x80
  v_sub_u32 v15, 2, v15
  s_waitcnt vmcnt(2)
  v_mfma_f32_16x16x32_bf16 v[124:127], v[16:19], v[112:115], v[124:127]
  v_bitop3_b32 v13, v112, v114, 1 bitop3:0x80
  v_cmp_ne_u32 vcc, v13, v15
  s_cbranch_vccnz L_pb_f3_1r
L_pb_f3_1:
  v_add_f32_dpp v124, v124, v124 row_ror:4 row_mask:0xf bank_mask:0xf
  v_add_f32_dpp v125, v125, v125 row_ror:4 row_mask:0xf bank_mask:0xf
  s_nop 0
  v_add_f32_dpp v124, v124, v124 row_ror:8 row_mask:0xf bank_mask:0xf
  v_add_f32_dpp v125, v125, v125 row_ror:8 row_mask:0xf bank_mask:0xf
  v_cvt_pk_bf16_f32 v14, v124, v125
  v_min_u32 v14, -2, v14
  buffer_store_dword v14, v6, s[36:39], s71 offen
  s_mov_b32 s72, s79
  s_add_u32 s79, s79, 8192
  v_cmp_ne_u32 vcc, 1, v12
  v_mov_b32 v124, -1
  buffer_store_dword v124, v6, s[36:39], s87 offen
  s_cbranch_vccnz L_flr_f3_1
L_fl_f3_1:
  s_xor_b32 s87, s87, 0x4000
  s_xor_b32 s93, s93, 0x4000
L_gap_gp32_3_63:
  s_nop 8
  s_nop 8
  s_nop 8
  buffer_load_dwordx4 v[36:39], v9, s[36:39], s92 offen offset:128 sc1
  buffer_load_dwordx4 v[40:43], v9, s[36:39], s92 offen offset:2176 sc1
  ds_read_b128 v[116:119], v1 offset:40960
  ds_read_b128 v[120:123], v1 offset:41984
  ds_read_b128 v[20:23], v1 offset:49152
  ds_read_b128 v[24:27], v1 offset:50176
  ds_read_b128 v[28:31], v1 offset:57344
  ds_read_b128 v[32:35], v1 offset:58368
  s_waitcnt vmcnt(4)
  ds_read_b128 v[108:111], v2 offset:0
  ds_read_b128 v[112:115], v2 offset:1024
L_gap_gp33_3_64:
  s_nop 3
  s_nop 3
  s_nop 3
  buffer_load_dwordx4 v[36:39], v9, s[36:39], s92 offen offset:128 sc1
  buffer_load_dwordx4 v[40:43], v9, s[36:39], s92 offen offset:2176 sc1
  s_branch L_step_f3_0
L_er0_f3_0:
  buffer_load_dwordx4 v[36:39], v9, s[36:39], s92 offen offset:128 sc1
  buffer_load_dwordx4 v[40:43], v9, s[36:39], s92 offen offset:2176 sc1
  s_waitcnt vmcnt(2)
  v_max_u32 v15, v39, v43
  v_cmp_eq_u32 vcc, -1, v15
  s_cbranch_vccz L_eb0_f3_0o
L_er0_f3_0s:
  buffer_load_dwordx4 v[36:39], v9, s[36:39], s92 offen offset:128 sc1
  buffer_load_dwordx4 v[40:43], v9, s[36:39], s92 offen offset:2176 sc1
  s_waitcnt vmcnt(2)
  v_max_u32 v15, v39, v43
  v_cmp_eq_u32 vcc, -1, v15
  s_cbranch_vccz L_eb0_f3_0o
  s_sub_u32 s3, s3, 1
  s_cbranch_scc1 L_end
  s_branch L_er0_f3_0s
L_eb0_f3_0o:
  ds_write_b64 v2, v[36:37] offset:32768
  s_branch L_eb0_f3_0
L_smr_f3_0:
  v_max_f32 v86, v116, v120
  v_max3_f32 v86, v86, v117, v121
  v_max3_f32 v86, v86, v118, v122
  v_max3_f32 v86, v86, v119, v123
  v_max3_f32 v86, v86, v124, v126
  v_mov_b32 v87, v86
  s_nop 1
  v_permlane32_swap_b32 v86, v87
  v_max_f32 v86, v86, v87
  v_mov_b32 v87, v86
  s_nop 1
  v_permlane16_swap_b32 v86, v87
  v_max_f32 v86, v86, v87
  v_sub_f32 v116, v116, v86
  v_sub_f32 v120, v120, v86
  v_sub_f32 v117, v117, v86
  v_sub_f32 v121, v121, v86
  v_sub_f32 v118, v118, v86
  v_sub_f32 v122, v122, v86
  v_sub_f32 v119, v119, v86
  v_sub_f32 v123, v123, v86
  v_sub_f32 v124, v124, v86
  v_sub_f32 v126, v126, v86
  v_exp_f32 v116, v116
  v_exp_f32 v120, v120
  v_exp_f32 v117, v117
  v_exp_f32 v121, v121
  v_exp_f32 v118, v118
  v_exp_f32 v122, v122
  v_exp_f32 v119, v119
  v_exp_f32 v123, v123
  v_exp_f32 v124, v124
  v_exp_f32 v126, v126
  v_cvt_pk_bf16_f32 v100, v116, v120
  v_cvt_pk_bf16_f32 v101, v117, v121
  v_cvt_pk_bf16_f32 v102, v118, v122
  v_cvt_pk_bf16_f32 v103, v119, v123
  v_cvt_pk_bf16_f32 v90, v124, v124
  v_cvt_pk_bf16_f32 v91, v126, v126
  s_waitcnt lgkmcnt(0)
  v_mov_b64 v[76:77], 0
  v_mov_b64 v[78:79], 0
  v_mfma_f32_16x16x32_bf16 v[104:107], v[16:19], v[100:103], 0
  v_mfma_f32_16x16x32_bf16 v[108:111], v[92:95], v[100:103], 0
  v_mfma_f32_16x16x32_bf16 v[112:115], v[96:99], v[100:103], 0
  v_mfma_f32_16x16x16_bf16 v[36:39], v[16:17], v[90:91], 0
  v_mfma_f32_16x16x16_bf16 v[108:111], v[84:85], v[90:91], v[108:111]
  v_mfma_f32_16x16x16_bf16 v[112:115], v[88:89], v[90:91], v[112:115]
  v_fma_f32 v106, v38, 0.5, v106
  v_rcp_f32 v107, v106
  s_nop 0
  v_mul_f32 v108, v108, v107
  v_mul_f32 v109, v109, v107
  v_mul_f32 v110, v110, v107
  v_mul_f32 v111, v111, v107
  v_cvt_pk_bf16_f32 v100, v108, v109
  v_cvt_pk_bf16_f32 v101, v110, v111
  v_mul_f32 v112, v112, v107
  v_mul_f32 v113, v113, v107
  v_mul_f32 v114, v114, v107
  v_mul_f32 v115, v115, v107
  v_cvt_pk_bf16_f32 v102, v112, v113
  v_cvt_pk_bf16_f32 v103, v114, v115
  v_cndmask_b32 v36, v100, v102, s[84:85]
  v_cndmask_b32 v37, v101, v103, s[84:85]
  ds_write_b64 v10, v[36:37]
  s_branch L_sm_f3_0
L_pb_f3_0r:
  buffer_load_dwordx4 v[108:111], v1, s[36:39], s64 offen offset:0 sc1
  buffer_load_dwordx4 v[112:115], v1, s[36:39], s64 offen offset:1024 sc1
  s_waitcnt vmcnt(3)
  v_mfma_f32_16x16x32_bf16 v[124:127], v[16:19], v[36:39], 0
  v_bitop3_b32 v15, v36, v38, 1 bitop3:0xa8
  v_lshlrev_b32 v15, 1, v15
  s_waitcnt vmcnt(2)
  v_mfma_f32_16x16x32_bf16 v[124:127], v[16:19], v[40:43], v[124:127]
  v_bitop3_b32 v13, v40, v42, 1 bitop3:0xa8
  v_cmp_ne_u32 vcc, v13, v15
  s_cbranch_vccz L_pb_f3_0
L_pb_f3_0s:
  buffer_load_dwordx4 v[36:39], v1, s[36:39], s64 offen offset:0 sc1
  buffer_load_dwordx4 v[40:43], v1, s[36:39], s64 offen offset:1024 sc1
  s_waitcnt vmcnt(3)
  v_mfma_f32_16x16x32_bf16 v[124:127], v[16:19], v[108:111], 0
  v_bitop3_b32 v15, v108, v110, 1 bitop3:0xa8
  v_lshlrev_b32 v15, 1, v15
  s_waitcnt vmcnt(2)
  v_mfma_f32_16x16x32_bf16 v[124:127], v[16:19], v[112:115], v[124:127]
  v_bitop3_b32 v13, v112, v114, 1 bitop3:0xa8
  v_cmp_ne_u32 vcc, v13, v15
  s_cbranch_vccz L_pb_f3_0
  buffer_load_dwordx4 v[108:111], v1, s[36:39], s64 offen offset:0 sc1
  buffer_load_dwordx4 v[112:115], v1, s[36:39], s64 offen offset:1024 sc1
  s_waitcnt vmcnt(3)
  v_mfma_f32_16x16x32_bf16 v[124:127], v[16:19], v[36:39], 0
  v_bitop3_b32 v15, v36, v38, 1 bitop3:0xa8
  v_lshlrev_b32 v15, 1, v15
  s_waitcnt vmcnt(2)
  v_mfma_f32_16x16x32_bf16 v[124:127], v[16:19], v[40:43], v[124:127]
  v_bitop3_b32 v13, v40, v42, 1 bitop3:0xa8
  v_cmp_ne_u32 vcc, v13, v15
  s_cbranch_vccz L_pb_f3_0
  s_sub_u32 s3, s3, 1
  s_cbranch_scc1 L_end
  s_branch L_pb_f3_0s
L_flr_f3_0:
L_spin_65:
  buffer_load_dword v12, off, s[36:39], s70 sc1
  s_waitcnt vmcnt(0)
  v_cmp_ne_u32 vcc, 1, v12
  s_cbranch_vccz L_ok_66
  s_sub_u32 s3, s3, 1
  s_cbranch_scc1 L_end
  s_sleep 2
  s_branch L_spin_65
L_ok_66:
  s_branch L_fl_f3_0
L_er0_f3_1:
  buffer_load_dwordx4 v[36:39], v9, s[36:39], s93 offen offset:128 sc1
  buffer_load_dwordx4 v[40:43], v9, s[36:39], s93 offen offset:2176 sc1
  s_waitcnt vmcnt(2)
  v_max_u32 v15, v39, v43
  v_cmp_eq_u32 vcc, -1, v15
  s_cbranch_vccz L_eb0_f3_1o
L_er0_f3_1s:
  buffer_load_dwordx4 v[36:39], v9, s[36:39], s93 offen offset:128 sc1
  buffer_load_dwordx4 v[40:43], v9, s[36:39], s93 offen offset:2176 sc1
  s_waitcnt vmcnt(2)
  v_max_u32 v15, v39, v43
  v_cmp_eq_u32 vcc, -1, v15
  s_cbranch_vccz L_eb0_f3_1o
  s_sub_u32 s3, s3, 1
  s_cbranch_scc1 L_end
  s_branch L_er0_f3_1s
L_eb0_f3_1o:
  ds_write_b64 v2, v[36:37] offset:32768
  s_branch L_eb0_f3_1
L_smr_f3_1:
  v_max_f32 v86, v116, v120
  v_max3_f32 v86, v86, v117, v121
  v_max3_f32 v86, v86, v118, v122
  v_max3_f32 v86, v86, v119, v123
  v_max3_f32 v86, v86, v124, v126
  v_mov_b32 v87, v86
  s_nop 1
  v_permlane32_swap_b32 v86, v87
  v_max_f32 v86, v86, v87
  v_mov_b32 v87, v86
  s_nop 1
  v_permlane16_swap_b32 v86, v87
  v_max_f32 v86, v86, v87
  v_sub_f32 v116, v116, v86
  v_sub_f32 v120, v120, v86
  v_sub_f32 v117, v117, v86
  v_sub_f32 v121, v121, v86
  v_sub_f32 v118, v118, v86
  v_sub_f32 v122, v122, v86
  v_sub_f32 v119, v119, v86
  v_sub_f32 v123, v123, v86
  v_sub_f32 v124, v124, v86
  v_sub_f32 v126, v126, v86
  v_exp_f32 v116, v116
  v_exp_f32 v120, v120
  v_exp_f32 v117, v117
  v_exp_f32 v121, v121
  v_exp_f32 v118, v118
  v_exp_f32 v122, v122
  v_exp_f32 v119, v119
  v_exp_f32 v123, v123
  v_exp_f32 v124, v124
  v_exp_f32 v126, v126
  v_cvt_pk_bf16_f32 v100, v116, v120
  v_cvt_pk_bf16_f32 v101, v117, v121
  v_cvt_pk_bf16_f32 v102, v118, v122
  v_cvt_pk_bf16_f32 v103, v119, v123
  v_cvt_pk_bf16_f32 v90, v124, v124
  v_cvt_pk_bf16_f32 v91, v126, v126
  s_waitcnt lgkmcnt(0)
  v_mov_b64 v[76:77], 0
  v_mov_b64 v[78:79], 0
  v_mfma_f32_16x16x32_bf16 v[104:107], v[16:19], v[100:103], 0
  v_mfma_f32_16x16x32_bf16 v[108:111], v[92:95], v[100:103], 0
  v_mfma_f32_16x16x32_bf16 v[112:115], v[96:99], v[100:103], 0
  v_mfma_f32_16x16x16_bf16 v[36:39], v[16:17], v[90:91], 0
  v_mfma_f32_16x16x16_bf16 v[108:111], v[84:85], v[90:91], v[108:111]
  v_mfma_f32_16x16x16_bf16 v[112:115], v[88:89], v[90:91], v[112:115]
  v_fma_f32 v106, v38, 0.5, v106
  v_rcp_f32 v107, v106
  s_nop 0
  v_mul_f32 v108, v108, v107
  v_mul_f32 v109, v109, v107
  v_mul_f32 v110, v110, v107
  v_mul_f32 v111, v111, v107
  v_cvt_pk_bf16_f32 v100, v108, v109
  v_cvt_pk_bf16_f32 v101, v110, v111
  v_mul_f32 v112, v112, v107
  v_mul_f32 v113, v113, v107
  v_mul_f32 v114, v114, v107
  v_mul_f32 v115, v115, v107
  v_cvt_pk_bf16_f32 v102, v112, v113
  v_cvt_pk_bf16_f32 v103, v114, v115
  v_cndmask_b32 v36, v100, v102, s[84:85]
  v_cndmask_b32 v37, v101, v103, s[84:85]
  ds_write_b64 v10, v[36:37]
  s_branch L_sm_f3_1
L_pb_f3_1r:
  buffer_load_dwordx4 v[108:111], v1, s[36:39], s64 offen offset:0 sc1
  buffer_load_dwordx4 v[112:115], v1, s[36:39], s64 offen offset:1024 sc1
  s_waitcnt vmcnt(3)
  v_mfma_f32_16x16x32_bf16 v[124:127], v[16:19], v[36:39], 0
  v_bitop3_b32 v15, v36, v38, 1 bitop3:0x80
  v_sub_u32 v15, 2, v15
  s_waitcnt vmcnt(2)
  v_mfma_f32_16x16x32_bf16 v[124:127], v[16:19], v[40:43], v[124:127]
  v_bitop3_b32 v13, v40, v42, 1 bitop3:0x80
  v_cmp_ne_u32 vcc, v13, v15
  s_cbranch_vccz L_pb_f3_1
L_pb_f3_1s:
  buffer_load_dwordx4 v[36:39], v1, s[36:39], s64 offen offset:0 sc1
  buffer_load_dwordx4 v[40:43], v1, s[36:39], s64 offen offset:1024 sc1
  s_waitcnt vmcnt(3)
  v_mfma_f32_16x16x32_bf16 v[124:127], v[16:19], v[108:111], 0
  v_bitop3_b32 v15, v108, v110, 1 bitop3:0x80
  v_sub_u32 v15, 2, v15
  s_waitcnt vmcnt(2)
  v_mfma_f32_16x16x32_bf16 v[124:127], v[16:19], v[112:115], v[124:127]
  v_bitop3_b32 v13, v112, v114, 1 bitop3:0x80
  v_cmp_ne_u32 vcc, v13, v15
  s_cbranch_vccz L_pb_f3_1
  buffer_load_dwordx4 v[108:111], v1, s[36:39], s64 offen offset:0 sc1
  buffer_load_dwordx4 v[112:115], v1, s[36:39], s64 offen offset:1024 sc1
  s_waitcnt vmcnt(3)
  v_mfma_f32_16x16x32_bf16 v[124:127], v[16:19], v[36:39], 0
  v_bitop3_b32 v15, v36, v38, 1 bitop3:0x80
  v_sub_u32 v15, 2, v15
  s_waitcnt vmcnt(2)
  v_mfma_f32_16x16x32_bf16 v[124:127], v[16:19], v[40:43], v[124:127]
  v_bitop3_b32 v13, v40, v42, 1 bitop3:0x80
  v_cmp_ne_u32 vcc, v13, v15
  s_cbranch_vccz L_pb_f3_1
  s_sub_u32 s3, s3, 1
  s_cbranch_scc1 L_end
  s_branch L_pb_f3_1s
L_flr_f3_1:
L_spin_67:
  buffer_load_dword v12, off, s[36:39], s70 sc1
  s_waitcnt vmcnt(0)
  v_cmp_ne_u32 vcc, 1, v12
  s_cbranch_vccz L_ok_68
  s_sub_u32 s3, s3, 1
  s_cbranch_scc1 L_end
  s_sleep 2
  s_branch L_spin_67
L_ok_68:
  s_branch L_fl_f3_1
.p2align 5
  s_nop 0
  s_nop 0
  s_nop 0
  s_nop 0
L_step_s0_0:
  s_waitcnt lgkmcnt(0)
  s_waitcnt vmcnt(0)
  v_max_u32 v15, v39, v43
  v_cmp_eq_u32 vcc, -1, v15
  ds_write_b64 v2, v[36:37] offset:32768
  s_cbranch_vccnz L_er0_s0_0
L_eb0_s0_0:
  v_smfmac_f32_16x16x64_bf16 v[88:91], v[36:39], v[44:51], v11
  ds_write_b64 v2, v[38:39] offset:32776
  v_smfmac_f32_16x16x64_bf16 v[88:91], v[40:43], v[52:59], v11
  ds_write_b64 v2, v[40:41] offset:33792
  v_smfmac_f32_16x16x64_bf16 v[84:87], v[36:39], v[60:67], v11
  ds_write_b64 v2, v[42:43] offset:33800
  v_smfmac_f32_16x16x64_bf16 v[84:87], v[40:43], v[92:99], v11
  s_add_u32 s69, s69, 16384
  s_add_u32 s78, s69, 8192
  v_smfmac_f32_16x16x64_bf16 v[80:83], v[36:39], v[100:107], v11
  s_add_u32 s70, s70, 2048
  s_min_u32 s70, s70, s77
  v_smfmac_f32_16x16x64_bf16 v[80:83], v[40:43], v[116:123], v11
  v_smfmac_f32_16x16x64_bf16 v[76:79], v[36:39], v[20:27], v11
  s_waitcnt lgkmcnt(0)
  s_barrier
  ds_read_b128 v[44:47], v4 offset:2048
  v_smfmac_f32_16x16x64_bf16 v[76:79], v[40:43], v[28:35], v11
  ds_read_b128 v[48:51], v4 offset:3072
  v_smfmac_f32_16x16x64_bf16 v[72:75], v[36:39], a[8:15], v11
  ds_read_b128 v[52:55], v4 offset:4096
  v_smfmac_f32_16x16x64_bf16 v[72:75], v[40:43], a[24:31], v11
  ds_read_b128 v[56:59], v4 offset:5120
  v_smfmac_f32_16x16x64_bf16 v[68:71], v[36:39], a[0:7], v11
  ds_read_b128 v[60:63], v4 offset:6144
  v_smfmac_f32_16x16x64_bf16 v[68:71], v[40:43], a[16:23], v11
  ds_read_b128 v[64:67], v4 offset:7168
  s_waitcnt lgkmcnt(5)
  v_smfmac_f32_16x16x64_bf16 v[68:71], v[44:47], a[32:39], v11
  s_waitcnt lgkmcnt(4)
  buffer_store_dword v14, v6, s[36:39], s72 offen sc1
  v_smfmac_f32_16x16x64_bf16 v[68:71], v[48:51], a[48:55], v11
  ds_read_b128 v[92:95], v2 offset:8192
  s_waitcnt lgkmcnt(4)
  v_smfmac_f32_16x16x64_bf16 v[68:71], v[52:55], a[64:71], v11
  ds_read_b128 v[96:99], v2 offset:9216
  s_waitcnt lgkmcnt(4)
  v_smfmac_f32_16x16x64_bf16 v[68:71], v[56:59], a[80:87], v11
  ds_read_b128 v[100:103], v2 offset:16384
  s_waitcnt lgkmcnt(4)
  v_smfmac_f32_16x16x64_bf16 v[68:71], v[60:63], a[96:103], v11
  buffer_load_dwordx4 v[20:23], v1, s[36:39], s69 offen offset:0 sc1
  s_waitcnt lgkmcnt(3)
  v_smfmac_f32_16x16x64_bf16 v[68:71], v[64:67], a[112:119], v11
  ds_read_b128 v[104:107], v2 offset:17408
  v_smfmac_f32_16x16x64_bf16 v[72:75], v[44:47], a[40:47], v11
  ds_read_b128 v[116:119], v2 offset:24576
  v_smfmac_f32_16x16x64_bf16 v[72:75], v[48:51], a[56:63], v11
  ds_read_b128 v[120:123], v2 offset:25600
  v_add_f32 v124, v68, v69
  v_smfmac_f32_16x16x64_bf16 v[72:75], v[52:55], a[72:79], v11
  buffer_load_dwordx4 v[24:27], v1, s[36:39], s69 offen offset:1024 sc1
  v_add_f32 v126, v70, v71
  v_smfmac_f32_16x16x64_bf16 v[72:75], v[56:59], a[88:95], v11
  v_mul_f32 v124, s73, v124
  v_smfmac_f32_16x16x64_bf16 v[72:75], v[60:63], a[104:111], v11
  v_mul_f32 v126, s73, v126
  v_smfmac_f32_16x16x64_bf16 v[72:75], v[64:67], a[120:127], v11
  s_waitcnt lgkmcnt(0) vmcnt(3)
  v_smfmac_f32_16x16x64_bf16 v[76:79], v[44:47], v[108:115], v11
  buffer_load_dwordx4 v[28:31], v1, s[36:39], s78 offen offset:0 sc1
  v_smfmac_f32_16x16x64_bf16 v[76:79], v[48:51], v[92:99], v11
  ds_read_b128 v[92:95], v4 offset:8192
  v_add_f32 v125, v72, v73
  v_smfmac_f32_16x16x64_bf16 v[76:79], v[52:55], v[100:107], v11
  ds_read_b128 v[96:99], v4 offset:10240
  v_add_f32 v127, v74, v75
  v_smfmac_f32_16x16x64_bf16 v[76:79], v[56:59], v[116:123], v11
  ds_read_b128 v[100:103], v4 offset:12288
  v_mul_f32 v125, s73, v125
  v_smfmac_f32_16x16x64_bf16 v[76:79], v[60:63], a[160:167], v11
  ds_read_b128 v[104:107], v4 offset:14336
  v_mul_f32 v127, s73, v127
  v_smfmac_f32_16x16x64_bf16 v[76:79], v[64:67], a[176:183], v11
  ds_read_b128 v[108:111], v4 offset:9216
  v_cvt_pk_bf16_f32 v124, v124, v125
  v_smfmac_f32_16x16x64_bf16 v[80:83], v[44:47], a[128:135], v11
  ds_read_b128 v[112:115], v4 offset:11264
  v_cvt_pk_bf16_f32 v125, v126, v127
  v_smfmac_f32_16x16x64_bf16 v[80:83], v[48:51], a[136:143], v11
  ds_write2_b32 v7, v124, v125 offset0:0 offset1:4
  v_smfmac_f32_16x16x64_bf16 v[80:83], v[52:55], a[144:151], v11
  ds_read_b128 v[36:39], v4 offset:13312
  v_add_f32 v120, v76, v77
  v_smfmac_f32_16x16x64_bf16 v[80:83], v[56:59], a[152:159], v11
  ds_read_b128 v[40:43], v4 offset:15360
  v_add_f32 v122, v78, v79
  v_smfmac_f32_16x16x64_bf16 v[80:83], v[60:63], a[168:175], v11
  buffer_load_dword v12, off, s[36:39], s70 sc1
  v_smfmac_f32_16x16x64_bf16 v[80:83], v[64:67], a[184:191], v11
  s_waitcnt lgkmcnt(2)
  s_barrier
  v_smfmac_f32_16x16x64_bf16 v[84:87], v[44:47], a[192:199], v11
  ds_read_b128 v[68:71], v8 offset:0
  v_smfmac_f32_16x16x64_bf16 v[84:87], v[48:51], a[208:215], v11
  ds_read_b128 v[72:75], v8 offset:1024
  v_add_f32 v121, v80, v81
  v_smfmac_f32_16x16x64_bf16 v[84:87], v[52:55], a[224:231], v11
  ds_read_b128 v[76:79], v8 offset:2048
  v_add_f32 v123, v82, v83
  v_smfmac_f32_16x16x64_bf16 v[84:87], v[56:59], a[240:247], v11
  ds_read_b128 v[80:83], v8 offset:3072
  v_cvt_pk_bf16_f32 v120, v120, v121
  v_smfmac_f32_16x16x64_bf16 v[84:87], v[60:63], v[224:231], v11
  buffer_load_dwordx4 v[32:35], v1, s[36:39], s78 offen offset:1024 sc1
  v_cvt_pk_bf16_f32 v121, v122, v123
  v_smfmac_f32_16x16x64_bf16 v[84:87], v[64:67], v[240:247], v11
  ds_write2_b32 v7, v120, v121 offset0:128 offset1:132
  v_smfmac_f32_16x16x64_bf16 v[88:91], v[44:47], a[200:207], v11
  v_smfmac_f32_16x16x64_bf16 v[88:91], v[48:51], a[216:223], v11
  v_cvt_pk_bf16_f32 v84, v84, v85
  v_smfmac_f32_16x16x64_bf16 v[88:91], v[52:55], a[232:239], v11
  v_cvt_pk_bf16_f32 v85, v86, v87
  v_smfmac_f32_16x16x64_bf16 v[88:91], v[56:59], a[248:255], v11
  v_smfmac_f32_16x16x64_bf16 v[88:91], v[60:63], v[232:239], v11
  s_waitcnt lgkmcnt(0)
  s_barrier
  v_smfmac_f32_16x16x64_bf16 v[88:91], v[64:67], v[248:255], v11
  ds_read_b128 v[44:47], v8 offset:512
  v_mfma_f32_16x16x32_bf16 v[116:119], v[92:95], v[68:71], 0
  ds_read_b128 v[92:95], v2 offset:49152
  v_mfma_f32_16x16x32_bf16 v[116:119], v[96:99], v[72:75], v[116:119]
  ds_read_b128 v[48:51], v8 offset:1536
  v_cvt_pk_bf16_f32 v88, v88, v89
  v_mfma_f32_16x16x32_bf16 v[116:119], v[100:103], v[76:79], v[116:119]
  ds_read_b128 v[52:55], v8 offset:2560
  v_cvt_pk_bf16_f32 v89, v90, v91
  v_mfma_f32_16x16x32_bf16 v[116:119], v[104:107], v[80:83], v[116:119]
  ds_read_b128 v[56:59], v8 offset:3584
  v_mfma_f32_16x16x32_bf16 v[120:123], v[108:111], v[68:71], 0
  ds_read_b128 v[96:99], v2 offset:50176
  v_mfma_f32_16x16x32_bf16 v[120:123], v[112:115], v[72:75], v[120:123]
  v_exp_f32 v60, v116
  v_mfma_f32_16x16x32_bf16 v[120:123], v[36:39], v[76:79], v[120:123]
  v_exp_f32 v61, v117
  v_mfma_f32_16x16x32_bf16 v[120:123], v[40:43], v[80:83], v[120:123]
  s_waitcnt lgkmcnt(5)
  v_exp_f32 v62, v118
  v_mfma_f32_16x16x32_bf16 v[124:127], v[44:47], v[68:71], 0
  s_waitcnt lgkmcnt(3)
  v_exp_f32 v63, v119
  v_mfma_f32_16x16x32_bf16 v[124:127], v[48:51], v[72:75], v[124:127]
  s_waitcnt lgkmcnt(2)
  v_exp_f32 v64, v120
  v_mfma_f32_16x16x32_bf16 v[124:127], v[52:55], v[76:79], v[124:127]
  s_waitcnt lgkmcnt(1)
  v_exp_f32 v65, v121
  v_mfma_f32_16x16x32_bf16 v[124:127], v[56:59], v[80:83], v[124:127]
  s_waitcnt lgkmcnt(0)
  v_exp_f32 v66, v122
  v_exp_f32 v67, v123
  v_cvt_pk_bf16_f32 v100, v60, v64
  v_cvt_pk_bf16_f32 v101, v61, v65
  v_cvt_pk_bf16_f32 v102, v62, v66
  v_cvt_pk_bf16_f32 v103, v63, v67
  v_exp_f32 v86, v124
  v_mov_b64 v[76:77], 0
  v_mfma_f32_16x16x32_bf16 v[104:107], v[16:19], v[100:103], 0
  v_exp_f32 v87, v126
  v_mfma_f32_16x16x32_bf16 v[108:111], v[92:95], v[100:103], 0
  v_cvt_pk_bf16_f32 v90, v86, v86
  v_cvt_pk_bf16_f32 v91, v87, v87
  v_mfma_f32_16x16x32_bf16 v[112:115], v[96:99], v[100:103], 0
  v_mov_b64 v[78:79], 0
  v_mov_b64 v[80:81], 0
  v_mfma_f32_16x16x16_bf16 v[36:39], v[16:17], v[90:91], 0
  v_mov_b64 v[82:83], 0
  v_mfma_f32_16x16x16_bf16 v[108:111], v[84:85], v[90:91], v[108:111]
  v_mfma_f32_16x16x16_bf16 v[112:115], v[88:89], v[90:91], v[112:115]
  v_fma_f32 v106, v38, 0.5, v106
  v_rcp_f32 v107, v106
  v_mov_b32 v13, 0
  v_mul_f32 v108, v108, v107
  v_mul_f32 v109, v109, v107
  v_mul_f32 v110, v110, v107
  v_mul_f32 v111, v111, v107
  v_cvt_pk_bf16_f32 v100, v108, v109
  v_cvt_pk_bf16_f32 v101, v110, v111
  v_mul_f32 v112, v112, v107
  v_mul_f32 v113, v113, v107
  v_mul_f32 v114, v114, v107
  v_mul_f32 v115, v115, v107
  v_cvt_pk_bf16_f32 v102, v112, v113
  v_cvt_pk_bf16_f32 v103, v114, v115
  v_cndmask_b32 v36, v100, v102, s[84:85]
  v_cndmask_b32 v37, v101, v103, s[84:85]
  ds_write_b64 v10, v[36:37]
  v_max_f32 v104, v106, v107
  v_cmp_nge_f32 vcc, s86, v104
  v_mov_b64 v[44:45], 0
  v_mov_b64 v[46:47], 0
  v_mov_b64 v[48:49], 0
  v_mov_b64 v[50:51], 0
  s_cbranch_vccnz L_smr_s0_0
L_sm_s0_0:
  v_smfmac_f32_16x16x64_bf16 v[76:79], v[100:103], v[128:135], v11
  s_waitcnt lgkmcnt(0)
  s_barrier
  ds_read_b128 v[60:63], v8 offset:5120
  v_smfmac_f32_16x16x64_bf16 v[80:83], v[100:103], v[160:167], v11
  ds_read_b128 v[64:67], v8 offset:6144
  v_mov_b64 v[84:85], 0
  v_smfmac_f32_16x16x64_bf16 v[44:47], v[100:103], v[192:199], v11
  ds_read_b128 v[40:43], v8 offset:7168
  v_mov_b64 v[86:87], 0
  v_smfmac_f32_16x16x64_bf16 v[48:51], v[100:103], v[216:223], v11
  ds_read_b128 v[92:95], v3 offset:0
  s_waitcnt lgkmcnt(3)
  v_smfmac_f32_16x16x64_bf16 v[76:79], v[60:63], v[136:143], v11
  ds_read_b128 v[96:99], v3 offset:1024
  s_waitcnt lgkmcnt(3)
  v_smfmac_f32_16x16x64_bf16 v[76:79], v[64:67], v[144:151], v11
  ds_read_b128 v[52:55], v3 offset:8192
  s_waitcnt lgkmcnt(3)
  v_smfmac_f32_16x16x64_bf16 v[76:79], v[40:43], v[152:159], v11
  ds_read_b128 v[56:59], v3 offset:9216
  v_mov_b64 v[88:89], 0
  v_smfmac_f32_16x16x64_bf16 v[80:83], v[60:63], v[168:175], v11
  ds_read_b128 v[68:71], v3 offset:16384
  v_mov_b64 v[90:91], 0
  v_smfmac_f32_16x16x64_bf16 v[80:83], v[64:67], v[176:183], v11
  ds_read_b128 v[72:75], v3 offset:17408
  v_cvt_pk_bf16_f32 v76, v76, v77
  v_cvt_pk_bf16_f32 v77, v78, v79
  v_and_b32 v76, -2, v76
  v_smfmac_f32_16x16x64_bf16 v[80:83], v[40:43], v[184:191], v11
  s_waitcnt lgkmcnt(2)
  buffer_store_dwordx2 v[76:77], v5, s[36:39], 0 offen sc1
  v_smfmac_f32_16x16x64_bf16 v[44:47], v[60:63], v[200:207], v11
  ds_read_b128 v[116:119], v3 offset:24576
  v_mov_b64 v[76:77], 0
  v_mov_b64 v[78:79], 0
  v_smfmac_f32_16x16x64_bf16 v[44:47], v[64:67], v[208:215], v11
  ds_read_b128 v[120:123], v3 offset:25600
  v_cvt_pk_bf16_f32 v80, v80, v81
  v_cvt_pk_bf16_f32 v81, v82, v83
  v_and_b32 v80, -2, v80
  v_smfmac_f32_16x16x64_bf16 v[44:47], v[40:43], v[92:99], v11
  buffer_store_dwordx2 v[80:81], v5, s[36:39], s74 offen sc1
  v_smfmac_f32_16x16x64_bf16 v[48:51], v[60:63], v[52:59], v11
  s_waitcnt lgkmcnt(2)
  v_mov_b64 v[80:81], 0
  v_mov_b64 v[82:83], 0
  v_smfmac_f32_16x16x64_bf16 v[48:51], v[64:67], v[68:75], v11
  s_waitcnt lgkmcnt(0)
  v_cvt_pk_bf16_f32 v44, v44, v45
  v_cvt_pk_bf16_f32 v45, v46, v47
  v_and_b32 v44, -2, v44
  v_smfmac_f32_16x16x64_bf16 v[48:51], v[40:43], v[116:123], v11
  buffer_store_dwordx2 v[44:45], v5, s[36:39], s76 offen sc1
  v_mov_b64 v[68:69], 0
  v_mov_b64 v[70:71], 0
  v_mov_b32 v13, 0
  v_mov_b32 v13, 0
  v_cvt_pk_bf16_f32 v48, v48, v49
  v_cvt_pk_bf16_f32 v49, v50, v51
  v_and_b32 v48, -2, v48
  buffer_store_dwordx2 v[48:49], v5, s[36:39], s65 offen sc1
  v_mov_b64 v[72:73], 0
  v_mov_b64 v[74:75], 0
L_gap_gp00_6_69:
  s_nop 5
  s_nop 5
  s_nop 5
  s_nop 5
  s_nop 5
  s_nop 4
  buffer_load_dwordx4 v[108:111], v1, s[36:39], s64 offen offset:0 sc1
  buffer_load_dwordx4 v[112:115], v1, s[36:39], s64 offen offset:1024 sc1
  s_waitcnt vmcnt(10)
  ds_write_b128 v2, v[20:23] offset:40960
  s_waitcnt vmcnt(9)
  ds_write_b128 v2, v[24:27] offset:41984
  s_waitcnt vmcnt(8)
  ds_write_b128 v2, v[28:31] offset:49152
  s_waitcnt vmcnt(6)
  ds_write_b128 v2, v[32:35] offset:50176
  ds_read_b128 v[44:47], v1 offset:0
  ds_read_b128 v[48:51], v1 offset:1024
  ds_read_b128 v[52:55], v1 offset:8192
  ds_read_b128 v[56:59], v1 offset:9216
.p2align 5
  s_nop 0
  s_nop 0
  s_nop 0
  s_nop 0
  s_waitcnt vmcnt(1)
  v_mfma_f32_16x16x32_bf16 v[124:127], v[16:19], v[108:111], 0
  v_bitop3_b32 v15, v108, v110, 1 bitop3:0xa8
  v_lshlrev_b32 v15, 1, v15
  s_waitcnt vmcnt(0)
  v_mfma_f32_16x16x32_bf16 v[124:127], v[16:19], v[112:115], v[124:127]
  v_bitop3_b32 v13, v112, v114, 1 bitop3:0xa8
  v_cmp_ne_u32 vcc, v13, v15
  s_cbranch_vccnz L_pb_s0_0r
L_pb_s0_0:
  v_add_f32_dpp v124, v124, v124 row_ror:4 row_mask:0xf bank_mask:0xf
  v_add_f32_dpp v125, v125, v125 row_ror:4 row_mask:0xf bank_mask:0xf
  s_nop 0
  v_add_f32_dpp v124, v124, v124 row_ror:8 row_mask:0xf bank_mask:0xf
  v_add_f32_dpp v125, v125, v125 row_ror:8 row_mask:0xf bank_mask:0xf
  v_cvt_pk_bf16_f32 v14, v124, v125
  v_min_u32 v14, -2, v14
  buffer_store_dword v14, v6, s[36:39], s87 offen sc1
  s_mov_b32 s72, s79
  s_add_u32 s79, s79, 8192
  s_cmp_eq_u32 s68, 62
  s_cbranch_scc1 L_chain_done
  s_add_u32 s68, s68, 2
  v_cmp_ne_u32 vcc, 1, v12
  v_mov_b32 v124, -1
  buffer_store_dword v124, v6, s[36:39], s71 offen sc1
  s_cbranch_vccnz L_flr_s0_0
L_fl_s0_0:
  s_xor_b32 s71, s71, 0x4000
  s_mov_b32 s75, s71
  s_add_u32 s92, s75, 0x1000
  ds_read_b128 v[60:63], v1 offset:16384
  ds_read_b128 v[64:67], v1 offset:17408
  ds_read_b128 v[92:95], v1 offset:24576
  ds_read_b128 v[96:99], v1 offset:25600
  ds_read_b128 v[100:103], v1 offset:32768
  ds_read_b128 v[104:107], v1 offset:33792
L_gap_gp01_3_70:
  s_nop 10
  s_nop 10
  s_nop 9
  buffer_load_dwordx4 v[36:39], v9, s[36:39], s87 offen offset:0 sc1
  buffer_load_dwordx4 v[40:43], v9, s[36:39], s87 offen offset:2048 sc1
  ds_read_b128 v[116:119], v1 offset:40960
  ds_read_b128 v[120:123], v1 offset:41984
  ds_read_b128 v[20:23], v1 offset:49152
  ds_read_b128 v[24:27], v1 offset:50176
  ds_read_b128 v[28:31], v1 offset:57344
  ds_read_b128 v[32:35], v1 offset:58368
  s_waitcnt vmcnt(4)
  ds_read_b128 v[108:111], v2 offset:0
  ds_read_b128 v[112:115], v2 offset:1024
.p2align 5
  s_nop 0
  s_nop 0
  s_nop 0
  s_nop 0
L_step_s0_1:
  s_waitcnt lgkmcnt(0)
  s_waitcnt vmcnt(0)
  v_max_u32 v15, v39, v43
  v_cmp_eq_u32 vcc, -1, v15
  ds_write_b64 v2, v[36:37] offset:32768
  s_cbranch_vccnz L_er0_s0_1
L_eb0_s0_1:
  v_smfmac_f32_16x16x64_bf16 v[88:91], v[36:39], v[44:51], v11
  ds_write_b64 v2, v[38:39] offset:32776
  v_smfmac_f32_16x16x64_bf16 v[88:91], v[40:43], v[52:59], v11
  ds_write_b64 v2, v[40:41] offset:33792
  v_smfmac_f32_16x16x64_bf16 v[84:87], v[36:39], v[60:67], v11
  ds_write_b64 v2, v[42:43] offset:33800
  v_smfmac_f32_16x16x64_bf16 v[84:87], v[40:43], v[92:99], v11
  s_add_u32 s69, s69, 16384
  s_add_u32 s78, s69, 8192
  v_smfmac_f32_16x16x64_bf16 v[80:83], v[36:39], v[100:107], v11
  s_add_u32 s70, s70, 2048
  s_min_u32 s70, s70, s77
  v_smfmac_f32_16x16x64_bf16 v[80:83], v[40:43], v[116:123], v11
  v_smfmac_f32_16x16x64_bf16 v[76:79], v[36:39], v[20:27], v11
  s_waitcnt lgkmcnt(0)
  s_barrier
  ds_read_b128 v[44:47], v4 offset:2048
  v_smfmac_f32_16x16x64_bf16 v[76:79], v[40:43], v[28:35], v11
  ds_read_b128 v[48:51], v4 offset:3072
  v_smfmac_f32_16x16x64_bf16 v[72:75], v[36:39], a[8:15], v11
  ds_read_b128 v[52:55], v4 offset:4096
  v_smfmac_f32_16x16x64_bf16 v[72:75], v[40:43], a[24:31], v11
  ds_read_b128 v[56:59], v4 offset:5120
  v_smfmac_f32_16x16x64_bf16 v[68:71], v[36:39], a[0:7], v11
  ds_read_b128 v[60:63], v4 offset:6144
  v_smfmac_f32_16x16x64_bf16 v[68:71], v[40:43], a[16:23], v11
  ds_read_b128 v[64:67], v4 offset:7168
  s_waitcnt lgkmcnt(5)
  v_smfmac_f32_16x16x64_bf16 v[68:71], v[44:47], a[32:39], v11
  s_waitcnt lgkmcnt(4)
  buffer_store_dword v14, v6, s[36:39], s72 offen sc1
  v_smfmac_f32_16x16x64_bf16 v[68:71], v[48:51], a[48:55], v11
  ds_read_b128 v[92:95], v2 offset:8192
  s_waitcnt lgkmcnt(4)
  v_smfmac_f32_16x16x64_bf16 v[68:71], v[52:55], a[64:71], v11
  ds_read_b128 v[96:99], v2 offset:9216
  s_waitcnt lgkmcnt(4)
  v_smfmac_f32_16x16x64_bf16 v[68:71], v[56:59], a[80:87], v11
  ds_read_b128 v[100:103], v2 offset:16384
  s_waitcnt lgkmcnt(4)
  v_smfmac_f32_16x16x64_bf16 v[68:71], v[60:63], a[96:103], v11
  buffer_load_dwordx4 v[20:23], v1, s[36:39], s69 offen offset:0 sc1
  s_waitcnt lgkmcnt(3)
  v_smfmac_f32_16x16x64_bf16 v[68:71], v[64:67], a[112:119], v11
  ds_read_b128 v[104:107], v2 offset:17408
  v_smfmac_f32_16x16x64_bf16 v[72:75], v[44:47], a[40:47], v11
  ds_read_b128 v[116:119], v2 offset:24576
  v_smfmac_f32_16x16x64_bf16 v[72:75], v[48:51], a[56:63], v11
  ds_read_b128 v[120:123], v2 offset:25600
  v_add_f32 v124, v68, v69
  v_smfmac_f32_16x16x64_bf16 v[72:75], v[52:55], a[72:79], v11
  buffer_load_dwordx4 v[24:27], v1, s[36:39], s69 offen offset:1024 sc1
  v_add_f32 v126, v70, v71
  v_smfmac_f32_16x16x64_bf16 v[72:75], v[56:59], a[88:95], v11
  v_mul_f32 v124, s73, v124
  v_smfmac_f32_16x16x64_bf16 v[72:75], v[60:63], a[104:111], v11
  v_mul_f32 v126, s73, v126
  v_smfmac_f32_16x16x64_bf16 v[72:75], v[64:67], a[120:127], v11
  s_waitcnt lgkmcnt(0) vmcnt(3)
  v_smfmac_f32_16x16x64_bf16 v[76:79], v[44:47], v[108:115], v11
  buffer_load_dwordx4 v[28:31], v1, s[36:39], s78 offen offset:0 sc1
  v_smfmac_f32_16x16x64_bf16 v[76:79], v[48:51], v[92:99], v11
  ds_read_b128 v[92:95], v4 offset:8192
  v_add_f32 v125, v72, v73
  v_smfmac_f32_16x16x64_bf16 v[76:79], v[52:55], v[100:107], v11
  ds_read_b128 v[96:99], v4 offset:10240
  v_add_f32 v127, v74, v75
  v_smfmac_f32_16x16x64_bf16 v[76:79], v[56:59], v[116:123], v11
  ds_read_b128 v[100:103], v4 offset:12288
  v_mul_f32 v125, s73, v125
  v_smfmac_f32_16x16x64_bf16 v[76:79], v[60:63], a[160:167], v11
  ds_read_b128 v[104:107], v4 offset:14336
  v_mul_f32 v127, s73, v127
  v_smfmac_f32_16x16x64_bf16 v[76:79], v[64:67], a[176:183], v11
  ds_read_b128 v[108:111], v4 offset:9216
  v_cvt_pk_bf16_f32 v124, v124, v125
  v_smfmac_f32_16x16x64_bf16 v[80:83], v[44:47], a[128:135], v11
  ds_read_b128 v[112:115], v4 offset:11264
  v_cvt_pk_bf16_f32 v125, v126, v127
  v_smfmac_f32_16x16x64_bf16 v[80:83], v[48:51], a[136:143], v11
  ds_write2_b32 v7, v124, v125 offset0:0 offset1:4
  v_smfmac_f32_16x16x64_bf16 v[80:83], v[52:55], a[144:151], v11
  ds_read_b128 v[36:39], v4 offset:13312
  v_add_f32 v120, v76, v77
  v_smfmac_f32_16x16x64_bf16 v[80:83], v[56:59], a[152:159], v11
  ds_read_b128 v[40:43], v4 offset:15360
  v_add_f32 v122, v78, v79
  v_smfmac_f32_16x16x64_bf16 v[80:83], v[60:63], a[168:175], v11
  buffer_load_dword v12, off, s[36:39], s70 sc1
  v_smfmac_f32_16x16x64_bf16 v[80:83], v[64:67], a[184:191], v11
  s_waitcnt lgkmcnt(2)
  s_barrier
  v_smfmac_f32_16x16x64_bf16 v[84:87], v[44:47], a[192:199], v11
  ds_read_b128 v[68:71], v8 offset:0
  v_smfmac_f32_16x16x64_bf16 v[84:87], v[48:51], a[208:215], v11
  ds_read_b128 v[72:75], v8 offset:1024
  v_add_f32 v121, v80, v81
  v_smfmac_f32_16x16x64_bf16 v[84:87], v[52:55], a[224:231], v11
  ds_read_b128 v[76:79], v8 offset:2048
  v_add_f32 v123, v82, v83
  v_smfmac_f32_16x16x64_bf16 v[84:87], v[56:59], a[240:247], v11
  ds_read_b128 v[80:83], v8 offset:3072
  v_cvt_pk_bf16_f32 v120, v120, v121
  v_smfmac_f32_16x16x64_bf16 v[84:87], v[60:63], v[224:231], v11
  buffer_load_dwordx4 v[32:35], v1, s[36:39], s78 offen offset:1024 sc1
  v_cvt_pk_bf16_f32 v121, v122, v123
  v_smfmac_f32_16x16x64_bf16 v[84:87], v[64:67], v[240:247], v11
  ds_write2_b32 v7, v120, v121 offset0:128 offset1:132
  v_smfmac_f32_16x16x64_bf16 v[88:91], v[44:47], a[200:207], v11
  v_smfmac_f32_16x16x64_bf16 v[88:91], v[48:51], a[216:223], v11
  v_cvt_pk_bf16_f32 v84, v84, v85
  v_smfmac_f32_16x16x64_bf16 v[88:91], v[52:55], a[232:239], v11
  v_cvt_pk_bf16_f32 v85, v86, v87
  v_smfmac_f32_16x16x64_bf16 v[88:91], v[56:59], a[248:255], v11
  v_smfmac_f32_16x16x64_bf16 v[88:91], v[60:63], v[232:239], v11
  s_waitcnt lgkmcnt(0)
  s_barrier
  v_smfmac_f32_16x16x64_bf16 v[88:91], v[64:67], v[248:255], v11
  ds_read_b128 v[44:47], v8 offset:512
  v_mfma_f32_16x16x32_bf16 v[116:119], v[92:95], v[68:71], 0
  ds_read_b128 v[92:95], v2 offset:49152
  v_mfma_f32_16x16x32_bf16 v[116:119], v[96:99], v[72:75], v[116:119]
  ds_read_b128 v[48:51], v8 offset:1536
  v_cvt_pk_bf16_f32 v88, v88, v89
  v_mfma_f32_16x16x32_bf16 v[116:119], v[100:103], v[76:79], v[116:119]
  ds_read_b128 v[52:55], v8 offset:2560
  v_cvt_pk_bf16_f32 v89, v90, v91
  v_mfma_f32_16x16x32_bf16 v[116:119], v[104:107], v[80:83], v[116:119]
  ds_read_b128 v[56:59], v8 offset:3584
  v_mfma_f32_16x16x32_bf16 v[120:123], v[108:111], v[68:71], 0
  ds_read_b128 v[96:99], v2 offset:50176
  v_mfma_f32_16x16x32_bf16 v[120:123], v[112:115], v[72:75], v[120:123]
  v_exp_f32 v60, v116
  v_mfma_f32_16x16x32_bf16 v[120:123], v[36:39], v[76:79], v[120:123]
  v_exp_f32 v61, v117
  v_mfma_f32_16x16x32_bf16 v[120:123], v[40:43], v[80:83], v[120:123]
  s_waitcnt lgkmcnt(5)
  v_exp_f32 v62, v118
  v_mfma_f32_16x16x32_bf16 v[124:127], v[44:47], v[68:71], 0
  s_waitcnt lgkmcnt(3)
  v_exp_f32 v63, v119
  v_mfma_f32_16x16x32_bf16 v[124:127], v[48:51], v[72:75], v[124:127]
  s_waitcnt lgkmcnt(2)
  v_exp_f32 v64, v120
  v_mfma_f32_16x16x32_bf16 v[124:127], v[52:55], v[76:79], v[124:127]
  s_waitcnt lgkmcnt(1)
  v_exp_f32 v65, v121
  v_mfma_f32_16x16x32_bf16 v[124:127], v[56:59], v[80:83], v[124:127]
  s_waitcnt lgkmcnt(0)
  v_exp_f32 v66, v122
  v_exp_f32 v67, v123
  v_cvt_pk_bf16_f32 v100, v60, v64
  v_cvt_pk_bf16_f32 v101, v61, v65
  v_cvt_pk_bf16_f32 v102, v62, v66
  v_cvt_pk_bf16_f32 v103, v63, v67
  v_exp_f32 v86, v124
  v_mov_b64 v[76:77], 0
  v_mfma_f32_16x16x32_bf16 v[104:107], v[16:19], v[100:103], 0
  v_exp_f32 v87, v126
  v_mfma_f32_16x16x32_bf16 v[108:111], v[92:95], v[100:103], 0
  v_cvt_pk_bf16_f32 v90, v86, v86
  v_cvt_pk_bf16_f32 v91, v87, v87
  v_mfma_f32_16x16x32_bf16 v[112:115], v[96:99], v[100:103], 0
  v_mov_b64 v[78:79], 0
  v_mov_b64 v[80:81], 0
  v_mfma_f32_16x16x16_bf16 v[36:39], v[16:17], v[90:91], 0
  v_mov_b64 v[82:83], 0
  v_mfma_f32_16x16x16_bf16 v[108:111], v[84:85], v[90:91], v[108:111]
  v_mfma_f32_16x16x16_bf16 v[112:115], v[88:89], v[90:91], v[112:115]
  v_fma_f32 v106, v38, 0.5, v106
  v_rcp_f32 v107, v106
  v_mov_b32 v13, 0
  v_mul_f32 v108, v108, v107
  v_mul_f32 v109, v109, v107
  v_mul_f32 v110, v110, v107
  v_mul_f32 v111, v111, v107
  v_cvt_pk_bf16_f32 v100, v108, v109
  v_cvt_pk_bf16_f32 v101, v110, v111
  v_mul_f32 v112, v112, v107
  v_mul_f32 v113, v113, v107
  v_mul_f32 v114, v114, v107
  v_mul_f32 v115, v115, v107
  v_cvt_pk_bf16_f32 v102, v112, v113
  v_cvt_pk_bf16_f32 v103, v114, v115
  v_cndmask_b32 v36, v100, v102, s[84:85]
  v_cndmask_b32 v37, v101, v103, s[84:85]
  ds_write_b64 v10, v[36:37]
  v_max_f32 v104, v106, v107
  v_cmp_nge_f32 vcc, s86, v104
  v_mov_b64 v[44:45], 0
  v_mov_b64 v[46:47], 0
  v_mov_b64 v[48:49], 0
  v_mov_b64 v[50:51], 0
  s_cbranch_vccnz L_smr_s0_1
L_sm_s0_1:
  v_smfmac_f32_16x16x64_bf16 v[76:79], v[100:103], v[128:135], v11
  s_waitcnt lgkmcnt(0)
  s_barrier
  ds_read_b128 v[60:63], v8 offset:5120
  v_smfmac_f32_16x16x64_bf16 v[80:83], v[100:103], v[160:167], v11
  ds_read_b128 v[64:67], v8 offset:6144
  v_mov_b64 v[84:85], 0
  v_smfmac_f32_16x16x64_bf16 v[44:47], v[100:103], v[192:199], v11
  ds_read_b128 v[40:43], v8 offset:7168
  v_mov_b64 v[86:87], 0
  v_smfmac_f32_16x16x64_bf16 v[48:51], v[100:103], v[216:223], v11
  ds_read_b128 v[92:95], v3 offset:0
  s_waitcnt lgkmcnt(3)
  v_smfmac_f32_16x16x64_bf16 v[76:79], v[60:63], v[136:143], v11
  ds_read_b128 v[96:99], v3 offset:1024
  s_waitcnt lgkmcnt(3)
  v_smfmac_f32_16x16x64_bf16 v[76:79], v[64:67], v[144:151], v11
  ds_read_b128 v[52:55], v3 offset:8192
  s_waitcnt lgkmcnt(3)
  v_smfmac_f32_16x16x64_bf16 v[76:79], v[40:43], v[152:159], v11
  ds_read_b128 v[56:59], v3 offset:9216
  v_mov_b64 v[88:89], 0
  v_smfmac_f32_16x16x64_bf16 v[80:83], v[60:63], v[168:175], v11
  ds_read_b128 v[68:71], v3 offset:16384
  v_mov_b64 v[90:91], 0
  v_smfmac_f32_16x16x64_bf16 v[80:83], v[64:67], v[176:183], v11
  ds_read_b128 v[72:75], v3 offset:17408
  v_cvt_pk_bf16_f32 v76, v76, v77
  v_cvt_pk_bf16_f32 v77, v78, v79
  v_or_b32 v76, 1, v76
  v_smfmac_f32_16x16x64_bf16 v[80:83], v[40:43], v[184:191], v11
  s_waitcnt lgkmcnt(2)
  buffer_store_dwordx2 v[76:77], v5, s[36:39], 0 offen sc1
  v_smfmac_f32_16x16x64_bf16 v[44:47], v[60:63], v[200:207], v11
  ds_read_b128 v[116:119], v3 offset:24576
  v_mov_b64 v[76:77], 0
  v_mov_b64 v[78:79], 0
  v_smfmac_f32_16x16x64_bf16 v[44:47], v[64:67], v[208:215], v11
  ds_read_b128 v[120:123], v3 offset:25600
  v_cvt_pk_bf16_f32 v80, v80, v81
  v_cvt_pk_bf16_f32 v81, v82, v83
  v_or_b32 v80, 1, v80
  v_smfmac_f32_16x16x64_bf16 v[44:47], v[40:43], v[92:99], v11
  buffer_store_dwordx2 v[80:81], v5, s[36:39], s74 offen sc1
  v_smfmac_f32_16x16x64_bf16 v[48:51], v[60:63], v[52:59], v11
  s_waitcnt lgkmcnt(2)
  v_mov_b64 v[80:81], 0
  v_mov_b64 v[82:83], 0
  v_smfmac_f32_16x16x64_bf16 v[48:51], v[64:67], v[68:75], v11
  s_waitcnt lgkmcnt(0)
  v_cvt_pk_bf16_f32 v44, v44, v45
  v_cvt_pk_bf16_f32 v45, v46, v47
  v_or_b32 v44, 1, v44
  v_smfmac_f32_16x16x64_bf16 v[48:51], v[40:43], v[116:123], v11
  buffer_store_dwordx2 v[44:45], v5, s[36:39], s76 offen sc1
  v_mov_b64 v[68:69], 0
  v_mov_b64 v[70:71], 0
  v_mov_b32 v13, 0
  v_mov_b32 v13, 0
  v_cvt_pk_bf16_f32 v48, v48, v49
  v_cvt_pk_bf16_f32 v49, v50, v51
  v_or_b32 v48, 1, v48
  buffer_store_dwordx2 v[48:49], v5, s[36:39], s65 offen sc1
  v_mov_b64 v[72:73], 0
  v_mov_b64 v[74:75], 0
L_gap_gp00_6_71:
  s_nop 5
  s_nop 5
  s_nop 5
  s_nop 5
  s_nop 5
  s_nop 4
  buffer_load_dwordx4 v[108:111], v1, s[36:39], s64 offen offset:0 sc1
  buffer_load_dwordx4 v[112:115], v1, s[36:39], s64 offen offset:1024 sc1
  s_waitcnt vmcnt(10)
  ds_write_b128 v2, v[20:23] offset:40960
  s_waitcnt vmcnt(9)
  ds_write_b128 v2, v[24:27] offset:41984
  s_waitcnt vmcnt(8)
  ds_write_b128 v2, v[28:31] offset:49152
  s_waitcnt vmcnt(6)
  ds_write_b128 v2, v[32:35] offset:50176
  ds_read_b128 v[44:47], v1 offset:0
  ds_read_b128 v[48:51], v1 offset:1024
  ds_read_b128 v[52:55], v1 offset:8192
  ds_read_b128 v[56:59], v1 offset:9216
.p2align 5
  s_nop 0
  s_nop 0
  s_nop 0
  s_nop 0
  s_waitcnt vmcnt(1)
  v_mfma_f32_16x16x32_bf16 v[124:127], v[16:19], v[108:111], 0
  v_bitop3_b32 v15, v108, v110, 1 bitop3:0x80
  v_sub_u32 v15, 2, v15
  s_waitcnt vmcnt(0)
  v_mfma_f32_16x16x32_bf16 v[124:127], v[16:19], v[112:115], v[124:127]
  v_bitop3_b32 v13, v112, v114, 1 bitop3:0x80
  v_cmp_ne_u32 vcc, v13, v15
  s_cbranch_vccnz L_pb_s0_1r
L_pb_s0_1:
  v_add_f32_dpp v124, v124, v124 row_ror:4 row_mask:0xf bank_mask:0xf
  v_add_f32_dpp v125, v125, v125 row_ror:4 row_mask:0xf bank_mask:0xf
  s_nop 0
  v_add_f32_dpp v124, v124, v124 row_ror:8 row_mask:0xf bank_mask:0xf
  v_add_f32_dpp v125, v125, v125 row_ror:8 row_mask:0xf bank_mask:0xf
  v_cvt_pk_bf16_f32 v14, v124, v125
  v_min_u32 v14, -2, v14
  buffer_store_dword v14, v6, s[36:39], s71 offen sc1
  s_mov_b32 s72, s79
  s_add_u32 s79, s79, 8192
  v_cmp_ne_u32 vcc, 1, v12
  v_mov_b32 v124, -1
  buffer_store_dword v124, v6, s[36:39], s87 offen sc1
  s_cbranch_vccnz L_flr_s0_1
L_fl_s0_1:
  s_xor_b32 s87, s87, 0x4000
  s_xor_b32 s93, s93, 0x4000
  ds_read_b128 v[60:63], v1 offset:16384
  ds_read_b128 v[64:67], v1 offset:17408
  ds_read_b128 v[92:95], v1 offset:24576
  ds_read_b128 v[96:99], v1 offset:25600
  ds_read_b128 v[100:103], v1 offset:32768
  ds_read_b128 v[104:107], v1 offset:33792
L_gap_gp01_3_72:
  s_nop 10
  s_nop 10
  s_nop 9
  buffer_load_dwordx4 v[36:39], v9, s[36:39], s75 offen offset:0 sc1
  buffer_load_dwordx4 v[40:43], v9, s[36:39], s75 offen offset:2048 sc1
  ds_read_b128 v[116:119], v1 offset:40960
  ds_read_b128 v[120:123], v1 offset:41984
  ds_read_b128 v[20:23], v1 offset:49152
  ds_read_b128 v[24:27], v1 offset:50176
  ds_read_b128 v[28:31], v1 offset:57344
  ds_read_b128 v[32:35], v1 offset:58368
  s_waitcnt vmcnt(4)
  ds_read_b128 v[108:111], v2 offset:0
  ds_read_b128 v[112:115], v2 offset:1024
  s_branch L_step_s0_0
L_er0_s0_0:
  buffer_load_dwordx4 v[36:39], v9, s[36:39], s75 offen offset:0 sc1
  buffer_load_dwordx4 v[40:43], v9, s[36:39], s75 offen offset:2048 sc1
  s_nop 15
  s_nop 7
L_er0_s0_0s:
  buffer_load_dwordx4 v[36:39], v9, s[36:39], s75 offen offset:0 sc1
  buffer_load_dwordx4 v[40:43], v9, s[36:39], s75 offen offset:2048 sc1
  s_waitcnt vmcnt(2)
  v_max_u32 v15, v39, v43
  v_cmp_eq_u32 vcc, -1, v15
  s_cbranch_vccz L_eb0_s0_0o
  s_sub_u32 s3, s3, 1
  s_cbranch_scc1 L_end
  s_branch L_er0_s0_0s
L_eb0_s0_0o:
  ds_write_b64 v2, v[36:37] offset:32768
  s_branch L_eb0_s0_0
L_smr_s0_0:
  v_max_f32 v86, v116, v120
  v_max3_f32 v86, v86, v117, v121
  v_max3_f32 v86, v86, v118, v122
  v_max3_f32 v86, v86, v119, v123
  v_max3_f32 v86, v86, v124, v126
  v_mov_b32 v87, v86
  s_nop 1
  v_permlane32_swap_b32 v86, v87
  v_max_f32 v86, v86, v87
  v_mov_b32 v87, v86
  s_nop 1
  v_permlane16_swap_b32 v86, v87
  v_max_f32 v86, v86, v87
  v_sub_f32 v116, v116, v86
  v_sub_f32 v120, v120, v86
  v_sub_f32 v117, v117, v86
  v_sub_f32 v121, v121, v86
  v_sub_f32 v118, v118, v86
  v_sub_f32 v122, v122, v86
  v_sub_f32 v119, v119, v86
  v_sub_f32 v123, v123, v86
  v_sub_f32 v124, v124, v86
  v_sub_f32 v126, v126, v86
  v_exp_f32 v116, v116
  v_exp_f32 v120, v120
  v_exp_f32 v117, v117
  v_exp_f32 v121, v121
  v_exp_f32 v118, v118
  v_exp_f32 v122, v122
  v_exp_f32 v119, v119
  v_exp_f32 v123, v123
  v_exp_f32 v124, v124
  v_exp_f32 v126, v126
  v_cvt_pk_bf16_f32 v100, v116, v120
  v_cvt_pk_bf16_f32 v101, v117, v121
  v_cvt_pk_bf16_f32 v102, v118, v122
  v_cvt_pk_bf16_f32 v103, v119, v123
  v_cvt_pk_bf16_f32 v90, v124, v124
  v_cvt_pk_bf16_f32 v91, v126, v126
  s_waitcnt lgkmcnt(0)
  v_mov_b64 v[76:77], 0
  v_mov_b64 v[78:79], 0
  v_mfma_f32_16x16x32_bf16 v[104:107], v[16:19], v[100:103], 0
  v_mfma_f32_16x16x32_bf16 v[108:111], v[92:95], v[100:103], 0
  v_mfma_f32_16x16x32_bf16 v[112:115], v[96:99], v[100:103], 0
  v_mfma_f32_16x16x16_bf16 v[36:39], v[16:17], v[90:91], 0
  v_mfma_f32_16x16x16_bf16 v[108:111], v[84:85], v[90:91], v[108:111]
  v_mfma_f32_16x16x16_bf16 v[112:115], v[88:89], v[90:91], v[112:115]
  v_fma_f32 v106, v38, 0.5, v106
  v_rcp_f32 v107, v106
  s_nop 0
  v_mul_f32 v108, v108, v107
  v_mul_f32 v109, v109, v107
  v_mul_f32 v110, v110, v107
  v_mul_f32 v111, v111, v107
  v_cvt_pk_bf16_f32 v100, v108, v109
  v_cvt_pk_bf16_f32 v101, v110, v111
  v_mul_f32 v112, v112, v107
  v_mul_f32 v113, v113, v107
  v_mul_f32 v114, v114, v107
  v_mul_f32 v115, v115, v107
  v_cvt_pk_bf16_f32 v102, v112, v113
  v_cvt_pk_bf16_f32 v103, v114, v115
  v_cndmask_b32 v36, v100, v102, s[84:85]
  v_cndmask_b32 v37, v101, v103, s[84:85]
  ds_write_b64 v10, v[36:37]
  s_branch L_sm_s0_0
L_pb_s0_0r:
  buffer_load_dwordx4 v[108:111], v1, s[36:39], s64 offen offset:0 sc1
  buffer_load_dwordx4 v[112:115], v1, s[36:39], s64 offen offset:1024 sc1
  s_nop 15
  s_nop 7
L_pb_s0_0s:
  buffer_load_dwordx4 v[36:39], v1, s[36:39], s64 offen offset:0 sc1
  buffer_load_dwordx4 v[40:43], v1, s[36:39], s64 offen offset:1024 sc1
  s_waitcnt vmcnt(3)
  v_mfma_f32_16x16x32_bf16 v[124:127], v[16:19], v[108:111], 0
  v_bitop3_b32 v15, v108, v110, 1 bitop3:0xa8
  v_lshlrev_b32 v15, 1, v15
  s_waitcnt vmcnt(2)
  v_mfma_f32_16x16x32_bf16 v[124:127], v[16:19], v[112:115], v[124:127]
  v_bitop3_b32 v13, v112, v114, 1 bitop3:0xa8
  v_cmp_ne_u32 vcc, v13, v15
  s_cbranch_vccz L_pb_s0_0
  buffer_load_dwordx4 v[108:111], v1, s[36:39], s64 offen offset:0 sc1
  buffer_load_dwordx4 v[112:115], v1, s[36:39], s64 offen offset:1024 sc1
  s_waitcnt vmcnt(3)
  v_mfma_f32_16x16x32_bf16 v[124:127], v[16:19], v[36:39], 0
  v_bitop3_b32 v15, v36, v38, 1 bitop3:0xa8
  v_lshlrev_b32 v15, 1, v15
  s_waitcnt vmcnt(2)
  v_mfma_f32_16x16x32_bf16 v[124:127], v[16:19], v[40:43], v[124:127]
  v_bitop3_b32 v13, v40, v42, 1 bitop3:0xa8
  v_cmp_ne_u32 vcc, v13, v15
  s_cbranch_vccz L_pb_s0_0
  s_sub_u32 s3, s3, 1
  s_cbranch_scc1 L_end
  s_branch L_pb_s0_0s
L_flr_s0_0:
L_spin_73:
  buffer_load_dword v12, off, s[36:39], s70 sc1
  s_waitcnt vmcnt(0)
  v_cmp_ne_u32 vcc, 1, v12
  s_cbranch_vccz L_ok_74
  s_sub_u32 s3, s3, 1
  s_cbranch_scc1 L_end
  s_sleep 2
  s_branch L_spin_73
L_ok_74:
  s_branch L_fl_s0_0
L_er0_s0_1:
  buffer_load_dwordx4 v[36:39], v9, s[36:39], s87 offen offset:0 sc1
  buffer_load_dwordx4 v[40:43], v9, s[36:39], s87 offen offset:2048 sc1
  s_nop 15
  s_nop 7
L_er0_s0_1s:
  buffer_load_dwordx4 v[36:39], v9, s[36:39], s87 offen offset:0 sc1
  buffer_load_dwordx4 v[40:43], v9, s[36:39], s87 offen offset:2048 sc1
  s_waitcnt vmcnt(2)
  v_max_u32 v15, v39, v43
  v_cmp_eq_u32 vcc, -1, v15
  s_cbranch_vccz L_eb0_s0_1o
  s_sub_u32 s3, s3, 1
  s_cbranch_scc1 L_end
  s_branch L_er0_s0_1s
L_eb0_s0_1o:
  ds_write_b64 v2, v[36:37] offset:32768
  s_branch L_eb0_s0_1
L_smr_s0_1:
  v_max_f32 v86, v116, v120
  v_max3_f32 v86, v86, v117, v121
  v_max3_f32 v86, v86, v118, v122
  v_max3_f32 v86, v86, v119, v123
  v_max3_f32 v86, v86, v124, v126
  v_mov_b32 v87, v86
  s_nop 1
  v_permlane32_swap_b32 v86, v87
  v_max_f32 v86, v86, v87
  v_mov_b32 v87, v86
  s_nop 1
  v_permlane16_swap_b32 v86, v87
  v_max_f32 v86, v86, v87
  v_sub_f32 v116, v116, v86
  v_sub_f32 v120, v120, v86
  v_sub_f32 v117, v117, v86
  v_sub_f32 v121, v121, v86
  v_sub_f32 v118, v118, v86
  v_sub_f32 v122, v122, v86
  v_sub_f32 v119, v119, v86
  v_sub_f32 v123, v123, v86
  v_sub_f32 v124, v124, v86
  v_sub_f32 v126, v126, v86
  v_exp_f32 v116, v116
  v_exp_f32 v120, v120
  v_exp_f32 v117, v117
  v_exp_f32 v121, v121
  v_exp_f32 v118, v118
  v_exp_f32 v122, v122
  v_exp_f32 v119, v119
  v_exp_f32 v123, v123
  v_exp_f32 v124, v124
  v_exp_f32 v126, v126
  v_cvt_pk_bf16_f32 v100, v116, v120
  v_cvt_pk_bf16_f32 v101, v117, v121
  v_cvt_pk_bf16_f32 v102, v118, v122
  v_cvt_pk_bf16_f32 v103, v119, v123
  v_cvt_pk_bf16_f32 v90, v124, v124
  v_cvt_pk_bf16_f32 v91, v126, v126
  s_waitcnt lgkmcnt(0)
  v_mov_b64 v[76:77], 0
  v_mov_b64 v[78:79], 0
  v_mfma_f32_16x16x32_bf16 v[104:107], v[16:19], v[100:103], 0
  v_mfma_f32_16x16x32_bf16 v[108:111], v[92:95], v[100:103], 0
  v_mfma_f32_16x16x32_bf16 v[112:115], v[96:99], v[100:103], 0
  v_mfma_f32_16x16x16_bf16 v[36:39], v[16:17], v[90:91], 0
  v_mfma_f32_16x16x16_bf16 v[108:111], v[84:85], v[90:91], v[108:111]
  v_mfma_f32_16x16x16_bf16 v[112:115], v[88:89], v[90:91], v[112:115]
  v_fma_f32 v106, v38, 0.5, v106
  v_rcp_f32 v107, v106
  s_nop 0
  v_mul_f32 v108, v108, v107
  v_mul_f32 v109, v109, v107
  v_mul_f32 v110, v110, v107
  v_mul_f32 v111, v111, v107
  v_cvt_pk_bf16_f32 v100, v108, v109
  v_cvt_pk_bf16_f32 v101, v110, v111
  v_mul_f32 v112, v112, v107
  v_mul_f32 v113, v113, v107
  v_mul_f32 v114, v114, v107
  v_mul_f32 v115, v115, v107
  v_cvt_pk_bf16_f32 v102, v112, v113
  v_cvt_pk_bf16_f32 v103, v114, v115
  v_cndmask_b32 v36, v100, v102, s[84:85]
  v_cndmask_b32 v37, v101, v103, s[84:85]
  ds_write_b64 v10, v[36:37]
  s_branch L_sm_s0_1
L_pb_s0_1r:
  buffer_load_dwordx4 v[108:111], v1, s[36:39], s64 offen offset:0 sc1
  buffer_load_dwordx4 v[112:115], v1, s[36:39], s64 offen offset:1024 sc1
  s_nop 15
  s_nop 7
L_pb_s0_1s:
  buffer_load_dwordx4 v[36:39], v1, s[36:39], s64 offen offset:0 sc1
  buffer_load_dwordx4 v[40:43], v1, s[36:39], s64 offen offset:1024 sc1
  s_waitcnt vmcnt(3)
  v_mfma_f32_16x16x32_bf16 v[124:127], v[16:19], v[108:111], 0
  v_bitop3_b32 v15, v108, v110, 1 bitop3:0x80
  v_sub_u32 v15, 2, v15
  s_waitcnt vmcnt(2)
  v_mfma_f32_16x16x32_bf16 v[124:127], v[16:19], v[112:115], v[124:127]
  v_bitop3_b32 v13, v112, v114, 1 bitop3:0x80
  v_cmp_ne_u32 vcc, v13, v15
  s_cbranch_vccz L_pb_s0_1
  buffer_load_dwordx4 v[108:111], v1, s[36:39], s64 offen offset:0 sc1
  buffer_load_dwordx4 v[112:115], v1, s[36:39], s64 offen offset:1024 sc1
  s_waitcnt vmcnt(3)
  v_mfma_f32_16x16x32_bf16 v[124:127], v[16:19], v[36:39], 0
  v_bitop3_b32 v15, v36, v38, 1 bitop3:0x80
  v_sub_u32 v15, 2, v15
  s_waitcnt vmcnt(2)
  v_mfma_f32_16x16x32_bf16 v[124:127], v[16:19], v[40:43], v[124:127]
  v_bitop3_b32 v13, v40, v42, 1 bitop3:0x80
  v_cmp_ne_u32 vcc, v13, v15
  s_cbranch_vccz L_pb_s0_1
  s_sub_u32 s3, s3, 1
  s_cbranch_scc1 L_end
  s_branch L_pb_s0_1s
L_flr_s0_1:
L_spin_75:
  buffer_load_dword v12, off, s[36:39], s70 sc1
  s_waitcnt vmcnt(0)
  v_cmp_ne_u32 vcc, 1, v12
  s_cbranch_vccz L_ok_76
  s_sub_u32 s3, s3, 1
  s_cbranch_scc1 L_end
  s_sleep 2
  s_branch L_spin_75
L_ok_76:
  s_branch L_fl_s0_1
.p2align 5
  s_nop 0
  s_nop 0
  s_nop 0
  s_nop 0
L_step_s1_0:
  s_waitcnt lgkmcnt(0)
  s_waitcnt vmcnt(2)
  v_max_u32 v15, v39, v43
  v_cmp_eq_u32 vcc, -1, v15
  ds_write_b64 v2, v[36:37] offset:32768
  s_cbranch_vccnz L_er0_s1_0
L_eb0_s1_0:
  v_smfmac_f32_16x16x64_bf16 v[88:91], v[36:39], v[44:51], v11
  ds_write_b64 v2, v[38:39] offset:32776
  v_smfmac_f32_16x16x64_bf16 v[88:91], v[40:43], v[52:59], v11
  ds_write_b64 v2, v[40:41] offset:33792
  v_smfmac_f32_16x16x64_bf16 v[84:87], v[36:39], v[60:67], v11
  ds_write_b64 v2, v[42:43] offset:33800
  v_smfmac_f32_16x16x64_bf16 v[84:87], v[40:43], v[92:99], v11
  s_add_u32 s69, s69, 16384
  s_add_u32 s78, s69, 8192
  v_smfmac_f32_16x16x64_bf16 v[80:83], v[36:39], v[100:107], v11
  s_add_u32 s70, s70, 2048
  s_min_u32 s70, s70, s77
  v_smfmac_f32_16x16x64_bf16 v[80:83], v[40:43], v[116:123], v11
  v_smfmac_f32_16x16x64_bf16 v[76:79], v[36:39], v[20:27], v11
  s_waitcnt lgkmcnt(0)
  s_barrier
  ds_read_b128 v[44:47], v4 offset:0
  v_smfmac_f32_16x16x64_bf16 v[76:79], v[40:43], v[28:35], v11
  ds_read_b128 v[48:51], v4 offset:1024
  v_smfmac_f32_16x16x64_bf16 v[72:75], v[36:39], a[8:15], v11
  ds_read_b128 v[52:55], v4 offset:6144
  v_smfmac_f32_16x16x64_bf16 v[72:75], v[40:43], a[24:31], v11
  ds_read_b128 v[56:59], v4 offset:7168
  v_smfmac_f32_16x16x64_bf16 v[68:71], v[36:39], a[0:7], v11
  ds_read_b128 v[60:63], v4 offset:4096
  v_smfmac_f32_16x16x64_bf16 v[68:71], v[40:43], a[16:23], v11
  ds_read_b128 v[64:67], v4 offset:5120
  s_waitcnt lgkmcnt(5)
  v_smfmac_f32_16x16x64_bf16 v[68:71], v[44:47], a[32:39], v11
  ds_read_b128 v[92:95], v2 offset:8192
  s_waitcnt lgkmcnt(5)
  v_smfmac_f32_16x16x64_bf16 v[68:71], v[48:51], a[48:55], v11
  s_waitcnt lgkmcnt(4)
  buffer_store_dword v14, v6, s[36:39], s72 offen sc1
  v_smfmac_f32_16x16x64_bf16 v[68:71], v[52:55], a[64:71], v11
  ds_read_b128 v[96:99], v2 offset:9216
  s_waitcnt lgkmcnt(4)
  v_smfmac_f32_16x16x64_bf16 v[68:71], v[56:59], a[80:87], v11
  ds_read_b128 v[100:103], v2 offset:16384
  s_waitcnt lgkmcnt(4)
  v_smfmac_f32_16x16x64_bf16 v[68:71], v[60:63], a[96:103], v11
  ds_read_b128 v[104:107], v2 offset:17408
  s_waitcnt lgkmcnt(4)
  v_smfmac_f32_16x16x64_bf16 v[68:71], v[64:67], a[112:119], v11
  buffer_load_dwordx4 v[20:23], v1, s[36:39], s69 offen offset:0 sc1
  v_smfmac_f32_16x16x64_bf16 v[72:75], v[44:47], a[40:47], v11
  ds_read_b128 v[116:119], v2 offset:24576
  v_smfmac_f32_16x16x64_bf16 v[72:75], v[48:51], a[56:63], v11
  ds_read_b128 v[120:123], v2 offset:25600
  v_add_f32 v124, v68, v69
  v_smfmac_f32_16x16x64_bf16 v[72:75], v[52:55], a[72:79], v11
  v_add_f32 v126, v70, v71
  v_smfmac_f32_16x16x64_bf16 v[72:75], v[56:59], a[88:95], v11
  buffer_load_dwordx4 v[24:27], v1, s[36:39], s69 offen offset:1024 sc1
  v_mul_f32 v124, s73, v124
  v_smfmac_f32_16x16x64_bf16 v[72:75], v[60:63], a[104:111], v11
  v_mul_f32 v126, s73, v126
  v_smfmac_f32_16x16x64_bf16 v[72:75], v[64:67], a[120:127], v11
  s_waitcnt lgkmcnt(0) vmcnt(3)
  v_smfmac_f32_16x16x64_bf16 v[76:79], v[44:47], v[108:115], v11
  ds_read_b128 v[108:111], v4 offset:9216
  v_smfmac_f32_16x16x64_bf16 v[76:79], v[48:51], v[92:99], v11
  buffer_load_dwordx4 v[28:31], v1, s[36:39], s78 offen offset:0 sc1
  v_add_f32 v125, v72, v73
  v_smfmac_f32_16x16x64_bf16 v[76:79], v[52:55], v[100:107], v11
  ds_read_b128 v[92:95], v4 offset:8192
  v_add_f32 v127, v74, v75
  v_smfmac_f32_16x16x64_bf16 v[76:79], v[56:59], v[116:123], v11
  ds_read_b128 v[96:99], v4 offset:10240
  v_mul_f32 v125, s73, v125
  v_smfmac_f32_16x16x64_bf16 v[76:79], v[60:63], a[160:167], v11
  ds_read_b128 v[100:103], v4 offset:12288
  v_mul_f32 v127, s73, v127
  v_smfmac_f32_16x16x64_bf16 v[76:79], v[64:67], a[176:183], v11
  ds_read_b128 v[104:107], v4 offset:14336
  v_cvt_pk_bf16_f32 v124, v124, v125
  v_smfmac_f32_16x16x64_bf16 v[80:83], v[44:47], a[128:135], v11
  ds_read_b128 v[112:115], v4 offset:11264
  v_cvt_pk_bf16_f32 v125, v126, v127
  v_smfmac_f32_16x16x64_bf16 v[80:83], v[48:51], a[136:143], v11
  ds_write2_b32 v7, v124, v125 offset0:0 offset1:4
  v_smfmac_f32_16x16x64_bf16 v[80:83], v[52:55], a[144:151], v11
  ds_read_b128 v[36:39], v4 offset:13312
  v_add_f32 v120, v76, v77
  v_smfmac_f32_16x16x64_bf16 v[80:83], v[56:59], a[152:159], v11
  ds_read_b128 v[40:43], v4 offset:15360
  v_add_f32 v122, v78, v79
  v_smfmac_f32_16x16x64_bf16 v[80:83], v[60:63], a[168:175], v11
  buffer_load_dword v12, off, s[36:39], s70 sc1
  v_smfmac_f32_16x16x64_bf16 v[80:83], v[64:67], a[184:191], v11
  s_waitcnt lgkmcnt(2)
  s_barrier
  v_smfmac_f32_16x16x64_bf16 v[84:87], v[44:47], a[192:199], v11
  ds_read_b128 v[68:71], v8 offset:0
  v_smfmac_f32_16x16x64_bf16 v[84:87], v[48:51], a[208:215], v11
  ds_read_b128 v[72:75], v8 offset:1024
  v_add_f32 v121, v80, v81
  v_smfmac_f32_16x16x64_bf16 v[84:87], v[52:55], a[224:231], v11
  ds_read_b128 v[76:79], v8 offset:2048
  v_add_f32 v123, v82, v83
  v_smfmac_f32_16x16x64_bf16 v[84:87], v[56:59], a[240:247], v11
  ds_read_b128 v[80:83], v8 offset:3072
  v_cvt_pk_bf16_f32 v120, v120, v121
  v_smfmac_f32_16x16x64_bf16 v[84:87], v[60:63], v[224:231], v11
  v_cvt_pk_bf16_f32 v121, v122, v123
  v_smfmac_f32_16x16x64_bf16 v[84:87], v[64:67], v[240:247], v11
  ds_write2_b32 v7, v120, v121 offset0:128 offset1:132
  v_smfmac_f32_16x16x64_bf16 v[88:91], v[44:47], a[200:207], v11
  buffer_load_dwordx4 v[32:35], v1, s[36:39], s78 offen offset:1024 sc1
  v_smfmac_f32_16x16x64_bf16 v[88:91], v[48:51], a[216:223], v11
  v_cvt_pk_bf16_f32 v84, v84, v85
  v_smfmac_f32_16x16x64_bf16 v[88:91], v[52:55], a[232:239], v11
  v_cvt_pk_bf16_f32 v85, v86, v87
  v_smfmac_f32_16x16x64_bf16 v[88:91], v[56:59], a[248:255], v11
  v_smfmac_f32_16x16x64_bf16 v[88:91], v[60:63], v[232:239], v11
  s_waitcnt lgkmcnt(0)
  s_barrier
  v_smfmac_f32_16x16x64_bf16 v[88:91], v[64:67], v[248:255], v11
  ds_read_b128 v[44:47], v8 offset:512
  v_mfma_f32_16x16x32_bf16 v[116:119], v[92:95], v[68:71], 0
  ds_read_b128 v[92:95], v2 offset:49152
  v_mfma_f32_16x16x32_bf16 v[116:119], v[96:99], v[72:75], v[116:119]
  ds_read_b128 v[48:51], v8 offset:1536
  v_cvt_pk_bf16_f32 v88, v88, v89
  v_mfma_f32_16x16x32_bf16 v[116:119], v[100:103], v[76:79], v[116:119]
  ds_read_b128 v[52:55], v8 offset:2560
  v_cvt_pk_bf16_f32 v89, v90, v91
  v_mfma_f32_16x16x32_bf16 v[116:119], v[104:107], v[80:83], v[116:119]
  ds_read_b128 v[56:59], v8 offset:3584
  v_mfma_f32_16x16x32_bf16 v[120:123], v[108:111], v[68:71], 0
  ds_read_b128 v[96:99], v2 offset:50176
  v_mfma_f32_16x16x32_bf16 v[120:123], v[112:115], v[72:75], v[120:123]
  v_exp_f32 v60, v116
  v_mfma_f32_16x16x32_bf16 v[120:123], v[36:39], v[76:79], v[120:123]
  v_exp_f32 v61, v117
  v_mfma_f32_16x16x32_bf16 v[120:123], v[40:43], v[80:83], v[120:123]
  s_waitcnt lgkmcnt(5)
  v_exp_f32 v62, v118
  v_mfma_f32_16x16x32_bf16 v[124:127], v[44:47], v[68:71], 0
  s_waitcnt lgkmcnt(3)
  v_exp_f32 v63, v119
  v_mfma_f32_16x16x32_bf16 v[124:127], v[48:51], v[72:75], v[124:127]
  s_waitcnt lgkmcnt(2)
  v_exp_f32 v64, v120
  v_mfma_f32_16x16x32_bf16 v[124:127], v[52:55], v[76:79], v[124:127]
  s_waitcnt lgkmcnt(1)
  v_exp_f32 v65, v121
  v_mfma_f32_16x16x32_bf16 v[124:127], v[56:59], v[80:83], v[124:127]
  s_waitcnt lgkmcnt(0)
  v_exp_f32 v66, v122
  v_exp_f32 v67, v123
  v_cvt_pk_bf16_f32 v100, v60, v64
  v_cvt_pk_bf16_f32 v101, v61, v65
  v_cvt_pk_bf16_f32 v102, v62, v66
  v_cvt_pk_bf16_f32 v103, v63, v67
  v_exp_f32 v86, v124
  v_mov_b64 v[76:77], 0
  v_mfma_f32_16x16x32_bf16 v[104:107], v[16:19], v[100:103], 0
  v_exp_f32 v87, v126
  v_mfma_f32_16x16x32_bf16 v[108:111], v[92:95], v[100:103], 0
  v_cvt_pk_bf16_f32 v90, v86, v86
  v_cvt_pk_bf16_f32 v91, v87, v87
  v_mfma_f32_16x16x32_bf16 v[112:115], v[96:99], v[100:103], 0
  v_mov_b64 v[78:79], 0
  v_mov_b64 v[80:81], 0
  v_mfma_f32_16x16x16_bf16 v[36:39], v[16:17], v[90:91], 0
  v_mov_b64 v[82:83], 0
  v_mfma_f32_16x16x16_bf16 v[108:111], v[84:85], v[90:91], v[108:111]
  v_mfma_f32_16x16x16_bf16 v[112:115], v[88:89], v[90:91], v[112:115]
  v_fma_f32 v106, v38, 0.5, v106
  v_rcp_f32 v107, v106
  v_mov_b32 v13, 0
  v_mul_f32 v108, v108, v107
  v_mul_f32 v109, v109, v107
  v_mul_f32 v110, v110, v107
  v_mul_f32 v111, v111, v107
  v_cvt_pk_bf16_f32 v100, v108, v109
  v_cvt_pk_bf16_f32 v101, v110, v111
  v_mul_f32 v112, v112, v107
  v_mul_f32 v113, v113, v107
  v_mul_f32 v114, v114, v107
  v_mul_f32 v115, v115, v107
  v_cvt_pk_bf16_f32 v102, v112, v113
  v_cvt_pk_bf16_f32 v103, v114, v115
  v_cndmask_b32 v36, v100, v102, s[84:85]
  v_cndmask_b32 v37, v101, v103, s[84:85]
  ds_write_b64 v10, v[36:37]
  v_max_f32 v104, v106, v107
  v_cmp_nge_f32 vcc, s86, v104
  v_mov_b64 v[44:45], 0
  v_mov_b64 v[46:47], 0
  v_mov_b64 v[48:49], 0
  v_mov_b64 v[50:51], 0
  s_cbranch_vccnz L_smr_s1_0
L_sm_s1_0:
  v_smfmac_f32_16x16x64_bf16 v[76:79], v[100:103], v[128:135], v11
  s_waitcnt lgkmcnt(0)
  s_barrier
  ds_read_b128 v[60:63], v8 offset:4096
  v_smfmac_f32_16x16x64_bf16 v[80:83], v[100:103], v[160:167], v11
  ds_read_b128 v[64:67], v8 offset:7168
  v_mov_b64 v[84:85], 0
  v_smfmac_f32_16x16x64_bf16 v[44:47], v[100:103], v[192:199], v11
  ds_read_b128 v[40:43], v8 offset:6144
  v_mov_b64 v[86:87], 0
  v_smfmac_f32_16x16x64_bf16 v[48:51], v[100:103], v[216:223], v11
  ds_read_b128 v[92:95], v3 offset:0
  s_waitcnt lgkmcnt(3)
  v_smfmac_f32_16x16x64_bf16 v[76:79], v[60:63], v[136:143], v11
  ds_read_b128 v[96:99], v3 offset:1024
  s_waitcnt lgkmcnt(3)
  v_smfmac_f32_16x16x64_bf16 v[76:79], v[64:67], v[144:151], v11
  ds_read_b128 v[52:55], v3 offset:8192
  s_waitcnt lgkmcnt(3)
  v_smfmac_f32_16x16x64_bf16 v[76:79], v[40:43], v[152:159], v11
  ds_read_b128 v[56:59], v3 offset:9216
  v_mov_b64 v[88:89], 0
  v_smfmac_f32_16x16x64_bf16 v[80:83], v[60:63], v[168:175], v11
  ds_read_b128 v[68:71], v3 offset:16384
  v_mov_b64 v[90:91], 0
  v_smfmac_f32_16x16x64_bf16 v[80:83], v[64:67], v[176:183], v11
  ds_read_b128 v[72:75], v3 offset:17408
  v_cvt_pk_bf16_f32 v76, v76, v77
  v_cvt_pk_bf16_f32 v77, v78, v79
  v_and_b32 v76, -2, v76
  v_smfmac_f32_16x16x64_bf16 v[80:83], v[40:43], v[184:191], v11
  s_waitcnt lgkmcnt(2)
  buffer_store_dwordx2 v[76:77], v5, s[36:39], 0 offen sc1
  v_smfmac_f32_16x16x64_bf16 v[44:47], v[60:63], v[200:207], v11
  ds_read_b128 v[116:119], v3 offset:24576
  v_mov_b64 v[76:77], 0
  v_mov_b64 v[78:79], 0
  v_smfmac_f32_16x16x64_bf16 v[44:47], v[64:67], v[208:215], v11
  ds_read_b128 v[120:123], v3 offset:25600
  v_cvt_pk_bf16_f32 v80, v80, v81
  v_cvt_pk_bf16_f32 v81, v82, v83
  v_and_b32 v80, -2, v80
  v_smfmac_f32_16x16x64_bf16 v[44:47], v[40:43], v[92:99], v11
  buffer_store_dwordx2 v[80:81], v5, s[36:39], s74 offen sc1
  v_smfmac_f32_16x16x64_bf16 v[48:51], v[60:63], v[52:59], v11
  s_waitcnt lgkmcnt(2)
  v_mov_b64 v[80:81], 0
  v_mov_b64 v[82:83], 0
  v_smfmac_f32_16x16x64_bf16 v[48:51], v[64:67], v[68:75], v11
  s_waitcnt lgkmcnt(0)
  v_cvt_pk_bf16_f32 v44, v44, v45
  v_cvt_pk_bf16_f32 v45, v46, v47
  v_and_b32 v44, -2, v44
  v_smfmac_f32_16x16x64_bf16 v[48:51], v[40:43], v[116:123], v11
  buffer_store_dwordx2 v[44:45], v5, s[36:39], s76 offen sc1
  v_mov_b64 v[68:69], 0
  v_mov_b64 v[70:71], 0
  v_mov_b32 v13, 0
  v_mov_b32 v13, 0
  v_cvt_pk_bf16_f32 v48, v48, v49
  v_cvt_pk_bf16_f32 v49, v50, v51
  v_and_b32 v48, -2, v48
  buffer_store_dwordx2 v[48:49], v5, s[36:39], s65 offen sc1
  v_mov_b64 v[72:73], 0
  v_mov_b64 v[74:75], 0
L_gap_gp10_6_77:
  s_nop 7
  s_nop 7
  s_nop 6
  s_nop 6
  s_nop 6
  s_nop 6
  buffer_load_dwordx4 v[108:111], v1, s[36:39], s64 offen offset:0 sc1
  buffer_load_dwordx4 v[112:115], v1, s[36:39], s64 offen offset:1024 sc1
  s_waitcnt vmcnt(10)
  ds_write_b128 v2, v[20:23] offset:40960
  s_waitcnt vmcnt(9)
  ds_write_b128 v2, v[24:27] offset:41984
  s_waitcnt vmcnt(8)
  ds_write_b128 v2, v[28:31] offset:49152
  s_waitcnt vmcnt(6)
  ds_write_b128 v2, v[32:35] offset:50176
  ds_read_b128 v[44:47], v1 offset:0
  ds_read_b128 v[48:51], v1 offset:1024
  ds_read_b128 v[52:55], v1 offset:8192
  ds_read_b128 v[56:59], v1 offset:9216
.p2align 5
  s_nop 0
  s_nop 0
  s_nop 0
  s_nop 0
  s_waitcnt vmcnt(1)
  v_mfma_f32_16x16x32_bf16 v[124:127], v[16:19], v[108:111], 0
  v_bitop3_b32 v15, v108, v110, 1 bitop3:0xa8
  v_lshlrev_b32 v15, 1, v15
  s_waitcnt vmcnt(0)
  v_mfma_f32_16x16x32_bf16 v[124:127], v[16:19], v[112:115], v[124:127]
  v_bitop3_b32 v13, v112, v114, 1 bitop3:0xa8
  v_cmp_ne_u32 vcc, v13, v15
  s_cbranch_vccnz L_pb_s1_0r
L_pb_s1_0:
  v_add_f32_dpp v124, v124, v124 row_ror:4 row_mask:0xf bank_mask:0xf
  v_add_f32_dpp v125, v125, v125 row_ror:4 row_mask:0xf bank_mask:0xf
  s_nop 0
  v_add_f32_dpp v124, v124, v124 row_ror:8 row_mask:0xf bank_mask:0xf
  v_add_f32_dpp v125, v125, v125 row_ror:8 row_mask:0xf bank_mask:0xf
  v_cvt_pk_bf16_f32 v14, v124, v125
  v_min_u32 v14, -2, v14
  buffer_store_dword v14, v6, s[36:39], s87 offen sc1
  s_mov_b32 s72, s79
  s_add_u32 s79, s79, 8192
  s_cmp_eq_u32 s68, 62
  s_cbranch_scc1 L_chain_done
  s_add_u32 s68, s68, 2
  v_cmp_ne_u32 vcc, 1, v12
  v_mov_b32 v124, -1
  buffer_store_dword v124, v6, s[36:39], s71 offen sc1
  s_cbranch_vccnz L_flr_s1_0
L_fl_s1_0:
  s_xor_b32 s71, s71, 0x4000
  s_mov_b32 s75, s71
  s_add_u32 s92, s75, 0x1000
  ds_read_b128 v[60:63], v1 offset:16384
  ds_read_b128 v[64:67], v1 offset:17408
  ds_read_b128 v[92:95], v1 offset:24576
  ds_read_b128 v[96:99], v1 offset:25600
  ds_read_b128 v[100:103], v1 offset:32768
  ds_read_b128 v[104:107], v1 offset:33792
L_gap_gp11_3_78:
  s_nop 3
  s_nop 3
  s_nop 3
  buffer_load_dwordx4 v[36:39], v9, s[36:39], s87 offen offset:128 sc1
  buffer_load_dwordx4 v[40:43], v9, s[36:39], s87 offen offset:2176 sc1
  ds_read_b128 v[116:119], v1 offset:40960
  ds_read_b128 v[120:123], v1 offset:41984
  ds_read_b128 v[20:23], v1 offset:49152
  ds_read_b128 v[24:27], v1 offset:50176
  ds_read_b128 v[28:31], v1 offset:57344
  ds_read_b128 v[32:35], v1 offset:58368
  s_waitcnt vmcnt(4)
  ds_read_b128 v[108:111], v2 offset:0
  ds_read_b128 v[112:115], v2 offset:1024
L_gap_gp12_3_79:
  s_nop 9
  s_nop 8
  s_nop 8
  buffer_load_dwordx4 v[36:39], v9, s[36:39], s87 offen offset:128 sc1
  buffer_load_dwordx4 v[40:43], v9, s[36:39], s87 offen offset:2176 sc1
.p2align 5
  s_nop 0
  s_nop 0
  s_nop 0
  s_nop 0
L_step_s1_1:
  s_waitcnt lgkmcnt(0)
  s_waitcnt vmcnt(2)
  v_max_u32 v15, v39, v43
  v_cmp_eq_u32 vcc, -1, v15
  ds_write_b64 v2, v[36:37] offset:32768
  s_cbranch_vccnz L_er0_s1_1
L_eb0_s1_1:
  v_smfmac_f32_16x16x64_bf16 v[88:91], v[36:39], v[44:51], v11
  ds_write_b64 v2, v[38:39] offset:32776
  v_smfmac_f32_16x16x64_bf16 v[88:91], v[40:43], v[52:59], v11
  ds_write_b64 v2, v[40:41] offset:33792
  v_smfmac_f32_16x16x64_bf16 v[84:87], v[36:39], v[60:67], v11
  ds_write_b64 v2, v[42:43] offset:33800
  v_smfmac_f32_16x16x64_bf16 v[84:87], v[40:43], v[92:99], v11
  s_add_u32 s69, s69, 16384
  s_add_u32 s78, s69, 8192
  v_smfmac_f32_16x16x64_bf16 v[80:83], v[36:39], v[100:107], v11
  s_add_u32 s70, s70, 2048
  s_min_u32 s70, s70, s77
  v_smfmac_f32_16x16x64_bf16 v[80:83], v[40:43], v[116:123], v11
  v_smfmac_f32_16x16x64_bf16 v[76:79], v[36:39], v[20:27], v11
  s_waitcnt lgkmcnt(0)
  s_barrier
  ds_read_b128 v[44:47], v4 offset:0
  v_smfmac_f32_16x16x64_bf16 v[76:79], v[40:43], v[28:35], v11
  ds_read_b128 v[48:51], v4 offset:1024
  v_smfmac_f32_16x16x64_bf16 v[72:75], v[36:39], a[8:15], v11
  ds_read_b128 v[52:55], v4 offset:6144
  v_smfmac_f32_16x16x64_bf16 v[72:75], v[40:43], a[24:31], v11
  ds_read_b128 v[56:59], v4 offset:7168
  v_smfmac_f32_16x16x64_bf16 v[68:71], v[36:39], a[0:7], v11
  ds_read_b128 v[60:63], v4 offset:4096
  v_smfmac_f32_16x16x64_bf16 v[68:71], v[40:43], a[16:23], v11
  ds_read_b128 v[64:67], v4 offset:5120
  s_waitcnt lgkmcnt(5)
  v_smfmac_f32_16x16x64_bf16 v[68:71], v[44:47], a[32:39], v11
  ds_read_b128 v[92:95], v2 offset:8192
  s_waitcnt lgkmcnt(5)
  v_smfmac_f32_16x16x64_bf16 v[68:71], v[48:51], a[48:55], v11
  s_waitcnt lgkmcnt(4)
  buffer_store_dword v14, v6, s[36:39], s72 offen sc1
  v_smfmac_f32_16x16x64_bf16 v[68:71], v[52:55], a[64:71], v11
  ds_read_b128 v[96:99], v2 offset:9216
  s_waitcnt lgkmcnt(4)
  v_smfmac_f32_16x16x64_bf16 v[68:71], v[56:59], a[80:87], v11
  ds_read_b128 v[100:103], v2 offset:16384
  s_waitcnt lgkmcnt(4)
  v_smfmac_f32_16x16x64_bf16 v[68:71], v[60:63], a[96:103], v11
  ds_read_b128 v[104:107], v2 offset:17408
  s_waitcnt lgkmcnt(4)
  v_smfmac_f32_16x16x64_bf16 v[68:71], v[64:67], a[112:119], v11
  buffer_load_dwordx4 v[20:23], v1, s[36:39], s69 offen offset:0 sc1
  v_smfmac_f32_16x16x64_bf16 v[72:75], v[44:47], a[40:47], v11
  ds_read_b128 v[116:119], v2 offset:24576
  v_smfmac_f32_16x16x64_bf16 v[72:75], v[48:51], a[56:63], v11
  ds_read_b128 v[120:123], v2 offset:25600
  v_add_f32 v124, v68, v69
  v_smfmac_f32_16x16x64_bf16 v[72:75], v[52:55], a[72:79], v11
  v_add_f32 v126, v70, v71
  v_smfmac_f32_16x16x64_bf16 v[72:75], v[56:59], a[88:95], v11
  buffer_load_dwordx4 v[24:27], v1, s[36:39], s69 offen offset:1024 sc1
  v_mul_f32 v124, s73, v124
  v_smfmac_f32_16x16x64_bf16 v[72:75], v[60:63], a[104:111], v11
  v_mul_f32 v126, s73, v126
  v_smfmac_f32_16x16x64_bf16 v[72:75], v[64:67], a[120:127], v11
  s_waitcnt lgkmcnt(0) vmcnt(3)
  v_smfmac_f32_16x16x64_bf16 v[76:79], v[44:47], v[108:115], v11
  ds_read_b128 v[108:111], v4 offset:9216
  v_smfmac_f32_16x16x64_bf16 v[76:79], v[48:51], v[92:99], v11
  buffer_load_dwordx4 v[28:31], v1, s[36:39], s78 offen offset:0 sc1
  v_add_f32 v125, v72, v73
  v_smfmac_f32_16x16x64_bf16 v[76:79], v[52:55], v[100:107], v11
  ds_read_b128 v[92:95], v4 offset:8192
  v_add_f32 v127, v74, v75
  v_smfmac_f32_16x16x64_bf16 v[76:79], v[56:59], v[116:123], v11
  ds_read_b128 v[96:99], v4 offset:10240
  v_mul_f32 v125, s73, v125
  v_smfmac_f32_16x16x64_bf16 v[76:79], v[60:63], a[160:167], v11
  ds_read_b128 v[100:103], v4 offset:12288
  v_mul_f32 v127, s73, v127
  v_smfmac_f32_16x16x64_bf16 v[76:79], v[64:67], a[176:183], v11
  ds_read_b128 v[104:107], v4 offset:14336
  v_cvt_pk_bf16_f32 v124, v124, v125
  v_smfmac_f32_16x16x64_bf16 v[80:83], v[44:47], a[128:135], v11
  ds_read_b128 v[112:115], v4 offset:11264
  v_cvt_pk_bf16_f32 v125, v126, v127
  v_smfmac_f32_16x16x64_bf16 v[80:83], v[48:51], a[136:143], v11
  ds_write2_b32 v7, v124, v125 offset0:0 offset1:4
  v_smfmac_f32_16x16x64_bf16 v[80:83], v[52:55], a[144:151], v11
  ds_read_b128 v[36:39], v4 offset:13312
  v_add_f32 v120, v76, v77
  v_smfmac_f32_16x16x64_bf16 v[80:83], v[56:59], a[152:159], v11
  ds_read_b128 v[40:43], v4 offset:15360
  v_add_f32 v122, v78, v79
  v_smfmac_f32_16x16x64_bf16 v[80:83], v[60:63], a[168:175], v11
  buffer_load_dword v12, off, s[36:39], s70 sc1
  v_smfmac_f32_16x16x64_bf16 v[80:83], v[64:67], a[184:191], v11
  s_waitcnt lgkmcnt(2)
  s_barrier
  v_smfmac_f32_16x16x64_bf16 v[84:87], v[44:47], a[192:199], v11
  ds_read_b128 v[68:71], v8 offset:0
  v_smfmac_f32_16x16x64_bf16 v[84:87], v[48:51], a[208:215], v11
  ds_read_b128 v[72:75], v8 offset:1024
  v_add_f32 v121, v80, v81
  v_smfmac_f32_16x16x64_bf16 v[84:87], v[52:55], a[224:231], v11
  ds_read_b128 v[76:79], v8 offset:2048
  v_add_f32 v123, v82, v83
  v_smfmac_f32_16x16x64_bf16 v[84:87], v[56:59], a[240:247], v11
  ds_read_b128 v[80:83], v8 offset:3072
  v_cvt_pk_bf16_f32 v120, v120, v121
  v_smfmac_f32_16x16x64_bf16 v[84:87], v[60:63], v[224:231], v11
  v_cvt_pk_bf16_f32 v121, v122, v123
  v_smfmac_f32_16x16x64_bf16 v[84:87], v[64:67], v[240:247], v11
  ds_write2_b32 v7, v120, v121 offset0:128 offset1:132
  v_smfmac_f32_16x16x64_bf16 v[88:91], v[44:47], a[200:207], v11
  buffer_load_dwordx4 v[32:35], v1, s[36:39], s78 offen offset:1024 sc1
  v_smfmac_f32_16x16x64_bf16 v[88:91], v[48:51], a[216:223], v11
  v_cvt_pk_bf16_f32 v84, v84, v85
  v_smfmac_f32_16x16x64_bf16 v[88:91], v[52:55], a[232:239], v11
  v_cvt_pk_bf16_f32 v85, v86, v87
  v_smfmac_f32_16x16x64_bf16 v[88:91], v[56:59], a[248:255], v11
  v_smfmac_f32_16x16x64_bf16 v[88:91], v[60:63], v[232:239], v11
  s_waitcnt lgkmcnt(0)
  s_barrier
  v_smfmac_f32_16x16x64_bf16 v[88:91], v[64:67], v[248:255], v11
  ds_read_b128 v[44:47], v8 offset:512
  v_mfma_f32_16x16x32_bf16 v[116:119], v[92:95], v[68:71], 0
  ds_read_b128 v[92:95], v2 offset:49152
  v_mfma_f32_16x16x32_bf16 v[116:119], v[96:99], v[72:75], v[116:119]
  ds_read_b128 v[48:51], v8 offset:1536
  v_cvt_pk_bf16_f32 v88, v88, v89
  v_mfma_f32_16x16x32_bf16 v[116:119], v[100:103], v[76:79], v[116:119]
  ds_read_b128 v[52:55], v8 offset:2560
  v_cvt_pk_bf16_f32 v89, v90, v91
  v_mfma_f32_16x16x32_bf16 v[116:119], v[104:107], v[80:83], v[116:119]
  ds_read_b128 v[56:59], v8 offset:3584
  v_mfma_f32_16x16x32_bf16 v[120:123], v[108:111], v[68:71], 0
  ds_read_b128 v[96:99], v2 offset:50176
  v_mfma_f32_16x16x32_bf16 v[120:123], v[112:115], v[72:75], v[120:123]
  v_exp_f32 v60, v116
  v_mfma_f32_16x16x32_bf16 v[120:123], v[36:39], v[76:79], v[120:123]
  v_exp_f32 v61, v117
  v_mfma_f32_16x16x32_bf16 v[120:123], v[40:43], v[80:83], v[120:123]
  s_waitcnt lgkmcnt(5)
  v_exp_f32 v62, v118
  v_mfma_f32_16x16x32_bf16 v[124:127], v[44:47], v[68:71], 0
  s_waitcnt lgkmcnt(3)
  v_exp_f32 v63, v119
  v_mfma_f32_16x16x32_bf16 v[124:127], v[48:51], v[72:75], v[124:127]
  s_waitcnt lgkmcnt(2)
  v_exp_f32 v64, v120
  v_mfma_f32_16x16x32_bf16 v[124:127], v[52:55], v[76:79], v[124:127]
  s_waitcnt lgkmcnt(1)
  v_exp_f32 v65, v121
  v_mfma_f32_16x16x32_bf16 v[124:127], v[56:59], v[80:83], v[124:127]
  s_waitcnt lgkmcnt(0)
  v_exp_f32 v66, v122
  v_exp_f32 v67, v123
  v_cvt_pk_bf16_f32 v100, v60, v64
  v_cvt_pk_bf16_f32 v101, v61, v65
  v_cvt_pk_bf16_f32 v102, v62, v66
  v_cvt_pk_bf16_f32 v103, v63, v67
  v_exp_f32 v86, v124
  v_mov_b64 v[76:77], 0
  v_mfma_f32_16x16x32_bf16 v[104:107], v[16:19], v[100:103], 0
  v_exp_f32 v87, v126
  v_mfma_f32_16x16x32_bf16 v[108:111], v[92:95], v[100:103], 0
  v_cvt_pk_bf16_f32 v90, v86, v86
  v_cvt_pk_bf16_f32 v91, v87, v87
  v_mfma_f32_16x16x32_bf16 v[112:115], v[96:99], v[100:103], 0
  v_mov_b64 v[78:79], 0
  v_mov_b64 v[80:81], 0
  v_mfma_f32_16x16x16_bf16 v[36:39], v[16:17], v[90:91], 0
  v_mov_b64 v[82:83], 0
  v_mfma_f32_16x16x16_bf16 v[108:111], v[84:85], v[90:91], v[108:111]
  v_mfma_f32_16x16x16_bf16 v[112:115], v[88:89], v[90:91], v[112:115]
  v_fma_f32 v106, v38, 0.5, v106
  v_rcp_f32 v107, v106
  v_mov_b32 v13, 0
  v_mul_f32 v108, v108, v107
  v_mul_f32 v109, v109, v107
  v_mul_f32 v110, v110, v107
  v_mul_f32 v111, v111, v107
  v_cvt_pk_bf16_f32 v100, v108, v109
  v_cvt_pk_bf16_f32 v101, v110, v111
  v_mul_f32 v112, v112, v107
  v_mul_f32 v113, v113, v107
  v_mul_f32 v114, v114, v107
  v_mul_f32 v115, v115, v107
  v_cvt_pk_bf16_f32 v102, v112, v113
  v_cvt_pk_bf16_f32 v103, v114, v115
  v_cndmask_b32 v36, v100, v102, s[84:85]
  v_cndmask_b32 v37, v101, v103, s[84:85]
  ds_write_b64 v10, v[36:37]
  v_max_f32 v104, v106, v107
  v_cmp_nge_f32 vcc, s86, v104
  v_mov_b64 v[44:45], 0
  v_mov_b64 v[46:47], 0
  v_mov_b64 v[48:49], 0
  v_mov_b64 v[50:51], 0
  s_cbranch_vccnz L_smr_s1_1
L_sm_s1_1:
  v_smfmac_f32_16x16x64_bf16 v[76:79], v[100:103], v[128:135], v11
  s_waitcnt lgkmcnt(0)
  s_barrier
  ds_read_b128 v[60:63], v8 offset:4096
  v_smfmac_f32_16x16x64_bf16 v[80:83], v[100:103], v[160:167], v11
  ds_read_b128 v[64:67], v8 offset:7168
  v_mov_b64 v[84:85], 0
  v_smfmac_f32_16x16x64_bf16 v[44:47], v[100:103], v[192:199], v11
  ds_read_b128 v[40:43], v8 offset:6144
  v_mov_b64 v[86:87], 0
  v_smfmac_f32_16x16x64_bf16 v[48:51], v[100:103], v[216:223], v11
  ds_read_b128 v[92:95], v3 offset:0
  s_waitcnt lgkmcnt(3)
  v_smfmac_f32_16x16x64_bf16 v[76:79], v[60:63], v[136:143], v11
  ds_read_b128 v[96:99], v3 offset:1024
  s_waitcnt lgkmcnt(3)
  v_smfmac_f32_16x16x64_bf16 v[76:79], v[64:67], v[144:151], v11
  ds_read_b128 v[52:55], v3 offset:8192
  s_waitcnt lgkmcnt(3)
  v_smfmac_f32_16x16x64_bf16 v[76:79], v[40:43], v[152:159], v11
  ds_read_b128 v[56:59], v3 offset:9216
  v_mov_b64 v[88:89], 0
  v_smfmac_f32_16x16x64_bf16 v[80:83], v[60:63], v[168:175], v11
  ds_read_b128 v[68:71], v3 offset:16384
  v_mov_b64 v[90:91], 0
  v_smfmac_f32_16x16x64_bf16 v[80:83], v[64:67], v[176:183], v11
  ds_read_b128 v[72:75], v3 offset:17408
  v_cvt_pk_bf16_f32 v76, v76, v77
  v_cvt_pk_bf16_f32 v77, v78, v79
  v_or_b32 v76, 1, v76
  v_smfmac_f32_16x16x64_bf16 v[80:83], v[40:43], v[184:191], v11
  s_waitcnt lgkmcnt(2)
  buffer_store_dwordx2 v[76:77], v5, s[36:39], 0 offen sc1
  v_smfmac_f32_16x16x64_bf16 v[44:47], v[60:63], v[200:207], v11
  ds_read_b128 v[116:119], v3 offset:24576
  v_mov_b64 v[76:77], 0
  v_mov_b64 v[78:79], 0
  v_smfmac_f32_16x16x64_bf16 v[44:47], v[64:67], v[208:215], v11
  ds_read_b128 v[120:123], v3 offset:25600
  v_cvt_pk_bf16_f32 v80, v80, v81
  v_cvt_pk_bf16_f32 v81, v82, v83
  v_or_b32 v80, 1, v80
  v_smfmac_f32_16x16x64_bf16 v[44:47], v[40:43], v[92:99], v11
  buffer_store_dwordx2 v[80:81], v5, s[36:39], s74 offen sc1
  v_smfmac_f32_16x16x64_bf16 v[48:51], v[60:63], v[52:59], v11
  s_waitcnt lgkmcnt(2)
  v_mov_b64 v[80:81], 0
  v_mov_b64 v[82:83], 0
  v_smfmac_f32_16x16x64_bf16 v[48:51], v[64:67], v[68:75], v11
  s_waitcnt lgkmcnt(0)
  v_cvt_pk_bf16_f32 v44, v44, v45
  v_cvt_pk_bf16_f32 v45, v46, v47
  v_or_b32 v44, 1, v44
  v_smfmac_f32_16x16x64_bf16 v[48:51], v[40:43], v[116:123], v11
  buffer_store_dwordx2 v[44:45], v5, s[36:39], s76 offen sc1
  v_mov_b64 v[68:69], 0
  v_mov_b64 v[70:71], 0
  v_mov_b32 v13, 0
  v_mov_b32 v13, 0
  v_cvt_pk_bf16_f32 v48, v48, v49
  v_cvt_pk_bf16_f32 v49, v50, v51
  v_or_b32 v48, 1, v48
  buffer_store_dwordx2 v[48:49], v5, s[36:39], s65 offen sc1
  v_mov_b64 v[72:73], 0
  v_mov_b64 v[74:75], 0
L_gap_gp10_6_80:
  s_nop 7
  s_nop 7
  s_nop 6
  s_nop 6
  s_nop 6
  s_nop 6
  buffer_load_dwordx4 v[108:111], v1, s[36:39], s64 offen offset:0 sc1
  buffer_load_dwordx4 v[112:115], v1, s[36:39], s64 offen offset:1024 sc1
  s_waitcnt vmcnt(10)
  ds_write_b128 v2, v[20:23] offset:40960
  s_waitcnt vmcnt(9)
  ds_write_b128 v2, v[24:27] offset:41984
  s_waitcnt vmcnt(8)
  ds_write_b128 v2, v[28:31] offset:49152
  s_waitcnt vmcnt(6)
  ds_write_b128 v2, v[32:35] offset:50176
  ds_read_b128 v[44:47], v1 offset:0
  ds_read_b128 v[48:51], v1 offset:1024
  ds_read_b128 v[52:55], v1 offset:8192
  ds_read_b128 v[56:59], v1 offset:9216
.p2align 5
  s_nop 0
  s_nop 0
  s_nop 0
  s_nop 0
  s_waitcnt vmcnt(1)
  v_mfma_f32_16x16x32_bf16 v[124:127], v[16:19], v[108:111], 0
  v_bitop3_b32 v15, v108, v110, 1 bitop3:0x80
  v_sub_u32 v15, 2, v15
  s_waitcnt vmcnt(0)
  v_mfma_f32_16x16x32_bf16 v[124:127], v[16:19], v[112:115], v[124:127]
  v_bitop3_b32 v13, v112, v114, 1 bitop3:0x80
  v_cmp_ne_u32 vcc, v13, v15
  s_cbranch_vccnz L_pb_s1_1r
L_pb_s1_1:
  v_add_f32_dpp v124, v124, v124 row_ror:4 row_mask:0xf bank_mask:0xf
  v_add_f32_dpp v125, v125, v125 row_ror:4 row_mask:0xf bank_mask:0xf
  s_nop 0
  v_add_f32_dpp v124, v124, v124 row_ror:8 row_mask:0xf bank_mask:0xf
  v_add_f32_dpp v125, v125, v125 row_ror:8 row_mask:0xf bank_mask:0xf
  v_cvt_pk_bf16_f32 v14, v124, v125
  v_min_u32 v14, -2, v14
  buffer_store_dword v14, v6, s[36:39], s71 offen sc1
  s_mov_b32 s72, s79
  s_add_u32 s79, s79, 8192
  v_cmp_ne_u32 vcc, 1, v12
  v_mov_b32 v124, -1
  buffer_store_dword v124, v6, s[36:39], s87 offen sc1
  s_cbranch_vccnz L_flr_s1_1
L_fl_s1_1:
  s_xor_b32 s87, s87, 0x4000
  s_xor_b32 s93, s93, 0x4000
  ds_read_b128 v[60:63], v1 offset:16384
  ds_read_b128 v[64:67], v1 offset:17408
  ds_read_b128 v[92:95], v1 offset:24576
  ds_read_b128 v[96:99], v1 offset:25600
  ds_read_b128 v[100:103], v1 offset:32768
  ds_read_b128 v[104:107], v1 offset:33792
L_gap_gp11_3_81:
  s_nop 3
  s_nop 3
  s_nop 3
  buffer_load_dwordx4 v[36:39], v9, s[36:39], s75 offen offset:128 sc1
  buffer_load_dwordx4 v[40:43], v9, s[36:39], s75 offen offset:2176 sc1
  ds_read_b128 v[116:119], v1 offset:40960
  ds_read_b128 v[120:123], v1 offset:41984
  ds_read_b128 v[20:23], v1 offset:49152
  ds_read_b128 v[24:27], v1 offset:50176
  ds_read_b128 v[28:31], v1 offset:57344
  ds_read_b128 v[32:35], v1 offset:58368
  s_waitcnt vmcnt(4)
  ds_read_b128 v[108:111], v2 offset:0
  ds_read_b128 v[112:115], v2 offset:1024
L_gap_gp12_3_82:
  s_nop 9
  s_nop 8
  s_nop 8
  buffer_load_dwordx4 v[36:39], v9, s[36:39], s75 offen offset:128 sc1
  buffer_load_dwordx4 v[40:43], v9, s[36:39], s75 offen offset:2176 sc1
  s_branch L_step_s1_0
L_er0_s1_0:
  buffer_load_dwordx4 v[36:39], v9, s[36:39], s75 offen offset:128 sc1
  buffer_load_dwordx4 v[40:43], v9, s[36:39], s75 offen offset:2176 sc1
  s_waitcnt vmcnt(2)
  v_max_u32 v15, v39, v43
  v_cmp_eq_u32 vcc, -1, v15
  s_cbranch_vccz L_eb0_s1_0o
L_er0_s1_0s:
  buffer_load_dwordx4 v[36:39], v9, s[36:39], s75 offen offset:128 sc1
  buffer_load_dwordx4 v[40:43], v9, s[36:39], s75 offen offset:2176 sc1
  s_waitcnt vmcnt(2)
  v_max_u32 v15, v39, v43
  v_cmp_eq_u32 vcc, -1, v15
  s_cbranch_vccz L_eb0_s1_0o
  s_sub_u32 s3, s3, 1
  s_cbranch_scc1 L_end
  s_branch L_er0_s1_0s
L_eb0_s1_0o:
  ds_write_b64 v2, v[36:37] offset:32768
  s_branch L_eb0_s1_0
L_smr_s1_0:
  v_max_f32 v86, v116, v120
  v_max3_f32 v86, v86, v117, v121
  v_max3_f32 v86, v86, v118, v122
  v_max3_f32 v86, v86, v119, v123
  v_max3_f32 v86, v86, v124, v126
  v_mov_b32 v87, v86
  s_nop 1
  v_permlane32_swap_b32 v86, v87
  v_max_f32 v86, v86, v87
  v_mov_b32 v87, v86
  s_nop 1
  v_permlane16_swap_b32 v86, v87
  v_max_f32 v86, v86, v87
  v_sub_f32 v116, v116, v86
  v_sub_f32 v120, v120, v86
  v_sub_f32 v117, v117, v86
  v_sub_f32 v121, v121, v86
  v_sub_f32 v118, v118, v86
  v_sub_f32 v122, v122, v86
  v_sub_f32 v119, v119, v86
  v_sub_f32 v123, v123, v86
  v_sub_f32 v124, v124, v86
  v_sub_f32 v126, v126, v86
  v_exp_f32 v116, v116
  v_exp_f32 v120, v120
  v_exp_f32 v117, v117
  v_exp_f32 v121, v121
  v_exp_f32 v118, v118
  v_exp_f32 v122, v122
  v_exp_f32 v119, v119
  v_exp_f32 v123, v123
  v_exp_f32 v124, v124
  v_exp_f32 v126, v126
  v_cvt_pk_bf16_f32 v100, v116, v120
  v_cvt_pk_bf16_f32 v101, v117, v121
  v_cvt_pk_bf16_f32 v102, v118, v122
  v_cvt_pk_bf16_f32 v103, v119, v123
  v_cvt_pk_bf16_f32 v90, v124, v124
  v_cvt_pk_bf16_f32 v91, v126, v126
  s_waitcnt lgkmcnt(0)
  v_mov_b64 v[76:77], 0
  v_mov_b64 v[78:79], 0
  v_mfma_f32_16x16x32_bf16 v[104:107], v[16:19], v[100:103], 0
  v_mfma_f32_16x16x32_bf16 v[108:111], v[92:95], v[100:103], 0
  v_mfma_f32_16x16x32_bf16 v[112:115], v[96:99], v[100:103], 0
  v_mfma_f32_16x16x16_bf16 v[36:39], v[16:17], v[90:91], 0
  v_mfma_f32_16x16x16_bf16 v[108:111], v[84:85], v[90:91], v[108:111]
  v_mfma_f32_16x16x16_bf16 v[112:115], v[88:89], v[90:91], v[112:115]
  v_fma_f32 v106, v38, 0.5, v106
  v_rcp_f32 v107, v106
  s_nop 0
  v_mul_f32 v108, v108, v107
  v_mul_f32 v109, v109, v107
  v_mul_f32 v110, v110, v107
  v_mul_f32 v111, v111, v107
  v_cvt_pk_bf16_f32 v100, v108, v109
  v_cvt_pk_bf16_f32 v101, v110, v111
  v_mul_f32 v112, v112, v107
  v_mul_f32 v113, v113, v107
  v_mul_f32 v114, v114, v107
  v_mul_f32 v115, v115, v107
  v_cvt_pk_bf16_f32 v102, v112, v113
  v_cvt_pk_bf16_f32 v103, v114, v115
  v_cndmask_b32 v36, v100, v102, s[84:85]
  v_cndmask_b32 v37, v101, v103, s[84:85]
  ds_write_b64 v10, v[36:37]
  s_branch L_sm_s1_0
L_pb_s1_0r:
  buffer_load_dwordx4 v[108:111], v1, s[36:39], s64 offen offset:0 sc1
  buffer_load_dwordx4 v[112:115], v1, s[36:39], s64 offen offset:1024 sc1
  s_nop 15
  s_nop 7
L_pb_s1_0s:
  buffer_load_dwordx4 v[36:39], v1, s[36:39], s64 offen offset:0 sc1
  buffer_load_dwordx4 v[40:43], v1, s[36:39], s64 offen offset:1024 sc1
  s_waitcnt vmcnt(3)
  v_mfma_f32_16x16x32_bf16 v[124:127], v[16:19], v[108:111], 0
  v_bitop3_b32 v15, v108, v110, 1 bitop3:0xa8
  v_lshlrev_b32 v15, 1, v15
  s_waitcnt vmcnt(2)
  v_mfma_f32_16x16x32_bf16 v[124:127], v[16:19], v[112:115], v[124:127]
  v_bitop3_b32 v13, v112, v114, 1 bitop3:0xa8
  v_cmp_ne_u32 vcc, v13, v15
  s_cbranch_vccz L_pb_s1_0
  buffer_load_dwordx4 v[108:111], v1, s[36:39], s64 offen offset:0 sc1
  buffer_load_dwordx4 v[112:115], v1, s[36:39], s64 offen offset:1024 sc1
  s_waitcnt vmcnt(3)
  v_mfma_f32_16x16x32_bf16 v[124:127], v[16:19], v[36:39], 0
  v_bitop3_b32 v15, v36, v38, 1 bitop3:0xa8
  v_lshlrev_b32 v15, 1, v15
  s_waitcnt vmcnt(2)
  v_mfma_f32_16x16x32_bf16 v[124:127], v[16:19], v[40:43], v[124:127]
  v_bitop3_b32 v13, v40, v42, 1 bitop3:0xa8
  v_cmp_ne_u32 vcc, v13, v15
  s_cbranch_vccz L_pb_s1_0
  s_sub_u32 s3, s3, 1
  s_cbranch_scc1 L_end
  s_branch L_pb_s1_0s
L_flr_s1_0:
L_spin_83:
  buffer_load_dword v12, off, s[36:39], s70 sc1
  s_waitcnt vmcnt(0)
  v_cmp_ne_u32 vcc, 1, v12
  s_cbranch_vccz L_ok_84
  s_sub_u32 s3, s3, 1
  s_cbranch_scc1 L_end
  s_sleep 2
  s_branch L_spin_83
L_ok_84:
  s_branch L_fl_s1_0
L_er0_s1_1:
  buffer_load_dwordx4 v[36:39], v9, s[36:39], s87 offen offset:128 sc1
  buffer_load_dwordx4 v[40:43], v9, s[36:39], s87 offen offset:2176 sc1
  s_waitcnt vmcnt(2)
  v_max_u32 v15, v39, v43
  v_cmp_eq_u32 vcc, -1, v15
  s_cbranch_vccz L_eb0_s1_1o
L_er0_s1_1s:
  buffer_load_dwordx4 v[36:39], v9, s[36:39], s87 offen offset:128 sc1
  buffer_load_dwordx4 v[40:43], v9, s[36:39], s87 offen offset:2176 sc1
  s_waitcnt vmcnt(2)
  v_max_u32 v15, v39, v43
  v_cmp_eq_u32 vcc, -1, v15
  s_cbranch_vccz L_eb0_s1_1o
  s_sub_u32 s3, s3, 1
  s_cbranch_scc1 L_end
  s_branch L_er0_s1_1s
L_eb0_s1_1o:
  ds_write_b64 v2, v[36:37] offset:32768
  s_branch L_eb0_s1_1
L_smr_s1_1:
  v_max_f32 v86, v116, v120
  v_max3_f32 v86, v86, v117, v121
  v_max3_f32 v86, v86, v118, v122
  v_max3_f32 v86, v86, v119, v123
  v_max3_f32 v86, v86, v124, v126
  v_mov_b32 v87, v86
  s_nop 1
  v_permlane32_swap_b32 v86, v87
  v_max_f32 v86, v86, v87
  v_mov_b32 v87, v86
  s_nop 1
  v_permlane16_swap_b32 v86, v87
  v_max_f32 v86, v86, v87
  v_sub_f32 v116, v116, v86
  v_sub_f32 v120, v120, v86
  v_sub_f32 v117, v117, v86
  v_sub_f32 v121, v121, v86
  v_sub_f32 v118, v118, v86
  v_sub_f32 v122, v122, v86
  v_sub_f32 v119, v119, v86
  v_sub_f32 v123, v123, v86
  v_sub_f32 v124, v124, v86
  v_sub_f32 v126, v126, v86
  v_exp_f32 v116, v116
  v_exp_f32 v120, v120
  v_exp_f32 v117, v117
  v_exp_f32 v121, v121
  v_exp_f32 v118, v118
  v_exp_f32 v122, v122
  v_exp_f32 v119, v119
  v_exp_f32 v123, v123
  v_exp_f32 v124, v124
  v_exp_f32 v126, v126
  v_cvt_pk_bf16_f32 v100, v116, v120
  v_cvt_pk_bf16_f32 v101, v117, v121
  v_cvt_pk_bf16_f32 v102, v118, v122
  v_cvt_pk_bf16_f32 v103, v119, v123
  v_cvt_pk_bf16_f32 v90, v124, v124
  v_cvt_pk_bf16_f32 v91, v126, v126
  s_waitcnt lgkmcnt(0)
  v_mov_b64 v[76:77], 0
  v_mov_b64 v[78:79], 0
  v_mfma_f32_16x16x32_bf16 v[104:107], v[16:19], v[100:103], 0
  v_mfma_f32_16x16x32_bf16 v[108:111], v[92:95], v[100:103], 0
  v_mfma_f32_16x16x32_bf16 v[112:115], v[96:99], v[100:103], 0
  v_mfma_f32_16x16x16_bf16 v[36:39], v[16:17], v[90:91], 0
  v_mfma_f32_16x16x16_bf16 v[108:111], v[84:85], v[90:91], v[108:111]
  v_mfma_f32_16x16x16_bf16 v[112:115], v[88:89], v[90:91], v[112:115]
  v_fma_f32 v106, v38, 0.5, v106
  v_rcp_f32 v107, v106
  s_nop 0
  v_mul_f32 v108, v108, v107
  v_mul_f32 v109, v109, v107
  v_mul_f32 v110, v110, v107
  v_mul_f32 v111, v111, v107
  v_cvt_pk_bf16_f32 v100, v108, v109
  v_cvt_pk_bf16_f32 v101, v110, v111
  v_mul_f32 v112, v112, v107
  v_mul_f32 v113, v113, v107
  v_mul_f32 v114, v114, v107
  v_mul_f32 v115, v115, v107
  v_cvt_pk_bf16_f32 v102, v112, v113
  v_cvt_pk_bf16_f32 v103, v114, v115
  v_cndmask_b32 v36, v100, v102, s[84:85]
  v_cndmask_b32 v37, v101, v103, s[84:85]
  ds_write_b64 v10, v[36:37]
  s_branch L_sm_s1_1
L_pb_s1_1r:
  buffer_load_dwordx4 v[108:111], v1, s[36:39], s64 offen offset:0 sc1
  buffer_load_dwordx4 v[112:115], v1, s[36:39], s64 offen offset:1024 sc1
  s_nop 15
  s_nop 7
L_pb_s1_1s:
  buffer_load_dwordx4 v[36:39], v1, s[36:39], s64 offen offset:0 sc1
  buffer_load_dwordx4 v[40:43], v1, s[36:39], s64 offen offset:1024 sc1
  s_waitcnt vmcnt(3)
  v_mfma_f32_16x16x32_bf16 v[124:127], v[16:19], v[108:111], 0
  v_bitop3_b32 v15, v108, v110, 1 bitop3:0x80
  v_sub_u32 v15, 2, v15
  s_waitcnt vmcnt(2)
  v_mfma_f32_16x16x32_bf16 v[124:127], v[16:19], v[112:115], v[124:127]
  v_bitop3_b32 v13, v112, v114, 1 bitop3:0x80
  v_cmp_ne_u32 vcc, v13, v15
  s_cbranch_vccz L_pb_s1_1
  buffer_load_dwordx4 v[108:111], v1, s[36:39], s64 offen offset:0 sc1
  buffer_load_dwordx4 v[112:115], v1, s[36:39], s64 offen offset:1024 sc1
  s_waitcnt vmcnt(3)
  v_mfma_f32_16x16x32_bf16 v[124:127], v[16:19], v[36:39], 0
  v_bitop3_b32 v15, v36, v38, 1 bitop3:0x80
  v_sub_u32 v15, 2, v15
  s_waitcnt vmcnt(2)
  v_mfma_f32_16x16x32_bf16 v[124:127], v[16:19], v[40:43], v[124:127]
  v_bitop3_b32 v13, v40, v42, 1 bitop3:0x80
  v_cmp_ne_u32 vcc, v13, v15
  s_cbranch_vccz L_pb_s1_1
  s_sub_u32 s3, s3, 1
  s_cbranch_scc1 L_end
  s_branch L_pb_s1_1s
L_flr_s1_1:
L_spin_85:
  buffer_load_dword v12, off, s[36:39], s70 sc1
  s_waitcnt vmcnt(0)
  v_cmp_ne_u32 vcc, 1, v12
  s_cbranch_vccz L_ok_86
  s_sub_u32 s3, s3, 1
  s_cbranch_scc1 L_end
  s_sleep 2
  s_branch L_spin_85
L_ok_86:
  s_branch L_fl_s1_1
.p2align 5
  s_nop 0
  s_nop 0
  s_nop 0
  s_nop 0
L_step_s2_0:
  s_waitcnt lgkmcnt(0)
  s_waitcnt vmcnt(2)
  v_max_u32 v15, v39, v43
  v_cmp_eq_u32 vcc, -1, v15
  ds_write_b64 v2, v[36:37] offset:32768
  s_cbranch_vccnz L_er0_s2_0
L_eb0_s2_0:
  v_smfmac_f32_16x16x64_bf16 v[88:91], v[36:39], v[44:51], v11
  ds_write_b64 v2, v[38:39] offset:32776
  v_smfmac_f32_16x16x64_bf16 v[88:91], v[40:43], v[52:59], v11
  ds_write_b64 v2, v[40:41] offset:33792
  v_smfmac_f32_16x16x64_bf16 v[84:87], v[36:39], v[60:67], v11
  ds_write_b64 v2, v[42:43] offset:33800
  v_smfmac_f32_16x16x64_bf16 v[84:87], v[40:43], v[92:99], v11
  s_add_u32 s69, s69, 16384
  s_add_u32 s78, s69, 8192
  v_smfmac_f32_16x16x64_bf16 v[80:83], v[36:39], v[100:107], v11
  s_add_u32 s70, s70, 2048
  s_min_u32 s70, s70, s77
  v_smfmac_f32_16x16x64_bf16 v[80:83], v[40:43], v[116:123], v11
  v_smfmac_f32_16x16x64_bf16 v[76:79], v[36:39], v[20:27], v11
  s_waitcnt lgkmcnt(0)
  s_barrier
  ds_read_b128 v[44:47], v4 offset:6144
  v_smfmac_f32_16x16x64_bf16 v[76:79], v[40:43], v[28:35], v11
  ds_read_b128 v[48:51], v4 offset:7168
  v_smfmac_f32_16x16x64_bf16 v[72:75], v[36:39], a[8:15], v11
  ds_read_b128 v[52:55], v4 offset:0
  v_smfmac_f32_16x16x64_bf16 v[72:75], v[40:43], a[24:31], v11
  ds_read_b128 v[56:59], v4 offset:1024
  v_smfmac_f32_16x16x64_bf16 v[68:71], v[36:39], a[0:7], v11
  ds_read_b128 v[60:63], v4 offset:2048
  v_smfmac_f32_16x16x64_bf16 v[68:71], v[40:43], a[16:23], v11
  ds_read_b128 v[64:67], v4 offset:3072
  s_waitcnt lgkmcnt(5)
  v_smfmac_f32_16x16x64_bf16 v[68:71], v[44:47], a[32:39], v11
  ds_read_b128 v[92:95], v2 offset:8192
  s_waitcnt lgkmcnt(5)
  v_smfmac_f32_16x16x64_bf16 v[68:71], v[48:51], a[48:55], v11
  ds_read_b128 v[96:99], v2 offset:9216
  s_waitcnt lgkmcnt(5)
  v_smfmac_f32_16x16x64_bf16 v[68:71], v[52:55], a[64:71], v11
  s_waitcnt lgkmcnt(4)
  buffer_store_dword v14, v6, s[36:39], s72 offen sc1
  v_smfmac_f32_16x16x64_bf16 v[68:71], v[56:59], a[80:87], v11
  ds_read_b128 v[100:103], v2 offset:16384
  s_waitcnt lgkmcnt(4)
  v_smfmac_f32_16x16x64_bf16 v[68:71], v[60:63], a[96:103], v11
  ds_read_b128 v[104:107], v2 offset:17408
  s_waitcnt lgkmcnt(4)
  v_smfmac_f32_16x16x64_bf16 v[68:71], v[64:67], a[112:119], v11
  ds_read_b128 v[116:119], v2 offset:24576
  v_smfmac_f32_16x16x64_bf16 v[72:75], v[44:47], a[40:47], v11
  buffer_load_dwordx4 v[20:23], v1, s[36:39], s69 offen offset:0 sc1
  v_smfmac_f32_16x16x64_bf16 v[72:75], v[48:51], a[56:63], v11
  ds_read_b128 v[120:123], v2 offset:25600
  v_add_f32 v124, v68, v69
  v_smfmac_f32_16x16x64_bf16 v[72:75], v[52:55], a[72:79], v11
  v_add_f32 v126, v70, v71
  v_smfmac_f32_16x16x64_bf16 v[72:75], v[56:59], a[88:95], v11
  v_mul_f32 v124, s73, v124
  v_smfmac_f32_16x16x64_bf16 v[72:75], v[60:63], a[104:111], v11
  buffer_load_dwordx4 v[24:27], v1, s[36:39], s69 offen offset:1024 sc1
  v_mul_f32 v126, s73, v126
  v_smfmac_f32_16x16x64_bf16 v[72:75], v[64:67], a[120:127], v11
  s_waitcnt lgkmcnt(0) vmcnt(3)
  v_smfmac_f32_16x16x64_bf16 v[76:79], v[44:47], v[108:115], v11
  ds_read_b128 v[108:111], v4 offset:9216
  v_smfmac_f32_16x16x64_bf16 v[76:79], v[48:51], v[92:99], v11
  ds_read_b128 v[92:95], v4 offset:8192
  v_add_f32 v125, v72, v73
  v_smfmac_f32_16x16x64_bf16 v[76:79], v[52:55], v[100:107], v11
  buffer_load_dwordx4 v[28:31], v1, s[36:39], s78 offen offset:0 sc1
  v_add_f32 v127, v74, v75
  v_smfmac_f32_16x16x64_bf16 v[76:79], v[56:59], v[116:123], v11
  ds_read_b128 v[96:99], v4 offset:10240
  v_mul_f32 v125, s73, v125
  v_smfmac_f32_16x16x64_bf16 v[76:79], v[60:63], a[160:167], v11
  ds_read_b128 v[100:103], v4 offset:12288
  v_mul_f32 v127, s73, v127
  v_smfmac_f32_16x16x64_bf16 v[76:79], v[64:67], a[176:183], v11
  ds_read_b128 v[104:107], v4 offset:14336
  v_cvt_pk_bf16_f32 v124, v124, v125
  v_smfmac_f32_16x16x64_bf16 v[80:83], v[44:47], a[128:135], v11
  ds_read_b128 v[112:115], v4 offset:11264
  v_cvt_pk_bf16_f32 v125, v126, v127
  v_smfmac_f32_16x16x64_bf16 v[80:83], v[48:51], a[136:143], v11
  ds_write2_b32 v7, v124, v125 offset0:0 offset1:4
  v_smfmac_f32_16x16x64_bf16 v[80:83], v[52:55], a[144:151], v11
  ds_read_b128 v[36:39], v4 offset:13312
  v_add_f32 v120, v76, v77
  v_smfmac_f32_16x16x64_bf16 v[80:83], v[56:59], a[152:159], v11
  ds_read_b128 v[40:43], v4 offset:15360
  v_add_f32 v122, v78, v79
  v_smfmac_f32_16x16x64_bf16 v[80:83], v[60:63], a[168:175], v11
  buffer_load_dword v12, off, s[36:39], s70 sc1
  v_smfmac_f32_16x16x64_bf16 v[80:83], v[64:67], a[184:191], v11
  s_waitcnt lgkmcnt(2)
  s_barrier
  v_smfmac_f32_16x16x64_bf16 v[84:87], v[44:47], a[192:199], v11
  ds_read_b128 v[68:71], v8 offset:0
  v_smfmac_f32_16x16x64_bf16 v[84:87], v[48:51], a[208:215], v11
  ds_read_b128 v[72:75], v8 offset:1024
  v_add_f32 v121, v80, v81
  v_smfmac_f32_16x16x64_bf16 v[84:87], v[52:55], a[224:231], v11
  ds_read_b128 v[76:79], v8 offset:2048
  v_add_f32 v123, v82, v83
  v_smfmac_f32_16x16x64_bf16 v[84:87], v[56:59], a[240:247], v11
  ds_read_b128 v[80:83], v8 offset:3072
  v_cvt_pk_bf16_f32 v120, v120, v121
  v_smfmac_f32_16x16x64_bf16 v[84:87], v[60:63], v[224:231], v11
  v_cvt_pk_bf16_f32 v121, v122, v123
  v_smfmac_f32_16x16x64_bf16 v[84:87], v[64:67], v[240:247], v11
  ds_write2_b32 v7, v120, v121 offset0:128 offset1:132
  v_smfmac_f32_16x16x64_bf16 v[88:91], v[44:47], a[200:207], v11
  v_smfmac_f32_16x16x64_bf16 v[88:91], v[48:51], a[216:223], v11
  buffer_load_dwordx4 v[32:35], v1, s[36:39], s78 offen offset:1024 sc1
  v_cvt_pk_bf16_f32 v84, v84, v85
  v_smfmac_f32_16x16x64_bf16 v[88:91], v[52:55], a[232:239], v11
  v_cvt_pk_bf16_f32 v85, v86, v87
  v_smfmac_f32_16x16x64_bf16 v[88:91], v[56:59], a[248:255], v11
  v_smfmac_f32_16x16x64_bf16 v[88:91], v[60:63], v[232:239], v11
  s_waitcnt lgkmcnt(0)
  s_barrier
  v_smfmac_f32_16x16x64_bf16 v[88:91], v[64:67], v[248:255], v11
  ds_read_b128 v[44:47], v8 offset:512
  v_mfma_f32_16x16x32_bf16 v[116:119], v[92:95], v[68:71], 0
  ds_read_b128 v[92:95], v2 offset:49152
  v_mfma_f32_16x16x32_bf16 v[116:119], v[96:99], v[72:75], v[116:119]
  ds_read_b128 v[48:51], v8 offset:1536
  v_cvt_pk_bf16_f32 v88, v88, v89
  v_mfma_f32_16x16x32_bf16 v[116:119], v[100:103], v[76:79], v[116:119]
  ds_read_b128 v[52:55], v8 offset:2560
  v_cvt_pk_bf16_f32 v89, v90, v91
  v_mfma_f32_16x16x32_bf16 v[116:119], v[104:107], v[80:83], v[116:119]
  ds_read_b128 v[56:59], v8 offset:3584
  v_mfma_f32_16x16x32_bf16 v[120:123], v[108:111], v[68:71], 0
  ds_read_b128 v[96:99], v2 offset:50176
  v_mfma_f32_16x16x32_bf16 v[120:123], v[112:115], v[72:75], v[120:123]
  v_exp_f32 v60, v116
  v_mfma_f32_16x16x32_bf16 v[120:123], v[36:39], v[76:79], v[120:123]
  v_exp_f32 v61, v117
  v_mfma_f32_16x16x32_bf16 v[120:123], v[40:43], v[80:83], v[120:123]
  s_waitcnt lgkmcnt(5)
  v_exp_f32 v62, v118
  v_mfma_f32_16x16x32_bf16 v[124:127], v[44:47], v[68:71], 0
  s_waitcnt lgkmcnt(3)
  v_exp_f32 v63, v119
  v_mfma_f32_16x16x32_bf16 v[124:127], v[48:51], v[72:75], v[124:127]
  s_waitcnt lgkmcnt(2)
  v_exp_f32 v64, v120
  v_mfma_f32_16x16x32_bf16 v[124:127], v[52:55], v[76:79], v[124:127]
  s_waitcnt lgkmcnt(1)
  v_exp_f32 v65, v121
  v_mfma_f32_16x16x32_bf16 v[124:127], v[56:59], v[80:83], v[124:127]
  s_waitcnt lgkmcnt(0)
  v_exp_f32 v66, v122
  v_exp_f32 v67, v123
  v_cvt_pk_bf16_f32 v100, v60, v64
  v_cvt_pk_bf16_f32 v101, v61, v65
  v_cvt_pk_bf16_f32 v102, v62, v66
  v_cvt_pk_bf16_f32 v103, v63, v67
  v_exp_f32 v86, v124
  v_mov_b64 v[76:77], 0
  v_mfma_f32_16x16x32_bf16 v[104:107], v[16:19], v[100:103], 0
  v_exp_f32 v87, v126
  v_mfma_f32_16x16x32_bf16 v[108:111], v[92:95], v[100:103], 0
  v_cvt_pk_bf16_f32 v90, v86, v86
  v_cvt_pk_bf16_f32 v91, v87, v87
  v_mfma_f32_16x16x32_bf16 v[112:115], v[96:99], v[100:103], 0
  v_mov_b64 v[78:79], 0
  v_mov_b64 v[80:81], 0
  v_mfma_f32_16x16x16_bf16 v[36:39], v[16:17], v[90:91], 0
  v_mov_b64 v[82:83], 0
  v_mfma_f32_16x16x16_bf16 v[108:111], v[84:85], v[90:91], v[108:111]
  v_mfma_f32_16x16x16_bf16 v[112:115], v[88:89], v[90:91], v[112:115]
  v_fma_f32 v106, v38, 0.5, v106
  v_rcp_f32 v107, v106
  v_mov_b32 v13, 0
  v_mul_f32 v108, v108, v107
  v_mul_f32 v109, v109, v107
  v_mul_f32 v110, v110, v107
  v_mul_f32 v111, v111, v107
  v_cvt_pk_bf16_f32 v100, v108, v109
  v_cvt_pk_bf16_f32 v101, v110, v111
  v_mul_f32 v112, v112, v107
  v_mul_f32 v113, v113, v107
  v_mul_f32 v114, v114, v107
  v_mul_f32 v115, v115, v107
  v_cvt_pk_bf16_f32 v102, v112, v113
  v_cvt_pk_bf16_f32 v103, v114, v115
  v_cndmask_b32 v36, v100, v102, s[84:85]
  v_cndmask_b32 v37, v101, v103, s[84:85]
  ds_write_b64 v10, v[36:37]
  v_max_f32 v104, v106, v107
  v_cmp_nge_f32 vcc, s86, v104
  v_mov_b64 v[44:45], 0
  v_mov_b64 v[46:47], 0
  v_mov_b64 v[48:49], 0
  v_mov_b64 v[50:51], 0
  s_cbranch_vccnz L_smr_s2_0
L_sm_s2_0:
  v_smfmac_f32_16x16x64_bf16 v[76:79], v[100:103], v[128:135], v11
  s_waitcnt lgkmcnt(0)
  s_barrier
  ds_read_b128 v[60:63], v8 offset:7168
  v_smfmac_f32_16x16x64_bf16 v[80:83], v[100:103], v[160:167], v11
  ds_read_b128 v[64:67], v8 offset:4096
  v_mov_b64 v[84:85], 0
  v_smfmac_f32_16x16x64_bf16 v[44:47], v[100:103], v[192:199], v11
  ds_read_b128 v[40:43], v8 offset:5120
  v_mov_b64 v[86:87], 0
  v_smfmac_f32_16x16x64_bf16 v[48:51], v[100:103], v[216:223], v11
  ds_read_b128 v[92:95], v3 offset:0
  s_waitcnt lgkmcnt(3)
  v_smfmac_f32_16x16x64_bf16 v[76:79], v[60:63], v[136:143], v11
  ds_read_b128 v[96:99], v3 offset:1024
  s_waitcnt lgkmcnt(3)
  v_smfmac_f32_16x16x64_bf16 v[76:79], v[64:67], v[144:151], v11
  ds_read_b128 v[52:55], v3 offset:8192
  s_waitcnt lgkmcnt(3)
  v_smfmac_f32_16x16x64_bf16 v[76:79], v[40:43], v[152:159], v11
  ds_read_b128 v[56:59], v3 offset:9216
  v_mov_b64 v[88:89], 0
  v_smfmac_f32_16x16x64_bf16 v[80:83], v[60:63], v[168:175], v11
  ds_read_b128 v[68:71], v3 offset:16384
  v_mov_b64 v[90:91], 0
  v_smfmac_f32_16x16x64_bf16 v[80:83], v[64:67], v[176:183], v11
  ds_read_b128 v[72:75], v3 offset:17408
  v_cvt_pk_bf16_f32 v76, v76, v77
  v_cvt_pk_bf16_f32 v77, v78, v79
  v_and_b32 v76, -2, v76
  v_smfmac_f32_16x16x64_bf16 v[80:83], v[40:43], v[184:191], v11
  s_waitcnt lgkmcnt(2)
  buffer_store_dwordx2 v[76:77], v5, s[36:39], 0 offen sc1
  v_smfmac_f32_16x16x64_bf16 v[44:47], v[60:63], v[200:207], v11
  ds_read_b128 v[116:119], v3 offset:24576
  v_mov_b64 v[76:77], 0
  v_mov_b64 v[78:79], 0
  v_smfmac_f32_16x16x64_bf16 v[44:47], v[64:67], v[208:215], v11
  ds_read_b128 v[120:123], v3 offset:25600
  v_cvt_pk_bf16_f32 v80, v80, v81
  v_cvt_pk_bf16_f32 v81, v82, v83
  v_and_b32 v80, -2, v80
  v_smfmac_f32_16x16x64_bf16 v[44:47], v[40:43], v[92:99], v11
  buffer_store_dwordx2 v[80:81], v5, s[36:39], s74 offen sc1
  v_smfmac_f32_16x16x64_bf16 v[48:51], v[60:63], v[52:59], v11
  s_waitcnt lgkmcnt(2)
  v_mov_b64 v[80:81], 0
  v_mov_b64 v[82:83], 0
  v_smfmac_f32_16x16x64_bf16 v[48:51], v[64:67], v[68:75], v11
  s_waitcnt lgkmcnt(0)
  v_cvt_pk_bf16_f32 v44, v44, v45
  v_cvt_pk_bf16_f32 v45, v46, v47
  v_and_b32 v44, -2, v44
  v_smfmac_f32_16x16x64_bf16 v[48:51], v[40:43], v[116:123], v11
  buffer_store_dwordx2 v[44:45], v5, s[36:39], s76 offen sc1
  v_mov_b64 v[68:69], 0
  v_mov_b64 v[70:71], 0
  v_mov_b32 v13, 0
  v_mov_b32 v13, 0
  v_cvt_pk_bf16_f32 v48, v48, v49
  v_cvt_pk_bf16_f32 v49, v50, v51
  v_and_b32 v48, -2, v48
  buffer_store_dwordx2 v[48:49], v5, s[36:39], s65 offen sc1
  v_mov_b64 v[72:73], 0
  v_mov_b64 v[74:75], 0
  s_waitcnt vmcnt(8)
  ds_write_b128 v2, v[20:23] offset:40960
  s_waitcnt vmcnt(7)
  ds_write_b128 v2, v[24:27] offset:41984
  s_waitcnt vmcnt(6)
  ds_write_b128 v2, v[28:31] offset:49152
  s_waitcnt vmcnt(4)
  ds_write_b128 v2, v[32:35] offset:50176
L_gap_gp20_6_87:
  s_nop 5
  s_nop 4
  s_nop 4
  s_nop 4
  s_nop 4
  s_nop 4
  buffer_load_dwordx4 v[108:111], v1, s[36:39], s64 offen offset:0 sc1
  buffer_load_dwordx4 v[112:115], v1, s[36:39], s64 offen offset:1024 sc1
  ds_read_b128 v[44:47], v1 offset:0
  ds_read_b128 v[48:51], v1 offset:1024
  ds_read_b128 v[52:55], v1 offset:8192
  ds_read_b128 v[56:59], v1 offset:9216
  ds_read_b128 v[60:63], v1 offset:16384
  ds_read_b128 v[64:67], v1 offset:17408
  ds_read_b128 v[92:95], v1 offset:24576
  ds_read_b128 v[96:99], v1 offset:25600
  ds_read_b128 v[100:103], v1 offset:32768
  ds_read_b128 v[104:107], v1 offset:33792
L_gap_gp21_3_88:
  s_nop 4
  s_nop 4
  s_nop 4
  buffer_load_dwordx4 v[36:39], v1, s[36:39], s64 offen offset:0 sc1
  buffer_load_dwordx4 v[40:43], v1, s[36:39], s64 offen offset:1024 sc1
.p2align 5
  s_nop 0
  s_nop 0
  s_nop 0
  s_nop 0
  s_waitcnt vmcnt(3)
  v_mfma_f32_16x16x32_bf16 v[124:127], v[16:19], v[108:111], 0
  v_bitop3_b32 v15, v108, v110, 1 bitop3:0xa8
  v_lshlrev_b32 v15, 1, v15
  s_waitcnt vmcnt(2)
  v_mfma_f32_16x16x32_bf16 v[124:127], v[16:19], v[112:115], v[124:127]
  v_bitop3_b32 v13, v112, v114, 1 bitop3:0xa8
  v_cmp_ne_u32 vcc, v13, v15
  s_cbranch_vccnz L_pb_s2_0r
L_pb_s2_0:
  v_add_f32_dpp v124, v124, v124 row_ror:4 row_mask:0xf bank_mask:0xf
  v_add_f32_dpp v125, v125, v125 row_ror:4 row_mask:0xf bank_mask:0xf
  s_nop 0
  v_add_f32_dpp v124, v124, v124 row_ror:8 row_mask:0xf bank_mask:0xf
  v_add_f32_dpp v125, v125, v125 row_ror:8 row_mask:0xf bank_mask:0xf
  v_cvt_pk_bf16_f32 v14, v124, v125
  v_min_u32 v14, -2, v14
  buffer_store_dword v14, v6, s[36:39], s87 offen sc1
  s_mov_b32 s72, s79
  s_add_u32 s79, s79, 8192
  s_cmp_eq_u32 s68, 62
  s_cbranch_scc1 L_chain_done
  s_add_u32 s68, s68, 2
  v_cmp_ne_u32 vcc, 1, v12
  v_mov_b32 v124, -1
  buffer_store_dword v124, v6, s[36:39], s71 offen sc1
  s_cbranch_vccnz L_flr_s2_0
L_fl_s2_0:
  s_xor_b32 s71, s71, 0x4000
  s_mov_b32 s75, s71
  s_add_u32 s92, s75, 0x1000
L_gap_gp22_3_89:
  s_nop 8
  s_nop 8
  s_nop 8
  buffer_load_dwordx4 v[36:39], v9, s[36:39], s93 offen offset:0 sc1
  buffer_load_dwordx4 v[40:43], v9, s[36:39], s93 offen offset:2048 sc1
  ds_read_b128 v[116:119], v1 offset:40960
  ds_read_b128 v[120:123], v1 offset:41984
  ds_read_b128 v[20:23], v1 offset:49152
  ds_read_b128 v[24:27], v1 offset:50176
  ds_read_b128 v[28:31], v1 offset:57344
  ds_read_b128 v[32:35], v1 offset:58368
  s_waitcnt vmcnt(4)
  ds_read_b128 v[108:111], v2 offset:0
  ds_read_b128 v[112:115], v2 offset:1024
L_gap_gp23_3_90:
  s_nop 5
  s_nop 5
  s_nop 5
  buffer_load_dwordx4 v[36:39], v9, s[36:39], s93 offen offset:0 sc1
  buffer_load_dwordx4 v[40:43], v9, s[36:39], s93 offen offset:2048 sc1
.p2align 5
  s_nop 0
  s_nop 0
  s_nop 0
  s_nop 0
L_step_s2_1:
  s_waitcnt lgkmcnt(0)
  s_waitcnt vmcnt(2)
  v_max_u32 v15, v39, v43
  v_cmp_eq_u32 vcc, -1, v15
  ds_write_b64 v2, v[36:37] offset:32768
  s_cbranch_vccnz L_er0_s2_1
L_eb0_s2_1:
  v_smfmac_f32_16x16x64_bf16 v[88:91], v[36:39], v[44:51], v11
  ds_write_b64 v2, v[38:39] offset:32776
  v_smfmac_f32_16x16x64_bf16 v[88:91], v[40:43], v[52:59], v11
  ds_write_b64 v2, v[40:41] offset:33792
  v_smfmac_f32_16x16x64_bf16 v[84:87], v[36:39], v[60:67], v11
  ds_write_b64 v2, v[42:43] offset:33800
  v_smfmac_f32_16x16x64_bf16 v[84:87], v[40:43], v[92:99], v11
  s_add_u32 s69, s69, 16384
  s_add_u32 s78, s69, 8192
  v_smfmac_f32_16x16x64_bf16 v[80:83], v[36:39], v[100:107], v11
  s_add_u32 s70, s70, 2048
  s_min_u32 s70, s70, s77
  v_smfmac_f32_16x16x64_bf16 v[80:83], v[40:43], v[116:123], v11
  v_smfmac_f32_16x16x64_bf16 v[76:79], v[36:39], v[20:27], v11
  s_waitcnt lgkmcnt(0)
  s_barrier
  ds_read_b128 v[44:47], v4 offset:6144
  v_smfmac_f32_16x16x64_bf16 v[76:79], v[40:43], v[28:35], v11
  ds_read_b128 v[48:51], v4 offset:7168
  v_smfmac_f32_16x16x64_bf16 v[72:75], v[36:39], a[8:15], v11
  ds_read_b128 v[52:55], v4 offset:0
  v_smfmac_f32_16x16x64_bf16 v[72:75], v[40:43], a[24:31], v11
  ds_read_b128 v[56:59], v4 offset:1024
  v_smfmac_f32_16x16x64_bf16 v[68:71], v[36:39], a[0:7], v11
  ds_read_b128 v[60:63], v4 offset:2048
  v_smfmac_f32_16x16x64_bf16 v[68:71], v[40:43], a[16:23], v11
  ds_read_b128 v[64:67], v4 offset:3072
  s_waitcnt lgkmcnt(5)
  v_smfmac_f32_16x16x64_bf16 v[68:71], v[44:47], a[32:39], v11
  ds_read_b128 v[92:95], v2 offset:8192
  s_waitcnt lgkmcnt(5)
  v_smfmac_f32_16x16x64_bf16 v[68:71], v[48:51], a[48:55], v11
  ds_read_b128 v[96:99], v2 offset:9216
  s_waitcnt lgkmcnt(5)
  v_smfmac_f32_16x16x64_bf16 v[68:71], v[52:55], a[64:71], v11
  s_waitcnt lgkmcnt(4)
  buffer_store_dword v14, v6, s[36:39], s72 offen sc1
  v_smfmac_f32_16x16x64_bf16 v[68:71], v[56:59], a[80:87], v11
  ds_read_b128 v[100:103], v2 offset:16384
  s_waitcnt lgkmcnt(4)
  v_smfmac_f32_16x16x64_bf16 v[68:71], v[60:63], a[96:103], v11
  ds_read_b128 v[104:107], v2 offset:17408
  s_waitcnt lgkmcnt(4)
  v_smfmac_f32_16x16x64_bf16 v[68:71], v[64:67], a[112:119], v11
  ds_read_b128 v[116:119], v2 offset:24576
  v_smfmac_f32_16x16x64_bf16 v[72:75], v[44:47], a[40:47], v11
  buffer_load_dwordx4 v[20:23], v1, s[36:39], s69 offen offset:0 sc1
  v_smfmac_f32_16x16x64_bf16 v[72:75], v[48:51], a[56:63], v11
  ds_read_b128 v[120:123], v2 offset:25600
  v_add_f32 v124, v68, v69
  v_smfmac_f32_16x16x64_bf16 v[72:75], v[52:55], a[72:79], v11
  v_add_f32 v126, v70, v71
  v_smfmac_f32_16x16x64_bf16 v[72:75], v[56:59], a[88:95], v11
  v_mul_f32 v124, s73, v124
  v_smfmac_f32_16x16x64_bf16 v[72:75], v[60:63], a[104:111], v11
  buffer_load_dwordx4 v[24:27], v1, s[36:39], s69 offen offset:1024 sc1
  v_mul_f32 v126, s73, v126
  v_smfmac_f32_16x16x64_bf16 v[72:75], v[64:67], a[120:127], v11
  s_waitcnt lgkmcnt(0) vmcnt(3)
  v_smfmac_f32_16x16x64_bf16 v[76:79], v[44:47], v[108:115], v11
  ds_read_b128 v[108:111], v4 offset:9216
  v_smfmac_f32_16x16x64_bf16 v[76:79], v[48:51], v[92:99], v11
  ds_read_b128 v[92:95], v4 offset:8192
  v_add_f32 v125, v72, v73
  v_smfmac_f32_16x16x64_bf16 v[76:79], v[52:55], v[100:107], v11
  buffer_load_dwordx4 v[28:31], v1, s[36:39], s78 offen offset:0 sc1
  v_add_f32 v127, v74, v75
  v_smfmac_f32_16x16x64_bf16 v[76:79], v[56:59], v[116:123], v11
  ds_read_b128 v[96:99], v4 offset:10240
  v_mul_f32 v125, s73, v125
  v_smfmac_f32_16x16x64_bf16 v[76:79], v[60:63], a[160:167], v11
  ds_read_b128 v[100:103], v4 offset:12288
  v_mul_f32 v127, s73, v127
  v_smfmac_f32_16x16x64_bf16 v[76:79], v[64:67], a[176:183], v11
  ds_read_b128 v[104:107], v4 offset:14336
  v_cvt_pk_bf16_f32 v124, v124, v125
  v_smfmac_f32_16x16x64_bf16 v[80:83], v[44:47], a[128:135], v11
  ds_read_b128 v[112:115], v4 offset:11264
  v_cvt_pk_bf16_f32 v125, v126, v127
  v_smfmac_f32_16x16x64_bf16 v[80:83], v[48:51], a[136:143], v11
  ds_write2_b32 v7, v124, v125 offset0:0 offset1:4
  v_smfmac_f32_16x16x64_bf16 v[80:83], v[52:55], a[144:151], v11
  ds_read_b128 v[36:39], v4 offset:13312
  v_add_f32 v120, v76, v77
  v_smfmac_f32_16x16x64_bf16 v[80:83], v[56:59], a[152:159], v11
  ds_read_b128 v[40:43], v4 offset:15360
  v_add_f32 v122, v78, v79
  v_smfmac_f32_16x16x64_bf16 v[80:83], v[60:63], a[168:175], v11
  buffer_load_dword v12, off, s[36:39], s70 sc1
  v_smfmac_f32_16x16x64_bf16 v[80:83], v[64:67], a[184:191], v11
  s_waitcnt lgkmcnt(2)
  s_barrier
  v_smfmac_f32_16x16x64_bf16 v[84:87], v[44:47], a[192:199], v11
  ds_read_b128 v[68:71], v8 offset:0
  v_smfmac_f32_16x16x64_bf16 v[84:87], v[48:51], a[208:215], v11
  ds_read_b128 v[72:75], v8 offset:1024
  v_add_f32 v121, v80, v81
  v_smfmac_f32_16x16x64_bf16 v[84:87], v[52:55], a[224:231], v11
  ds_read_b128 v[76:79], v8 offset:2048
  v_add_f32 v123, v82, v83
  v_smfmac_f32_16x16x64_bf16 v[84:87], v[56:59], a[240:247], v11
  ds_read_b128 v[80:83], v8 offset:3072
  v_cvt_pk_bf16_f32 v120, v120, v121
  v_smfmac_f32_16x16x64_bf16 v[84:87], v[60:63], v[224:231], v11
  v_cvt_pk_bf16_f32 v121, v122, v123
  v_smfmac_f32_16x16x64_bf16 v[84:87], v[64:67], v[240:247], v11
  ds_write2_b32 v7, v120, v121 offset0:128 offset1:132
  v_smfmac_f32_16x16x64_bf16 v[88:91], v[44:47], a[200:207], v11
  v_smfmac_f32_16x16x64_bf16 v[88:91], v[48:51], a[216:223], v11
  buffer_load_dwordx4 v[32:35], v1, s[36:39], s78 offen offset:1024 sc1
  v_cvt_pk_bf16_f32 v84, v84, v85
  v_smfmac_f32_16x16x64_bf16 v[88:91], v[52:55], a[232:239], v11
  v_cvt_pk_bf16_f32 v85, v86, v87
  v_smfmac_f32_16x16x64_bf16 v[88:91], v[56:59], a[248:255], v11
  v_smfmac_f32_16x16x64_bf16 v[88:91], v[60:63], v[232:239], v11
  s_waitcnt lgkmcnt(0)
  s_barrier
  v_smfmac_f32_16x16x64_bf16 v[88:91], v[64:67], v[248:255], v11
  ds_read_b128 v[44:47], v8 offset:512
  v_mfma_f32_16x16x32_bf16 v[116:119], v[92:95], v[68:71], 0
  ds_read_b128 v[92:95], v2 offset:49152
  v_mfma_f32_16x16x32_bf16 v[116:119], v[96:99], v[72:75], v[116:119]
  ds_read_b128 v[48:51], v8 offset:1536
  v_cvt_pk_bf16_f32 v88, v88, v89
  v_mfma_f32_16x16x32_bf16 v[116:119], v[100:103], v[76:79], v[116:119]
  ds_read_b128 v[52:55], v8 offset:2560
  v_cvt_pk_bf16_f32 v89, v90, v91
  v_mfma_f32_16x16x32_bf16 v[116:119], v[104:107], v[80:83], v[116:119]
  ds_read_b128 v[56:59], v8 offset:3584
  v_mfma_f32_16x16x32_bf16 v[120:123], v[108:111], v[68:71], 0
  ds_read_b128 v[96:99], v2 offset:50176
  v_mfma_f32_16x16x32_bf16 v[120:123], v[112:115], v[72:75], v[120:123]
  v_exp_f32 v60, v116
  v_mfma_f32_16x16x32_bf16 v[120:123], v[36:39], v[76:79], v[120:123]
  v_exp_f32 v61, v117
  v_mfma_f32_16x16x32_bf16 v[120:123], v[40:43], v[80:83], v[120:123]
  s_waitcnt lgkmcnt(5)
  v_exp_f32 v62, v118
  v_mfma_f32_16x16x32_bf16 v[124:127], v[44:47], v[68:71], 0
  s_waitcnt lgkmcnt(3)
  v_exp_f32 v63, v119
  v_mfma_f32_16x16x32_bf16 v[124:127], v[48:51], v[72:75], v[124:127]
  s_waitcnt lgkmcnt(2)
  v_exp_f32 v64, v120
  v_mfma_f32_16x16x32_bf16 v[124:127], v[52:55], v[76:79], v[124:127]
  s_waitcnt lgkmcnt(1)
  v_exp_f32 v65, v121
  v_mfma_f32_16x16x32_bf16 v[124:127], v[56:59], v[80:83], v[124:127]
  s_waitcnt lgkmcnt(0)
  v_exp_f32 v66, v122
  v_exp_f32 v67, v123
  v_cvt_pk_bf16_f32 v100, v60, v64
  v_cvt_pk_bf16_f32 v101, v61, v65
  v_cvt_pk_bf16_f32 v102, v62, v66
  v_cvt_pk_bf16_f32 v103, v63, v67
  v_exp_f32 v86, v124
  v_mov_b64 v[76:77], 0
  v_mfma_f32_16x16x32_bf16 v[104:107], v[16:19], v[100:103], 0
  v_exp_f32 v87, v126
  v_mfma_f32_16x16x32_bf16 v[108:111], v[92:95], v[100:103], 0
  v_cvt_pk_bf16_f32 v90, v86, v86
  v_cvt_pk_bf16_f32 v91, v87, v87
  v_mfma_f32_16x16x32_bf16 v[112:115], v[96:99], v[100:103], 0
  v_mov_b64 v[78:79], 0
  v_mov_b64 v[80:81], 0
  v_mfma_f32_16x16x16_bf16 v[36:39], v[16:17], v[90:91], 0
  v_mov_b64 v[82:83], 0
  v_mfma_f32_16x16x16_bf16 v[108:111], v[84:85], v[90:91], v[108:111]
  v_mfma_f32_16x16x16_bf16 v[112:115], v[88:89], v[90:91], v[112:115]
  v_fma_f32 v106, v38, 0.5, v106
  v_rcp_f32 v107, v106
  v_mov_b32 v13, 0
  v_mul_f32 v108, v108, v107
  v_mul_f32 v109, v109, v107
  v_mul_f32 v110, v110, v107
  v_mul_f32 v111, v111, v107
  v_cvt_pk_bf16_f32 v100, v108, v109
  v_cvt_pk_bf16_f32 v101, v110, v111
  v_mul_f32 v112, v112, v107
  v_mul_f32 v113, v113, v107
  v_mul_f32 v114, v114, v107
  v_mul_f32 v115, v115, v107
  v_cvt_pk_bf16_f32 v102, v112, v113
  v_cvt_pk_bf16_f32 v103, v114, v115
  v_cndmask_b32 v36, v100, v102, s[84:85]
  v_cndmask_b32 v37, v101, v103, s[84:85]
  ds_write_b64 v10, v[36:37]
  v_max_f32 v104, v106, v107
  v_cmp_nge_f32 vcc, s86, v104
  v_mov_b64 v[44:45], 0
  v_mov_b64 v[46:47], 0
  v_mov_b64 v[48:49], 0
  v_mov_b64 v[50:51], 0
  s_cbranch_vccnz L_smr_s2_1
L_sm_s2_1:
  v_smfmac_f32_16x16x64_bf16 v[76:79], v[100:103], v[128:135], v11
  s_waitcnt lgkmcnt(0)
  s_barrier
  ds_read_b128 v[60:63], v8 offset:7168
  v_smfmac_f32_16x16x64_bf16 v[80:83], v[100:103], v[160:167], v11
  ds_read_b128 v[64:67], v8 offset:4096
  v_mov_b64 v[84:85], 0
  v_smfmac_f32_16x16x64_bf16 v[44:47], v[100:103], v[192:199], v11
  ds_read_b128 v[40:43], v8 offset:5120
  v_mov_b64 v[86:87], 0
  v_smfmac_f32_16x16x64_bf16 v[48:51], v[100:103], v[216:223], v11
  ds_read_b128 v[92:95], v3 offset:0
  s_waitcnt lgkmcnt(3)
  v_smfmac_f32_16x16x64_bf16 v[76:79], v[60:63], v[136:143], v11
  ds_read_b128 v[96:99], v3 offset:1024
  s_waitcnt lgkmcnt(3)
  v_smfmac_f32_16x16x64_bf16 v[76:79], v[64:67], v[144:151], v11
  ds_read_b128 v[52:55], v3 offset:8192
  s_waitcnt lgkmcnt(3)
  v_smfmac_f32_16x16x64_bf16 v[76:79], v[40:43], v[152:159], v11
  ds_read_b128 v[56:59], v3 offset:9216
  v_mov_b64 v[88:89], 0
  v_smfmac_f32_16x16x64_bf16 v[80:83], v[60:63], v[168:175], v11
  ds_read_b128 v[68:71], v3 offset:16384
  v_mov_b64 v[90:91], 0
  v_smfmac_f32_16x16x64_bf16 v[80:83], v[64:67], v[176:183], v11
  ds_read_b128 v[72:75], v3 offset:17408
  v_cvt_pk_bf16_f32 v76, v76, v77
  v_cvt_pk_bf16_f32 v77, v78, v79
  v_or_b32 v76, 1, v76
  v_smfmac_f32_16x16x64_bf16 v[80:83], v[40:43], v[184:191], v11
  s_waitcnt lgkmcnt(2)
  buffer_store_dwordx2 v[76:77], v5, s[36:39], 0 offen sc1
  v_smfmac_f32_16x16x64_bf16 v[44:47], v[60:63], v[200:207], v11
  ds_read_b128 v[116:119], v3 offset:24576
  v_mov_b64 v[76:77], 0
  v_mov_b64 v[78:79], 0
  v_smfmac_f32_16x16x64_bf16 v[44:47], v[64:67], v[208:215], v11
  ds_read_b128 v[120:123], v3 offset:25600
  v_cvt_pk_bf16_f32 v80, v80, v81
  v_cvt_pk_bf16_f32 v81, v82, v83
  v_or_b32 v80, 1, v80
  v_smfmac_f32_16x16x64_bf16 v[44:47], v[40:43], v[92:99], v11
  buffer_store_dwordx2 v[80:81], v5, s[36:39], s74 offen sc1
  v_smfmac_f32_16x16x64_bf16 v[48:51], v[60:63], v[52:59], v11
  s_waitcnt lgkmcnt(2)
  v_mov_b64 v[80:81], 0
  v_mov_b64 v[82:83], 0
  v_smfmac_f32_16x16x64_bf16 v[48:51], v[64:67], v[68:75], v11
  s_waitcnt lgkmcnt(0)
  v_cvt_pk_bf16_f32 v44, v44, v45
  v_cvt_pk_bf16_f32 v45, v46, v47
  v_or_b32 v44, 1, v44
  v_smfmac_f32_16x16x64_bf16 v[48:51], v[40:43], v[116:123], v11
  buffer_store_dwordx2 v[44:45], v5, s[36:39], s76 offen sc1
  v_mov_b64 v[68:69], 0
  v_mov_b64 v[70:71], 0
  v_mov_b32 v13, 0
  v_mov_b32 v13, 0
  v_cvt_pk_bf16_f32 v48, v48, v49
  v_cvt_pk_bf16_f32 v49, v50, v51
  v_or_b32 v48, 1, v48
  buffer_store_dwordx2 v[48:49], v5, s[36:39], s65 offen sc1
  v_mov_b64 v[72:73], 0
  v_mov_b64 v[74:75], 0
  s_waitcnt vmcnt(8)
  ds_write_b128 v2, v[20:23] offset:40960
  s_waitcnt vmcnt(7)
  ds_write_b128 v2, v[24:27] offset:41984
  s_waitcnt vmcnt(6)
  ds_write_b128 v2, v[28:31] offset:49152
  s_waitcnt vmcnt(4)
  ds_write_b128 v2, v[32:35] offset:50176
L_gap_gp20_6_91:
  s_nop 5
  s_nop 4
  s_nop 4
  s_nop 4
  s_nop 4
  s_nop 4
  buffer_load_dwordx4 v[108:111], v1, s[36:39], s64 offen offset:0 sc1
  buffer_load_dwordx4 v[112:115], v1, s[36:39], s64 offen offset:1024 sc1
  ds_read_b128 v[44:47], v1 offset:0
  ds_read_b128 v[48:51], v1 offset:1024
  ds_read_b128 v[52:55], v1 offset:8192
  ds_read_b128 v[56:59], v1 offset:9216
  ds_read_b128 v[60:63], v1 offset:16384
  ds_read_b128 v[64:67], v1 offset:17408
  ds_read_b128 v[92:95], v1 offset:24576
  ds_read_b128 v[96:99], v1 offset:25600
  ds_read_b128 v[100:103], v1 offset:32768
  ds_read_b128 v[104:107], v1 offset:33792
L_gap_gp21_3_92:
  s_nop 4
  s_nop 4
  s_nop 4
  buffer_load_dwordx4 v[36:39], v1, s[36:39], s64 offen offset:0 sc1
  buffer_load_dwordx4 v[40:43], v1, s[36:39], s64 offen offset:1024 sc1
.p2align 5
  s_nop 0
  s_nop 0
  s_nop 0
  s_nop 0
  s_waitcnt vmcnt(3)
  v_mfma_f32_16x16x32_bf16 v[124:127], v[16:19], v[108:111], 0
  v_bitop3_b32 v15, v108, v110, 1 bitop3:0x80
  v_sub_u32 v15, 2, v15
  s_waitcnt vmcnt(2)
  v_mfma_f32_16x16x32_bf16 v[124:127], v[16:19], v[112:115], v[124:127]
  v_bitop3_b32 v13, v112, v114, 1 bitop3:0x80
  v_cmp_ne_u32 vcc, v13, v15
  s_cbranch_vccnz L_pb_s2_1r
L_pb_s2_1:
  v_add_f32_dpp v124, v124, v124 row_ror:4 row_mask:0xf bank_mask:0xf
  v_add_f32_dpp v125, v125, v125 row_ror:4 row_mask:0xf bank_mask:0xf
  s_nop 0
  v_add_f32_dpp v124, v124, v124 row_ror:8 row_mask:0xf bank_mask:0xf
  v_add_f32_dpp v125, v125, v125 row_ror:8 row_mask:0xf bank_mask:0xf
  v_cvt_pk_bf16_f32 v14, v124, v125
  v_min_u32 v14, -2, v14
  buffer_store_dword v14, v6, s[36:39], s71 offen sc1
  s_mov_b32 s72, s79
  s_add_u32 s79, s79, 8192
  v_cmp_ne_u32 vcc, 1, v12
  v_mov_b32 v124, -1
  buffer_store_dword v124, v6, s[36:39], s87 offen sc1
  s_cbranch_vccnz L_flr_s2_1
L_fl_s2_1:
  s_xor_b32 s87, s87, 0x4000
  s_xor_b32 s93, s93, 0x4000
L_gap_gp22_3_93:
  s_nop 8
  s_nop 8
  s_nop 8
  buffer_load_dwordx4 v[36:39], v9, s[36:39], s92 offen offset:0 sc1
  buffer_load_dwordx4 v[40:43], v9, s[36:39], s92 offen offset:2048 sc1
  ds_read_b128 v[116:119], v1 offset:40960
  ds_read_b128 v[120:123], v1 offset:41984
  ds_read_b128 v[20:23], v1 offset:49152
  ds_read_b128 v[24:27], v1 offset:50176
  ds_read_b128 v[28:31], v1 offset:57344
  ds_read_b128 v[32:35], v1 offset:58368
  s_waitcnt vmcnt(4)
  ds_read_b128 v[108:111], v2 offset:0
  ds_read_b128 v[112:115], v2 offset:1024
L_gap_gp23_3_94:
  s_nop 5
  s_nop 5
  s_nop 5
  buffer_load_dwordx4 v[36:39], v9, s[36:39], s92 offen offset:0 sc1
  buffer_load_dwordx4 v[40:43], v9, s[36:39], s92 offen offset:2048 sc1
  s_branch L_step_s2_0
L_er0_s2_0:
  buffer_load_dwordx4 v[36:39], v9, s[36:39], s92 offen offset:0 sc1
  buffer_load_dwordx4 v[40:43], v9, s[36:39], s92 offen offset:2048 sc1
  s_waitcnt vmcnt(2)
  v_max_u32 v15, v39, v43
  v_cmp_eq_u32 vcc, -1, v15
  s_cbranch_vccz L_eb0_s2_0o
L_er0_s2_0s:
  buffer_load_dwordx4 v[36:39], v9, s[36:39], s92 offen offset:0 sc1
  buffer_load_dwordx4 v[40:43], v9, s[36:39], s92 offen offset:2048 sc1
  s_waitcnt vmcnt(2)
  v_max_u32 v15, v39, v43
  v_cmp_eq_u32 vcc, -1, v15
  s_cbranch_vccz L_eb0_s2_0o
  s_sub_u32 s3, s3, 1
  s_cbranch_scc1 L_end
  s_branch L_er0_s2_0s
L_eb0_s2_0o:
  ds_write_b64 v2, v[36:37] offset:32768
  s_branch L_eb0_s2_0
L_smr_s2_0:
  v_max_f32 v86, v116, v120
  v_max3_f32 v86, v86, v117, v121
  v_max3_f32 v86, v86, v118, v122
  v_max3_f32 v86, v86, v119, v123
  v_max3_f32 v86, v86, v124, v126
  v_mov_b32 v87, v86
  s_nop 1
  v_permlane32_swap_b32 v86, v87
  v_max_f32 v86, v86, v87
  v_mov_b32 v87, v86
  s_nop 1
  v_permlane16_swap_b32 v86, v87
  v_max_f32 v86, v86, v87
  v_sub_f32 v116, v116, v86
  v_sub_f32 v120, v120, v86
  v_sub_f32 v117, v117, v86
  v_sub_f32 v121, v121, v86
  v_sub_f32 v118, v118, v86
  v_sub_f32 v122, v122, v86
  v_sub_f32 v119, v119, v86
  v_sub_f32 v123, v123, v86
  v_sub_f32 v124, v124, v86
  v_sub_f32 v126, v126, v86
  v_exp_f32 v116, v116
  v_exp_f32 v120, v120
  v_exp_f32 v117, v117
  v_exp_f32 v121, v121
  v_exp_f32 v118, v118
  v_exp_f32 v122, v122
  v_exp_f32 v119, v119
  v_exp_f32 v123, v123
  v_exp_f32 v124, v124
  v_exp_f32 v126, v126
  v_cvt_pk_bf16_f32 v100, v116, v120
  v_cvt_pk_bf16_f32 v101, v117, v121
  v_cvt_pk_bf16_f32 v102, v118, v122
  v_cvt_pk_bf16_f32 v103, v119, v123
  v_cvt_pk_bf16_f32 v90, v124, v124
  v_cvt_pk_bf16_f32 v91, v126, v126
  s_waitcnt lgkmcnt(0)
  v_mov_b64 v[76:77], 0
  v_mov_b64 v[78:79], 0
  v_mfma_f32_16x16x32_bf16 v[104:107], v[16:19], v[100:103], 0
  v_mfma_f32_16x16x32_bf16 v[108:111], v[92:95], v[100:103], 0
  v_mfma_f32_16x16x32_bf16 v[112:115], v[96:99], v[100:103], 0
  v_mfma_f32_16x16x16_bf16 v[36:39], v[16:17], v[90:91], 0
  v_mfma_f32_16x16x16_bf16 v[108:111], v[84:85], v[90:91], v[108:111]
  v_mfma_f32_16x16x16_bf16 v[112:115], v[88:89], v[90:91], v[112:115]
  v_fma_f32 v106, v38, 0.5, v106
  v_rcp_f32 v107, v106
  s_nop 0
  v_mul_f32 v108, v108, v107
  v_mul_f32 v109, v109, v107
  v_mul_f32 v110, v110, v107
  v_mul_f32 v111, v111, v107
  v_cvt_pk_bf16_f32 v100, v108, v109
  v_cvt_pk_bf16_f32 v101, v110, v111
  v_mul_f32 v112, v112, v107
  v_mul_f32 v113, v113, v107
  v_mul_f32 v114, v114, v107
  v_mul_f32 v115, v115, v107
  v_cvt_pk_bf16_f32 v102, v112, v113
  v_cvt_pk_bf16_f32 v103, v114, v115
  v_cndmask_b32 v36, v100, v102, s[84:85]
  v_cndmask_b32 v37, v101, v103, s[84:85]
  ds_write_b64 v10, v[36:37]
  s_branch L_sm_s2_0
L_pb_s2_0r:
  buffer_load_dwordx4 v[108:111], v1, s[36:39], s64 offen offset:0 sc1
  buffer_load_dwordx4 v[112:115], v1, s[36:39], s64 offen offset:1024 sc1
  s_waitcnt vmcnt(3)
  v_mfma_f32_16x16x32_bf16 v[124:127], v[16:19], v[36:39], 0
  v_bitop3_b32 v15, v36, v38, 1 bitop3:0xa8
  v_lshlrev_b32 v15, 1, v15
  s_waitcnt vmcnt(2)
  v_mfma_f32_16x16x32_bf16 v[124:127], v[16:19], v[40:43], v[124:127]
  v_bitop3_b32 v13, v40, v42, 1 bitop3:0xa8
  v_cmp_ne_u32 vcc, v13, v15
  s_cbranch_vccz L_pb_s2_0
L_pb_s2_0s:
  buffer_load_dwordx4 v[36:39], v1, s[36:39], s64 offen offset:0 sc1
  buffer_load_dwordx4 v[40:43], v1, s[36:39], s64 offen offset:1024 sc1
  s_waitcnt vmcnt(3)
  v_mfma_f32_16x16x32_bf16 v[124:127], v[16:19], v[108:111], 0
  v_bitop3_b32 v15, v108, v110, 1 bitop3:0xa8
  v_lshlrev_b32 v15, 1, v15
  s_waitcnt vmcnt(2)
  v_mfma_f32_16x16x32_bf16 v[124:127], v[16:19], v[112:115], v[124:127]
  v_bitop3_b32 v13, v112, v114, 1 bitop3:0xa8
  v_cmp_ne_u32 vcc, v13, v15
  s_cbranch_vccz L_pb_s2_0
  buffer_load_dwordx4 v[108:111], v1, s[36:39], s64 offen offset:0 sc1
  buffer_load_dwordx4 v[112:115], v1, s[36:39], s64 offen offset:1024 sc1
  s_waitcnt vmcnt(3)
  v_mfma_f32_16x16x32_bf16 v[124:127], v[16:19], v[36:39], 0
  v_bitop3_b32 v15, v36, v38, 1 bitop3:0xa8
  v_lshlrev_b32 v15, 1, v15
  s_waitcnt vmcnt(2)
  v_mfma_f32_16x16x32_bf16 v[124:127], v[16:19], v[40:43], v[124:127]
  v_bitop3_b32 v13, v40, v42, 1 bitop3:0xa8
  v_cmp_ne_u32 vcc, v13, v15
  s_cbranch_vccz L_pb_s2_0
  s_sub_u32 s3, s3, 1
  s_cbranch_scc1 L_end
  s_branch L_pb_s2_0s
L_flr_s2_0:
L_spin_95:
  buffer_load_dword v12, off, s[36:39], s70 sc1
  s_waitcnt vmcnt(0)
  v_cmp_ne_u32 vcc, 1, v12
  s_cbranch_vccz L_ok_96
  s_sub_u32 s3, s3, 1
  s_cbranch_scc1 L_end
  s_sleep 2
  s_branch L_spin_95
L_ok_96:
  s_branch L_fl_s2_0
L_er0_s2_1:
  buffer_load_dwordx4 v[36:39], v9, s[36:39], s93 offen offset:0 sc1
  buffer_load_dwordx4 v[40:43], v9, s[36:39], s93 offen offset:2048 sc1
  s_waitcnt vmcnt(2)
  v_max_u32 v15, v39, v43
  v_cmp_eq_u32 vcc, -1, v15
  s_cbranch_vccz L_eb0_s2_1o
L_er0_s2_1s:
  buffer_load_dwordx4 v[36:39], v9, s[36:39], s93 offen offset:0 sc1
  buffer_load_dwordx4 v[40:43], v9, s[36:39], s93 offen offset:2048 sc1
  s_waitcnt vmcnt(2)
  v_max_u32 v15, v39, v43
  v_cmp_eq_u32 vcc, -1, v15
  s_cbranch_vccz L_eb0_s2_1o
  s_sub_u32 s3, s3, 1
  s_cbranch_scc1 L_end
  s_branch L_er0_s2_1s
L_eb0_s2_1o:
  ds_write_b64 v2, v[36:37] offset:32768
  s_branch L_eb0_s2_1
L_smr_s2_1:
  v_max_f32 v86, v116, v120
  v_max3_f32 v86, v86, v117, v121
  v_max3_f32 v86, v86, v118, v122
  v_max3_f32 v86, v86, v119, v123
  v_max3_f32 v86, v86, v124, v126
  v_mov_b32 v87, v86
  s_nop 1
  v_permlane32_swap_b32 v86, v87
  v_max_f32 v86, v86, v87
  v_mov_b32 v87, v86
  s_nop 1
  v_permlane16_swap_b32 v86, v87
  v_max_f32 v86, v86, v87
  v_sub_f32 v116, v116, v86
  v_sub_f32 v120, v120, v86
  v_sub_f32 v117, v117, v86
  v_sub_f32 v121, v121, v86
  v_sub_f32 v118, v118, v86
  v_sub_f32 v122, v122, v86
  v_sub_f32 v119, v119, v86
  v_sub_f32 v123, v123, v86
  v_sub_f32 v124, v124, v86
  v_sub_f32 v126, v126, v86
  v_exp_f32 v116, v116
  v_exp_f32 v120, v120
  v_exp_f32 v117, v117
  v_exp_f32 v121, v121
  v_exp_f32 v118, v118
  v_exp_f32 v122, v122
  v_exp_f32 v119, v119
  v_exp_f32 v123, v123
  v_exp_f32 v124, v124
  v_exp_f32 v126, v126
  v_cvt_pk_bf16_f32 v100, v116, v120
  v_cvt_pk_bf16_f32 v101, v117, v121
  v_cvt_pk_bf16_f32 v102, v118, v122
  v_cvt_pk_bf16_f32 v103, v119, v123
  v_cvt_pk_bf16_f32 v90, v124, v124
  v_cvt_pk_bf16_f32 v91, v126, v126
  s_waitcnt lgkmcnt(0)
  v_mov_b64 v[76:77], 0
  v_mov_b64 v[78:79], 0
  v_mfma_f32_16x16x32_bf16 v[104:107], v[16:19], v[100:103], 0
  v_mfma_f32_16x16x32_bf16 v[108:111], v[92:95], v[100:103], 0
  v_mfma_f32_16x16x32_bf16 v[112:115], v[96:99], v[100:103], 0
  v_mfma_f32_16x16x16_bf16 v[36:39], v[16:17], v[90:91], 0
  v_mfma_f32_16x16x16_bf16 v[108:111], v[84:85], v[90:91], v[108:111]
  v_mfma_f32_16x16x16_bf16 v[112:115], v[88:89], v[90:91], v[112:115]
  v_fma_f32 v106, v38, 0.5, v106
  v_rcp_f32 v107, v106
  s_nop 0
  v_mul_f32 v108, v108, v107
  v_mul_f32 v109, v109, v107
  v_mul_f32 v110, v110, v107
  v_mul_f32 v111, v111, v107
  v_cvt_pk_bf16_f32 v100, v108, v109
  v_cvt_pk_bf16_f32 v101, v110, v111
  v_mul_f32 v112, v112, v107
  v_mul_f32 v113, v113, v107
  v_mul_f32 v114, v114, v107
  v_mul_f32 v115, v115, v107
  v_cvt_pk_bf16_f32 v102, v112, v113
  v_cvt_pk_bf16_f32 v103, v114, v115
  v_cndmask_b32 v36, v100, v102, s[84:85]
  v_cndmask_b32 v37, v101, v103, s[84:85]
  ds_write_b64 v10, v[36:37]
  s_branch L_sm_s2_1
L_pb_s2_1r:
  buffer_load_dwordx4 v[108:111], v1, s[36:39], s64 offen offset:0 sc1
  buffer_load_dwordx4 v[112:115], v1, s[36:39], s64 offen offset:1024 sc1
  s_waitcnt vmcnt(3)
  v_mfma_f32_16x16x32_bf16 v[124:127], v[16:19], v[36:39], 0
  v_bitop3_b32 v15, v36, v38, 1 bitop3:0x80
  v_sub_u32 v15, 2, v15
  s_waitcnt vmcnt(2)
  v_mfma_f32_16x16x32_bf16 v[124:127], v[16:19], v[40:43], v[124:127]
  v_bitop3_b32 v13, v40, v42, 1 bitop3:0x80
  v_cmp_ne_u32 vcc, v13, v15
  s_cbranch_vccz L_pb_s2_1
L_pb_s2_1s:
  buffer_load_dwordx4 v[36:39], v1, s[36:39], s64 offen offset:0 sc1
  buffer_load_dwordx4 v[40:43], v1, s[36:39], s64 offen offset:1024 sc1
  s_waitcnt vmcnt(3)
  v_mfma_f32_16x16x32_bf16 v[124:127], v[16:19], v[108:111], 0
  v_bitop3_b32 v15, v108, v110, 1 bitop3:0x80
  v_sub_u32 v15, 2, v15
  s_waitcnt vmcnt(2)
  v_mfma_f32_16x16x32_bf16 v[124:127], v[16:19], v[112:115], v[124:127]
  v_bitop3_b32 v13, v112, v114, 1 bitop3:0x80
  v_cmp_ne_u32 vcc, v13, v15
  s_cbranch_vccz L_pb_s2_1
  buffer_load_dwordx4 v[108:111], v1, s[36:39], s64 offen offset:0 sc1
  buffer_load_dwordx4 v[112:115], v1, s[36:39], s64 offen offset:1024 sc1
  s_waitcnt vmcnt(3)
  v_mfma_f32_16x16x32_bf16 v[124:127], v[16:19], v[36:39], 0
  v_bitop3_b32 v15, v36, v38, 1 bitop3:0x80
  v_sub_u32 v15, 2, v15
  s_waitcnt vmcnt(2)
  v_mfma_f32_16x16x32_bf16 v[124:127], v[16:19], v[40:43], v[124:127]
  v_bitop3_b32 v13, v40, v42, 1 bitop3:0x80
  v_cmp_ne_u32 vcc, v13, v15
  s_cbranch_vccz L_pb_s2_1
  s_sub_u32 s3, s3, 1
  s_cbranch_scc1 L_end
  s_branch L_pb_s2_1s
L_flr_s2_1:
L_spin_97:
  buffer_load_dword v12, off, s[36:39], s70 sc1
  s_waitcnt vmcnt(0)
  v_cmp_ne_u32 vcc, 1, v12
  s_cbranch_vccz L_ok_98
  s_sub_u32 s3, s3, 1
  s_cbranch_scc1 L_end
  s_sleep 2
  s_branch L_spin_97
L_ok_98:
  s_branch L_fl_s2_1
.p2align 5
  s_nop 0
  s_nop 0
  s_nop 0
  s_nop 0
L_step_s3_0:
  s_waitcnt lgkmcnt(0)
  s_waitcnt vmcnt(2)
  v_max_u32 v15, v39, v43
  v_cmp_eq_u32 vcc, -1, v15
  ds_write_b64 v2, v[36:37] offset:32768
  s_cbranch_vccnz L_er0_s3_0
L_eb0_s3_0:
  v_smfmac_f32_16x16x64_bf16 v[88:91], v[36:39], v[44:51], v11
  ds_write_b64 v2, v[38:39] offset:32776
  v_smfmac_f32_16x16x64_bf16 v[88:91], v[40:43], v[52:59], v11
  ds_write_b64 v2, v[40:41] offset:33792
  v_smfmac_f32_16x16x64_bf16 v[84:87], v[36:39], v[60:67], v11
  ds_write_b64 v2, v[42:43] offset:33800
  v_smfmac_f32_16x16x64_bf16 v[84:87], v[40:43], v[92:99], v11
  s_add_u32 s69, s69, 16384
  s_add_u32 s78, s69, 8192
  v_smfmac_f32_16x16x64_bf16 v[80:83], v[36:39], v[100:107], v11
  s_add_u32 s70, s70, 2048
  s_min_u32 s70, s70, s77
  v_smfmac_f32_16x16x64_bf16 v[80:83], v[40:43], v[116:123], v11
  v_smfmac_f32_16x16x64_bf16 v[76:79], v[36:39], v[20:27], v11
  s_waitcnt lgkmcnt(0)
  s_barrier
  ds_read_b128 v[44:47], v4 offset:4096
  v_smfmac_f32_16x16x64_bf16 v[76:79], v[40:43], v[28:35], v11
  ds_read_b128 v[48:51], v4 offset:5120
  v_smfmac_f32_16x16x64_bf16 v[72:75], v[36:39], a[8:15], v11
  ds_read_b128 v[52:55], v4 offset:2048
  v_smfmac_f32_16x16x64_bf16 v[72:75], v[40:43], a[24:31], v11
  ds_read_b128 v[56:59], v4 offset:3072
  v_smfmac_f32_16x16x64_bf16 v[68:71], v[36:39], a[0:7], v11
  ds_read_b128 v[60:63], v4 offset:0
  v_smfmac_f32_16x16x64_bf16 v[68:71], v[40:43], a[16:23], v11
  ds_read_b128 v[64:67], v4 offset:1024
  s_waitcnt lgkmcnt(5)
  v_smfmac_f32_16x16x64_bf16 v[68:71], v[44:47], a[32:39], v11
  ds_read_b128 v[92:95], v2 offset:8192
  s_waitcnt lgkmcnt(5)
  v_smfmac_f32_16x16x64_bf16 v[68:71], v[48:51], a[48:55], v11
  ds_read_b128 v[96:99], v2 offset:9216
  s_waitcnt lgkmcnt(5)
  v_smfmac_f32_16x16x64_bf16 v[68:71], v[52:55], a[64:71], v11
  ds_read_b128 v[100:103], v2 offset:16384
  s_waitcnt lgkmcnt(5)
  v_smfmac_f32_16x16x64_bf16 v[68:71], v[56:59], a[80:87], v11
  s_waitcnt lgkmcnt(4)
  buffer_store_dword v14, v6, s[36:39], s72 offen sc1
  v_smfmac_f32_16x16x64_bf16 v[68:71], v[60:63], a[96:103], v11
  ds_read_b128 v[104:107], v2 offset:17408
  s_waitcnt lgkmcnt(4)
  v_smfmac_f32_16x16x64_bf16 v[68:71], v[64:67], a[112:119], v11
  ds_read_b128 v[116:119], v2 offset:24576
  v_smfmac_f32_16x16x64_bf16 v[72:75], v[44:47], a[40:47], v11
  ds_read_b128 v[120:123], v2 offset:25600
  v_smfmac_f32_16x16x64_bf16 v[72:75], v[48:51], a[56:63], v11
  buffer_load_dwordx4 v[20:23], v1, s[36:39], s69 offen offset:0 sc1
  v_add_f32 v124, v68, v69
  v_smfmac_f32_16x16x64_bf16 v[72:75], v[52:55], a[72:79], v11
  v_add_f32 v126, v70, v71
  v_smfmac_f32_16x16x64_bf16 v[72:75], v[56:59], a[88:95], v11
  v_mul_f32 v124, s73, v124
  v_smfmac_f32_16x16x64_bf16 v[72:75], v[60:63], a[104:111], v11
  v_mul_f32 v126, s73, v126
  v_smfmac_f32_16x16x64_bf16 v[72:75], v[64:67], a[120:127], v11
  buffer_load_dwordx4 v[24:27], v1, s[36:39], s69 offen offset:1024 sc1
  s_waitcnt lgkmcnt(0) vmcnt(3)
  v_smfmac_f32_16x16x64_bf16 v[76:79], v[44:47], v[108:115], v11
  ds_read_b128 v[108:111], v4 offset:9216
  v_smfmac_f32_16x16x64_bf16 v[76:79], v[48:51], v[92:99], v11
  ds_read_b128 v[92:95], v4 offset:8192
  v_add_f32 v125, v72, v73
  v_smfmac_f32_16x16x64_bf16 v[76:79], v[52:55], v[100:107], v11
  ds_read_b128 v[96:99], v4 offset:10240
  v_add_f32 v127, v74, v75
  v_smfmac_f32_16x16x64_bf16 v[76:79], v[56:59], v[116:123], v11
  buffer_load_dwordx4 v[28:31], v1, s[36:39], s78 offen offset:0 sc1
  v_mul_f32 v125, s73, v125
  v_smfmac_f32_16x16x64_bf16 v[76:79], v[60:63], a[160:167], v11
  ds_read_b128 v[100:103], v4 offset:12288
  v_mul_f32 v127, s73, v127
  v_smfmac_f32_16x16x64_bf16 v[76:79], v[64:67], a[176:183], v11
  ds_read_b128 v[104:107], v4 offset:14336
  v_cvt_pk_bf16_f32 v124, v124, v125
  v_smfmac_f32_16x16x64_bf16 v[80:83], v[44:47], a[128:135], v11
  ds_read_b128 v[112:115], v4 offset:11264
  v_cvt_pk_bf16_f32 v125, v126, v127
  v_smfmac_f32_16x16x64_bf16 v[80:83], v[48:51], a[136:143], v11
  ds_write2_b32 v7, v124, v125 offset0:0 offset1:4
  v_smfmac_f32_16x16x64_bf16 v[80:83], v[52:55], a[144:151], v11
  ds_read_b128 v[36:39], v4 offset:13312
  v_add_f32 v120, v76, v77
  v_smfmac_f32_16x16x64_bf16 v[80:83], v[56:59], a[152:159], v11
  ds_read_b128 v[40:43], v4 offset:15360
  v_add_f32 v122, v78, v79
  v_smfmac_f32_16x16x64_bf16 v[80:83], v[60:63], a[168:175], v11
  buffer_load_dword v12, off, s[36:39], s70 sc1
  v_smfmac_f32_16x16x64_bf16 v[80:83], v[64:67], a[184:191], v11
  s_waitcnt lgkmcnt(2)
  s_barrier
  v_smfmac_f32_16x16x64_bf16 v[84:87], v[44:47], a[192:199], v11
  ds_read_b128 v[68:71], v8 offset:0
  v_smfmac_f32_16x16x64_bf16 v[84:87], v[48:51], a[208:215], v11
  ds_read_b128 v[72:75], v8 offset:1024
  v_add_f32 v121, v80, v81
  v_smfmac_f32_16x16x64_bf16 v[84:87], v[52:55], a[224:231], v11
  ds_read_b128 v[76:79], v8 offset:2048
  v_add_f32 v123, v82, v83
  v_smfmac_f32_16x16x64_bf16 v[84:87], v[56:59], a[240:247], v11
  ds_read_b128 v[80:83], v8 offset:3072
  v_cvt_pk_bf16_f32 v120, v120, v121
  v_smfmac_f32_16x16x64_bf16 v[84:87], v[60:63], v[224:231], v11
  v_cvt_pk_bf16_f32 v121, v122, v123
  v_smfmac_f32_16x16x64_bf16 v[84:87], v[64:67], v[240:247], v11
  ds_write2_b32 v7, v120, v121 offset0:128 offset1:132
  v_smfmac_f32_16x16x64_bf16 v[88:91], v[44:47], a[200:207], v11
  v_smfmac_f32_16x16x64_bf16 v[88:91], v[48:51], a[216:223], v11
  v_cvt_pk_bf16_f32 v84, v84, v85
  v_smfmac_f32_16x16x64_bf16 v[88:91], v[52:55], a[232:239], v11
  buffer_load_dwordx4 v[32:35], v1, s[36:39], s78 offen offset:1024 sc1
  v_cvt_pk_bf16_f32 v85, v86, v87
  v_smfmac_f32_16x16x64_bf16 v[88:91], v[56:59], a[248:255], v11
  v_smfmac_f32_16x16x64_bf16 v[88:91], v[60:63], v[232:239], v11
  s_waitcnt lgkmcnt(0)
  s_barrier
  v_smfmac_f32_16x16x64_bf16 v[88:91], v[64:67], v[248:255], v11
  ds_read_b128 v[44:47], v8 offset:512
  v_mfma_f32_16x16x32_bf16 v[116:119], v[92:95], v[68:71], 0
  ds_read_b128 v[92:95], v2 offset:49152
  v_mfma_f32_16x16x32_bf16 v[116:119], v[96:99], v[72:75], v[116:119]
  ds_read_b128 v[48:51], v8 offset:1536
  v_cvt_pk_bf16_f32 v88, v88, v89
  v_mfma_f32_16x16x32_bf16 v[116:119], v[100:103], v[76:79], v[116:119]
  ds_read_b128 v[52:55], v8 offset:2560
  v_cvt_pk_bf16_f32 v89, v90, v91
  v_mfma_f32_16x16x32_bf16 v[116:119], v[104:107], v[80:83], v[116:119]
  ds_read_b128 v[56:59], v8 offset:3584
  v_mfma_f32_16x16x32_bf16 v[120:123], v[108:111], v[68:71], 0
  ds_read_b128 v[96:99], v2 offset:50176
  v_mfma_f32_16x16x32_bf16 v[120:123], v[112:115], v[72:75], v[120:123]
  v_exp_f32 v60, v116
  v_mfma_f32_16x16x32_bf16 v[120:123], v[36:39], v[76:79], v[120:123]
  v_exp_f32 v61, v117
  v_mfma_f32_16x16x32_bf16 v[120:123], v[40:43], v[80:83], v[120:123]
  s_waitcnt lgkmcnt(5)
  v_exp_f32 v62, v118
  v_mfma_f32_16x16x32_bf16 v[124:127], v[44:47], v[68:71], 0
  s_waitcnt lgkmcnt(3)
  v_exp_f32 v63, v119
  v_mfma_f32_16x16x32_bf16 v[124:127], v[48:51], v[72:75], v[124:127]
  s_waitcnt lgkmcnt(2)
  v_exp_f32 v64, v120
  v_mfma_f32_16x16x32_bf16 v[124:127], v[52:55], v[76:79], v[124:127]
  s_waitcnt lgkmcnt(1)
  v_exp_f32 v65, v121
  v_mfma_f32_16x16x32_bf16 v[124:127], v[56:59], v[80:83], v[124:127]
  s_waitcnt lgkmcnt(0)
  v_exp_f32 v66, v122
  v_exp_f32 v67, v123
  v_cvt_pk_bf16_f32 v100, v60, v64
  v_cvt_pk_bf16_f32 v101, v61, v65
  v_cvt_pk_bf16_f32 v102, v62, v66
  v_cvt_pk_bf16_f32 v103, v63, v67
  v_exp_f32 v86, v124
  v_mov_b64 v[76:77], 0
  v_mfma_f32_16x16x32_bf16 v[104:107], v[16:19], v[100:103], 0
  v_exp_f32 v87, v126
  v_mfma_f32_16x16x32_bf16 v[108:111], v[92:95], v[100:103], 0
  v_cvt_pk_bf16_f32 v90, v86, v86
  v_cvt_pk_bf16_f32 v91, v87, v87
  v_mfma_f32_16x16x32_bf16 v[112:115], v[96:99], v[100:103], 0
  v_mov_b64 v[78:79], 0
  v_mov_b64 v[80:81], 0
  v_mfma_f32_16x16x16_bf16 v[36:39], v[16:17], v[90:91], 0
  v_mov_b64 v[82:83], 0
  v_mfma_f32_16x16x16_bf16 v[108:111], v[84:85], v[90:91], v[108:111]
  v_mfma_f32_16x16x16_bf16 v[112:115], v[88:89], v[90:91], v[112:115]
  v_fma_f32 v106, v38, 0.5, v106
  v_rcp_f32 v107, v106
  v_mov_b32 v13, 0
  v_mul_f32 v108, v108, v107
  v_mul_f32 v109, v109, v107
  v_mul_f32 v110, v110, v107
  v_mul_f32 v111, v111, v107
  v_cvt_pk_bf16_f32 v100, v108, v109
  v_cvt_pk_bf16_f32 v101, v110, v111
  v_mul_f32 v112, v112, v107
  v_mul_f32 v113, v113, v107
  v_mul_f32 v114, v114, v107
  v_mul_f32 v115, v115, v107
  v_cvt_pk_bf16_f32 v102, v112, v113
  v_cvt_pk_bf16_f32 v103, v114, v115
  v_cndmask_b32 v36, v100, v102, s[84:85]
  v_cndmask_b32 v37, v101, v103, s[84:85]
  ds_write_b64 v10, v[36:37]
  v_max_f32 v104, v106, v107
  v_cmp_nge_f32 vcc, s86, v104
  v_mov_b64 v[44:45], 0
  v_mov_b64 v[46:47], 0
  v_mov_b64 v[48:49], 0
  v_mov_b64 v[50:51], 0
  s_cbranch_vccnz L_smr_s3_0
L_sm_s3_0:
  v_smfmac_f32_16x16x64_bf16 v[76:79], v[100:103], v[128:135], v11
  s_waitcnt lgkmcnt(0)
  s_barrier
  ds_read_b128 v[60:63], v8 offset:6144
  v_smfmac_f32_16x16x64_bf16 v[80:83], v[100:103], v[160:167], v11
  ds_read_b128 v[64:67], v8 offset:5120
  v_mov_b64 v[84:85], 0
  v_smfmac_f32_16x16x64_bf16 v[44:47], v[100:103], v[192:199], v11
  ds_read_b128 v[40:43], v8 offset:4096
  v_mov_b64 v[86:87], 0
  v_smfmac_f32_16x16x64_bf16 v[48:51], v[100:103], v[216:223], v11
  ds_read_b128 v[92:95], v3 offset:0
  s_waitcnt lgkmcnt(3)
  v_smfmac_f32_16x16x64_bf16 v[76:79], v[60:63], v[136:143], v11
  ds_read_b128 v[96:99], v3 offset:1024
  s_waitcnt lgkmcnt(3)
  v_smfmac_f32_16x16x64_bf16 v[76:79], v[64:67], v[144:151], v11
  ds_read_b128 v[52:55], v3 offset:8192
  s_waitcnt lgkmcnt(3)
  v_smfmac_f32_16x16x64_bf16 v[76:79], v[40:43], v[152:159], v11
  ds_read_b128 v[56:59], v3 offset:9216
  v_mov_b64 v[88:89], 0
  v_smfmac_f32_16x16x64_bf16 v[80:83], v[60:63], v[168:175], v11
  ds_read_b128 v[68:71], v3 offset:16384
  v_mov_b64 v[90:91], 0
  v_smfmac_f32_16x16x64_bf16 v[80:83], v[64:67], v[176:183], v11
  ds_read_b128 v[72:75], v3 offset:17408
  v_cvt_pk_bf16_f32 v76, v76, v77
  v_cvt_pk_bf16_f32 v77, v78, v79
  v_and_b32 v76, -2, v76
  v_smfmac_f32_16x16x64_bf16 v[80:83], v[40:43], v[184:191], v11
  s_waitcnt lgkmcnt(2)
  buffer_store_dwordx2 v[76:77], v5, s[36:39], 0 offen sc1
  v_smfmac_f32_16x16x64_bf16 v[44:47], v[60:63], v[200:207], v11
  ds_read_b128 v[116:119], v3 offset:24576
  v_mov_b64 v[76:77], 0
  v_mov_b64 v[78:79], 0
  v_smfmac_f32_16x16x64_bf16 v[44:47], v[64:67], v[208:215], v11
  ds_read_b128 v[120:123], v3 offset:25600
  v_cvt_pk_bf16_f32 v80, v80, v81
  v_cvt_pk_bf16_f32 v81, v82, v83
  v_and_b32 v80, -2, v80
  v_smfmac_f32_16x16x64_bf16 v[44:47], v[40:43], v[92:99], v11
  buffer_store_dwordx2 v[80:81], v5, s[36:39], s74 offen sc1
  v_smfmac_f32_16x16x64_bf16 v[48:51], v[60:63], v[52:59], v11
  s_waitcnt lgkmcnt(2)
  v_mov_b64 v[80:81], 0
  v_mov_b64 v[82:83], 0
  v_smfmac_f32_16x16x64_bf16 v[48:51], v[64:67], v[68:75], v11
  s_waitcnt lgkmcnt(0)
  v_cvt_pk_bf16_f32 v44, v44, v45
  v_cvt_pk_bf16_f32 v45, v46, v47
  v_and_b32 v44, -2, v44
  v_smfmac_f32_16x16x64_bf16 v[48:51], v[40:43], v[116:123], v11
  buffer_store_dwordx2 v[44:45], v5, s[36:39], s76 offen sc1
  v_mov_b64 v[68:69], 0
  v_mov_b64 v[70:71], 0
  v_mov_b32 v13, 0
  v_mov_b32 v13, 0
  v_cvt_pk_bf16_f32 v48, v48, v49
  v_cvt_pk_bf16_f32 v49, v50, v51
  v_and_b32 v48, -2, v48
  buffer_store_dwordx2 v[48:49], v5, s[36:39], s65 offen sc1
  v_mov_b64 v[72:73], 0
  v_mov_b64 v[74:75], 0
  s_waitcnt vmcnt(8)
  ds_write_b128 v2, v[20:23] offset:40960
  s_waitcnt vmcnt(7)
  ds_write_b128 v2, v[24:27] offset:41984
  s_waitcnt vmcnt(6)
  ds_write_b128 v2, v[28:31] offset:49152
  s_waitcnt vmcnt(4)
  ds_write_b128 v2, v[32:35] offset:50176
L_gap_gp30_6_99:
  s_nop 6
  s_nop 6
  s_nop 6
  s_nop 6
  s_nop 6
  s_nop 5
  buffer_load_dwordx4 v[108:111], v1, s[36:39], s64 offen offset:0 sc1
  buffer_load_dwordx4 v[112:115], v1, s[36:39], s64 offen offset:1024 sc1
  ds_read_b128 v[44:47], v1 offset:0
  ds_read_b128 v[48:51], v1 offset:1024
  ds_read_b128 v[52:55], v1 offset:8192
  ds_read_b128 v[56:59], v1 offset:9216
  ds_read_b128 v[60:63], v1 offset:16384
  ds_read_b128 v[64:67], v1 offset:17408
  ds_read_b128 v[92:95], v1 offset:24576
  ds_read_b128 v[96:99], v1 offset:25600
  ds_read_b128 v[100:103], v1 offset:32768
  ds_read_b128 v[104:107], v1 offset:33792
L_gap_gp31_3_100:
  s_nop 4
  s_nop 3
  s_nop 3
  buffer_load_dwordx4 v[36:39], v1, s[36:39], s64 offen offset:0 sc1
  buffer_load_dwordx4 v[40:43], v1, s[36:39], s64 offen offset:1024 sc1
.p2align 5
  s_nop 0
  s_nop 0
  s_nop 0
  s_nop 0
  s_waitcnt vmcnt(3)
  v_mfma_f32_16x16x32_bf16 v[124:127], v[16:19], v[108:111], 0
  v_bitop3_b32 v15, v108, v110, 1 bitop3:0xa8
  v_lshlrev_b32 v15, 1, v15
  s_waitcnt vmcnt(2)
  v_mfma_f32_16x16x32_bf16 v[124:127], v[16:19], v[112:115], v[124:127]
  v_bitop3_b32 v13, v112, v114, 1 bitop3:0xa8
  v_cmp_ne_u32 vcc, v13, v15
  s_cbranch_vccnz L_pb_s3_0r
L_pb_s3_0:
  v_add_f32_dpp v124, v124, v124 row_ror:4 row_mask:0xf bank_mask:0xf
  v_add_f32_dpp v125, v125, v125 row_ror:4 row_mask:0xf bank_mask:0xf
  s_nop 0
  v_add_f32_dpp v124, v124, v124 row_ror:8 row_mask:0xf bank_mask:0xf
  v_add_f32_dpp v125, v125, v125 row_ror:8 row_mask:0xf bank_mask:0xf
  v_cvt_pk_bf16_f32 v14, v124, v125
  v_min_u32 v14, -2, v14
  buffer_store_dword v14, v6, s[36:39], s87 offen sc1
  s_mov_b32 s72, s79
  s_add_u32 s79, s79, 8192
  s_cmp_eq_u32 s68, 62
  s_cbranch_scc1 L_chain_done
  s_add_u32 s68, s68, 2
  v_cmp_ne_u32 vcc, 1, v12
  v_mov_b32 v124, -1
  buffer_store_dword v124, v6, s[36:39], s71 offen sc1
  s_cbranch_vccnz L_flr_s3_0
L_fl_s3_0:
  s_xor_b32 s71, s71, 0x4000
  s_mov_b32 s75, s71
  s_add_u32 s92, s75, 0x1000
L_gap_gp32_3_101:
  s_nop 8
  s_nop 8
  s_nop 8
  buffer_load_dwordx4 v[36:39], v9, s[36:39], s93 offen offset:128 sc1
  buffer_load_dwordx4 v[40:43], v9, s[36:39], s93 offen offset:2176 sc1
  ds_read_b128 v[116:119], v1 offset:40960
  ds_read_b128 v[120:123], v1 offset:41984
  ds_read_b128 v[20:23], v1 offset:49152
  ds_read_b128 v[24:27], v1 offset:50176
  ds_read_b128 v[28:31], v1 offset:57344
  ds_read_b128 v[32:35], v1 offset:58368
  s_waitcnt vmcnt(4)
  ds_read_b128 v[108:111], v2 offset:0
  ds_read_b128 v[112:115], v2 offset:1024
L_gap_gp33_3_102:
  s_nop 3
  s_nop 3
  s_nop 3
  buffer_load_dwordx4 v[36:39], v9, s[36:39], s93 offen offset:128 sc1
  buffer_load_dwordx4 v[40:43], v9, s[36:39], s93 offen offset:2176 sc1
.p2align 5
  s_nop 0
  s_nop 0
  s_nop 0
  s_nop 0
L_step_s3_1:
  s_waitcnt lgkmcnt(0)
  s_waitcnt vmcnt(2)
  v_max_u32 v15, v39, v43
  v_cmp_eq_u32 vcc, -1, v15
  ds_write_b64 v2, v[36:37] offset:32768
  s_cbranch_vccnz L_er0_s3_1
L_eb0_s3_1:
  v_smfmac_f32_16x16x64_bf16 v[88:91], v[36:39], v[44:51], v11
  ds_write_b64 v2, v[38:39] offset:32776
  v_smfmac_f32_16x16x64_bf16 v[88:91], v[40:43], v[52:59], v11
  ds_write_b64 v2, v[40:41] offset:33792
  v_smfmac_f32_16x16x64_bf16 v[84:87], v[36:39], v[60:67], v11
  ds_write_b64 v2, v[42:43] offset:33800
  v_smfmac_f32_16x16x64_bf16 v[84:87], v[40:43], v[92:99], v11
  s_add_u32 s69, s69, 16384
  s_add_u32 s78, s69, 8192
  v_smfmac_f32_16x16x64_bf16 v[80:83], v[36:39], v[100:107], v11
  s_add_u32 s70, s70, 2048
  s_min_u32 s70, s70, s77
  v_smfmac_f32_16x16x64_bf16 v[80:83], v[40:43], v[116:123], v11
  v_smfmac_f32_16x16x64_bf16 v[76:79], v[36:39], v[20:27], v11
  s_waitcnt lgkmcnt(0)
  s_barrier
  ds_read_b128 v[44:47], v4 offset:4096
  v_smfmac_f32_16x16x64_bf16 v[76:79], v[40:43], v[28:35], v11
  ds_read_b128 v[48:51], v4 offset:5120
  v_smfmac_f32_16x16x64_bf16 v[72:75], v[36:39], a[8:15], v11
  ds_read_b128 v[52:55], v4 offset:2048
  v_smfmac_f32_16x16x64_bf16 v[72:75], v[40:43], a[24:31], v11
  ds_read_b128 v[56:59], v4 offset:3072
  v_smfmac_f32_16x16x64_bf16 v[68:71], v[36:39], a[0:7], v11
  ds_read_b128 v[60:63], v4 offset:0
  v_smfmac_f32_16x16x64_bf16 v[68:71], v[40:43], a[16:23], v11
  ds_read_b128 v[64:67], v4 offset:1024
  s_waitcnt lgkmcnt(5)
  v_smfmac_f32_16x16x64_bf16 v[68:71], v[44:47], a[32:39], v11
  ds_read_b128 v[92:95], v2 offset:8192
  s_waitcnt lgkmcnt(5)
  v_smfmac_f32_16x16x64_bf16 v[68:71], v[48:51], a[48:55], v11
  ds_read_b128 v[96:99], v2 offset:9216
  s_waitcnt lgkmcnt(5)
  v_smfmac_f32_16x16x64_bf16 v[68:71], v[52:55], a[64:71], v11
  ds_read_b128 v[100:103], v2 offset:16384
  s_waitcnt lgkmcnt(5)
  v_smfmac_f32_16x16x64_bf16 v[68:71], v[56:59], a[80:87], v11
  s_waitcnt lgkmcnt(4)
  buffer_store_dword v14, v6, s[36:39], s72 offen sc1
  v_smfmac_f32_16x16x64_bf16 v[68:71], v[60:63], a[96:103], v11
  ds_read_b128 v[104:107], v2 offset:17408
  s_waitcnt lgkmcnt(4)
  v_smfmac_f32_16x16x64_bf16 v[68:71], v[64:67], a[112:119], v11
  ds_read_b128 v[116:119], v2 offset:24576
  v_smfmac_f32_16x16x64_bf16 v[72:75], v[44:47], a[40:47], v11
  ds_read_b128 v[120:123], v2 offset:25600
  v_smfmac_f32_16x16x64_bf16 v[72:75], v[48:51], a[56:63], v11
  buffer_load_dwordx4 v[20:23], v1, s[36:39], s69 offen offset:0 sc1
  v_add_f32 v124, v68, v69
  v_smfmac_f32_16x16x64_bf16 v[72:75], v[52:55], a[72:79], v11
  v_add_f32 v126, v70, v71
  v_smfmac_f32_16x16x64_bf16 v[72:75], v[56:59], a[88:95], v11
  v_mul_f32 v124, s73, v124
  v_smfmac_f32_16x16x64_bf16 v[72:75], v[60:63], a[104:111], v11
  v_mul_f32 v126, s73, v126
  v_smfmac_f32_16x16x64_bf16 v[72:75], v[64:67], a[120:127], v11
  buffer_load_dwordx4 v[24:27], v1, s[36:39], s69 offen offset:1024 sc1
  s_waitcnt lgkmcnt(0) vmcnt(3)
  v_smfmac_f32_16x16x64_bf16 v[76:79], v[44:47], v[108:115], v11
  ds_read_b128 v[108:111], v4 offset:9216
  v_smfmac_f32_16x16x64_bf16 v[76:79], v[48:51], v[92:99], v11
  ds_read_b128 v[92:95], v4 offset:8192
  v_add_f32 v125, v72, v73
  v_smfmac_f32_16x16x64_bf16 v[76:79], v[52:55], v[100:107], v11
  ds_read_b128 v[96:99], v4 offset:10240
  v_add_f32 v127, v74, v75
  v_smfmac_f32_16x16x64_bf16 v[76:79], v[56:59], v[116:123], v11
  buffer_load_dwordx4 v[28:31], v1, s[36:39], s78 offen offset:0 sc1
  v_mul_f32 v125, s73, v125
  v_smfmac_f32_16x16x64_bf16 v[76:79], v[60:63], a[160:167], v11
  ds_read_b128 v[100:103], v4 offset:12288
  v_mul_f32 v127, s73, v127
  v_smfmac_f32_16x16x64_bf16 v[76:79], v[64:67], a[176:183], v11
  ds_read_b128 v[104:107], v4 offset:14336
  v_cvt_pk_bf16_f32 v124, v124, v125
  v_smfmac_f32_16x16x64_bf16 v[80:83], v[44:47], a[128:135], v11
  ds_read_b128 v[112:115], v4 offset:11264
  v_cvt_pk_bf16_f32 v125, v126, v127
  v_smfmac_f32_16x16x64_bf16 v[80:83], v[48:51], a[136:143], v11
  ds_write2_b32 v7, v124, v125 offset0:0 offset1:4
  v_smfmac_f32_16x16x64_bf16 v[80:83], v[52:55], a[144:151], v11
  ds_read_b128 v[36:39], v4 offset:13312
  v_add_f32 v120, v76, v77
  v_smfmac_f32_16x16x64_bf16 v[80:83], v[56:59], a[152:159], v11
  ds_read_b128 v[40:43], v4 offset:15360
  v_add_f32 v122, v78, v79
  v_smfmac_f32_16x16x64_bf16 v[80:83], v[60:63], a[168:175], v11
  buffer_load_dword v12, off, s[36:39], s70 sc1
  v_smfmac_f32_16x16x64_bf16 v[80:83], v[64:67], a[184:191], v11
  s_waitcnt lgkmcnt(2)
  s_barrier
  v_smfmac_f32_16x16x64_bf16 v[84:87], v[44:47], a[192:199], v11
  ds_read_b128 v[68:71], v8 offset:0
  v_smfmac_f32_16x16x64_bf16 v[84:87], v[48:51], a[208:215], v11
  ds_read_b128 v[72:75], v8 offset:1024
  v_add_f32 v121, v80, v81
  v_smfmac_f32_16x16x64_bf16 v[84:87], v[52:55], a[224:231], v11
  ds_read_b128 v[76:79], v8 offset:2048
  v_add_f32 v123, v82, v83
  v_smfmac_f32_16x16x64_bf16 v[84:87], v[56:59], a[240:247], v11
  ds_read_b128 v[80:83], v8 offset:3072
  v_cvt_pk_bf16_f32 v120, v120, v121
  v_smfmac_f32_16x16x64_bf16 v[84:87], v[60:63], v[224:231], v11
  v_cvt_pk_bf16_f32 v121, v122, v123
  v_smfmac_f32_16x16x64_bf16 v[84:87], v[64:67], v[240:247], v11
  ds_write2_b32 v7, v120, v121 offset0:128 offset1:132
  v_smfmac_f32_16x16x64_bf16 v[88:91], v[44:47], a[200:207], v11
  v_smfmac_f32_16x16x64_bf16 v[88:91], v[48:51], a[216:223], v11
  v_cvt_pk_bf16_f32 v84, v84, v85
  v_smfmac_f32_16x16x64_bf16 v[88:91], v[52:55], a[232:239], v11
  buffer_load_dwordx4 v[32:35], v1, s[36:39], s78 offen offset:1024 sc1
  v_cvt_pk_bf16_f32 v85, v86, v87
  v_smfmac_f32_16x16x64_bf16 v[88:91], v[56:59], a[248:255], v11
  v_smfmac_f32_16x16x64_bf16 v[88:91], v[60:63], v[232:239], v11
  s_waitcnt lgkmcnt(0)
  s_barrier
  v_smfmac_f32_16x16x64_bf16 v[88:91], v[64:67], v[248:255], v11
  ds_read_b128 v[44:47], v8 offset:512
  v_mfma_f32_16x16x32_bf16 v[116:119], v[92:95], v[68:71], 0
  ds_read_b128 v[92:95], v2 offset:49152
  v_mfma_f32_16x16x32_bf16 v[116:119], v[96:99], v[72:75], v[116:119]
  ds_read_b128 v[48:51], v8 offset:1536
  v_cvt_pk_bf16_f32 v88, v88, v89
  v_mfma_f32_16x16x32_bf16 v[116:119], v[100:103], v[76:79], v[116:119]
  ds_read_b128 v[52:55], v8 offset:2560
  v_cvt_pk_bf16_f32 v89, v90, v91
  v_mfma_f32_16x16x32_bf16 v[116:119], v[104:107], v[80:83], v[116:119]
  ds_read_b128 v[56:59], v8 offset:3584
  v_mfma_f32_16x16x32_bf16 v[120:123], v[108:111], v[68:71], 0
  ds_read_b128 v[96:99], v2 offset:50176
  v_mfma_f32_16x16x32_bf16 v[120:123], v[112:115], v[72:75], v[120:123]
  v_exp_f32 v60, v116
  v_mfma_f32_16x16x32_bf16 v[120:123], v[36:39], v[76:79], v[120:123]
  v_exp_f32 v61, v117
  v_mfma_f32_16x16x32_bf16 v[120:123], v[40:43], v[80:83], v[120:123]
  s_waitcnt lgkmcnt(5)
  v_exp_f32 v62, v118
  v_mfma_f32_16x16x32_bf16 v[124:127], v[44:47], v[68:71], 0
  s_waitcnt lgkmcnt(3)
  v_exp_f32 v63, v119
  v_mfma_f32_16x16x32_bf16 v[124:127], v[48:51], v[72:75], v[124:127]
  s_waitcnt lgkmcnt(2)
  v_exp_f32 v64, v120
  v_mfma_f32_16x16x32_bf16 v[124:127], v[52:55], v[76:79], v[124:127]
  s_waitcnt lgkmcnt(1)
  v_exp_f32 v65, v121
  v_mfma_f32_16x16x32_bf16 v[124:127], v[56:59], v[80:83], v[124:127]
  s_waitcnt lgkmcnt(0)
  v_exp_f32 v66, v122
  v_exp_f32 v67, v123
  v_cvt_pk_bf16_f32 v100, v60, v64
  v_cvt_pk_bf16_f32 v101, v61, v65
  v_cvt_pk_bf16_f32 v102, v62, v66
  v_cvt_pk_bf16_f32 v103, v63, v67
  v_exp_f32 v86, v124
  v_mov_b64 v[76:77], 0
  v_mfma_f32_16x16x32_bf16 v[104:107], v[16:19], v[100:103], 0
  v_exp_f32 v87, v126
  v_mfma_f32_16x16x32_bf16 v[108:111], v[92:95], v[100:103], 0
  v_cvt_pk_bf16_f32 v90, v86, v86
  v_cvt_pk_bf16_f32 v91, v87, v87
  v_mfma_f32_16x16x32_bf16 v[112:115], v[96:99], v[100:103], 0
  v_mov_b64 v[78:79], 0
  v_mov_b64 v[80:81], 0
  v_mfma_f32_16x16x16_bf16 v[36:39], v[16:17], v[90:91], 0
  v_mov_b64 v[82:83], 0
  v_mfma_f32_16x16x16_bf16 v[108:111], v[84:85], v[90:91], v[108:111]
  v_mfma_f32_16x16x16_bf16 v[112:115], v[88:89], v[90:91], v[112:115]
  v_fma_f32 v106, v38, 0.5, v106
  v_rcp_f32 v107, v106
  v_mov_b32 v13, 0
  v_mul_f32 v108, v108, v107
  v_mul_f32 v109, v109, v107
  v_mul_f32 v110, v110, v107
  v_mul_f32 v111, v111, v107
  v_cvt_pk_bf16_f32 v100, v108, v109
  v_cvt_pk_bf16_f32 v101, v110, v111
  v_mul_f32 v112, v112, v107
  v_mul_f32 v113, v113, v107
  v_mul_f32 v114, v114, v107
  v_mul_f32 v115, v115, v107
  v_cvt_pk_bf16_f32 v102, v112, v113
  v_cvt_pk_bf16_f32 v103, v114, v115
  v_cndmask_b32 v36, v100, v102, s[84:85]
  v_cndmask_b32 v37, v101, v103, s[84:85]
  ds_write_b64 v10, v[36:37]
  v_max_f32 v104, v106, v107
  v_cmp_nge_f32 vcc, s86, v104
  v_mov_b64 v[44:45], 0
  v_mov_b64 v[46:47], 0
  v_mov_b64 v[48:49], 0
  v_mov_b64 v[50:51], 0
  s_cbranch_vccnz L_smr_s3_1
L_sm_s3_1:
  v_smfmac_f32_16x16x64_bf16 v[76:79], v[100:103], v[128:135], v11
  s_waitcnt lgkmcnt(0)
  s_barrier
  ds_read_b128 v[60:63], v8 offset:6144
  v_smfmac_f32_16x16x64_bf16 v[80:83], v[100:103], v[160:167], v11
  ds_read_b128 v[64:67], v8 offset:5120
  v_mov_b64 v[84:85], 0
  v_smfmac_f32_16x16x64_bf16 v[44:47], v[100:103], v[192:199], v11
  ds_read_b128 v[40:43], v8 offset:4096
  v_mov_b64 v[86:87], 0
  v_smfmac_f32_16x16x64_bf16 v[48:51], v[100:103], v[216:223], v11
  ds_read_b128 v[92:95], v3 offset:0
  s_waitcnt lgkmcnt(3)
  v_smfmac_f32_16x16x64_bf16 v[76:79], v[60:63], v[136:143], v11
  ds_read_b128 v[96:99], v3 offset:1024
  s_waitcnt lgkmcnt(3)
  v_smfmac_f32_16x16x64_bf16 v[76:79], v[64:67], v[144:151], v11
  ds_read_b128 v[52:55], v3 offset:8192
  s_waitcnt lgkmcnt(3)
  v_smfmac_f32_16x16x64_bf16 v[76:79], v[40:43], v[152:159], v11
  ds_read_b128 v[56:59], v3 offset:9216
  v_mov_b64 v[88:89], 0
  v_smfmac_f32_16x16x64_bf16 v[80:83], v[60:63], v[168:175], v11
  ds_read_b128 v[68:71], v3 offset:16384
  v_mov_b64 v[90:91], 0
  v_smfmac_f32_16x16x64_bf16 v[80:83], v[64:67], v[176:183], v11
  ds_read_b128 v[72:75], v3 offset:17408
  v_cvt_pk_bf16_f32 v76, v76, v77
  v_cvt_pk_bf16_f32 v77, v78, v79
  v_or_b32 v76, 1, v76
  v_smfmac_f32_16x16x64_bf16 v[80:83], v[40:43], v[184:191], v11
  s_waitcnt lgkmcnt(2)
  buffer_store_dwordx2 v[76:77], v5, s[36:39], 0 offen sc1
  v_smfmac_f32_16x16x64_bf16 v[44:47], v[60:63], v[200:207], v11
  ds_read_b128 v[116:119], v3 offset:24576
  v_mov_b64 v[76:77], 0
  v_mov_b64 v[78:79], 0
  v_smfmac_f32_16x16x64_bf16 v[44:47], v[64:67], v[208:215], v11
  ds_read_b128 v[120:123], v3 offset:25600
  v_cvt_pk_bf16_f32 v80, v80, v81
  v_cvt_pk_bf16_f32 v81, v82, v83
  v_or_b32 v80, 1, v80
  v_smfmac_f32_16x16x64_bf16 v[44:47], v[40:43], v[92:99], v11
  buffer_store_dwordx2 v[80:81], v5, s[36:39], s74 offen sc1
  v_smfmac_f32_16x16x64_bf16 v[48:51], v[60:63], v[52:59], v11
  s_waitcnt lgkmcnt(2)
  v_mov_b64 v[80:81], 0
  v_mov_b64 v[82:83], 0
  v_smfmac_f32_16x16x64_bf16 v[48:51], v[64:67], v[68:75], v11
  s_waitcnt lgkmcnt(0)
  v_cvt_pk_bf16_f32 v44, v44, v45
  v_cvt_pk_bf16_f32 v45, v46, v47
  v_or_b32 v44, 1, v44
  v_smfmac_f32_16x16x64_bf16 v[48:51], v[40:43], v[116:123], v11
  buffer_store_dwordx2 v[44:45], v5, s[36:39], s76 offen sc1
  v_mov_b64 v[68:69], 0
  v_mov_b64 v[70:71], 0
  v_mov_b32 v13, 0
  v_mov_b32 v13, 0
  v_cvt_pk_bf16_f32 v48, v48, v49
  v_cvt_pk_bf16_f32 v49, v50, v51
  v_or_b32 v48, 1, v48
  buffer_store_dwordx2 v[48:49], v5, s[36:39], s65 offen sc1
  v_mov_b64 v[72:73], 0
  v_mov_b64 v[74:75], 0
  s_waitcnt vmcnt(8)
  ds_write_b128 v2, v[20:23] offset:40960
  s_waitcnt vmcnt(7)
  ds_write_b128 v2, v[24:27] offset:41984
  s_waitcnt vmcnt(6)
  ds_write_b128 v2, v[28:31] offset:49152
  s_waitcnt vmcnt(4)
  ds_write_b128 v2, v[32:35] offset:50176
L_gap_gp30_6_103:
  s_nop 6
  s_nop 6
  s_nop 6
  s_nop 6
  s_nop 6
  s_nop 5
  buffer_load_dwordx4 v[108:111], v1, s[36:39], s64 offen offset:0 sc1
  buffer_load_dwordx4 v[112:115], v1, s[36:39], s64 offen offset:1024 sc1
  ds_read_b128 v[44:47], v1 offset:0
  ds_read_b128 v[48:51], v1 offset:1024
  ds_read_b128 v[52:55], v1 offset:8192
  ds_read_b128 v[56:59], v1 offset:9216
  ds_read_b128 v[60:63], v1 offset:16384
  ds_read_b128 v[64:67], v1 offset:17408
  ds_read_b128 v[92:95], v1 offset:24576
  ds_read_b128 v[96:99], v1 offset:25600
  ds_read_b128 v[100:103], v1 offset:32768
  ds_read_b128 v[104:107], v1 offset:33792
L_gap_gp31_3_104:
  s_nop 4
  s_nop 3
  s_nop 3
  buffer_load_dwordx4 v[36:39], v1, s[36:39], s64 offen offset:0 sc1
  buffer_load_dwordx4 v[40:43], v1, s[36:39], s64 offen offset:1024 sc1
.p2align 5
  s_nop 0
  s_nop 0
  s_nop 0
  s_nop 0
  s_waitcnt vmcnt(3)
  v_mfma_f32_16x16x32_bf16 v[124:127], v[16:19], v[108:111], 0
  v_bitop3_b32 v15, v108, v110, 1 bitop3:0x80
  v_sub_u32 v15, 2, v15
  s_waitcnt vmcnt(2)
  v_mfma_f32_16x16x32_bf16 v[124:127], v[16:19], v[112:115], v[124:127]
  v_bitop3_b32 v13, v112, v114, 1 bitop3:0x80
  v_cmp_ne_u32 vcc, v13, v15
  s_cbranch_vccnz L_pb_s3_1r
L_pb_s3_1:
  v_add_f32_dpp v124, v124, v124 row_ror:4 row_mask:0xf bank_mask:0xf
  v_add_f32_dpp v125, v125, v125 row_ror:4 row_mask:0xf bank_mask:0xf
  s_nop 0
  v_add_f32_dpp v124, v124, v124 row_ror:8 row_mask:0xf bank_mask:0xf
  v_add_f32_dpp v125, v125, v125 row_ror:8 row_mask:0xf bank_mask:0xf
  v_cvt_pk_bf16_f32 v14, v124, v125
  v_min_u32 v14, -2, v14
  buffer_store_dword v14, v6, s[36:39], s71 offen sc1
  s_mov_b32 s72, s79
  s_add_u32 s79, s79, 8192
  v_cmp_ne_u32 vcc, 1, v12
  v_mov_b32 v124, -1
  buffer_store_dword v124, v6, s[36:39], s87 offen sc1
  s_cbranch_vccnz L_flr_s3_1
L_fl_s3_1:
  s_xor_b32 s87, s87, 0x4000
  s_xor_b32 s93, s93, 0x4000
L_gap_gp32_3_105:
  s_nop 8
  s_nop 8
  s_nop 8
  buffer_load_dwordx4 v[36:39], v9, s[36:39], s92 offen offset:128 sc1
  buffer_load_dwordx4 v[40:43], v9, s[36:39], s92 offen offset:2176 sc1
  ds_read_b128 v[116:119], v1 offset:40960
  ds_read_b128 v[120:123], v1 offset:41984
  ds_read_b128 v[20:23], v1 offset:49152
  ds_read_b128 v[24:27], v1 offset:50176
  ds_read_b128 v[28:31], v1 offset:57344
  ds_read_b128 v[32:35], v1 offset:58368
  s_waitcnt vmcnt(4)
  ds_read_b128 v[108:111], v2 offset:0
  ds_read_b128 v[112:115], v2 offset:1024
L_gap_gp33_3_106:
  s_nop 3
  s_nop 3
  s_nop 3
  buffer_load_dwordx4 v[36:39], v9, s[36:39], s92 offen offset:128 sc1
  buffer_load_dwordx4 v[40:43], v9, s[36:39], s92 offen offset:2176 sc1
  s_branch L_step_s3_0
L_er0_s3_0:
  buffer_load_dwordx4 v[36:39], v9, s[36:39], s92 offen offset:128 sc1
  buffer_load_dwordx4 v[40:43], v9, s[36:39], s92 offen offset:2176 sc1
  s_waitcnt vmcnt(2)
  v_max_u32 v15, v39, v43
  v_cmp_eq_u32 vcc, -1, v15
  s_cbranch_vccz L_eb0_s3_0o
L_er0_s3_0s:
  buffer_load_dwordx4 v[36:39], v9, s[36:39], s92 offen offset:128 sc1
  buffer_load_dwordx4 v[40:43], v9, s[36:39], s92 offen offset:2176 sc1
  s_waitcnt vmcnt(2)
  v_max_u32 v15, v39, v43
  v_cmp_eq_u32 vcc, -1, v15
  s_cbranch_vccz L_eb0_s3_0o
  s_sub_u32 s3, s3, 1
  s_cbranch_scc1 L_end
  s_branch L_er0_s3_0s
L_eb0_s3_0o:
  ds_write_b64 v2, v[36:37] offset:32768
  s_branch L_eb0_s3_0
L_smr_s3_0:
  v_max_f32 v86, v116, v120
  v_max3_f32 v86, v86, v117, v121
  v_max3_f32 v86, v86, v118, v122
  v_max3_f32 v86, v86, v119, v123
  v_max3_f32 v86, v86, v124, v126
  v_mov_b32 v87, v86
  s_nop 1
  v_permlane32_swap_b32 v86, v87
  v_max_f32 v86, v86, v87
  v_mov_b32 v87, v86
  s_nop 1
  v_permlane16_swap_b32 v86, v87
  v_max_f32 v86, v86, v87
  v_sub_f32 v116, v116, v86
  v_sub_f32 v120, v120, v86
  v_sub_f32 v117, v117, v86
  v_sub_f32 v121, v121, v86
  v_sub_f32 v118, v118, v86
  v_sub_f32 v122, v122, v86
  v_sub_f32 v119, v119, v86
  v_sub_f32 v123, v123, v86
  v_sub_f32 v124, v124, v86
  v_sub_f32 v126, v126, v86
  v_exp_f32 v116, v116
  v_exp_f32 v120, v120
  v_exp_f32 v117, v117
  v_exp_f32 v121, v121
  v_exp_f32 v118, v118
  v_exp_f32 v122, v122
  v_exp_f32 v119, v119
  v_exp_f32 v123, v123
  v_exp_f32 v124, v124
  v_exp_f32 v126, v126
  v_cvt_pk_bf16_f32 v100, v116, v120
  v_cvt_pk_bf16_f32 v101, v117, v121
  v_cvt_pk_bf16_f32 v102, v118, v122
  v_cvt_pk_bf16_f32 v103, v119, v123
  v_cvt_pk_bf16_f32 v90, v124, v124
  v_cvt_pk_bf16_f32 v91, v126, v126
  s_waitcnt lgkmcnt(0)
  v_mov_b64 v[76:77], 0
  v_mov_b64 v[78:79], 0
  v_mfma_f32_16x16x32_bf16 v[104:107], v[16:19], v[100:103], 0
  v_mfma_f32_16x16x32_bf16 v[108:111], v[92:95], v[100:103], 0
  v_mfma_f32_16x16x32_bf16 v[112:115], v[96:99], v[100:103], 0
  v_mfma_f32_16x16x16_bf16 v[36:39], v[16:17], v[90:91], 0
  v_mfma_f32_16x16x16_bf16 v[108:111], v[84:85], v[90:91], v[108:111]
  v_mfma_f32_16x16x16_bf16 v[112:115], v[88:89], v[90:91], v[112:115]
  v_fma_f32 v106, v38, 0.5, v106
  v_rcp_f32 v107, v106
  s_nop 0
  v_mul_f32 v108, v108, v107
  v_mul_f32 v109, v109, v107
  v_mul_f32 v110, v110, v107
  v_mul_f32 v111, v111, v107
  v_cvt_pk_bf16_f32 v100, v108, v109
  v_cvt_pk_bf16_f32 v101, v110, v111
  v_mul_f32 v112, v112, v107
  v_mul_f32 v113, v113, v107
  v_mul_f32 v114, v114, v107
  v_mul_f32 v115, v115, v107
  v_cvt_pk_bf16_f32 v102, v112, v113
  v_cvt_pk_bf16_f32 v103, v114, v115
  v_cndmask_b32 v36, v100, v102, s[84:85]
  v_cndmask_b32 v37, v101, v103, s[84:85]
  ds_write_b64 v10, v[36:37]
  s_branch L_sm_s3_0
L_pb_s3_0r:
  buffer_load_dwordx4 v[108:111], v1, s[36:39], s64 offen offset:0 sc1
  buffer_load_dwordx4 v[112:115], v1, s[36:39], s64 offen offset:1024 sc1
  s_waitcnt vmcnt(3)
  v_mfma_f32_16x16x32_bf16 v[124:127], v[16:19], v[36:39], 0
  v_bitop3_b32 v15, v36, v38, 1 bitop3:0xa8
  v_lshlrev_b32 v15, 1, v15
  s_waitcnt vmcnt(2)
  v_mfma_f32_16x16x32_bf16 v[124:127], v[16:19], v[40:43], v[124:127]
  v_bitop3_b32 v13, v40, v42, 1 bitop3:0xa8
  v_cmp_ne_u32 vcc, v13, v15
  s_cbranch_vccz L_pb_s3_0
L_pb_s3_0s:
  buffer_load_dwordx4 v[36:39], v1, s[36:39], s64 offen offset:0 sc1
  buffer_load_dwordx4 v[40:43], v1, s[36:39], s64 offen offset:1024 sc1
  s_waitcnt vmcnt(3)
  v_mfma_f32_16x16x32_bf16 v[124:127], v[16:19], v[108:111], 0
  v_bitop3_b32 v15, v108, v110, 1 bitop3:0xa8
  v_lshlrev_b32 v15, 1, v15
  s_waitcnt vmcnt(2)
  v_mfma_f32_16x16x32_bf16 v[124:127], v[16:19], v[112:115], v[124:127]
  v_bitop3_b32 v13, v112, v114, 1 bitop3:0xa8
  v_cmp_ne_u32 vcc, v13, v15
  s_cbranch_vccz L_pb_s3_0
  buffer_load_dwordx4 v[108:111], v1, s[36:39], s64 offen offset:0 sc1
  buffer_load_dwordx4 v[112:115], v1, s[36:39], s64 offen offset:1024 sc1
  s_waitcnt vmcnt(3)
  v_mfma_f32_16x16x32_bf16 v[124:127], v[16:19], v[36:39], 0
  v_bitop3_b32 v15, v36, v38, 1 bitop3:0xa8
  v_lshlrev_b32 v15, 1, v15
  s_waitcnt vmcnt(2)
  v_mfma_f32_16x16x32_bf16 v[124:127], v[16:19], v[40:43], v[124:127]
  v_bitop3_b32 v13, v40, v42, 1 bitop3:0xa8
  v_cmp_ne_u32 vcc, v13, v15
  s_cbranch_vccz L_pb_s3_0
  s_sub_u32 s3, s3, 1
  s_cbranch_scc1 L_end
  s_branch L_pb_s3_0s
L_flr_s3_0:
L_spin_107:
  buffer_load_dword v12, off, s[36:39], s70 sc1
  s_waitcnt vmcnt(0)
  v_cmp_ne_u32 vcc, 1, v12
  s_cbranch_vccz L_ok_108
  s_sub_u32 s3, s3, 1
  s_cbranch_scc1 L_end
  s_sleep 2
  s_branch L_spin_107
L_ok_108:
  s_branch L_fl_s3_0
L_er0_s3_1:
  buffer_load_dwordx4 v[36:39], v9, s[36:39], s93 offen offset:128 sc1
  buffer_load_dwordx4 v[40:43], v9, s[36:39], s93 offen offset:2176 sc1
  s_waitcnt vmcnt(2)
  v_max_u32 v15, v39, v43
  v_cmp_eq_u32 vcc, -1, v15
  s_cbranch_vccz L_eb0_s3_1o
L_er0_s3_1s:
  buffer_load_dwordx4 v[36:39], v9, s[36:39], s93 offen offset:128 sc1
  buffer_load_dwordx4 v[40:43], v9, s[36:39], s93 offen offset:2176 sc1
  s_waitcnt vmcnt(2)
  v_max_u32 v15, v39, v43
  v_cmp_eq_u32 vcc, -1, v15
  s_cbranch_vccz L_eb0_s3_1o
  s_sub_u32 s3, s3, 1
  s_cbranch_scc1 L_end
  s_branch L_er0_s3_1s
L_eb0_s3_1o:
  ds_write_b64 v2, v[36:37] offset:32768
  s_branch L_eb0_s3_1
L_smr_s3_1:
  v_max_f32 v86, v116, v120
  v_max3_f32 v86, v86, v117, v121
  v_max3_f32 v86, v86, v118, v122
  v_max3_f32 v86, v86, v119, v123
  v_max3_f32 v86, v86, v124, v126
  v_mov_b32 v87, v86
  s_nop 1
  v_permlane32_swap_b32 v86, v87
  v_max_f32 v86, v86, v87
  v_mov_b32 v87, v86
  s_nop 1
  v_permlane16_swap_b32 v86, v87
  v_max_f32 v86, v86, v87
  v_sub_f32 v116, v116, v86
  v_sub_f32 v120, v120, v86
  v_sub_f32 v117, v117, v86
  v_sub_f32 v121, v121, v86
  v_sub_f32 v118, v118, v86
  v_sub_f32 v122, v122, v86
  v_sub_f32 v119, v119, v86
  v_sub_f32 v123, v123, v86
  v_sub_f32 v124, v124, v86
  v_sub_f32 v126, v126, v86
  v_exp_f32 v116, v116
  v_exp_f32 v120, v120
  v_exp_f32 v117, v117
  v_exp_f32 v121, v121
  v_exp_f32 v118, v118
  v_exp_f32 v122, v122
  v_exp_f32 v119, v119
  v_exp_f32 v123, v123
  v_exp_f32 v124, v124
  v_exp_f32 v126, v126
  v_cvt_pk_bf16_f32 v100, v116, v120
  v_cvt_pk_bf16_f32 v101, v117, v121
  v_cvt_pk_bf16_f32 v102, v118, v122
  v_cvt_pk_bf16_f32 v103, v119, v123
  v_cvt_pk_bf16_f32 v90, v124, v124
  v_cvt_pk_bf16_f32 v91, v126, v126
  s_waitcnt lgkmcnt(0)
  v_mov_b64 v[76:77], 0
  v_mov_b64 v[78:79], 0
  v_mfma_f32_16x16x32_bf16 v[104:107], v[16:19], v[100:103], 0
  v_mfma_f32_16x16x32_bf16 v[108:111], v[92:95], v[100:103], 0
  v_mfma_f32_16x16x32_bf16 v[112:115], v[96:99], v[100:103], 0
  v_mfma_f32_16x16x16_bf16 v[36:39], v[16:17], v[90:91], 0
  v_mfma_f32_16x16x16_bf16 v[108:111], v[84:85], v[90:91], v[108:111]
  v_mfma_f32_16x16x16_bf16 v[112:115], v[88:89], v[90:91], v[112:115]
  v_fma_f32 v106, v38, 0.5, v106
  v_rcp_f32 v107, v106
  s_nop 0
  v_mul_f32 v108, v108, v107
  v_mul_f32 v109, v109, v107
  v_mul_f32 v110, v110, v107
  v_mul_f32 v111, v111, v107
  v_cvt_pk_bf16_f32 v100, v108, v109
  v_cvt_pk_bf16_f32 v101, v110, v111
  v_mul_f32 v112, v112, v107
  v_mul_f32 v113, v113, v107
  v_mul_f32 v114, v114, v107
  v_mul_f32 v115, v115, v107
  v_cvt_pk_bf16_f32 v102, v112, v113
  v_cvt_pk_bf16_f32 v103, v114, v115
  v_cndmask_b32 v36, v100, v102, s[84:85]
  v_cndmask_b32 v37, v101, v103, s[84:85]
  ds_write_b64 v10, v[36:37]
  s_branch L_sm_s3_1
L_pb_s3_1r:
  buffer_load_dwordx4 v[108:111], v1, s[36:39], s64 offen offset:0 sc1
  buffer_load_dwordx4 v[112:115], v1, s[36:39], s64 offen offset:1024 sc1
  s_waitcnt vmcnt(3)
  v_mfma_f32_16x16x32_bf16 v[124:127], v[16:19], v[36:39], 0
  v_bitop3_b32 v15, v36, v38, 1 bitop3:0x80
  v_sub_u32 v15, 2, v15
  s_waitcnt vmcnt(2)
  v_mfma_f32_16x16x32_bf16 v[124:127], v[16:19], v[40:43], v[124:127]
  v_bitop3_b32 v13, v40, v42, 1 bitop3:0x80
  v_cmp_ne_u32 vcc, v13, v15
  s_cbranch_vccz L_pb_s3_1
L_pb_s3_1s:
  buffer_load_dwordx4 v[36:39], v1, s[36:39], s64 offen offset:0 sc1
  buffer_load_dwordx4 v[40:43], v1, s[36:39], s64 offen offset:1024 sc1
  s_waitcnt vmcnt(3)
  v_mfma_f32_16x16x32_bf16 v[124:127], v[16:19], v[108:111], 0
  v_bitop3_b32 v15, v108, v110, 1 bitop3:0x80
  v_sub_u32 v15, 2, v15
  s_waitcnt vmcnt(2)
  v_mfma_f32_16x16x32_bf16 v[124:127], v[16:19], v[112:115], v[124:127]
  v_bitop3_b32 v13, v112, v114, 1 bitop3:0x80
  v_cmp_ne_u32 vcc, v13, v15
  s_cbranch_vccz L_pb_s3_1
  buffer_load_dwordx4 v[108:111], v1, s[36:39], s64 offen offset:0 sc1
  buffer_load_dwordx4 v[112:115], v1, s[36:39], s64 offen offset:1024 sc1
  s_waitcnt vmcnt(3)
  v_mfma_f32_16x16x32_bf16 v[124:127], v[16:19], v[36:39], 0
  v_bitop3_b32 v15, v36, v38, 1 bitop3:0x80
  v_sub_u32 v15, 2, v15
  s_waitcnt vmcnt(2)
  v_mfma_f32_16x16x32_bf16 v[124:127], v[16:19], v[40:43], v[124:127]
  v_bitop3_b32 v13, v40, v42, 1 bitop3:0x80
  v_cmp_ne_u32 vcc, v13, v15
  s_cbranch_vccz L_pb_s3_1
  s_sub_u32 s3, s3, 1
  s_cbranch_scc1 L_end
  s_branch L_pb_s3_1s
L_flr_s3_1:
L_spin_109:
  buffer_load_dword v12, off, s[36:39], s70 sc1
  s_waitcnt vmcnt(0)
  v_cmp_ne_u32 vcc, 1, v12
  s_cbranch_vccz L_ok_110
  s_sub_u32 s3, s3, 1
  s_cbranch_scc1 L_end
  s_sleep 2
  s_branch L_spin_109
L_ok_110:
  s_branch L_fl_s3_1
L_chain_done:
  buffer_store_dword v14, v6, s[36:39], s72 offen sc1
  s_waitcnt vmcnt(0)
  s_endpgm
L_end:
  s_endpgm
L_restart:
  s_mov_b32 s100, s18
  s_waitcnt vmcnt(0) lgkmcnt(0)
  s_barrier
  s_branch L_dispatch
L_roles:
  s_waitcnt lgkmcnt(0)
  s_mov_b32 s3, 0x80000
  s_mov_b32 s16, 0x05040100
  s_mov_b32 s17, 0x07060302
  s_mov_b32 s36, s32
  s_mov_b32 s37, s33
  s_mov_b32 s38, 0x10000000
  s_mov_b32 s39, 0x20000
  s_mov_b32 s40, s30
  s_mov_b32 s41, s31
  s_mov_b32 s42, 0x100
  s_mov_b32 s43, 0x20000
  s_cmp_lg_u32 s2, 0
  s_cbranch_scc1 L_notwg0_111
  v_mov_b32 v1, s100
  s_mov_b64 exec, 1
  buffer_store_dword v1, off, s[40:43], 0 offset:4 sc1
  s_mov_b64 exec, -1
L_notwg0_111:
  s_mov_b32 s101, 0
  s_cmp_eq_u32 s60, 4
  s_cbranch_scc1 L_helper
  s_cmp_gt_u32 s60, 4
  s_cbranch_scc1 L_final
L_head:
  s_getpc_b64 s[62:63]
L_pc_112:
  s_lshl_b32 s61, s34, 12
  v_lshl_add_u32 v6, v0, 6, s61
  v_min_u32 v7, L_head_ready-L_pc_112-4, v6
  v_mov_b32 v5, s63
  v_add_co_u32 v4, vcc, s62, v7
  s_nop 1
  v_addc_co_u32 v5, vcc, 0, v5, vcc
  global_load_dword v8, v[4:5], off
  s_sub_u32 s18, s60, 1
  s_lshl_b32 s18, s18, 5
  s_add_u32 s18, s18, s35
  s_mul_i32 s64, s18, 21846
  s_lshr_b32 s64, s64, 16
  s_mul_i32 s19, s64, 3
  s_sub_u32 s65, s18, s19
  s_sub_u32 s19, 2, s65
  s_cmp_ge_u32 s18, 48
  s_cselect_b32 s65, s19, s65
  s_add_u32 s64, s64, 1
  s_and_b32 s64, s64, 31
  s_lshl_b32 s83, s65, 20
  s_mov_b32 s44, s8
  s_mov_b32 s45, s9
  s_mov_b32 s46, 0x400000
  s_mov_b32 s47, 0x20000
  s_mov_b32 s48, s10
  s_mov_b32 s49, s11
  s_mov_b32 s50, 0x400000
  s_mov_b32 s51, 0x20000
  s_mov_b32 s52, s12
  s_mov_b32 s53, s13
  s_mov_b32 s54, 0x400000
  s_mov_b32 s55, 0x20000
  s_and_b32 s18, s34, 1
  s_lshr_b32 s19, s34, 1
  s_lshl_b32 s61, s18, 1
  s_lshl_b32 s62, s19, 3
  s_add_u32 s61, s61, s62
  s_lshl_b32 s62, s61, 10
  s_lshl_b32 s61, s61, 15
  s_lshl_b32 s63, s64, 8
  s_add_u32 s61, s61, s63
  s_lshl_b32 s18, s18, 2
  s_lshl_b32 s19, s19, 3
  s_add_u32 s18, s18, s19
  v_lshrrev_b32 v123, 4, v0
  v_and_b32 v121, 1, v123
  v_lshl_add_u32 v121, v121, 1, s18
  v_and_b32 v122, 15, v0
  v_xor_b32 v121, v121, v122
  v_lshlrev_b32 v121, 4, v121
  v_lshlrev_b32 v120, 13, v123
  v_add3_u32 v120, v120, v121, s61
  s_add_u32 m0, s62, 0x0
  s_xor_b32 s63, s83, 0x0
  buffer_load_dwordx4 v120, s[52:55], s63 offen lds
  s_add_u32 m0, s62, 0x400
  s_xor_b32 s63, s83, 0x8000
  buffer_load_dwordx4 v120, s[52:55], s63 offen lds
  s_add_u32 m0, s62, 0x1000
  s_xor_b32 s63, s83, 0x20000
  buffer_load_dwordx4 v120, s[52:55], s63 offen lds
  s_add_u32 m0, s62, 0x1400
  s_xor_b32 s63, s83, 0x28000
  buffer_load_dwordx4 v120, s[52:55], s63 offen lds
  s_add_u32 m0, s62, 0x4000
  s_xor_b32 s63, s83, 0x80000
  buffer_load_dwordx4 v120, s[52:55], s63 offen lds
  s_add_u32 m0, s62, 0x4400
  s_xor_b32 s63, s83, 0x88000
  buffer_load_dwordx4 v120, s[52:55], s63 offen lds
  s_add_u32 m0, s62, 0x5000
  s_xor_b32 s63, s83, 0xa0000
  buffer_load_dwordx4 v120, s[52:55], s63 offen lds
  s_add_u32 m0, s62, 0x5400
  s_xor_b32 s63, s83, 0xa8000
  buffer_load_dwordx4 v120, s[52:55], s63 offen lds
  s_add_u32 m0, s62, 0x8000
  s_xor_b32 s63, s83, 0x100000
  buffer_load_dwordx4 v120, s[52:55], s63 offen lds
  s_add_u32 m0, s62, 0x8400
  s_xor_b32 s63, s83, 0x108000
  buffer_load_dwordx4 v120, s[52:55], s63 offen lds
  s_add_u32 m0, s62, 0x9000
  s_xor_b32 s63, s83, 0x120000
  buffer_load_dwordx4 v120, s[52:55], s63 offen lds
  s_add_u32 m0, s62, 0x9400
  s_xor_b32 s63, s83, 0x128000
  buffer_load_dwordx4 v120, s[52:55], s63 offen lds
  s_add_u32 m0, s62, 0xc000
  s_xor_b32 s63, s83, 0x180000
  buffer_load_dwordx4 v120, s[52:55], s63 offen lds
  s_add_u32 m0, s62, 0xc400
  s_xor_b32 s63, s83, 0x188000
  buffer_load_dwordx4 v120, s[52:55], s63 offen lds
  s_add_u32 m0, s62, 0xd000
  s_xor_b32 s63, s83, 0x1a0000
  buffer_load_dwordx4 v120, s[52:55], s63 offen lds
  s_add_u32 m0, s62, 0xd400
  s_xor_b32 s63, s83, 0x1a8000
  buffer_load_dwordx4 v120, s[52:55], s63 offen lds
  s_add_u32 m0, s62, 0x10000
  s_xor_b32 s63, s83, 0x200000
  buffer_load_dwordx4 v120, s[52:55], s63 offen lds
  s_add_u32 m0, s62, 0x10400
  s_xor_b32 s63, s83, 0x208000
  buffer_load_dwordx4 v120, s[52:55], s63 offen lds
  s_add_u32 m0, s62, 0x11000
  s_xor_b32 s63, s83, 0x220000
  buffer_load_dwordx4 v120, s[52:55], s63 offen lds
  s_add_u32 m0, s62, 0x11400
  s_xor_b32 s63, s83, 0x228000
  buffer_load_dwordx4 v120, s[52:55], s63 offen lds
  s_add_u32 m0, s62, 0x14000
  s_xor_b32 s63, s83, 0x280000
  buffer_load_dwordx4 v120, s[52:55], s63 offen lds
  s_add_u32 m0, s62, 0x14400
  s_xor_b32 s63, s83, 0x288000
  buffer_load_dwordx4 v120, s[52:55], s63 offen lds
  s_add_u32 m0, s62, 0x15000
  s_xor_b32 s63, s83, 0x2a0000
  buffer_load_dwordx4 v120, s[52:55], s63 offen lds
  s_add_u32 m0, s62, 0x15400
  s_xor_b32 s63, s83, 0x2a8000
  buffer_load_dwordx4 v120, s[52:55], s63 offen lds
  v_lshrrev_b32 v123, 4, v0
  v_lshlrev_b32 v121, 13, v123
  v_and_b32 v123, 1, v123
  v_lshlrev_b32 v122, 3, v123
  v_bfe_u32 v123, v0, 3, 1
  v_lshl_add_u32 v121, v123, 11, v121
  v_lshl_add_u32 v122, v123, 2, v122
  v_bfe_u32 v123, v0, 2, 1
  v_lshl_add_u32 v121, v123, 8, v121
  v_lshl_add_u32 v122, v123, 1, v122
  v_bfe_u32 v123, v0, 1, 1
  s_lshl_b32 s18, s34, 2
  v_add_u32 v123, s18, v123
  v_xor_b32 v122, v122, v123
  v_lshl_add_u32 v121, v122, 4, v121
  v_and_b32 v123, 1, v0
  v_lshl_add_u32 v121, v123, 3, v121
L_head_c0:
  s_waitcnt vmcnt(16)
  s_barrier
  s_add_u32 m0, s62, 0x18000
  s_xor_b32 s63, s83, 0x300000
  buffer_load_dwordx4 v120, s[52:55], s63 offen lds
  s_add_u32 m0, s62, 0x18400
  s_xor_b32 s63, s83, 0x308000
  buffer_load_dwordx4 v120, s[52:55], s63 offen lds
  s_add_u32 m0, s62, 0x19000
  s_xor_b32 s63, s83, 0x320000
  buffer_load_dwordx4 v120, s[52:55], s63 offen lds
  s_add_u32 m0, s62, 0x19400
  s_xor_b32 s63, s83, 0x328000
  buffer_load_dwordx4 v120, s[52:55], s63 offen lds
  s_add_u32 m0, s62, 0x1c000
  s_xor_b32 s63, s83, 0x380000
  buffer_load_dwordx4 v120, s[52:55], s63 offen lds
  s_add_u32 m0, s62, 0x1c400
  s_xor_b32 s63, s83, 0x388000
  buffer_load_dwordx4 v120, s[52:55], s63 offen lds
  s_add_u32 m0, s62, 0x1d000
  s_xor_b32 s63, s83, 0x3a0000
  buffer_load_dwordx4 v120, s[52:55], s63 offen lds
  s_add_u32 m0, s62, 0x1d400
  s_xor_b32 s63, s83, 0x3a8000
  buffer_load_dwordx4 v120, s[52:55], s63 offen lds
  v_xor_b32 v123, 0x0, v121
  ds_read_b64_tr_b16 v[128:129], v123 offset:0
  ds_read_b64_tr_b16 v[130:131], v123 offset:4096
  v_xor_b32 v123, 0x20, v121
  ds_read_b64_tr_b16 v[136:137], v123 offset:0
  ds_read_b64_tr_b16 v[138:139], v123 offset:4096
  v_xor_b32 v123, 0x200, v121
  ds_read_b64_tr_b16 v[160:161], v123 offset:0
  ds_read_b64_tr_b16 v[162:163], v123 offset:4096
  v_xor_b32 v123, 0x220, v121
  ds_read_b64_tr_b16 v[168:169], v123 offset:0
  ds_read_b64_tr_b16 v[170:171], v123 offset:4096
  v_xor_b32 v123, 0x400, v121
  ds_read_b64_tr_b16 v[192:193], v123 offset:0
  ds_read_b64_tr_b16 v[194:195], v123 offset:4096
  v_xor_b32 v123, 0x420, v121
  ds_read_b64_tr_b16 v[200:201], v123 offset:0
  ds_read_b64_tr_b16 v[202:203], v123 offset:4096
  v_xor_b32 v123, 0x600, v121
  ds_read_b64_tr_b16 v[224:225], v123 offset:0
  ds_read_b64_tr_b16 v[226:227], v123 offset:4096
  v_xor_b32 v123, 0x620, v121
  ds_read_b64_tr_b16 v[232:233], v123 offset:0
  ds_read_b64_tr_b16 v[234:235], v123 offset:4096
  s_waitcnt lgkmcnt(0)
L_head_c1:
  s_waitcnt vmcnt(16)
  s_barrier
  buffer_load_dword v15, off, s[40:43], 0 offset:4 sc1
  s_add_u32 m0, s62, 0x0
  s_xor_b32 s63, s83, 0x0
  buffer_load_dwordx4 v120, s[48:51], s63 offen lds
  s_add_u32 m0, s62, 0x400
  s_xor_b32 s63, s83, 0x8000
  buffer_load_dwordx4 v120, s[48:51], s63 offen lds
  s_add_u32 m0, s62, 0x1000
  s_xor_b32 s63, s83, 0x20000
  buffer_load_dwordx4 v120, s[48:51], s63 offen lds
  s_add_u32 m0, s62, 0x1400
  s_xor_b32 s63, s83, 0x28000
  buffer_load_dwordx4 v120, s[48:51], s63 offen lds
  s_add_u32 m0, s62, 0x4000
  s_xor_b32 s63, s83, 0x80000
  buffer_load_dwordx4 v120, s[48:51], s63 offen lds
  s_add_u32 m0, s62, 0x4400
  s_xor_b32 s63, s83, 0x88000
  buffer_load_dwordx4 v120, s[48:51], s63 offen lds
  s_add_u32 m0, s62, 0x5000
  s_xor_b32 s63, s83, 0xa0000
  buffer_load_dwordx4 v120, s[48:51], s63 offen lds
  s_add_u32 m0, s62, 0x5400
  s_xor_b32 s63, s83, 0xa8000
  buffer_load_dwordx4 v120, s[48:51], s63 offen lds
  s_lshl_b32 s18, s34, 11
  v_lshlrev_b32 v2, 4, v0
  v_add_u32 v1, s18, v2
  v_lshrrev_b32 v112, 4, v0
  v_and_b32 v113, 15, v0
  v_lshrrev_b32 v114, 2, v113
  v_and_b32 v115, 1, v114
  v_lshlrev_b32 v115, 1, v115
  v_xor_b32 v115, v115, v112
  v_lshlrev_b32 v6, 5, v115
  v_lshl_add_u32 v6, v114, 7, v6
  v_and_b32 v115, 3, v0
  v_lshl_add_u32 v6, v115, 2, v6
  s_lshl_b32 s18, s34, 10
  s_add_u32 s19, s18, 0x1e000
  v_add_u32 v6, s19, v6
  v_and_b32 v115, 1, v0
  v_mul_u32_u24 v8, 0xaaaa, v115
  v_add_u32 v8, 0x4444, v8
  v_lshl_add_u32 v115, v114, 1, v115
  v_and_b32 v116, 1, v112
  v_lshlrev_b32 v116, 2, v116
  v_xor_b32 v115, v115, v116
  v_lshlrev_b32 v115, 4, v115
  v_lshl_add_u32 v115, v112, 7, v115
  v_add_u32 v7, 0x1e000, v115
  v_mov_b32 v9, 1
  v_mov_b32 v11, 0xff61b1e6
  v_lshlrev_b32 v114, 2, v112
  s_mov_b32 s67, 0x3e0293ee
  v_add_u32 v115, 0, v114
  v_cmp_le_u32 s[70:71], v115, v113
  v_add_u32 v115, 1, v114
  v_cmp_le_u32 s[72:73], v115, v113
  v_add_u32 v115, 2, v114
  v_cmp_le_u32 s[74:75], v115, v113
  v_add_u32 v115, 3, v114
  v_cmp_le_u32 s[76:77], v115, v113
  s_lshr_b32 s18, s34, 1
  s_lshl_b32 s18, s18, 12
  s_and_b32 s19, s34, 1
  s_lshl_b32 s19, s19, 7
  s_add_u32 s18, s18, s19
  v_lshrrev_b32 v112, 3, v0
  v_lshl_add_u32 v14, v112, 8, s18
  v_and_b32 v112, 7, v0
  v_lshl_add_u32 v14, v112, 4, v14
  s_mov_b32 s68, 0
  s_mov_b32 s66, 0
  s_lshl_b32 s81, s65, 2
  v_xor_b32 v123, 0x0, v121
  ds_read_b64_tr_b16 v[132:133], v123 offset:32768
  ds_read_b64_tr_b16 v[134:135], v123 offset:36864
  v_xor_b32 v123, 0x20, v121
  ds_read_b64_tr_b16 v[140:141], v123 offset:32768
  ds_read_b64_tr_b16 v[142:143], v123 offset:36864
  v_xor_b32 v123, 0x200, v121
  ds_read_b64_tr_b16 v[164:165], v123 offset:32768
  ds_read_b64_tr_b16 v[166:167], v123 offset:36864
  v_xor_b32 v123, 0x220, v121
  ds_read_b64_tr_b16 v[172:173], v123 offset:32768
  ds_read_b64_tr_b16 v[174:175], v123 offset:36864
  v_xor_b32 v123, 0x400, v121
  ds_read_b64_tr_b16 v[196:197], v123 offset:32768
  ds_read_b64_tr_b16 v[198:199], v123 offset:36864
  v_xor_b32 v123, 0x420, v121
  ds_read_b64_tr_b16 v[204:205], v123 offset:32768
  ds_read_b64_tr_b16 v[206:207], v123 offset:36864
  v_xor_b32 v123, 0x600, v121
  ds_read_b64_tr_b16 v[228:229], v123 offset:32768
  ds_read_b64_tr_b16 v[230:231], v123 offset:36864
  v_xor_b32 v123, 0x620, v121
  ds_read_b64_tr_b16 v[236:237], v123 offset:32768
  ds_read_b64_tr_b16 v[238:239], v123 offset:36864
  s_waitcnt lgkmcnt(0)
L_head_c2:
  s_waitcnt vmcnt(17)
  s_barrier
  s_add_u32 m0, s62, 0x8000
  s_xor_b32 s63, s83, 0x100000
  buffer_load_dwordx4 v120, s[48:51], s63 offen lds
  s_add_u32 m0, s62, 0x8400
  s_xor_b32 s63, s83, 0x108000
  buffer_load_dwordx4 v120, s[48:51], s63 offen lds
  s_add_u32 m0, s62, 0x9000
  s_xor_b32 s63, s83, 0x120000
  buffer_load_dwordx4 v120, s[48:51], s63 offen lds
  s_add_u32 m0, s62, 0x9400
  s_xor_b32 s63, s83, 0x128000
  buffer_load_dwordx4 v120, s[48:51], s63 offen lds
  s_add_u32 m0, s62, 0xc000
  s_xor_b32 s63, s83, 0x180000
  buffer_load_dwordx4 v120, s[48:51], s63 offen lds
  s_add_u32 m0, s62, 0xc400
  s_xor_b32 s63, s83, 0x188000
  buffer_load_dwordx4 v120, s[48:51], s63 offen lds
  s_add_u32 m0, s62, 0xd000
  s_xor_b32 s63, s83, 0x1a0000
  buffer_load_dwordx4 v120, s[48:51], s63 offen lds
  s_add_u32 m0, s62, 0xd400
  s_xor_b32 s63, s83, 0x1a8000
  buffer_load_dwordx4 v120, s[48:51], s63 offen lds
  v_xor_b32 v123, 0x10000, v121
  ds_read_b64_tr_b16 v[144:145], v123 offset:0
  ds_read_b64_tr_b16 v[146:147], v123 offset:4096
  v_xor_b32 v123, 0x10020, v121
  ds_read_b64_tr_b16 v[152:153], v123 offset:0
  ds_read_b64_tr_b16 v[154:155], v123 offset:4096
  v_xor_b32 v123, 0x10200, v121
  ds_read_b64_tr_b16 v[176:177], v123 offset:0
  ds_read_b64_tr_b16 v[178:179], v123 offset:4096
  v_xor_b32 v123, 0x10220, v121
  ds_read_b64_tr_b16 v[184:185], v123 offset:0
  ds_read_b64_tr_b16 v[186:187], v123 offset:4096
  v_xor_b32 v123, 0x10400, v121
  ds_read_b64_tr_b16 v[208:209], v123 offset:0
  ds_read_b64_tr_b16 v[210:211], v123 offset:4096
  v_xor_b32 v123, 0x10420, v121
  ds_read_b64_tr_b16 v[216:217], v123 offset:0
  ds_read_b64_tr_b16 v[218:219], v123 offset:4096
  v_xor_b32 v123, 0x10600, v121
  ds_read_b64_tr_b16 v[240:241], v123 offset:0
  ds_read_b64_tr_b16 v[242:243], v123 offset:4096
  v_xor_b32 v123, 0x10620, v121
  ds_read_b64_tr_b16 v[248:249], v123 offset:0
  ds_read_b64_tr_b16 v[250:251], v123 offset:4096
  s_waitcnt lgkmcnt(0)
L_head_c3:
  s_waitcnt vmcnt(17)
  s_barrier
  s_add_u32 m0, s62, 0x10000
  s_xor_b32 s63, s83, 0x200000
  buffer_load_dwordx4 v120, s[48:51], s63 offen lds
  s_add_u32 m0, s62, 0x10400
  s_xor_b32 s63, s83, 0x208000
  buffer_load_dwordx4 v120, s[48:51], s63 offen lds
  s_add_u32 m0, s62, 0x11000
  s_xor_b32 s63, s83, 0x220000
  buffer_load_dwordx4 v120, s[48:51], s63 offen lds
  s_add_u32 m0, s62, 0x11400
  s_xor_b32 s63, s83, 0x228000
  buffer_load_dwordx4 v120, s[48:51], s63 offen lds
  s_add_u32 m0, s62, 0x14000
  s_xor_b32 s63, s83, 0x280000
  buffer_load_dwordx4 v120, s[48:51], s63 offen lds
  s_add_u32 m0, s62, 0x14400
  s_xor_b32 s63, s83, 0x288000
  buffer_load_dwordx4 v120, s[48:51], s63 offen lds
  s_add_u32 m0, s62, 0x15000
  s_xor_b32 s63, s83, 0x2a0000
  buffer_load_dwordx4 v120, s[48:51], s63 offen lds
  s_add_u32 m0, s62, 0x15400
  s_xor_b32 s63, s83, 0x2a8000
  buffer_load_dwordx4 v120, s[48:51], s63 offen lds
  v_xor_b32 v123, 0x10000, v121
  ds_read_b64_tr_b16 v[148:149], v123 offset:32768
  ds_read_b64_tr_b16 v[150:151], v123 offset:36864
  v_xor_b32 v123, 0x10020, v121
  ds_read_b64_tr_b16 v[156:157], v123 offset:32768
  ds_read_b64_tr_b16 v[158:159], v123 offset:36864
  v_xor_b32 v123, 0x10200, v121
  ds_read_b64_tr_b16 v[180:181], v123 offset:32768
  ds_read_b64_tr_b16 v[182:183], v123 offset:36864
  v_xor_b32 v123, 0x10220, v121
  ds_read_b64_tr_b16 v[188:189], v123 offset:32768
  ds_read_b64_tr_b16 v[190:191], v123 offset:36864
  v_xor_b32 v123, 0x10400, v121
  ds_read_b64_tr_b16 v[212:213], v123 offset:32768
  ds_read_b64_tr_b16 v[214:215], v123 offset:36864
  v_xor_b32 v123, 0x10420, v121
  ds_read_b64_tr_b16 v[220:221], v123 offset:32768
  ds_read_b64_tr_b16 v[222:223], v123 offset:36864
  v_xor_b32 v123, 0x10600, v121
  ds_read_b64_tr_b16 v[244:245], v123 offset:32768
  ds_read_b64_tr_b16 v[246:247], v123 offset:36864
  v_xor_b32 v123, 0x10620, v121
  ds_read_b64_tr_b16 v[252:253], v123 offset:32768
  ds_read_b64_tr_b16 v[254:255], v123 offset:36864
  s_waitcnt lgkmcnt(0)
L_head_c4:
  s_waitcnt vmcnt(16)
  s_barrier
  s_add_u32 m0, s62, 0x18000
  s_xor_b32 s63, s83, 0x300000
  buffer_load_dwordx4 v120, s[48:51], s63 offen lds
  s_add_u32 m0, s62, 0x18400
  s_xor_b32 s63, s83, 0x308000
  buffer_load_dwordx4 v120, s[48:51], s63 offen lds
  s_add_u32 m0, s62, 0x19000
  s_xor_b32 s63, s83, 0x320000
  buffer_load_dwordx4 v120, s[48:51], s63 offen lds
  s_add_u32 m0, s62, 0x19400
  s_xor_b32 s63, s83, 0x328000
  buffer_load_dwordx4 v120, s[48:51], s63 offen lds
  s_add_u32 m0, s62, 0x1c000
  s_xor_b32 s63, s83, 0x380000
  buffer_load_dwordx4 v120, s[48:51], s63 offen lds
  s_add_u32 m0, s62, 0x1c400
  s_xor_b32 s63, s83, 0x388000
  buffer_load_dwordx4 v120, s[48:51], s63 offen lds
  s_add_u32 m0, s62, 0x1d000
  s_xor_b32 s63, s83, 0x3a0000
  buffer_load_dwordx4 v120, s[48:51], s63 offen lds
  s_add_u32 m0, s62, 0x1d400
  s_xor_b32 s63, s83, 0x3a8000
  buffer_load_dwordx4 v120, s[48:51], s63 offen lds
  v_readfirstlane_b32 s18, v15
L_rot_113:
  s_cmp_eq_u32 s18, s100
  s_cbranch_scc1 L_rotok_114
  s_cmp_lg_u32 s18, 0
  s_cbranch_scc1 L_restart
  s_sub_u32 s3, s3, 1
  s_cbranch_scc1 L_end
  buffer_load_dword v15, off, s[40:43], 0 offset:4 sc1
  s_waitcnt vmcnt(0)
  v_readfirstlane_b32 s18, v15
  s_branch L_rot_113
L_rotok_114:
  v_xor_b32 v123, 0x0, v121
  ds_read_b64_tr_b16 a[128:129], v123 offset:0
  ds_read_b64_tr_b16 a[130:131], v123 offset:4096
  v_xor_b32 v123, 0x20, v121
  ds_read_b64_tr_b16 a[136:137], v123 offset:0
  ds_read_b64_tr_b16 a[138:139], v123 offset:4096
  v_xor_b32 v123, 0x200, v121
  ds_read_b64_tr_b16 a[160:161], v123 offset:0
  ds_read_b64_tr_b16 a[162:163], v123 offset:4096
  v_xor_b32 v123, 0x220, v121
  ds_read_b64_tr_b16 a[168:169], v123 offset:0
  ds_read_b64_tr_b16 a[170:171], v123 offset:4096
  v_xor_b32 v123, 0x400, v121
  ds_read_b64_tr_b16 a[192:193], v123 offset:0
  ds_read_b64_tr_b16 a[194:195], v123 offset:4096
  v_xor_b32 v123, 0x420, v121
  ds_read_b64_tr_b16 a[200:201], v123 offset:0
  ds_read_b64_tr_b16 a[202:203], v123 offset:4096
  v_xor_b32 v123, 0x600, v121
  ds_read_b64_tr_b16 a[224:225], v123 offset:0
  ds_read_b64_tr_b16 a[226:227], v123 offset:4096
  v_xor_b32 v123, 0x620, v121
  ds_read_b64_tr_b16 a[232:233], v123 offset:0
  ds_read_b64_tr_b16 a[234:235], v123 offset:4096
  s_waitcnt lgkmcnt(0)
L_head_c5:
  s_waitcnt vmcnt(16)
  s_barrier
  s_add_u32 m0, s62, 0x0
  s_xor_b32 s63, s83, 0x0
  buffer_load_dwordx4 v120, s[44:47], s63 offen lds
  s_add_u32 m0, s62, 0x400
  s_xor_b32 s63, s83, 0x8000
  buffer_load_dwordx4 v120, s[44:47], s63 offen lds
  s_add_u32 m0, s62, 0x1000
  s_xor_b32 s63, s83, 0x20000
  buffer_load_dwordx4 v120, s[44:47], s63 offen lds
  s_add_u32 m0, s62, 0x1400
  s_xor_b32 s63, s83, 0x28000
  buffer_load_dwordx4 v120, s[44:47], s63 offen lds
  s_add_u32 m0, s62, 0x4000
  s_xor_b32 s63, s83, 0x80000
  buffer_load_dwordx4 v120, s[44:47], s63 offen lds
  s_add_u32 m0, s62, 0x4400
  s_xor_b32 s63, s83, 0x88000
  buffer_load_dwordx4 v120, s[44:47], s63 offen lds
  s_add_u32 m0, s62, 0x5000
  s_xor_b32 s63, s83, 0xa0000
  buffer_load_dwordx4 v120, s[44:47], s63 offen lds
  s_add_u32 m0, s62, 0x5400
  s_xor_b32 s63, s83, 0xa8000
  buffer_load_dwordx4 v120, s[44:47], s63 offen lds
  v_xor_b32 v123, 0x0, v121
  ds_read_b64_tr_b16 a[132:133], v123 offset:32768
  ds_read_b64_tr_b16 a[134:135], v123 offset:36864
  v_xor_b32 v123, 0x20, v121
  ds_read_b64_tr_b16 a[140:141], v123 offset:32768
  ds_read_b64_tr_b16 a[142:143], v123 offset:36864
  v_xor_b32 v123, 0x200, v121
  ds_read_b64_tr_b16 a[164:165], v123 offset:32768
  ds_read_b64_tr_b16 a[166:167], v123 offset:36864
  v_xor_b32 v123, 0x220, v121
  ds_read_b64_tr_b16 a[172:173], v123 offset:32768
  ds_read_b64_tr_b16 a[174:175], v123 offset:36864
  v_xor_b32 v123, 0x400, v121
  ds_read_b64_tr_b16 a[196:197], v123 offset:32768
  ds_read_b64_tr_b16 a[198:199], v123 offset:36864
  v_xor_b32 v123, 0x420, v121
  ds_read_b64_tr_b16 a[204:205], v123 offset:32768
  ds_read_b64_tr_b16 a[206:207], v123 offset:36864
  v_xor_b32 v123, 0x600, v121
  ds_read_b64_tr_b16 a[228:229], v123 offset:32768
  ds_read_b64_tr_b16 a[230:231], v123 offset:36864
  v_xor_b32 v123, 0x620, v121
  ds_read_b64_tr_b16 a[236:237], v123 offset:32768
  ds_read_b64_tr_b16 a[238:239], v123 offset:36864
  s_waitcnt lgkmcnt(0)
L_head_c6:
  s_waitcnt vmcnt(16)
  s_barrier
  s_add_u32 m0, s62, 0x8000
  s_xor_b32 s63, s83, 0x100000
  buffer_load_dwordx4 v120, s[44:47], s63 offen lds
  s_add_u32 m0, s62, 0x8400
  s_xor_b32 s63, s83, 0x108000
  buffer_load_dwordx4 v120, s[44:47], s63 offen lds
  s_add_u32 m0, s62, 0x9000
  s_xor_b32 s63, s83, 0x120000
  buffer_load_dwordx4 v120, s[44:47], s63 offen lds
  s_add_u32 m0, s62, 0x9400
  s_xor_b32 s63, s83, 0x128000
  buffer_load_dwordx4 v120, s[44:47], s63 offen lds
  s_add_u32 m0, s62, 0xc000
  s_xor_b32 s63, s83, 0x180000
  buffer_load_dwordx4 v120, s[44:47], s63 offen lds
  s_add_u32 m0, s62, 0xc400
  s_xor_b32 s63, s83, 0x188000
  buffer_load_dwordx4 v120, s[44:47], s63 offen lds
  s_add_u32 m0, s62, 0xd000
  s_xor_b32 s63, s83, 0x1a0000
  buffer_load_dwordx4 v120, s[44:47], s63 offen lds
  s_add_u32 m0, s62, 0xd400
  s_xor_b32 s63, s83, 0x1a8000
  buffer_load_dwordx4 v120, s[44:47], s63 offen lds
  v_xor_b32 v123, 0x10000, v121
  ds_read_b64_tr_b16 a[144:145], v123 offset:0
  ds_read_b64_tr_b16 a[146:147], v123 offset:4096
  v_xor_b32 v123, 0x10020, v121
  ds_read_b64_tr_b16 a[152:153], v123 offset:0
  ds_read_b64_tr_b16 a[154:155], v123 offset:4096
  v_xor_b32 v123, 0x10200, v121
  ds_read_b64_tr_b16 a[176:177], v123 offset:0
  ds_read_b64_tr_b16 a[178:179], v123 offset:4096
  v_xor_b32 v123, 0x10220, v121
  ds_read_b64_tr_b16 a[184:185], v123 offset:0
  ds_read_b64_tr_b16 a[186:187], v123 offset:4096
  v_xor_b32 v123, 0x10400, v121
  ds_read_b64_tr_b16 a[208:209], v123 offset:0
  ds_read_b64_tr_b16 a[210:211], v123 offset:4096
  v_xor_b32 v123, 0x10420, v121
  ds_read_b64_tr_b16 a[216:217], v123 offset:0
  ds_read_b64_tr_b16 a[218:219], v123 offset:4096
  v_xor_b32 v123, 0x10600, v121
  ds_read_b64_tr_b16 a[240:241], v123 offset:0
  ds_read_b64_tr_b16 a[242:243], v123 offset:4096
  v_xor_b32 v123, 0x10620, v121
  ds_read_b64_tr_b16 a[248:249], v123 offset:0
  ds_read_b64_tr_b16 a[250:251], v123 offset:4096
  s_waitcnt lgkmcnt(0)
L_head_c7:
  s_waitcnt vmcnt(16)
  s_barrier
  s_add_u32 m0, s62, 0x10000
  s_xor_b32 s63, s83, 0x200000
  buffer_load_dwordx4 v120, s[44:47], s63 offen lds
  s_add_u32 m0, s62, 0x10400
  s_xor_b32 s63, s83, 0x208000
  buffer_load_dwordx4 v120, s[44:47], s63 offen lds
  s_add_u32 m0, s62, 0x11000
  s_xor_b32 s63, s83, 0x220000
  buffer_load_dwordx4 v120, s[44:47], s63 offen lds
  s_add_u32 m0, s62, 0x11400
  s_xor_b32 s63, s83, 0x228000
  buffer_load_dwordx4 v120, s[44:47], s63 offen lds
  s_add_u32 m0, s62, 0x14000
  s_xor_b32 s63, s83, 0x280000
  buffer_load_dwordx4 v120, s[44:47], s63 offen lds
  s_add_u32 m0, s62, 0x14400
  s_xor_b32 s63, s83, 0x288000
  buffer_load_dwordx4 v120, s[44:47], s63 offen lds
  s_add_u32 m0, s62, 0x15000
  s_xor_b32 s63, s83, 0x2a0000
  buffer_load_dwordx4 v120, s[44:47], s63 offen lds
  s_add_u32 m0, s62, 0x15400
  s_xor_b32 s63, s83, 0x2a8000
  buffer_load_dwordx4 v120, s[44:47], s63 offen lds
  v_xor_b32 v123, 0x10000, v121
  ds_read_b64_tr_b16 a[148:149], v123 offset:32768
  ds_read_b64_tr_b16 a[150:151], v123 offset:36864
  v_xor_b32 v123, 0x10020, v121
  ds_read_b64_tr_b16 a[156:157], v123 offset:32768
  ds_read_b64_tr_b16 a[158:159], v123 offset:36864
  v_xor_b32 v123, 0x10200, v121
  ds_read_b64_tr_b16 a[180:181], v123 offset:32768
  ds_read_b64_tr_b16 a[182:183], v123 offset:36864
  v_xor_b32 v123, 0x10220, v121
  ds_read_b64_tr_b16 a[188:189], v123 offset:32768
  ds_read_b64_tr_b16 a[190:191], v123 offset:36864
  v_xor_b32 v123, 0x10400, v121
  ds_read_b64_tr_b16 a[212:213], v123 offset:32768
  ds_read_b64_tr_b16 a[214:215], v123 offset:36864
  v_xor_b32 v123, 0x10420, v121
  ds_read_b64_tr_b16 a[220:221], v123 offset:32768
  ds_read_b64_tr_b16 a[222:223], v123 offset:36864
  v_xor_b32 v123, 0x10600, v121
  ds_read_b64_tr_b16 a[244:245], v123 offset:32768
  ds_read_b64_tr_b16 a[246:247], v123 offset:36864
  v_xor_b32 v123, 0x10620, v121
  ds_read_b64_tr_b16 a[252:253], v123 offset:32768
  ds_read_b64_tr_b16 a[254:255], v123 offset:36864
  s_waitcnt lgkmcnt(0)
L_head_c8:
  s_waitcnt vmcnt(16)
  s_barrier
  buffer_load_dword v112, off, s[40:43], s81 offset:32 sc1
  s_add_u32 m0, s62, 0x18000
  s_xor_b32 s63, s83, 0x300000
  buffer_load_dwordx4 v120, s[44:47], s63 offen lds
  s_add_u32 m0, s62, 0x18400
  s_xor_b32 s63, s83, 0x308000
  buffer_load_dwordx4 v120, s[44:47], s63 offen lds
  s_add_u32 m0, s62, 0x19000
  s_xor_b32 s63, s83, 0x320000
  buffer_load_dwordx4 v120, s[44:47], s63 offen lds
  s_add_u32 m0, s62, 0x19400
  s_xor_b32 s63, s83, 0x328000
  buffer_load_dwordx4 v120, s[44:47], s63 offen lds
  s_add_u32 m0, s62, 0x1c000
  s_xor_b32 s63, s83, 0x380000
  buffer_load_dwordx4 v120, s[44:47], s63 offen lds
  s_add_u32 m0, s62, 0x1c400
  s_xor_b32 s63, s83, 0x388000
  buffer_load_dwordx4 v120, s[44:47], s63 offen lds
  s_add_u32 m0, s62, 0x1d000
  s_xor_b32 s63, s83, 0x3a0000
  buffer_load_dwordx4 v120, s[44:47], s63 offen lds
  s_add_u32 m0, s62, 0x1d400
  s_xor_b32 s63, s83, 0x3a8000
  buffer_load_dwordx4 v120, s[44:47], s63 offen lds
  s_getpc_b64 s[96:97]
L_pc_115:
  s_mul_i32 s95, s34, 4096
  s_add_u32 s95, s95, L_head_ready-L_pc_115
  v_lshl_add_u32 v114, v0, 7, s95
  v_min_u32 v114, L_hid-L_pc_115-4, v114
  v_mov_b32 v115, s97
  v_add_co_u32 v114, vcc, s96, v114
  s_nop 1
  v_addc_co_u32 v115, vcc, 0, v115, vcc
  global_load_dword v13, v[114:115], off
  v_xor_b32 v123, 0x0, v121
  ds_read_b64_tr_b16 a[0:1], v123 offset:0
  ds_read_b64_tr_b16 a[2:3], v123 offset:4096
  v_xor_b32 v123, 0x20, v121
  ds_read_b64_tr_b16 a[8:9], v123 offset:0
  ds_read_b64_tr_b16 a[10:11], v123 offset:4096
  v_xor_b32 v123, 0x200, v121
  ds_read_b64_tr_b16 a[32:33], v123 offset:0
  ds_read_b64_tr_b16 a[34:35], v123 offset:4096
  v_xor_b32 v123, 0x220, v121
  ds_read_b64_tr_b16 a[40:41], v123 offset:0
  ds_read_b64_tr_b16 a[42:43], v123 offset:4096
  v_xor_b32 v123, 0x400, v121
  ds_read_b64_tr_b16 a[64:65], v123 offset:0
  ds_read_b64_tr_b16 a[66:67], v123 offset:4096
  v_xor_b32 v123, 0x420, v121
  ds_read_b64_tr_b16 a[72:73], v123 offset:0
  ds_read_b64_tr_b16 a[74:75], v123 offset:4096
  v_xor_b32 v123, 0x600, v121
  ds_read_b64_tr_b16 a[96:97], v123 offset:0
  ds_read_b64_tr_b16 a[98:99], v123 offset:4096
  v_xor_b32 v123, 0x620, v121
  ds_read_b64_tr_b16 a[104:105], v123 offset:0
  ds_read_b64_tr_b16 a[106:107], v123 offset:4096
  s_waitcnt lgkmcnt(0)
L_head_c9:
  s_waitcnt vmcnt(18)
  s_barrier
  v_xor_b32 v123, 0x0, v121
  ds_read_b64_tr_b16 a[4:5], v123 offset:32768
  ds_read_b64_tr_b16 a[6:7], v123 offset:36864
  v_xor_b32 v123, 0x20, v121
  ds_read_b64_tr_b16 a[12:13], v123 offset:32768
  ds_read_b64_tr_b16 a[14:15], v123 offset:36864
  v_xor_b32 v123, 0x200, v121
  ds_read_b64_tr_b16 a[36:37], v123 offset:32768
  ds_read_b64_tr_b16 a[38:39], v123 offset:36864
  v_xor_b32 v123, 0x220, v121
  ds_read_b64_tr_b16 a[44:45], v123 offset:32768
  ds_read_b64_tr_b16 a[46:47], v123 offset:36864
  v_xor_b32 v123, 0x400, v121
  ds_read_b64_tr_b16 a[68:69], v123 offset:32768
  ds_read_b64_tr_b16 a[70:71], v123 offset:36864
  v_xor_b32 v123, 0x420, v121
  ds_read_b64_tr_b16 a[76:77], v123 offset:32768
  ds_read_b64_tr_b16 a[78:79], v123 offset:36864
  v_xor_b32 v123, 0x600, v121
  ds_read_b64_tr_b16 a[100:101], v123 offset:32768
  ds_read_b64_tr_b16 a[102:103], v123 offset:36864
  v_xor_b32 v123, 0x620, v121
  ds_read_b64_tr_b16 a[108:109], v123 offset:32768
  ds_read_b64_tr_b16 a[110:111], v123 offset:36864
  s_waitcnt lgkmcnt(0)
L_head_c10:
  s_waitcnt vmcnt(10)
  s_barrier
  s_waitcnt vmcnt(9)
  v_cmp_ne_u32 vcc, 1, v112
  s_cbranch_vccz L_xok_116
L_spin_117:
  buffer_load_dword v112, off, s[40:43], s81 offset:32 sc1
  s_waitcnt vmcnt(0)
  v_cmp_ne_u32 vcc, 1, v112
  s_cbranch_vccz L_ok_118
  s_sub_u32 s3, s3, 1
  s_cbranch_scc1 L_end
  s_sleep 2
  s_branch L_spin_117
L_ok_118:
L_xok_116:
  s_lshl_b32 s78, s65, 15
  s_lshl_b32 s79, s34, 13
  s_add_u32 s78, s78, s79
  s_add_u32 s78, s78, 0x0
  s_xor_b32 s80, s68, 1
  s_lshl_b32 s80, s80, 17
  s_add_u32 s79, s79, s80
  s_lshr_b32 s80, s83, 9
  s_add_u32 s78, s78, s80
  s_add_u32 m0, s79, 0
  s_xor_b32 s80, s78, 0
  buffer_load_dwordx4 v2, s[36:39], s80 offen offset:0 sc1 lds
  buffer_load_dwordx4 v2, s[36:39], s80 offen offset:1024 sc1 lds
  s_add_u32 m0, s79, 2048
  s_xor_b32 s80, s78, 2048
  buffer_load_dwordx4 v2, s[36:39], s80 offen offset:0 sc1 lds
  buffer_load_dwordx4 v2, s[36:39], s80 offen offset:1024 sc1 lds
  s_add_u32 m0, s79, 4096
  s_xor_b32 s80, s78, 4096
  buffer_load_dwordx4 v2, s[36:39], s80 offen offset:0 sc1 lds
  buffer_load_dwordx4 v2, s[36:39], s80 offen offset:1024 sc1 lds
  s_add_u32 m0, s79, 6144
  s_xor_b32 s80, s78, 6144
  buffer_load_dwordx4 v2, s[36:39], s80 offen offset:0 sc1 lds
  buffer_load_dwordx4 v2, s[36:39], s80 offen offset:1024 sc1 lds
  buffer_load_dword v12, off, s[40:43], 0 sc1
  v_xor_b32 v123, 0x10000, v121
  ds_read_b64_tr_b16 a[16:17], v123 offset:0
  ds_read_b64_tr_b16 a[18:19], v123 offset:4096
  v_xor_b32 v123, 0x10020, v121
  ds_read_b64_tr_b16 a[24:25], v123 offset:0
  ds_read_b64_tr_b16 a[26:27], v123 offset:4096
  v_xor_b32 v123, 0x10200, v121
  ds_read_b64_tr_b16 a[48:49], v123 offset:0
  ds_read_b64_tr_b16 a[50:51], v123 offset:4096
  v_xor_b32 v123, 0x10220, v121
  ds_read_b64_tr_b16 a[56:57], v123 offset:0
  ds_read_b64_tr_b16 a[58:59], v123 offset:4096
  v_xor_b32 v123, 0x10400, v121
  ds_read_b64_tr_b16 a[80:81], v123 offset:0
  ds_read_b64_tr_b16 a[82:83], v123 offset:4096
  v_xor_b32 v123, 0x10420, v121
  ds_read_b64_tr_b16 a[88:89], v123 offset:0
  ds_read_b64_tr_b16 a[90:91], v123 offset:4096
  v_xor_b32 v123, 0x10600, v121
  ds_read_b64_tr_b16 a[112:113], v123 offset:0
  ds_read_b64_tr_b16 a[114:115], v123 offset:4096
  v_xor_b32 v123, 0x10620, v121
  ds_read_b64_tr_b16 a[120:121], v123 offset:0
  ds_read_b64_tr_b16 a[122:123], v123 offset:4096
  s_waitcnt lgkmcnt(0)
L_head_c11:
  s_waitcnt vmcnt(10)
  s_barrier
  v_xor_b32 v123, 0x10000, v121
  ds_read_b64_tr_b16 a[20:21], v123 offset:32768
  ds_read_b64_tr_b16 a[22:23], v123 offset:36864
  v_xor_b32 v123, 0x10020, v121
  ds_read_b64_tr_b16 a[28:29], v123 offset:32768
  ds_read_b64_tr_b16 a[30:31], v123 offset:36864
  v_xor_b32 v123, 0x10200, v121
  ds_read_b64_tr_b16 a[52:53], v123 offset:32768
  ds_read_b64_tr_b16 a[54:55], v123 offset:36864
  v_xor_b32 v123, 0x10220, v121
  ds_read_b64_tr_b16 a[60:61], v123 offset:32768
  ds_read_b64_tr_b16 a[62:63], v123 offset:36864
  v_xor_b32 v123, 0x10400, v121
  ds_read_b64_tr_b16 a[84:85], v123 offset:32768
  ds_read_b64_tr_b16 a[86:87], v123 offset:36864
  v_xor_b32 v123, 0x10420, v121
  ds_read_b64_tr_b16 a[92:93], v123 offset:32768
  ds_read_b64_tr_b16 a[94:95], v123 offset:36864
  v_xor_b32 v123, 0x10600, v121
  ds_read_b64_tr_b16 a[116:117], v123 offset:32768
  ds_read_b64_tr_b16 a[118:119], v123 offset:36864
  v_xor_b32 v123, 0x10620, v121
  ds_read_b64_tr_b16 a[124:125], v123 offset:32768
  ds_read_b64_tr_b16 a[126:127], v123 offset:36864
  s_waitcnt lgkmcnt(0)
  s_barrier
L_head_ready:
  s_waitcnt vmcnt(0)
  v_cmp_ne_u32 vcc, 64, v12
  s_cbranch_vccz L_init_119
L_spin_120:
  buffer_load_dword v12, off, s[40:43], 0 offset:0 sc1
  s_waitcnt vmcnt(0)
  v_cmp_ne_u32 vcc, 64, v12
  s_cbranch_vccz L_ok_121
  s_sub_u32 s3, s3, 1
  s_cbranch_scc1 L_end
  s_sleep 8
  s_branch L_spin_120
L_ok_121:
L_init_119:
  s_barrier
  s_lshl_b32 s79, s34, 11
  s_mov_b32 s78, 0x400000
  s_add_u32 m0, s79, 0x1c000
  s_mov_b32 s80, 0x400400
  buffer_load_dwordx4 v14, s[36:39], s78 offen sc1 lds
  buffer_load_dwordx4 v14, s[36:39], s80 offen offset:1024 sc1 lds
  s_add_u32 s81, s65, 3
  s_mov_b32 s82, 1
  s_lshl_b32 s78, s81, 15
  s_lshl_b32 s79, s34, 13
  s_add_u32 s78, s78, s79
  s_add_u32 s78, s78, 0x0
  s_xor_b32 s80, s82, 1
  s_lshl_b32 s80, s80, 17
  s_add_u32 s79, s79, s80
  s_lshr_b32 s80, s83, 9
  s_add_u32 s78, s78, s80
  s_add_u32 m0, s79, 0
  s_xor_b32 s80, s78, 0
  buffer_load_dwordx4 v2, s[36:39], s80 offen offset:0 sc1 lds
  buffer_load_dwordx4 v2, s[36:39], s80 offen offset:1024 sc1 lds
  s_add_u32 m0, s79, 2048
  s_xor_b32 s80, s78, 2048
  buffer_load_dwordx4 v2, s[36:39], s80 offen offset:0 sc1 lds
  buffer_load_dwordx4 v2, s[36:39], s80 offen offset:1024 sc1 lds
  s_add_u32 m0, s79, 4096
  s_xor_b32 s80, s78, 4096
  buffer_load_dwordx4 v2, s[36:39], s80 offen offset:0 sc1 lds
  buffer_load_dwordx4 v2, s[36:39], s80 offen offset:1024 sc1 lds
  s_add_u32 m0, s79, 6144
  s_xor_b32 s80, s78, 6144
  buffer_load_dwordx4 v2, s[36:39], s80 offen offset:0 sc1 lds
  buffer_load_dwordx4 v2, s[36:39], s80 offen offset:1024 sc1 lds
L_head_loop:
  s_cmp_ge_u32 s65, 64
  s_cbranch_scc1 L_head_B
  s_xor_b32 s18, s68, 1
  s_lshl_b32 s18, s18, 17
  v_add_u32 v3, s18, v2
  s_mul_i32 s18, s68, 24576
  s_add_u32 s18, s18, 0x10000
  v_add_u32 v4, s18, v1
  s_lshl_b32 s78, s64, 6
  s_add_u32 s78, s78, s65
  s_lshl_b32 s78, s78, 14
  s_add_u32 s78, s78, 0x2000000
  s_add_u32 s79, s78, 8192
  s_cmp_eq_u32 s65, 0
  s_cbranch_scc1 L_head_first
  ds_read_b128 v[64:67], v3 offset:0
  ds_read_b128 v[68:71], v3 offset:1024
  ds_read_b128 v[72:75], v3 offset:2048
  ds_read_b128 v[76:79], v3 offset:3072
  s_lshl_b32 s84, s65, 8
  s_lshl_b32 s85, s64, 2
  s_add_u32 s85, s85, s34
  s_add_u32 s84, s84, s85
  s_lshl_b32 s84, s84, 10
  s_add_u32 s84, s84, 0x1000000
  s_add_u32 s85, s84, 0x20000
  v_mov_b64 v[120:121], -1
  v_mov_b64 v[122:123], -1
  s_waitcnt lgkmcnt(3)
  v_mfma_f32_16x16x32_bf16 v[32:35], a[128:131], v[64:67], 0
  ds_read_b128 v[80:83], v3 offset:4096
  s_waitcnt lgkmcnt(2)
  v_mfma_f32_16x16x32_bf16 v[32:35], a[132:135], v[72:75], v[32:35]
  ds_read_b128 v[84:87], v3 offset:5120
  v_mfma_f32_16x16x32_bf16 v[40:43], a[128:131], v[68:71], 0
  ds_read_b128 v[88:91], v3 offset:6144
  s_waitcnt lgkmcnt(3)
  v_mfma_f32_16x16x32_bf16 v[40:43], a[132:135], v[76:79], v[40:43]
  ds_read_b128 v[92:95], v3 offset:7168
  v_mfma_f32_16x16x32_bf16 v[36:39], a[136:139], v[64:67], 0
  v_mfma_f32_16x16x32_bf16 v[36:39], a[140:143], v[72:75], v[36:39]
  v_mfma_f32_16x16x32_bf16 v[44:47], a[136:139], v[68:71], 0
  v_mfma_f32_16x16x32_bf16 v[44:47], a[140:143], v[76:79], v[44:47]
  v_mfma_f32_16x16x32_bf16 v[48:51], v[64:67], v[128:131], 0
  v_mfma_f32_16x16x32_bf16 v[48:51], v[72:75], v[132:135], v[48:51]
  v_mfma_f32_16x16x32_bf16 v[56:59], v[68:71], v[128:131], 0
  v_mfma_f32_16x16x32_bf16 v[56:59], v[76:79], v[132:135], v[56:59]
  v_mfma_f32_16x16x32_bf16 v[52:55], v[64:67], v[136:139], 0
  v_mfma_f32_16x16x32_bf16 v[52:55], v[72:75], v[140:143], v[52:55]
  v_mfma_f32_16x16x32_bf16 v[60:63], v[68:71], v[136:139], 0
  v_mfma_f32_16x16x32_bf16 v[60:63], v[76:79], v[140:143], v[60:63]
  s_waitcnt lgkmcnt(3)
  v_mfma_f32_16x16x32_bf16 v[32:35], a[144:147], v[80:83], v[32:35]
  ds_read_b128 v[64:67], v3 offset:8192
  s_waitcnt lgkmcnt(2)
  v_mfma_f32_16x16x32_bf16 v[32:35], a[148:151], v[88:91], v[32:35]
  ds_read_b128 v[68:71], v3 offset:9216
  v_mfma_f32_16x16x32_bf16 v[40:43], a[144:147], v[84:87], v[40:43]
  ds_read_b128 v[72:75], v3 offset:10240
  s_waitcnt lgkmcnt(3)
  v_mfma_f32_16x16x32_bf16 v[40:43], a[148:151], v[92:95], v[40:43]
  ds_read_b128 v[76:79], v3 offset:11264
  v_mfma_f32_16x16x32_bf16 v[36:39], a[152:155], v[80:83], v[36:39]
  v_mfma_f32_16x16x32_bf16 v[36:39], a[156:159], v[88:91], v[36:39]
  v_mfma_f32_16x16x32_bf16 v[44:47], a[152:155], v[84:87], v[44:47]
  v_mfma_f32_16x16x32_bf16 v[44:47], a[156:159], v[92:95], v[44:47]
  v_mfma_f32_16x16x32_bf16 v[48:51], v[80:83], v[144:147], v[48:51]
  v_mfma_f32_16x16x32_bf16 v[48:51], v[88:91], v[148:151], v[48:51]
  v_mfma_f32_16x16x32_bf16 v[56:59], v[84:87], v[144:147], v[56:59]
  v_mfma_f32_16x16x32_bf16 v[56:59], v[92:95], v[148:151], v[56:59]
  v_mfma_f32_16x16x32_bf16 v[52:55], v[80:83], v[152:155], v[52:55]
  v_mfma_f32_16x16x32_bf16 v[52:55], v[88:91], v[156:159], v[52:55]
  v_mfma_f32_16x16x32_bf16 v[60:63], v[84:87], v[152:155], v[60:63]
  v_mfma_f32_16x16x32_bf16 v[60:63], v[92:95], v[156:159], v[60:63]
  s_waitcnt lgkmcnt(3)
  v_mfma_f32_16x16x32_bf16 v[32:35], a[160:163], v[64:67], v[32:35]
  ds_read_b128 v[80:83], v3 offset:12288
  s_waitcnt lgkmcnt(2)
  v_mfma_f32_16x16x32_bf16 v[32:35], a[164:167], v[72:75], v[32:35]
  ds_read_b128 v[84:87], v3 offset:13312
  v_mfma_f32_16x16x32_bf16 v[40:43], a[160:163], v[68:71], v[40:43]
  ds_read_b128 v[88:91], v3 offset:14336
  s_waitcnt lgkmcnt(3)
  v_mfma_f32_16x16x32_bf16 v[40:43], a[164:167], v[76:79], v[40:43]
  ds_read_b128 v[92:95], v3 offset:15360
  v_mfma_f32_16x16x32_bf16 v[36:39], a[168:171], v[64:67], v[36:39]
  v_mfma_f32_16x16x32_bf16 v[36:39], a[172:175], v[72:75], v[36:39]
  v_mfma_f32_16x16x32_bf16 v[44:47], a[168:171], v[68:71], v[44:47]
  v_mfma_f32_16x16x32_bf16 v[44:47], a[172:175], v[76:79], v[44:47]
  v_mfma_f32_16x16x32_bf16 v[48:51], v[64:67], v[160:163], v[48:51]
  v_mfma_f32_16x16x32_bf16 v[48:51], v[72:75], v[164:167], v[48:51]
  v_mfma_f32_16x16x32_bf16 v[56:59], v[68:71], v[160:163], v[56:59]
  v_mfma_f32_16x16x32_bf16 v[56:59], v[76:79], v[164:167], v[56:59]
  v_mfma_f32_16x16x32_bf16 v[52:55], v[64:67], v[168:171], v[52:55]
  v_mfma_f32_16x16x32_bf16 v[52:55], v[72:75], v[172:175], v[52:55]
  v_mfma_f32_16x16x32_bf16 v[60:63], v[68:71], v[168:171], v[60:63]
  v_mfma_f32_16x16x32_bf16 v[60:63], v[76:79], v[172:175], v[60:63]
  s_waitcnt lgkmcnt(3)
  v_mfma_f32_16x16x32_bf16 v[32:35], a[176:179], v[80:83], v[32:35]
  ds_read_b128 v[64:67], v3 offset:16384
  s_waitcnt lgkmcnt(2)
  v_mfma_f32_16x16x32_bf16 v[32:35], a[180:183], v[88:91], v[32:35]
  ds_read_b128 v[68:71], v3 offset:17408
  v_mfma_f32_16x16x32_bf16 v[40:43], a[176:179], v[84:87], v[40:43]
  ds_read_b128 v[72:75], v3 offset:18432
  s_waitcnt lgkmcnt(3)
  v_mfma_f32_16x16x32_bf16 v[40:43], a[180:183], v[92:95], v[40:43]
  ds_read_b128 v[76:79], v3 offset:19456
  v_mfma_f32_16x16x32_bf16 v[36:39], a[184:187], v[80:83], v[36:39]
  v_mfma_f32_16x16x32_bf16 v[36:39], a[188:191], v[88:91], v[36:39]
  v_mfma_f32_16x16x32_bf16 v[44:47], a[184:187], v[84:87], v[44:47]
  v_mfma_f32_16x16x32_bf16 v[44:47], a[188:191], v[92:95], v[44:47]
  v_mfma_f32_16x16x32_bf16 v[48:51], v[80:83], v[176:179], v[48:51]
  v_mfma_f32_16x16x32_bf16 v[48:51], v[88:91], v[180:183], v[48:51]
  v_mfma_f32_16x16x32_bf16 v[56:59], v[84:87], v[176:179], v[56:59]
  v_mfma_f32_16x16x32_bf16 v[56:59], v[92:95], v[180:183], v[56:59]
  v_mfma_f32_16x16x32_bf16 v[52:55], v[80:83], v[184:187], v[52:55]
  v_mfma_f32_16x16x32_bf16 v[52:55], v[88:91], v[188:191], v[52:55]
  v_mfma_f32_16x16x32_bf16 v[60:63], v[84:87], v[184:187], v[60:63]
  v_mfma_f32_16x16x32_bf16 v[60:63], v[92:95], v[188:191], v[60:63]
  s_waitcnt lgkmcnt(3)
  v_mfma_f32_16x16x32_bf16 v[32:35], a[192:195], v[64:67], v[32:35]
  ds_read_b128 v[80:83], v3 offset:20480
  s_waitcnt lgkmcnt(2)
  v_mfma_f32_16x16x32_bf16 v[32:35], a[196:199], v[72:75], v[32:35]
  ds_read_b128 v[84:87], v3 offset:21504
  v_mfma_f32_16x16x32_bf16 v[40:43], a[192:195], v[68:71], v[40:43]
  ds_read_b128 v[88:91], v3 offset:22528
  s_waitcnt lgkmcnt(3)
  v_mfma_f32_16x16x32_bf16 v[40:43], a[196:199], v[76:79], v[40:43]
  ds_read_b128 v[92:95], v3 offset:23552
  v_mfma_f32_16x16x32_bf16 v[36:39], a[200:203], v[64:67], v[36:39]
  v_mfma_f32_16x16x32_bf16 v[36:39], a[204:207], v[72:75], v[36:39]
  v_mfma_f32_16x16x32_bf16 v[44:47], a[200:203], v[68:71], v[44:47]
  v_mfma_f32_16x16x32_bf16 v[44:47], a[204:207], v[76:79], v[44:47]
  v_mfma_f32_16x16x32_bf16 v[48:51], v[64:67], v[192:195], v[48:51]
  v_mfma_f32_16x16x32_bf16 v[48:51], v[72:75], v[196:199], v[48:51]
  v_mfma_f32_16x16x32_bf16 v[56:59], v[68:71], v[192:195], v[56:59]
  v_mfma_f32_16x16x32_bf16 v[56:59], v[76:79], v[196:199], v[56:59]
  v_mfma_f32_16x16x32_bf16 v[52:55], v[64:67], v[200:203], v[52:55]
  v_mfma_f32_16x16x32_bf16 v[52:55], v[72:75], v[204:207], v[52:55]
  v_mfma_f32_16x16x32_bf16 v[60:63], v[68:71], v[200:203], v[60:63]
  v_mfma_f32_16x16x32_bf16 v[60:63], v[76:79], v[204:207], v[60:63]
  s_waitcnt lgkmcnt(3)
  v_mfma_f32_16x16x32_bf16 v[32:35], a[208:211], v[80:83], v[32:35]
  ds_read_b128 v[64:67], v3 offset:24576
  s_waitcnt lgkmcnt(2)
  v_mfma_f32_16x16x32_bf16 v[32:35], a[212:215], v[88:91], v[32:35]
  ds_read_b128 v[68:71], v3 offset:25600
  v_mfma_f32_16x16x32_bf16 v[40:43], a[208:211], v[84:87], v[40:43]
  ds_read_b128 v[72:75], v3 offset:26624
  s_waitcnt lgkmcnt(3)
  v_mfma_f32_16x16x32_bf16 v[40:43], a[212:215], v[92:95], v[40:43]
  ds_read_b128 v[76:79], v3 offset:27648
  v_mfma_f32_16x16x32_bf16 v[36:39], a[216:219], v[80:83], v[36:39]
  v_mfma_f32_16x16x32_bf16 v[36:39], a[220:223], v[88:91], v[36:39]
  v_mfma_f32_16x16x32_bf16 v[44:47], a[216:219], v[84:87], v[44:47]
  v_mfma_f32_16x16x32_bf16 v[44:47], a[220:223], v[92:95], v[44:47]
  v_mfma_f32_16x16x32_bf16 v[48:51], v[80:83], v[208:211], v[48:51]
  v_mfma_f32_16x16x32_bf16 v[48:51], v[88:91], v[212:215], v[48:51]
  v_mfma_f32_16x16x32_bf16 v[56:59], v[84:87], v[208:211], v[56:59]
  v_mfma_f32_16x16x32_bf16 v[56:59], v[92:95], v[212:215], v[56:59]
  v_mfma_f32_16x16x32_bf16 v[52:55], v[80:83], v[216:219], v[52:55]
  v_mfma_f32_16x16x32_bf16 v[52:55], v[88:91], v[220:223], v[52:55]
  v_mfma_f32_16x16x32_bf16 v[60:63], v[84:87], v[216:219], v[60:63]
  v_mfma_f32_16x16x32_bf16 v[60:63], v[92:95], v[220:223], v[60:63]
  s_waitcnt lgkmcnt(3)
  v_mfma_f32_16x16x32_bf16 v[32:35], a[224:227], v[64:67], v[32:35]
  ds_read_b128 v[80:83], v3 offset:28672
  s_waitcnt lgkmcnt(2)
  v_mfma_f32_16x16x32_bf16 v[32:35], a[228:231], v[72:75], v[32:35]
  ds_read_b128 v[84:87], v3 offset:29696
  v_mfma_f32_16x16x32_bf16 v[40:43], a[224:227], v[68:71], v[40:43]
  ds_read_b128 v[88:91], v3 offset:30720
  s_waitcnt lgkmcnt(3)
  v_mfma_f32_16x16x32_bf16 v[40:43], a[228:231], v[76:79], v[40:43]
  ds_read_b128 v[92:95], v3 offset:31744
  v_mfma_f32_16x16x32_bf16 v[36:39], a[232:235], v[64:67], v[36:39]
  v_mfma_f32_16x16x32_bf16 v[36:39], a[236:239], v[72:75], v[36:39]
  v_mfma_f32_16x16x32_bf16 v[44:47], a[232:235], v[68:71], v[44:47]
  v_mfma_f32_16x16x32_bf16 v[44:47], a[236:239], v[76:79], v[44:47]
  v_mfma_f32_16x16x32_bf16 v[48:51], v[64:67], v[224:227], v[48:51]
  v_mfma_f32_16x16x32_bf16 v[48:51], v[72:75], v[228:231], v[48:51]
  v_mfma_f32_16x16x32_bf16 v[56:59], v[68:71], v[224:227], v[56:59]
  v_mfma_f32_16x16x32_bf16 v[56:59], v[76:79], v[228:231], v[56:59]
  v_mfma_f32_16x16x32_bf16 v[52:55], v[64:67], v[232:235], v[52:55]
  v_mfma_f32_16x16x32_bf16 v[52:55], v[72:75], v[236:239], v[52:55]
  v_mfma_f32_16x16x32_bf16 v[60:63], v[68:71], v[232:235], v[60:63]
  v_mfma_f32_16x16x32_bf16 v[60:63], v[76:79], v[236:239], v[60:63]
  s_waitcnt lgkmcnt(3)
  v_mfma_f32_16x16x32_bf16 v[32:35], a[240:243], v[80:83], v[32:35]
  ds_read_b128 v[64:67], v3 offset:0
  s_waitcnt lgkmcnt(2)
  v_mfma_f32_16x16x32_bf16 v[32:35], a[244:247], v[88:91], v[32:35]
  ds_read_b128 v[68:71], v3 offset:1024
  v_mfma_f32_16x16x32_bf16 v[40:43], a[240:243], v[84:87], v[40:43]
  ds_read_b128 v[72:75], v3 offset:2048
  s_waitcnt lgkmcnt(3)
  v_mfma_f32_16x16x32_bf16 v[40:43], a[244:247], v[92:95], v[40:43]
  ds_read_b128 v[76:79], v3 offset:3072
  v_mfma_f32_16x16x32_bf16 v[36:39], a[248:251], v[80:83], v[36:39]
  v_mfma_f32_16x16x32_bf16 v[36:39], a[252:255], v[88:91], v[36:39]
  v_mfma_f32_16x16x32_bf16 v[44:47], a[248:251], v[84:87], v[44:47]
  v_mfma_f32_16x16x32_bf16 v[44:47], a[252:255], v[92:95], v[44:47]
  v_mfma_f32_16x16x32_bf16 v[48:51], v[80:83], v[240:243], v[48:51]
  v_mfma_f32_16x16x32_bf16 v[48:51], v[88:91], v[244:247], v[48:51]
  v_mfma_f32_16x16x32_bf16 v[56:59], v[84:87], v[240:243], v[56:59]
  v_mfma_f32_16x16x32_bf16 v[56:59], v[92:95], v[244:247], v[56:59]
  v_mfma_f32_16x16x32_bf16 v[52:55], v[80:83], v[248:251], v[52:55]
  v_mfma_f32_16x16x32_bf16 v[52:55], v[88:91], v[252:255], v[52:55]
  v_mfma_f32_16x16x32_bf16 v[60:63], v[84:87], v[248:251], v[60:63]
  v_mfma_f32_16x16x32_bf16 v[60:63], v[92:95], v[252:255], v[60:63]
  s_waitcnt lgkmcnt(3)
  v_mfma_f32_16x16x32_bf16 v[16:19], a[0:3], v[64:67], 0
  ds_read_b128 v[80:83], v3 offset:4096
  s_waitcnt lgkmcnt(2)
  v_mfma_f32_16x16x32_bf16 v[16:19], a[4:7], v[72:75], v[16:19]
  ds_read_b128 v[84:87], v3 offset:5120
  v_mfma_f32_16x16x32_bf16 v[24:27], a[0:3], v[68:71], 0
  ds_read_b128 v[88:91], v3 offset:6144
  v_cvt_pk_bf16_f32 v104, v32, v36
  s_waitcnt lgkmcnt(3)
  v_mfma_f32_16x16x32_bf16 v[24:27], a[4:7], v[76:79], v[24:27]
  ds_read_b128 v[92:95], v3 offset:7168
  v_cvt_pk_bf16_f32 v105, v33, v37
  v_mfma_f32_16x16x32_bf16 v[20:23], a[8:11], v[64:67], 0
  v_cvt_pk_bf16_f32 v106, v34, v38
  v_cvt_pk_bf16_f32 v107, v35, v39
  v_mfma_f32_16x16x32_bf16 v[20:23], a[12:15], v[72:75], v[20:23]
  buffer_store_dwordx4 v[104:107], v1, s[36:39], s78 offen offset:0 sc1
  v_mfma_f32_16x16x32_bf16 v[28:31], a[8:11], v[68:71], 0
  ds_write_b128 v4, v[104:107] offset:8192
  v_mfma_f32_16x16x32_bf16 v[28:31], a[12:15], v[76:79], v[28:31]
  v_cvt_pk_bf16_f32 v108, v40, v44
  v_cvt_pk_bf16_f32 v109, v41, v45
  s_waitcnt lgkmcnt(4)
  v_mfma_f32_16x16x32_bf16 v[16:19], a[16:19], v[80:83], v[16:19]
  ds_read_b128 v[64:67], v3 offset:8192
  v_cvt_pk_bf16_f32 v110, v42, v46
  s_waitcnt lgkmcnt(3)
  v_mfma_f32_16x16x32_bf16 v[16:19], a[20:23], v[88:91], v[16:19]
  ds_read_b128 v[68:71], v3 offset:9216
  v_cvt_pk_bf16_f32 v111, v43, v47
  v_mfma_f32_16x16x32_bf16 v[24:27], a[16:19], v[84:87], v[24:27]
  ds_read_b128 v[72:75], v3 offset:10240
  s_waitcnt lgkmcnt(4)
  v_mfma_f32_16x16x32_bf16 v[24:27], a[20:23], v[92:95], v[24:27]
  ds_read_b128 v[76:79], v3 offset:11264
  v_mfma_f32_16x16x32_bf16 v[20:23], a[24:27], v[80:83], v[20:23]
  buffer_store_dwordx4 v[108:111], v1, s[36:39], s78 offen offset:1024 sc1
  v_mfma_f32_16x16x32_bf16 v[20:23], a[28:31], v[88:91], v[20:23]
  ds_write_b128 v4, v[108:111] offset:9216
  v_mfma_f32_16x16x32_bf16 v[28:31], a[24:27], v[84:87], v[28:31]
  v_cvt_pk_bf16_f32 v112, v48, v56
  v_cvt_pk_bf16_f32 v113, v49, v57
  v_mfma_f32_16x16x32_bf16 v[28:31], a[28:31], v[92:95], v[28:31]
  v_cvt_pk_bf16_f32 v114, v50, v58
  v_cvt_pk_bf16_f32 v115, v51, v59
  s_waitcnt lgkmcnt(4)
  v_mfma_f32_16x16x32_bf16 v[16:19], a[32:35], v[64:67], v[16:19]
  ds_read_b128 v[80:83], v3 offset:12288
  s_waitcnt lgkmcnt(3)
  v_mfma_f32_16x16x32_bf16 v[16:19], a[36:39], v[72:75], v[16:19]
  ds_read_b128 v[84:87], v3 offset:13312
  v_mfma_f32_16x16x32_bf16 v[24:27], a[32:35], v[68:71], v[24:27]
  ds_read_b128 v[88:91], v3 offset:14336
  s_waitcnt lgkmcnt(4)
  v_mfma_f32_16x16x32_bf16 v[24:27], a[36:39], v[76:79], v[24:27]
  ds_read_b128 v[92:95], v3 offset:15360
  v_mfma_f32_16x16x32_bf16 v[20:23], a[40:43], v[64:67], v[20:23]
  buffer_store_dwordx4 v[112:115], v1, s[36:39], s79 offen offset:0 sc1
  v_mfma_f32_16x16x32_bf16 v[20:23], a[44:47], v[72:75], v[20:23]
  ds_write_b128 v4, v[112:115] offset:16384
  v_mfma_f32_16x16x32_bf16 v[28:31], a[40:43], v[68:71], v[28:31]
  v_cvt_pk_bf16_f32 v116, v52, v60
  v_cvt_pk_bf16_f32 v117, v53, v61
  v_mfma_f32_16x16x32_bf16 v[28:31], a[44:47], v[76:79], v[28:31]
  v_cvt_pk_bf16_f32 v118, v54, v62
  v_cvt_pk_bf16_f32 v119, v55, v63
  s_waitcnt lgkmcnt(4)
  v_mfma_f32_16x16x32_bf16 v[16:19], a[48:51], v[80:83], v[16:19]
  ds_read_b128 v[64:67], v3 offset:16384
  s_waitcnt lgkmcnt(3)
  v_mfma_f32_16x16x32_bf16 v[16:19], a[52:55], v[88:91], v[16:19]
  ds_read_b128 v[68:71], v3 offset:17408
  v_mfma_f32_16x16x32_bf16 v[24:27], a[48:51], v[84:87], v[24:27]
  ds_read_b128 v[72:75], v3 offset:18432
  s_waitcnt lgkmcnt(4)
  v_mfma_f32_16x16x32_bf16 v[24:27], a[52:55], v[92:95], v[24:27]
  ds_read_b128 v[76:79], v3 offset:19456
  v_mfma_f32_16x16x32_bf16 v[20:23], a[56:59], v[80:83], v[20:23]
  buffer_store_dwordx4 v[116:119], v1, s[36:39], s79 offen offset:1024 sc1
  v_mfma_f32_16x16x32_bf16 v[20:23], a[60:63], v[88:91], v[20:23]
  ds_write_b128 v4, v[116:119] offset:17408
  v_mfma_f32_16x16x32_bf16 v[28:31], a[56:59], v[84:87], v[28:31]
  buffer_store_dwordx4 v[120:123], v2, s[36:39], s84 offen sc1
  v_mfma_f32_16x16x32_bf16 v[28:31], a[60:63], v[92:95], v[28:31]
  buffer_store_dwordx4 v[120:123], v2, s[36:39], s85 offen sc1
  s_waitcnt lgkmcnt(4)
  v_mfma_f32_16x16x32_bf16 v[16:19], a[64:67], v[64:67], v[16:19]
  ds_read_b128 v[80:83], v3 offset:20480
  s_waitcnt lgkmcnt(3)
  v_mfma_f32_16x16x32_bf16 v[16:19], a[68:71], v[72:75], v[16:19]
  ds_read_b128 v[84:87], v3 offset:21504
  v_mfma_f32_16x16x32_bf16 v[24:27], a[64:67], v[68:71], v[24:27]
  ds_read_b128 v[88:91], v3 offset:22528
  s_waitcnt lgkmcnt(4)
  v_mfma_f32_16x16x32_bf16 v[24:27], a[68:71], v[76:79], v[24:27]
  ds_read_b128 v[92:95], v3 offset:23552
  v_mfma_f32_16x16x32_bf16 v[20:23], a[72:75], v[64:67], v[20:23]
  v_mfma_f32_16x16x32_bf16 v[20:23], a[76:79], v[72:75], v[20:23]
  v_mfma_f32_16x16x32_bf16 v[28:31], a[72:75], v[68:71], v[28:31]
  v_mfma_f32_16x16x32_bf16 v[28:31], a[76:79], v[76:79], v[28:31]
  s_waitcnt lgkmcnt(3)
  v_mfma_f32_16x16x32_bf16 v[16:19], a[80:83], v[80:83], v[16:19]
  ds_read_b128 v[64:67], v3 offset:24576
  s_waitcnt lgkmcnt(2)
  v_mfma_f32_16x16x32_bf16 v[16:19], a[84:87], v[88:91], v[16:19]
  ds_read_b128 v[68:71], v3 offset:25600
  v_mfma_f32_16x16x32_bf16 v[24:27], a[80:83], v[84:87], v[24:27]
  ds_read_b128 v[72:75], v3 offset:26624
  s_waitcnt lgkmcnt(3)
  v_mfma_f32_16x16x32_bf16 v[24:27], a[84:87], v[92:95], v[24:27]
  ds_read_b128 v[76:79], v3 offset:27648
  v_mfma_f32_16x16x32_bf16 v[20:23], a[88:91], v[80:83], v[20:23]
  v_mfma_f32_16x16x32_bf16 v[20:23], a[92:95], v[88:91], v[20:23]
  v_mfma_f32_16x16x32_bf16 v[28:31], a[88:91], v[84:87], v[28:31]
  v_mfma_f32_16x16x32_bf16 v[28:31], a[92:95], v[92:95], v[28:31]
  s_waitcnt lgkmcnt(3)
  v_mfma_f32_16x16x32_bf16 v[16:19], a[96:99], v[64:67], v[16:19]
  ds_read_b128 v[80:83], v3 offset:28672
  s_waitcnt lgkmcnt(2)
  v_mfma_f32_16x16x32_bf16 v[16:19], a[100:103], v[72:75], v[16:19]
  ds_read_b128 v[84:87], v3 offset:29696
  v_mfma_f32_16x16x32_bf16 v[24:27], a[96:99], v[68:71], v[24:27]
  ds_read_b128 v[88:91], v3 offset:30720
  s_waitcnt lgkmcnt(3)
  v_mfma_f32_16x16x32_bf16 v[24:27], a[100:103], v[76:79], v[24:27]
  ds_read_b128 v[92:95], v3 offset:31744
  v_mfma_f32_16x16x32_bf16 v[20:23], a[104:107], v[64:67], v[20:23]
  v_mfma_f32_16x16x32_bf16 v[20:23], a[108:111], v[72:75], v[20:23]
  v_mfma_f32_16x16x32_bf16 v[28:31], a[104:107], v[68:71], v[28:31]
  v_mfma_f32_16x16x32_bf16 v[28:31], a[108:111], v[76:79], v[28:31]
  s_waitcnt lgkmcnt(3)
  v_mfma_f32_16x16x32_bf16 v[16:19], a[112:115], v[80:83], v[16:19]
  s_waitcnt lgkmcnt(1)
  v_mfma_f32_16x16x32_bf16 v[16:19], a[116:119], v[88:91], v[16:19]
  v_mfma_f32_16x16x32_bf16 v[24:27], a[112:115], v[84:87], v[24:27]
  s_waitcnt lgkmcnt(0)
  v_mfma_f32_16x16x32_bf16 v[24:27], a[116:119], v[92:95], v[24:27]
  v_mfma_f32_16x16x32_bf16 v[20:23], a[120:123], v[80:83], v[20:23]
  v_mfma_f32_16x16x32_bf16 v[20:23], a[124:127], v[88:91], v[20:23]
  v_mfma_f32_16x16x32_bf16 v[28:31], a[120:123], v[84:87], v[28:31]
  v_mfma_f32_16x16x32_bf16 v[28:31], a[124:127], v[92:95], v[28:31]
L_head_q:
  v_cvt_pk_bf16_f32 v96, v16, v20
  v_cvt_pk_bf16_f32 v97, v17, v21
  v_cvt_pk_bf16_f32 v98, v18, v22
  v_cvt_pk_bf16_f32 v99, v19, v23
  ds_write_b128 v4, v[96:99] offset:0
  s_nop 1
  v_cvt_pk_bf16_f32 v100, v24, v28
  v_cvt_pk_bf16_f32 v101, v25, v29
  v_cvt_pk_bf16_f32 v102, v26, v30
  v_cvt_pk_bf16_f32 v103, v27, v31
  ds_write_b128 v4, v[100:103] offset:1024
  s_waitcnt vmcnt(0) lgkmcnt(0)
  s_barrier
  s_cmp_lg_u32 s34, 0
  s_cbranch_scc1 L_noflag_123
  s_lshl_b32 s78, s65, 11
  s_lshl_b32 s79, s64, 2
  s_add_u32 s78, s78, s79
  s_add_u32 s78, s78, 0x580000
  s_cmp_eq_u32 s65, 2
  s_movk_i32 s80, 160
  s_cselect_b32 s79, s80, 0x1000
  s_mov_b64 exec, 1
  buffer_atomic_add v9, off, s[40:43], s79 sc1
  buffer_store_dword v9, off, s[36:39], s78 sc1
  s_mov_b64 exec, -1
L_noflag_123:
  s_cmp_ge_u32 s65, 61
  s_cbranch_scc1 L_nopf_124
  s_cmp_eq_u32 s66, 0
  s_cbranch_scc1 L_nopf_124
  s_add_u32 s81, s65, 3
  s_xor_b32 s82, s68, 1
  s_lshl_b32 s78, s81, 15
  s_lshl_b32 s79, s34, 13
  s_add_u32 s78, s78, s79
  s_add_u32 s78, s78, 0x0
  s_xor_b32 s80, s82, 1
  s_lshl_b32 s80, s80, 17
  s_add_u32 s79, s79, s80
  s_lshr_b32 s80, s83, 9
  s_add_u32 s78, s78, s80
  s_add_u32 m0, s79, 0
  s_xor_b32 s80, s78, 0
  buffer_load_dwordx4 v2, s[36:39], s80 offen offset:0 sc1 lds
  buffer_load_dwordx4 v2, s[36:39], s80 offen offset:1024 sc1 lds
  s_add_u32 m0, s79, 2048
  s_xor_b32 s80, s78, 2048
  buffer_load_dwordx4 v2, s[36:39], s80 offen offset:0 sc1 lds
  buffer_load_dwordx4 v2, s[36:39], s80 offen offset:1024 sc1 lds
  s_add_u32 m0, s79, 4096
  s_xor_b32 s80, s78, 4096
  buffer_load_dwordx4 v2, s[36:39], s80 offen offset:0 sc1 lds
  buffer_load_dwordx4 v2, s[36:39], s80 offen offset:1024 sc1 lds
  s_add_u32 m0, s79, 6144
  s_xor_b32 s80, s78, 6144
  buffer_load_dwordx4 v2, s[36:39], s80 offen offset:0 sc1 lds
  buffer_load_dwordx4 v2, s[36:39], s80 offen offset:1024 sc1 lds
L_nopf_124:
  s_cmp_lg_u32 s65, 4
  s_cbranch_scc1 L_notsecond_125
  v_add_u32 v124, 0x10000, v2
  v_add_u32 v125, 0x10000, v1
  v_add_u32 v126, 0x1c000, v2
  ds_read_b128 v[16:19], v124 offset:8192
  ds_read_b128 v[20:23], v124 offset:9216
  ds_read_b128 v[24:27], v124 offset:10240
  ds_read_b128 v[28:31], v124 offset:11264
  ds_read_b128 v[32:35], v124 offset:12288
  ds_read_b128 v[36:39], v124 offset:13312
  ds_read_b128 v[40:43], v124 offset:14336
  ds_read_b128 v[44:47], v124 offset:15360
  ds_read_b128 v[104:107], v125 offset:16384
  ds_read_b128 v[108:111], v125 offset:17408
  v_mov_b64 v[80:81], 0
  v_mov_b64 v[82:83], 0
  v_mov_b64 v[84:85], 0
  v_mov_b64 v[86:87], 0
  v_mov_b64 v[88:89], 0
  v_mov_b64 v[90:91], 0
  v_mov_b64 v[92:93], 0
  v_mov_b64 v[94:95], 0
  v_mov_b64 v[96:97], 0
  v_mov_b64 v[98:99], 0
  v_mov_b64 v[100:101], 0
  v_mov_b64 v[102:103], 0
  v_lshrrev_b32 v112, 4, v0
  v_and_b32 v113, 1, v112
  v_lshlrev_b32 v113, 2, v113
  v_bfe_u32 v114, v0, 1, 3
  v_xor_b32 v113, v113, v114
  v_lshlrev_b32 v113, 4, v113
  v_lshl_add_u32 v127, v112, 7, v113
  v_add_u32 v127, 0x1e000, v127
  s_lshr_b32 s80, s83, 11
  v_add_u32 v116, 0x1c000, v1
  v_xor_b32 v116, s80, v116
  v_xor_b32 v117, 0x400, v116
  s_mov_b32 s78, 0x402000
  s_waitcnt lgkmcnt(0)
L_spin_126:
  buffer_load_dwordx4 v[48:51], v14, s[36:39], s78 offen sc1
  buffer_load_dwordx4 v[52:55], v14, s[36:39], s78 offen offset:2048 sc1
  s_waitcnt vmcnt(0)
  v_max3_u32 v120, v48, v49, v50
  v_max3_u32 v120, v120, v51, v52
  v_max3_u32 v120, v120, v53, v54
  v_max_u32 v120, v120, v55
  v_cmp_eq_u32 vcc, -1, v120
  s_cbranch_vccz L_ok_127
  s_sub_u32 s3, s3, 1
  s_cbranch_scc1 L_end
  s_branch L_spin_126
L_ok_127:
  ds_write_b128 v116, v[48:51]
  ds_write_b128 v117, v[52:55]
  s_waitcnt lgkmcnt(0)
  s_barrier
  ds_read_b128 v[48:51], v126 offset:0
  ds_read_b128 v[52:55], v126 offset:1024
  ds_read_b128 v[56:59], v126 offset:2048
  ds_read_b128 v[60:63], v126 offset:3072
  ds_read_b128 v[64:67], v126 offset:4096
  ds_read_b128 v[68:71], v126 offset:5120
  ds_read_b128 v[72:75], v126 offset:6144
  ds_read_b128 v[76:79], v126 offset:7168
  s_waitcnt lgkmcnt(7)
  v_smfmac_f32_16x16x64_bf16 v[80:83], v[48:51], a[0:7], v8
  s_waitcnt lgkmcnt(6)
  v_smfmac_f32_16x16x64_bf16 v[80:83], v[52:55], a[16:23], v8
  s_waitcnt lgkmcnt(5)
  v_smfmac_f32_16x16x64_bf16 v[80:83], v[56:59], a[32:39], v8
  s_waitcnt lgkmcnt(4)
  v_smfmac_f32_16x16x64_bf16 v[80:83], v[60:63], a[48:55], v8
  s_waitcnt lgkmcnt(3)
  v_smfmac_f32_16x16x64_bf16 v[80:83], v[64:67], a[64:71], v8
  s_waitcnt lgkmcnt(2)
  v_smfmac_f32_16x16x64_bf16 v[80:83], v[68:71], a[80:87], v8
  s_waitcnt lgkmcnt(1)
  v_smfmac_f32_16x16x64_bf16 v[80:83], v[72:75], a[96:103], v8
  s_waitcnt lgkmcnt(0)
  v_smfmac_f32_16x16x64_bf16 v[80:83], v[76:79], a[112:119], v8
  v_smfmac_f32_16x16x64_bf16 v[84:87], v[48:51], a[8:15], v8
  v_smfmac_f32_16x16x64_bf16 v[84:87], v[52:55], a[24:31], v8
  v_smfmac_f32_16x16x64_bf16 v[84:87], v[56:59], a[40:47], v8
  v_smfmac_f32_16x16x64_bf16 v[84:87], v[60:63], a[56:63], v8
  v_smfmac_f32_16x16x64_bf16 v[84:87], v[64:67], a[72:79], v8
  v_smfmac_f32_16x16x64_bf16 v[84:87], v[68:71], a[88:95], v8
  v_smfmac_f32_16x16x64_bf16 v[84:87], v[72:75], a[104:111], v8
  v_smfmac_f32_16x16x64_bf16 v[84:87], v[76:79], a[120:127], v8
  v_smfmac_f32_16x16x64_bf16 v[88:91], v[48:51], a[128:135], v8
  v_smfmac_f32_16x16x64_bf16 v[88:91], v[52:55], a[144:151], v8
  v_smfmac_f32_16x16x64_bf16 v[88:91], v[56:59], a[160:167], v8
  v_add_f32 v112, v80, v81
  v_smfmac_f32_16x16x64_bf16 v[88:91], v[60:63], a[176:183], v8
  v_mul_f32 v112, s67, v112
  v_smfmac_f32_16x16x64_bf16 v[88:91], v[64:67], a[192:199], v8
  v_add_f32 v113, v84, v85
  v_smfmac_f32_16x16x64_bf16 v[88:91], v[68:71], a[208:215], v8
  v_mul_f32 v113, s67, v113
  v_smfmac_f32_16x16x64_bf16 v[88:91], v[72:75], a[224:231], v8
  v_add_f32 v114, v82, v83
  v_smfmac_f32_16x16x64_bf16 v[88:91], v[76:79], a[240:247], v8
  v_mul_f32 v114, s67, v114
  v_smfmac_f32_16x16x64_bf16 v[92:95], v[48:51], a[136:143], v8
  v_add_f32 v115, v86, v87
  v_smfmac_f32_16x16x64_bf16 v[92:95], v[52:55], a[152:159], v8
  v_mul_f32 v115, s67, v115
  v_smfmac_f32_16x16x64_bf16 v[92:95], v[56:59], a[168:175], v8
  v_cvt_pk_bf16_f32 v112, v112, v113
  v_smfmac_f32_16x16x64_bf16 v[92:95], v[60:63], a[184:191], v8
  v_cvt_pk_bf16_f32 v113, v114, v115
  v_smfmac_f32_16x16x64_bf16 v[92:95], v[64:67], a[200:207], v8
  ds_write2_b32 v6, v112, v113 offset0:0 offset1:4
  v_smfmac_f32_16x16x64_bf16 v[92:95], v[68:71], a[216:223], v8
  v_smfmac_f32_16x16x64_bf16 v[92:95], v[72:75], a[232:239], v8
  v_smfmac_f32_16x16x64_bf16 v[92:95], v[76:79], a[248:255], v8
  v_smfmac_f32_16x16x64_bf16 v[96:99], v[48:51], v[128:135], v8
  v_smfmac_f32_16x16x64_bf16 v[96:99], v[52:55], v[144:151], v8
  v_add_f32 v116, v88, v89
  v_smfmac_f32_16x16x64_bf16 v[96:99], v[56:59], v[160:167], v8
  v_add_f32 v117, v92, v93
  v_smfmac_f32_16x16x64_bf16 v[96:99], v[60:63], v[176:183], v8
  v_add_f32 v118, v90, v91
  v_smfmac_f32_16x16x64_bf16 v[96:99], v[64:67], v[192:199], v8
  v_add_f32 v119, v94, v95
  v_smfmac_f32_16x16x64_bf16 v[96:99], v[68:71], v[208:215], v8
  v_cvt_pk_bf16_f32 v116, v116, v117
  v_smfmac_f32_16x16x64_bf16 v[96:99], v[72:75], v[224:231], v8
  v_cvt_pk_bf16_f32 v117, v118, v119
  v_smfmac_f32_16x16x64_bf16 v[96:99], v[76:79], v[240:247], v8
  ds_write2_b32 v6, v116, v117 offset0:128 offset1:132
  v_smfmac_f32_16x16x64_bf16 v[100:103], v[48:51], v[136:143], v8
  v_smfmac_f32_16x16x64_bf16 v[100:103], v[52:55], v[152:159], v8
  v_smfmac_f32_16x16x64_bf16 v[100:103], v[56:59], v[168:175], v8
  v_smfmac_f32_16x16x64_bf16 v[100:103], v[60:63], v[184:191], v8
  s_waitcnt lgkmcnt(0)
  s_barrier
  v_smfmac_f32_16x16x64_bf16 v[100:103], v[64:67], v[200:207], v8
  ds_read_b128 v[48:51], v127 offset:0
  v_smfmac_f32_16x16x64_bf16 v[100:103], v[68:71], v[216:223], v8
  ds_read_b128 v[52:55], v127 offset:1024
  v_smfmac_f32_16x16x64_bf16 v[100:103], v[72:75], v[232:239], v8
  ds_read_b128 v[56:59], v127 offset:2048
  v_smfmac_f32_16x16x64_bf16 v[100:103], v[76:79], v[248:255], v8
  ds_read_b128 v[60:63], v127 offset:3072
  ds_read_b128 v[64:67], v127 offset:512
  ds_read_b128 v[68:71], v127 offset:1536
  ds_read_b128 v[72:75], v127 offset:2560
  ds_read_b128 v[76:79], v127 offset:3584
  v_cvt_pk_bf16_f32 v96, v96, v97
  v_cvt_pk_bf16_f32 v97, v98, v99
  v_mov_b32 v15, 0
  v_cvt_pk_bf16_f32 v100, v100, v101
  v_cvt_pk_bf16_f32 v101, v102, v103
  s_waitcnt lgkmcnt(7)
  v_mfma_f32_16x16x32_bf16 v[112:115], v[16:19], v[48:51], 0
  s_waitcnt lgkmcnt(6)
  v_mfma_f32_16x16x32_bf16 v[112:115], v[24:27], v[52:55], v[112:115]
  s_waitcnt lgkmcnt(5)
  v_mfma_f32_16x16x32_bf16 v[112:115], v[32:35], v[56:59], v[112:115]
  s_waitcnt lgkmcnt(4)
  v_mfma_f32_16x16x32_bf16 v[112:115], v[40:43], v[60:63], v[112:115]
  v_mfma_f32_16x16x32_bf16 v[116:119], v[20:23], v[48:51], 0
  v_mfma_f32_16x16x32_bf16 v[116:119], v[28:31], v[52:55], v[116:119]
  v_mfma_f32_16x16x32_bf16 v[116:119], v[36:39], v[56:59], v[116:119]
  v_mfma_f32_16x16x32_bf16 v[116:119], v[44:47], v[60:63], v[116:119]
  s_waitcnt lgkmcnt(3)
  v_mfma_f32_16x16x32_bf16 v[120:123], v[64:67], v[48:51], 0
  s_waitcnt lgkmcnt(2)
  v_mfma_f32_16x16x32_bf16 v[120:123], v[68:71], v[52:55], v[120:123]
  s_waitcnt lgkmcnt(1)
  v_mfma_f32_16x16x32_bf16 v[120:123], v[72:75], v[56:59], v[120:123]
  s_waitcnt lgkmcnt(0)
  v_mfma_f32_16x16x32_bf16 v[120:123], v[76:79], v[60:63], v[120:123]
  v_max_f32 v124, v112, v116
  v_max3_f32 v124, v124, v113, v117
  v_max3_f32 v124, v124, v114, v118
  v_max3_f32 v124, v124, v115, v119
  v_mov_b32 v15, 0
  v_mov_b32 v15, 0
  v_mov_b32 v15, 0
  v_max3_f32 v124, v124, v120, v122
  v_mov_b32 v126, v124
  v_mov_b32 v15, 0
  v_mov_b32 v15, 0
  v_permlane32_swap_b32 v124, v126
  v_max_f32 v124, v124, v126
  v_mov_b32 v126, v124
  v_mov_b32 v15, 0
  v_mov_b32 v15, 0
  v_permlane16_swap_b32 v124, v126
  v_max_f32 v124, v124, v126
  v_sub_f32 v112, v112, v124
  v_sub_f32 v116, v116, v124
  v_sub_f32 v113, v113, v124
  v_sub_f32 v117, v117, v124
  v_sub_f32 v114, v114, v124
  v_sub_f32 v118, v118, v124
  v_sub_f32 v115, v115, v124
  v_sub_f32 v119, v119, v124
  v_sub_f32 v120, v120, v124
  v_sub_f32 v122, v122, v124
  v_exp_f32 v112, v112
  v_exp_f32 v116, v116
  v_exp_f32 v113, v113
  v_exp_f32 v117, v117
  v_exp_f32 v114, v114
  v_exp_f32 v118, v118
  v_exp_f32 v115, v115
  v_exp_f32 v119, v119
  v_exp_f32 v120, v120
  v_exp_f32 v122, v122
  v_cvt_pk_bf16_f32 v80, v112, v116
  v_cvt_pk_bf16_f32 v81, v113, v117
  v_cvt_pk_bf16_f32 v82, v114, v118
  v_cvt_pk_bf16_f32 v83, v115, v119
  v_cvt_pk_bf16_f32 v84, v120, v120
  v_cvt_pk_bf16_f32 v85, v122, v122
  v_mfma_f32_16x16x32_bf16 v[88:91], v[104:107], v[80:83], 0
  v_mfma_f32_16x16x32_bf16 v[92:95], v[108:111], v[80:83], 0
  v_mfma_f32_16x16x16_bf16 v[88:91], v[96:97], v[84:85], v[88:91]
  v_mfma_f32_16x16x16_bf16 v[92:95], v[100:101], v[84:85], v[92:95]
  v_add_f32 v125, v112, v116
  v_add_f32 v125, v125, v113
  v_add_f32 v125, v125, v117
  v_add_f32 v125, v125, v114
  v_add_f32 v125, v125, v118
  v_add_f32 v125, v125, v115
  v_add_f32 v125, v125, v119
  v_add_f32 v125, v125, v120
  v_add_f32 v125, v125, v122
  v_mov_b32 v126, v125
  v_mov_b32 v15, 0
  v_mov_b32 v15, 0
  v_permlane32_swap_b32 v125, v126
  v_add_f32 v125, v125, v126
  v_mov_b32 v126, v125
  v_mov_b32 v15, 0
  v_mov_b32 v15, 0
  v_permlane16_swap_b32 v125, v126
  v_add_f32 v125, v125, v126
  v_rcp_f32 v125, v125
  v_mov_b32 v15, 0
  v_mul_f32 v88, v88, v125
  v_mul_f32 v89, v89, v125
  v_mul_f32 v90, v90, v125
  v_mul_f32 v91, v91, v125
  v_mul_f32 v92, v92, v125
  v_mul_f32 v93, v93, v125
  v_mul_f32 v94, v94, v125
  v_mul_f32 v95, v95, v125
  v_cvt_pk_bf16_f32 v80, v88, v89
  v_cvt_pk_bf16_f32 v81, v90, v91
  v_cvt_pk_bf16_f32 v82, v92, v93
  v_cvt_pk_bf16_f32 v83, v94, v95
  v_min_u32 v80, -2, v80
  s_lshl_b32 s78, s64, 2
  s_add_u32 s78, s78, s34
  s_lshl_b32 s78, s78, 10
  s_add_u32 s78, s78, 0x560000
  buffer_store_dwordx4 v[80:83], v2, s[36:39], s78 offen sc1
L_notsecond_125:
L_head_B:
  s_cmp_eq_u32 s66, 0
  s_cbranch_scc1 L_head_next
  s_xor_b32 s69, s68, 1
  s_mul_i32 s18, s69, 24576
  s_add_u32 s18, s18, 0x10000
  v_add_u32 v5, s18, v2
  v_add_u32 v10, s18, v1
  s_sub_u32 s81, s65, 3
  s_lshl_b32 s78, s81, 13
  s_add_u32 s78, s78, 0x400000
  ds_read_b128 v[16:19], v5 offset:0
  ds_read_b128 v[48:51], v5 offset:8192
  ds_read_b128 v[20:23], v5 offset:1024
  ds_read_b128 v[52:55], v5 offset:9216
  ds_read_b128 v[24:27], v5 offset:2048
  ds_read_b128 v[56:59], v5 offset:10240
  ds_read_b128 v[28:31], v5 offset:3072
  ds_read_b128 v[60:63], v5 offset:11264
  ds_read_b128 v[32:35], v5 offset:4096
  ds_read_b128 v[64:67], v5 offset:12288
  ds_read_b128 v[36:39], v5 offset:5120
  ds_read_b128 v[68:71], v5 offset:13312
  ds_read_b128 v[40:43], v5 offset:6144
  ds_read_b128 v[72:75], v5 offset:14336
  ds_read_b128 v[44:47], v5 offset:7168
  ds_read_b128 v[76:79], v5 offset:15360
  v_mov_b64 v[100:101], 0
  v_mov_b64 v[102:103], 0
  v_mov_b64 v[104:105], 0
  v_mov_b64 v[106:107], 0
  v_mov_b64 v[108:109], 0
  v_mov_b64 v[110:111], 0
  v_mov_b64 v[112:113], 0
  v_mov_b64 v[114:115], 0
  s_waitcnt lgkmcnt(14)
  v_mfma_f32_16x16x32_bf16 v[80:83], v[48:51], v[16:19], 0
  s_waitcnt lgkmcnt(13)
  v_mfma_f32_16x16x32_bf16 v[84:87], v[48:51], v[20:23], 0
  s_waitcnt lgkmcnt(12)
  v_mfma_f32_16x16x32_bf16 v[88:91], v[52:55], v[20:23], 0
  s_waitcnt lgkmcnt(10)
  v_mfma_f32_16x16x32_bf16 v[80:83], v[56:59], v[24:27], v[80:83]
  s_waitcnt lgkmcnt(9)
  v_mfma_f32_16x16x32_bf16 v[84:87], v[56:59], v[28:31], v[84:87]
  s_waitcnt lgkmcnt(8)
  v_mfma_f32_16x16x32_bf16 v[88:91], v[60:63], v[28:31], v[88:91]
  s_waitcnt lgkmcnt(6)
  v_mfma_f32_16x16x32_bf16 v[80:83], v[64:67], v[32:35], v[80:83]
  s_waitcnt lgkmcnt(5)
  v_mfma_f32_16x16x32_bf16 v[84:87], v[64:67], v[36:39], v[84:87]
  s_waitcnt lgkmcnt(4)
  v_mfma_f32_16x16x32_bf16 v[88:91], v[68:71], v[36:39], v[88:91]
  s_waitcnt lgkmcnt(2)
  v_mfma_f32_16x16x32_bf16 v[80:83], v[72:75], v[40:43], v[80:83]
  s_waitcnt lgkmcnt(1)
  v_mfma_f32_16x16x32_bf16 v[84:87], v[72:75], v[44:47], v[84:87]
  s_waitcnt lgkmcnt(0)
  v_mfma_f32_16x16x32_bf16 v[88:91], v[76:79], v[44:47], v[88:91]
  buffer_load_dwordx4 v[48:51], v14, s[36:39], s78 offen sc1
  buffer_load_dwordx4 v[52:55], v14, s[36:39], s78 offen offset:2048 sc1
  ds_read_b128 v[116:119], v10 offset:16384
  ds_read_b128 v[120:123], v10 offset:17408
  v_mul_f32 v80, s67, v80
  v_mul_f32 v81, s67, v81
  v_mul_f32 v82, s67, v82
  v_mul_f32 v83, s67, v83
  v_mul_f32 v84, s67, v84
  v_mul_f32 v85, s67, v85
  v_mul_f32 v86, s67, v86
  v_mul_f32 v87, s67, v87
  v_mul_f32 v88, s67, v88
  v_mul_f32 v89, s67, v89
  v_mul_f32 v90, s67, v90
  v_mul_f32 v91, s67, v91
  v_cndmask_b32 v80, v11, v80, s[70:71]
  v_cndmask_b32 v88, v11, v88, s[70:71]
  v_cndmask_b32 v81, v11, v81, s[72:73]
  v_cndmask_b32 v89, v11, v89, s[72:73]
  v_cndmask_b32 v82, v11, v82, s[74:75]
  v_cndmask_b32 v90, v11, v90, s[74:75]
  v_cndmask_b32 v83, v11, v83, s[76:77]
  v_cndmask_b32 v91, v11, v91, s[76:77]
  v_max_f32 v12, v80, v81
  v_max3_f32 v12, v12, v82, v83
  v_max_f32 v13, v84, v85
  v_max3_f32 v13, v13, v86, v87
  v_max3_f32 v13, v13, v88, v89
  v_max3_f32 v13, v13, v90, v91
  v_mov_b32 v124, v12
  v_mov_b32 v125, v13
  v_mov_b32 v15, 0
  v_permlane32_swap_b32 v12, v124
  v_permlane32_swap_b32 v13, v125
  v_max_f32 v12, v12, v124
  v_max_f32 v13, v13, v125
  v_mov_b32 v124, v12
  v_mov_b32 v125, v13
  v_mov_b32 v15, 0
  v_permlane16_swap_b32 v12, v124
  v_permlane16_swap_b32 v13, v125
  v_max_f32 v12, v12, v124
  v_max_f32 v13, v13, v125
  v_sub_f32 v80, v80, v12
  v_sub_f32 v81, v81, v12
  v_sub_f32 v82, v82, v12
  v_sub_f32 v83, v83, v12
  v_exp_f32 v80, v80
  v_exp_f32 v81, v81
  v_exp_f32 v82, v82
  v_exp_f32 v83, v83
  v_cvt_pk_bf16_f32 v56, v80, 0
  v_cvt_pk_bf16_f32 v57, v81, 0
  v_cvt_pk_bf16_f32 v58, v82, 0
  v_cvt_pk_bf16_f32 v59, v83, 0
  v_add_f32 v124, v80, v81
  v_add_f32 v124, v124, v82
  v_add_f32 v124, v124, v83
  v_sub_f32 v84, v84, v13
  v_sub_f32 v85, v85, v13
  v_sub_f32 v86, v86, v13
  v_sub_f32 v87, v87, v13
  v_sub_f32 v88, v88, v13
  v_sub_f32 v89, v89, v13
  v_sub_f32 v90, v90, v13
  v_sub_f32 v91, v91, v13
  v_exp_f32 v84, v84
  v_exp_f32 v85, v85
  v_exp_f32 v86, v86
  v_exp_f32 v87, v87
  v_exp_f32 v88, v88
  v_exp_f32 v89, v89
  v_exp_f32 v90, v90
  v_exp_f32 v91, v91
  v_cvt_pk_bf16_f32 v60, v84, v88
  v_cvt_pk_bf16_f32 v61, v85, v89
  v_cvt_pk_bf16_f32 v62, v86, v90
  v_cvt_pk_bf16_f32 v63, v87, v91
  v_add_f32 v125, v84, v85
  v_add_f32 v125, v125, v86
  v_add_f32 v125, v125, v87
  v_add_f32 v125, v125, v88
  v_add_f32 v125, v125, v89
  v_add_f32 v125, v125, v90
  v_add_f32 v125, v125, v91
  s_waitcnt lgkmcnt(1)
  v_mfma_f32_16x16x32_bf16 v[80:83], v[116:119], v[56:59], 0
  v_mfma_f32_16x16x32_bf16 v[84:87], v[116:119], v[60:63], 0
  s_waitcnt lgkmcnt(0)
  v_mfma_f32_16x16x32_bf16 v[88:91], v[120:123], v[56:59], 0
  v_mfma_f32_16x16x32_bf16 v[116:119], v[120:123], v[60:63], 0
  s_lshl_b32 s84, s81, 8
  s_lshl_b32 s79, s64, 2
  s_add_u32 s79, s79, s34
  s_add_u32 s84, s84, s79
  s_lshl_b32 s84, s84, 10
  s_add_u32 s84, s84, 0x1000000
  s_add_u32 s85, s84, 0x20000
  v_mov_b64 v[120:121], v[124:125]
  s_lshr_b32 s80, s83, 11
  v_add_u32 v126, 0x1c000, v1
  v_xor_b32 v126, s80, v126
  v_xor_b32 v127, 0x400, v126
  v_add_u32 v125, 0x1c000, v2
  s_waitcnt vmcnt(0)
  v_max3_u32 v124, v48, v49, v50
  v_max3_u32 v124, v124, v51, v52
  v_max3_u32 v124, v124, v53, v54
  v_max_u32 v124, v124, v55
  v_cmp_eq_u32 vcc, -1, v124
  s_cbranch_vccz L_have_128
L_spin_129:
  buffer_load_dwordx4 v[48:51], v14, s[36:39], s78 offen sc1
  buffer_load_dwordx4 v[52:55], v14, s[36:39], s78 offen offset:2048 sc1
  s_waitcnt vmcnt(0)
  v_max3_u32 v124, v48, v49, v50
  v_max3_u32 v124, v124, v51, v52
  v_max3_u32 v124, v124, v53, v54
  v_max_u32 v124, v124, v55
  v_cmp_eq_u32 vcc, -1, v124
  s_cbranch_vccz L_ok_130
  s_sub_u32 s3, s3, 1
  s_cbranch_scc1 L_end
  s_sleep 1
  s_branch L_spin_129
L_ok_130:
L_have_128:
  ds_write_b128 v126, v[48:51]
  ds_write_b128 v127, v[52:55]
  s_waitcnt lgkmcnt(0)
  s_barrier
  ds_read_b128 v[48:51], v125 offset:0
  ds_read_b128 v[52:55], v125 offset:1024
  ds_read_b128 v[56:59], v125 offset:2048
  ds_read_b128 v[60:63], v125 offset:3072
  ds_read_b128 v[64:67], v125 offset:4096
  ds_read_b128 v[68:71], v125 offset:5120
  ds_read_b128 v[72:75], v125 offset:6144
  ds_read_b128 v[76:79], v125 offset:7168
  s_waitcnt lgkmcnt(7)
  v_smfmac_f32_16x16x64_bf16 v[100:103], v[48:51], a[128:135], v8
  v_smfmac_f32_16x16x64_bf16 v[104:107], v[48:51], a[136:143], v8
  s_waitcnt lgkmcnt(6)
  v_smfmac_f32_16x16x64_bf16 v[100:103], v[52:55], a[144:151], v8
  v_smfmac_f32_16x16x64_bf16 v[104:107], v[52:55], a[152:159], v8
  s_waitcnt lgkmcnt(5)
  v_smfmac_f32_16x16x64_bf16 v[100:103], v[56:59], a[160:167], v8
  v_smfmac_f32_16x16x64_bf16 v[104:107], v[56:59], a[168:175], v8
  s_waitcnt lgkmcnt(4)
  v_smfmac_f32_16x16x64_bf16 v[100:103], v[60:63], a[176:183], v8
  v_smfmac_f32_16x16x64_bf16 v[104:107], v[60:63], a[184:191], v8
  s_waitcnt lgkmcnt(3)
  v_smfmac_f32_16x16x64_bf16 v[100:103], v[64:67], a[192:199], v8
  v_smfmac_f32_16x16x64_bf16 v[104:107], v[64:67], a[200:207], v8
  s_waitcnt lgkmcnt(2)
  v_smfmac_f32_16x16x64_bf16 v[100:103], v[68:71], a[208:215], v8
  v_smfmac_f32_16x16x64_bf16 v[104:107], v[68:71], a[216:223], v8
  s_waitcnt lgkmcnt(1)
  v_smfmac_f32_16x16x64_bf16 v[100:103], v[72:75], a[224:231], v8
  v_smfmac_f32_16x16x64_bf16 v[104:107], v[72:75], a[232:239], v8
  s_waitcnt lgkmcnt(0)
  v_smfmac_f32_16x16x64_bf16 v[100:103], v[76:79], a[240:247], v8
  v_smfmac_f32_16x16x64_bf16 v[104:107], v[76:79], a[248:255], v8
  v_smfmac_f32_16x16x64_bf16 v[108:111], v[48:51], v[128:135], v8
  v_smfmac_f32_16x16x64_bf16 v[112:115], v[48:51], v[136:143], v8
  v_add_f32 v124, v100, v101
  v_add_f32 v126, v102, v103
  v_smfmac_f32_16x16x64_bf16 v[108:111], v[52:55], v[144:151], v8
  v_add_f32 v125, v104, v105
  v_add_f32 v127, v106, v107
  v_smfmac_f32_16x16x64_bf16 v[112:115], v[52:55], v[152:159], v8
  v_cvt_pk_bf16_f32 v124, v124, v125
  v_cvt_pk_bf16_f32 v125, v126, v127
  v_smfmac_f32_16x16x64_bf16 v[108:111], v[56:59], v[160:167], v8
  ds_write2_b32 v6, v124, v125 offset0:0 offset1:4
  v_smfmac_f32_16x16x64_bf16 v[112:115], v[56:59], v[168:175], v8
  v_smfmac_f32_16x16x64_bf16 v[108:111], v[60:63], v[176:183], v8
  v_smfmac_f32_16x16x64_bf16 v[112:115], v[60:63], v[184:191], v8
  v_smfmac_f32_16x16x64_bf16 v[108:111], v[64:67], v[192:199], v8
  s_waitcnt lgkmcnt(0)
  s_barrier
  v_smfmac_f32_16x16x64_bf16 v[112:115], v[64:67], v[200:207], v8
  ds_read_b128 v[48:51], v7 offset:0
  v_smfmac_f32_16x16x64_bf16 v[108:111], v[68:71], v[208:215], v8
  ds_read_b128 v[52:55], v7 offset:1024
  v_smfmac_f32_16x16x64_bf16 v[112:115], v[68:71], v[216:223], v8
  ds_read_b128 v[56:59], v7 offset:2048
  v_smfmac_f32_16x16x64_bf16 v[108:111], v[72:75], v[224:231], v8
  ds_read_b128 v[60:63], v7 offset:3072
  v_smfmac_f32_16x16x64_bf16 v[112:115], v[72:75], v[232:239], v8
  s_waitcnt lgkmcnt(3)
  v_mfma_f32_16x16x32_bf16 v[92:95], v[48:51], v[16:19], 0
  s_waitcnt lgkmcnt(2)
  v_mfma_f32_16x16x32_bf16 v[92:95], v[52:55], v[24:27], v[92:95]
  s_waitcnt lgkmcnt(1)
  v_mfma_f32_16x16x32_bf16 v[92:95], v[56:59], v[32:35], v[92:95]
  s_waitcnt lgkmcnt(0)
  v_mfma_f32_16x16x32_bf16 v[92:95], v[60:63], v[40:43], v[92:95]
  v_mfma_f32_16x16x32_bf16 v[96:99], v[48:51], v[20:23], 0
  v_mfma_f32_16x16x32_bf16 v[96:99], v[52:55], v[28:31], v[96:99]
  v_mfma_f32_16x16x32_bf16 v[96:99], v[56:59], v[36:39], v[96:99]
  v_mfma_f32_16x16x32_bf16 v[96:99], v[60:63], v[44:47], v[96:99]
  v_smfmac_f32_16x16x64_bf16 v[108:111], v[76:79], v[240:247], v8
  v_smfmac_f32_16x16x64_bf16 v[112:115], v[76:79], v[248:255], v8
  v_mul_f32 v92, s67, v92
  v_mul_f32 v93, s67, v93
  v_max3_f32 v48, v12, v92, v93
  v_mul_f32 v96, s67, v96
  v_mul_f32 v97, s67, v97
  v_max3_f32 v49, v13, v96, v97
  v_mov_b32 v124, v48
  v_mov_b32 v125, v49
  v_mov_b32 v15, 0
  v_permlane32_swap_b32 v48, v124
  v_permlane32_swap_b32 v49, v125
  v_max_f32 v48, v48, v124
  v_max_f32 v49, v49, v125
  v_mov_b32 v124, v48
  v_mov_b32 v125, v49
  v_mov_b32 v15, 0
  v_permlane16_swap_b32 v48, v124
  v_permlane16_swap_b32 v49, v125
  v_max_f32 v48, v48, v124
  v_max_f32 v49, v49, v125
  v_sub_f32 v92, v92, v48
  v_sub_f32 v93, v93, v48
  v_exp_f32 v92, v92
  v_exp_f32 v93, v93
  v_sub_f32 v96, v96, v49
  v_sub_f32 v97, v97, v49
  v_exp_f32 v96, v96
  v_exp_f32 v97, v97
  v_cvt_pk_bf16_f32 v108, v108, v109
  v_cvt_pk_bf16_f32 v109, v110, v111
  v_cvt_pk_bf16_f32 v112, v112, v113
  v_cvt_pk_bf16_f32 v113, v114, v115
  v_cvt_pk_bf16_f32 v52, v92, v92
  v_cvt_pk_bf16_f32 v53, v93, v93
  v_cvt_pk_bf16_f32 v54, v96, v96
  v_cvt_pk_bf16_f32 v55, v97, v97
  v_mfma_f32_16x16x16_bf16 v[64:67], v[108:109], v[52:53], 0
  v_sub_f32 v50, v12, v48
  v_add_f32 v92, v92, v93
  v_mfma_f32_16x16x16_bf16 v[68:71], v[112:113], v[52:53], 0
  v_sub_f32 v51, v13, v49
  v_add_f32 v96, v96, v97
  v_mfma_f32_16x16x16_bf16 v[72:75], v[108:109], v[54:55], 0
  v_exp_f32 v50, v50
  v_mfma_f32_16x16x16_bf16 v[76:79], v[112:113], v[54:55], 0
  v_exp_f32 v51, v51
  v_fma_f32 v120, v120, v50, v92
  v_fma_f32 v121, v121, v51, v96
  v_mov_b32 v124, v120
  v_mov_b32 v125, v121
  v_mov_b32 v15, 0
  v_permlane32_swap_b32 v120, v124
  v_permlane32_swap_b32 v121, v125
  v_add_f32 v120, v120, v124
  v_add_f32 v121, v121, v125
  v_mov_b32 v124, v120
  v_mov_b32 v125, v121
  v_mov_b32 v15, 0
  v_permlane16_swap_b32 v120, v124
  v_permlane16_swap_b32 v121, v125
  v_add_f32 v120, v120, v124
  v_add_f32 v121, v121, v125
  v_rcp_f32 v120, v120
  v_rcp_f32 v121, v121
  v_fma_f32 v64, v80, v50, v64
  v_fma_f32 v65, v81, v50, v65
  v_fma_f32 v66, v82, v50, v66
  v_fma_f32 v67, v83, v50, v67
  v_fma_f32 v68, v88, v50, v68
  v_fma_f32 v69, v89, v50, v69
  v_fma_f32 v70, v90, v50, v70
  v_fma_f32 v71, v91, v50, v71
  v_mul_f32 v64, v64, v120
  v_mul_f32 v68, v68, v120
  v_cvt_pk_bf16_f32 v16, v64, v68
  v_mul_f32 v65, v65, v120
  v_mul_f32 v69, v69, v120
  v_cvt_pk_bf16_f32 v17, v65, v69
  v_mul_f32 v66, v66, v120
  v_mul_f32 v70, v70, v120
  v_cvt_pk_bf16_f32 v18, v66, v70
  v_mul_f32 v67, v67, v120
  v_mul_f32 v71, v71, v120
  v_cvt_pk_bf16_f32 v19, v67, v71
  v_min_u32 v16, -2, v16
  buffer_store_dwordx4 v[16:19], v2, s[36:39], s84 offen sc1
  v_fma_f32 v72, v84, v51, v72
  v_fma_f32 v73, v85, v51, v73
  v_fma_f32 v74, v86, v51, v74
  v_fma_f32 v75, v87, v51, v75
  v_fma_f32 v76, v116, v51, v76
  v_fma_f32 v77, v117, v51, v77
  v_fma_f32 v78, v118, v51, v78
  v_fma_f32 v79, v119, v51, v79
  v_mul_f32 v72, v72, v121
  v_mul_f32 v76, v76, v121
  v_cvt_pk_bf16_f32 v20, v72, v76
  v_mul_f32 v73, v73, v121
  v_mul_f32 v77, v77, v121
  v_cvt_pk_bf16_f32 v21, v73, v77
  v_mul_f32 v74, v74, v121
  v_mul_f32 v78, v78, v121
  v_cvt_pk_bf16_f32 v22, v74, v78
  v_mul_f32 v75, v75, v121
  v_mul_f32 v79, v79, v121
  v_cvt_pk_bf16_f32 v23, v75, v79
  v_min_u32 v20, -2, v20
  buffer_store_dwordx4 v[20:23], v2, s[36:39], s85 offen sc1
L_head_next:
  s_add_u32 s65, s65, 3
  s_xor_b32 s68, s68, 1
  s_add_u32 s66, s66, 1
  s_cmp_lt_u32 s65, 67
  s_cbranch_scc1 L_head_loop
  s_waitcnt vmcnt(0)
  s_endpgm
L_head_first:
  ds_read_b128 v[64:67], v3 offset:0
  ds_read_b128 v[68:71], v3 offset:1024
  ds_read_b128 v[72:75], v3 offset:2048
  ds_read_b128 v[76:79], v3 offset:3072
  s_lshl_b32 s84, s65, 8
  s_lshl_b32 s85, s64, 2
  s_add_u32 s85, s85, s34
  s_add_u32 s84, s84, s85
  s_lshl_b32 s84, s84, 10
  s_add_u32 s84, s84, 0x1000000
  s_add_u32 s85, s84, 0x20000
  v_mov_b64 v[120:121], -1
  v_mov_b64 v[122:123], -1
  s_waitcnt lgkmcnt(3)
  v_mfma_f32_16x16x32_bf16 v[32:35], a[128:131], v[64:67], 0
  ds_read_b128 v[80:83], v3 offset:4096
  s_waitcnt lgkmcnt(2)
  v_mfma_f32_16x16x32_bf16 v[32:35], a[132:135], v[72:75], v[32:35]
  ds_read_b128 v[84:87], v3 offset:5120
  v_mfma_f32_16x16x32_bf16 v[40:43], a[128:131], v[68:71], 0
  ds_read_b128 v[88:91], v3 offset:6144
  s_waitcnt lgkmcnt(3)
  v_mfma_f32_16x16x32_bf16 v[40:43], a[132:135], v[76:79], v[40:43]
  ds_read_b128 v[92:95], v3 offset:7168
  v_mfma_f32_16x16x32_bf16 v[36:39], a[136:139], v[64:67], 0
  v_mfma_f32_16x16x32_bf16 v[36:39], a[140:143], v[72:75], v[36:39]
  v_mfma_f32_16x16x32_bf16 v[44:47], a[136:139], v[68:71], 0
  v_mfma_f32_16x16x32_bf16 v[44:47], a[140:143], v[76:79], v[44:47]
  v_mfma_f32_16x16x32_bf16 v[48:51], v[64:67], v[128:131], 0
  v_mfma_f32_16x16x32_bf16 v[48:51], v[72:75], v[132:135], v[48:51]
  v_mfma_f32_16x16x32_bf16 v[56:59], v[68:71], v[128:131], 0
  v_mfma_f32_16x16x32_bf16 v[56:59], v[76:79], v[132:135], v[56:59]
  v_mfma_f32_16x16x32_bf16 v[52:55], v[64:67], v[136:139], 0
  v_mfma_f32_16x16x32_bf16 v[52:55], v[72:75], v[140:143], v[52:55]
  v_mfma_f32_16x16x32_bf16 v[60:63], v[68:71], v[136:139], 0
  v_mfma_f32_16x16x32_bf16 v[60:63], v[76:79], v[140:143], v[60:63]
  s_waitcnt lgkmcnt(3)
  v_mfma_f32_16x16x32_bf16 v[32:35], a[144:147], v[80:83], v[32:35]
  ds_read_b128 v[64:67], v3 offset:8192
  s_waitcnt lgkmcnt(2)
  v_mfma_f32_16x16x32_bf16 v[32:35], a[148:151], v[88:91], v[32:35]
  ds_read_b128 v[68:71], v3 offset:9216
  v_mfma_f32_16x16x32_bf16 v[40:43], a[144:147], v[84:87], v[40:43]
  ds_read_b128 v[72:75], v3 offset:10240
  s_waitcnt lgkmcnt(3)
  v_mfma_f32_16x16x32_bf16 v[40:43], a[148:151], v[92:95], v[40:43]
  ds_read_b128 v[76:79], v3 offset:11264
  v_mfma_f32_16x16x32_bf16 v[36:39], a[152:155], v[80:83], v[36:39]
  v_mfma_f32_16x16x32_bf16 v[36:39], a[156:159], v[88:91], v[36:39]
  v_mfma_f32_16x16x32_bf16 v[44:47], a[152:155], v[84:87], v[44:47]
  v_mfma_f32_16x16x32_bf16 v[44:47], a[156:159], v[92:95], v[44:47]
  v_mfma_f32_16x16x32_bf16 v[48:51], v[80:83], v[144:147], v[48:51]
  v_mfma_f32_16x16x32_bf16 v[48:51], v[88:91], v[148:151], v[48:51]
  v_mfma_f32_16x16x32_bf16 v[56:59], v[84:87], v[144:147], v[56:59]
  v_mfma_f32_16x16x32_bf16 v[56:59], v[92:95], v[148:151], v[56:59]
  v_mfma_f32_16x16x32_bf16 v[52:55], v[80:83], v[152:155], v[52:55]
  v_mfma_f32_16x16x32_bf16 v[52:55], v[88:91], v[156:159], v[52:55]
  v_mfma_f32_16x16x32_bf16 v[60:63], v[84:87], v[152:155], v[60:63]
  v_mfma_f32_16x16x32_bf16 v[60:63], v[92:95], v[156:159], v[60:63]
  s_waitcnt lgkmcnt(3)
  v_mfma_f32_16x16x32_bf16 v[32:35], a[160:163], v[64:67], v[32:35]
  ds_read_b128 v[80:83], v3 offset:12288
  s_waitcnt lgkmcnt(2)
  v_mfma_f32_16x16x32_bf16 v[32:35], a[164:167], v[72:75], v[32:35]
  ds_read_b128 v[84:87], v3 offset:13312
  v_mfma_f32_16x16x32_bf16 v[40:43], a[160:163], v[68:71], v[40:43]
  ds_read_b128 v[88:91], v3 offset:14336
  s_waitcnt lgkmcnt(3)
  v_mfma_f32_16x16x32_bf16 v[40:43], a[164:167], v[76:79], v[40:43]
  ds_read_b128 v[92:95], v3 offset:15360
  v_mfma_f32_16x16x32_bf16 v[36:39], a[168:171], v[64:67], v[36:39]
  v_mfma_f32_16x16x32_bf16 v[36:39], a[172:175], v[72:75], v[36:39]
  v_mfma_f32_16x16x32_bf16 v[44:47], a[168:171], v[68:71], v[44:47]
  v_mfma_f32_16x16x32_bf16 v[44:47], a[172:175], v[76:79], v[44:47]
  v_mfma_f32_16x16x32_bf16 v[48:51], v[64:67], v[160:163], v[48:51]
  v_mfma_f32_16x16x32_bf16 v[48:51], v[72:75], v[164:167], v[48:51]
  v_mfma_f32_16x16x32_bf16 v[56:59], v[68:71], v[160:163], v[56:59]
  v_mfma_f32_16x16x32_bf16 v[56:59], v[76:79], v[164:167], v[56:59]
  v_mfma_f32_16x16x32_bf16 v[52:55], v[64:67], v[168:171], v[52:55]
  v_mfma_f32_16x16x32_bf16 v[52:55], v[72:75], v[172:175], v[52:55]
  v_mfma_f32_16x16x32_bf16 v[60:63], v[68:71], v[168:171], v[60:63]
  v_mfma_f32_16x16x32_bf16 v[60:63], v[76:79], v[172:175], v[60:63]
  s_waitcnt lgkmcnt(3)
  v_mfma_f32_16x16x32_bf16 v[32:35], a[176:179], v[80:83], v[32:35]
  ds_read_b128 v[64:67], v3 offset:16384
  s_waitcnt lgkmcnt(2)
  v_mfma_f32_16x16x32_bf16 v[32:35], a[180:183], v[88:91], v[32:35]
  ds_read_b128 v[68:71], v3 offset:17408
  v_mfma_f32_16x16x32_bf16 v[40:43], a[176:179], v[84:87], v[40:43]
  ds_read_b128 v[72:75], v3 offset:18432
  s_waitcnt lgkmcnt(3)
  v_mfma_f32_16x16x32_bf16 v[40:43], a[180:183], v[92:95], v[40:43]
  ds_read_b128 v[76:79], v3 offset:19456
  v_mfma_f32_16x16x32_bf16 v[36:39], a[184:187], v[80:83], v[36:39]
  v_mfma_f32_16x16x32_bf16 v[36:39], a[188:191], v[88:91], v[36:39]
  v_mfma_f32_16x16x32_bf16 v[44:47], a[184:187], v[84:87], v[44:47]
  v_mfma_f32_16x16x32_bf16 v[44:47], a[188:191], v[92:95], v[44:47]
  v_mfma_f32_16x16x32_bf16 v[48:51], v[80:83], v[176:179], v[48:51]
  v_mfma_f32_16x16x32_bf16 v[48:51], v[88:91], v[180:183], v[48:51]
  v_mfma_f32_16x16x32_bf16 v[56:59], v[84:87], v[176:179], v[56:59]
  v_mfma_f32_16x16x32_bf16 v[56:59], v[92:95], v[180:183], v[56:59]
  v_mfma_f32_16x16x32_bf16 v[52:55], v[80:83], v[184:187], v[52:55]
  v_mfma_f32_16x16x32_bf16 v[52:55], v[88:91], v[188:191], v[52:55]
  v_mfma_f32_16x16x32_bf16 v[60:63], v[84:87], v[184:187], v[60:63]
  v_mfma_f32_16x16x32_bf16 v[60:63], v[92:95], v[188:191], v[60:63]
  s_waitcnt lgkmcnt(3)
  v_mfma_f32_16x16x32_bf16 v[32:35], a[192:195], v[64:67], v[32:35]
  ds_read_b128 v[80:83], v3 offset:20480
  s_waitcnt lgkmcnt(2)
  v_mfma_f32_16x16x32_bf16 v[32:35], a[196:199], v[72:75], v[32:35]
  ds_read_b128 v[84:87], v3 offset:21504
  v_mfma_f32_16x16x32_bf16 v[40:43], a[192:195], v[68:71], v[40:43]
  ds_read_b128 v[88:91], v3 offset:22528
  s_waitcnt lgkmcnt(3)
  v_mfma_f32_16x16x32_bf16 v[40:43], a[196:199], v[76:79], v[40:43]
  ds_read_b128 v[92:95], v3 offset:23552
  v_mfma_f32_16x16x32_bf16 v[36:39], a[200:203], v[64:67], v[36:39]
  v_mfma_f32_16x16x32_bf16 v[36:39], a[204:207], v[72:75], v[36:39]
  v_mfma_f32_16x16x32_bf16 v[44:47], a[200:203], v[68:71], v[44:47]
  v_mfma_f32_16x16x32_bf16 v[44:47], a[204:207], v[76:79], v[44:47]
  v_mfma_f32_16x16x32_bf16 v[48:51], v[64:67], v[192:195], v[48:51]
  v_mfma_f32_16x16x32_bf16 v[48:51], v[72:75], v[196:199], v[48:51]
  v_mfma_f32_16x16x32_bf16 v[56:59], v[68:71], v[192:195], v[56:59]
  v_mfma_f32_16x16x32_bf16 v[56:59], v[76:79], v[196:199], v[56:59]
  v_mfma_f32_16x16x32_bf16 v[52:55], v[64:67], v[200:203], v[52:55]
  v_mfma_f32_16x16x32_bf16 v[52:55], v[72:75], v[204:207], v[52:55]
  v_mfma_f32_16x16x32_bf16 v[60:63], v[68:71], v[200:203], v[60:63]
  v_mfma_f32_16x16x32_bf16 v[60:63], v[76:79], v[204:207], v[60:63]
  s_waitcnt lgkmcnt(3)
  v_mfma_f32_16x16x32_bf16 v[32:35], a[208:211], v[80:83], v[32:35]
  ds_read_b128 v[64:67], v3 offset:24576
  s_waitcnt lgkmcnt(2)
  v_mfma_f32_16x16x32_bf16 v[32:35], a[212:215], v[88:91], v[32:35]
  ds_read_b128 v[68:71], v3 offset:25600
  v_mfma_f32_16x16x32_bf16 v[40:43], a[208:211], v[84:87], v[40:43]
  ds_read_b128 v[72:75], v3 offset:26624
  s_waitcnt lgkmcnt(3)
  v_mfma_f32_16x16x32_bf16 v[40:43], a[212:215], v[92:95], v[40:43]
  ds_read_b128 v[76:79], v3 offset:27648
  v_mfma_f32_16x16x32_bf16 v[36:39], a[216:219], v[80:83], v[36:39]
  v_mfma_f32_16x16x32_bf16 v[36:39], a[220:223], v[88:91], v[36:39]
  v_mfma_f32_16x16x32_bf16 v[44:47], a[216:219], v[84:87], v[44:47]
  v_mfma_f32_16x16x32_bf16 v[44:47], a[220:223], v[92:95], v[44:47]
  v_mfma_f32_16x16x32_bf16 v[48:51], v[80:83], v[208:211], v[48:51]
  v_mfma_f32_16x16x32_bf16 v[48:51], v[88:91], v[212:215], v[48:51]
  v_mfma_f32_16x16x32_bf16 v[56:59], v[84:87], v[208:211], v[56:59]
  v_mfma_f32_16x16x32_bf16 v[56:59], v[92:95], v[212:215], v[56:59]
  v_mfma_f32_16x16x32_bf16 v[52:55], v[80:83], v[216:219], v[52:55]
  v_mfma_f32_16x16x32_bf16 v[52:55], v[88:91], v[220:223], v[52:55]
  v_mfma_f32_16x16x32_bf16 v[60:63], v[84:87], v[216:219], v[60:63]
  v_mfma_f32_16x16x32_bf16 v[60:63], v[92:95], v[220:223], v[60:63]
  s_waitcnt lgkmcnt(3)
  v_mfma_f32_16x16x32_bf16 v[32:35], a[224:227], v[64:67], v[32:35]
  ds_read_b128 v[80:83], v3 offset:28672
  s_waitcnt lgkmcnt(2)
  v_mfma_f32_16x16x32_bf16 v[32:35], a[228:231], v[72:75], v[32:35]
  ds_read_b128 v[84:87], v3 offset:29696
  v_mfma_f32_16x16x32_bf16 v[40:43], a[224:227], v[68:71], v[40:43]
  ds_read_b128 v[88:91], v3 offset:30720
  s_waitcnt lgkmcnt(3)
  v_mfma_f32_16x16x32_bf16 v[40:43], a[228:231], v[76:79], v[40:43]
  ds_read_b128 v[92:95], v3 offset:31744
  v_mfma_f32_16x16x32_bf16 v[36:39], a[232:235], v[64:67], v[36:39]
  v_mfma_f32_16x16x32_bf16 v[36:39], a[236:239], v[72:75], v[36:39]
  v_mfma_f32_16x16x32_bf16 v[44:47], a[232:235], v[68:71], v[44:47]
  v_mfma_f32_16x16x32_bf16 v[44:47], a[236:239], v[76:79], v[44:47]
  v_mfma_f32_16x16x32_bf16 v[48:51], v[64:67], v[224:227], v[48:51]
  v_mfma_f32_16x16x32_bf16 v[48:51], v[72:75], v[228:231], v[48:51]
  v_mfma_f32_16x16x32_bf16 v[56:59], v[68:71], v[224:227], v[56:59]
  v_mfma_f32_16x16x32_bf16 v[56:59], v[76:79], v[228:231], v[56:59]
  v_mfma_f32_16x16x32_bf16 v[52:55], v[64:67], v[232:235], v[52:55]
  v_mfma_f32_16x16x32_bf16 v[52:55], v[72:75], v[236:239], v[52:55]
  v_mfma_f32_16x16x32_bf16 v[60:63], v[68:71], v[232:235], v[60:63]
  v_mfma_f32_16x16x32_bf16 v[60:63], v[76:79], v[236:239], v[60:63]
  s_waitcnt lgkmcnt(3)
  v_mfma_f32_16x16x32_bf16 v[32:35], a[240:243], v[80:83], v[32:35]
  s_waitcnt lgkmcnt(1)
  v_mfma_f32_16x16x32_bf16 v[32:35], a[244:247], v[88:91], v[32:35]
  v_mfma_f32_16x16x32_bf16 v[40:43], a[240:243], v[84:87], v[40:43]
  s_waitcnt lgkmcnt(0)
  v_mfma_f32_16x16x32_bf16 v[40:43], a[244:247], v[92:95], v[40:43]
  v_mfma_f32_16x16x32_bf16 v[36:39], a[248:251], v[80:83], v[36:39]
  v_mfma_f32_16x16x32_bf16 v[36:39], a[252:255], v[88:91], v[36:39]
  v_mfma_f32_16x16x32_bf16 v[44:47], a[248:251], v[84:87], v[44:47]
  v_mfma_f32_16x16x32_bf16 v[44:47], a[252:255], v[92:95], v[44:47]
  v_mfma_f32_16x16x32_bf16 v[48:51], v[80:83], v[240:243], v[48:51]
  v_mfma_f32_16x16x32_bf16 v[48:51], v[88:91], v[244:247], v[48:51]
  v_mfma_f32_16x16x32_bf16 v[56:59], v[84:87], v[240:243], v[56:59]
  v_mfma_f32_16x16x32_bf16 v[56:59], v[92:95], v[244:247], v[56:59]
  v_mfma_f32_16x16x32_bf16 v[52:55], v[80:83], v[248:251], v[52:55]
  v_mfma_f32_16x16x32_bf16 v[52:55], v[88:91], v[252:255], v[52:55]
  v_mfma_f32_16x16x32_bf16 v[60:63], v[84:87], v[248:251], v[60:63]
  v_mfma_f32_16x16x32_bf16 v[60:63], v[92:95], v[252:255], v[60:63]
  v_cvt_pk_bf16_f32 v104, v32, v36
  v_cvt_pk_bf16_f32 v105, v33, v37
  v_cvt_pk_bf16_f32 v106, v34, v38
  v_cvt_pk_bf16_f32 v107, v35, v39
  ds_write_b128 v4, v[104:107] offset:8192
  v_cvt_pk_bf16_f32 v108, v40, v44
  v_cvt_pk_bf16_f32 v109, v41, v45
  v_cvt_pk_bf16_f32 v110, v42, v46
  v_cvt_pk_bf16_f32 v111, v43, v47
  ds_write_b128 v4, v[108:111] offset:9216
  v_cvt_pk_bf16_f32 v112, v48, v56
  v_cvt_pk_bf16_f32 v113, v49, v57
  v_cvt_pk_bf16_f32 v114, v50, v58
  v_cvt_pk_bf16_f32 v115, v51, v59
  ds_write_b128 v4, v[112:115] offset:16384
  v_cvt_pk_bf16_f32 v116, v52, v60
  v_cvt_pk_bf16_f32 v117, v53, v61
  v_cvt_pk_bf16_f32 v118, v54, v62
  v_cvt_pk_bf16_f32 v119, v55, v63
  ds_write_b128 v4, v[116:119] offset:17408
  s_waitcnt vmcnt(0)
  buffer_store_dwordx4 v[104:107], v1, s[36:39], s78 offen offset:0 sc1
  buffer_store_dwordx4 v[108:111], v1, s[36:39], s78 offen offset:1024 sc1
  buffer_store_dwordx4 v[112:115], v1, s[36:39], s79 offen offset:0 sc1
  buffer_store_dwordx4 v[116:119], v1, s[36:39], s79 offen offset:1024 sc1
  buffer_store_dwordx4 v[120:123], v2, s[36:39], s84 offen sc1
  buffer_store_dwordx4 v[120:123], v2, s[36:39], s85 offen sc1
  s_waitcnt lgkmcnt(0)
  s_barrier
  v_add_u32 v124, 0x10000, v2
  v_add_u32 v125, 0x10000, v1
  v_add_u32 v126, 0x1c000, v2
  ds_read_b128 v[48:51], v126 offset:0
  ds_read_b128 v[52:55], v126 offset:1024
  ds_read_b128 v[56:59], v126 offset:2048
  ds_read_b128 v[60:63], v126 offset:3072
  ds_read_b128 v[64:67], v126 offset:4096
  ds_read_b128 v[68:71], v126 offset:5120
  ds_read_b128 v[72:75], v126 offset:6144
  ds_read_b128 v[76:79], v126 offset:7168
  ds_read_b128 v[16:19], v124 offset:8192
  ds_read_b128 v[20:23], v124 offset:9216
  ds_read_b128 v[24:27], v124 offset:10240
  ds_read_b128 v[28:31], v124 offset:11264
  ds_read_b128 v[32:35], v124 offset:12288
  ds_read_b128 v[36:39], v124 offset:13312
  ds_read_b128 v[40:43], v124 offset:14336
  ds_read_b128 v[44:47], v124 offset:15360
  ds_read_b128 v[104:107], v125 offset:16384
  ds_read_b128 v[108:111], v125 offset:17408
  v_mov_b64 v[80:81], 0
  v_mov_b64 v[82:83], 0
  v_mov_b64 v[84:85], 0
  v_mov_b64 v[86:87], 0
  v_mov_b64 v[88:89], 0
  v_mov_b64 v[90:91], 0
  v_mov_b64 v[92:93], 0
  v_mov_b64 v[94:95], 0
  v_mov_b64 v[96:97], 0
  v_mov_b64 v[98:99], 0
  v_mov_b64 v[100:101], 0
  v_mov_b64 v[102:103], 0
  v_lshrrev_b32 v112, 4, v0
  v_and_b32 v113, 1, v112
  v_lshlrev_b32 v113, 2, v113
  v_bfe_u32 v114, v0, 1, 3
  v_xor_b32 v113, v113, v114
  v_lshlrev_b32 v113, 4, v113
  v_lshl_add_u32 v127, v112, 7, v113
  v_add_u32 v127, 0x1e000, v127
  s_waitcnt lgkmcnt(15)
  v_smfmac_f32_16x16x64_bf16 v[80:83], v[48:51], a[0:7], v8
  v_smfmac_f32_16x16x64_bf16 v[80:83], v[52:55], a[16:23], v8
  v_smfmac_f32_16x16x64_bf16 v[80:83], v[56:59], a[32:39], v8
  s_waitcnt lgkmcnt(14)
  v_smfmac_f32_16x16x64_bf16 v[80:83], v[60:63], a[48:55], v8
  s_waitcnt lgkmcnt(13)
  v_smfmac_f32_16x16x64_bf16 v[80:83], v[64:67], a[64:71], v8
  s_waitcnt lgkmcnt(12)
  v_smfmac_f32_16x16x64_bf16 v[80:83], v[68:71], a[80:87], v8
  s_waitcnt lgkmcnt(11)
  v_smfmac_f32_16x16x64_bf16 v[80:83], v[72:75], a[96:103], v8
  s_waitcnt lgkmcnt(10)
  v_smfmac_f32_16x16x64_bf16 v[80:83], v[76:79], a[112:119], v8
  v_smfmac_f32_16x16x64_bf16 v[84:87], v[48:51], a[8:15], v8
  v_smfmac_f32_16x16x64_bf16 v[84:87], v[52:55], a[24:31], v8
  v_smfmac_f32_16x16x64_bf16 v[84:87], v[56:59], a[40:47], v8
  v_smfmac_f32_16x16x64_bf16 v[84:87], v[60:63], a[56:63], v8
  v_smfmac_f32_16x16x64_bf16 v[84:87], v[64:67], a[72:79], v8
  v_smfmac_f32_16x16x64_bf16 v[84:87], v[68:71], a[88:95], v8
  v_smfmac_f32_16x16x64_bf16 v[84:87], v[72:75], a[104:111], v8
  v_smfmac_f32_16x16x64_bf16 v[84:87], v[76:79], a[120:127], v8
  v_smfmac_f32_16x16x64_bf16 v[88:91], v[48:51], a[128:135], v8
  v_smfmac_f32_16x16x64_bf16 v[88:91], v[52:55], a[144:151], v8
  v_smfmac_f32_16x16x64_bf16 v[88:91], v[56:59], a[160:167], v8
  v_add_f32 v112, v80, v81
  v_smfmac_f32_16x16x64_bf16 v[88:91], v[60:63], a[176:183], v8
  v_mul_f32 v112, s67, v112
  v_smfmac_f32_16x16x64_bf16 v[88:91], v[64:67], a[192:199], v8
  v_add_f32 v113, v84, v85
  v_smfmac_f32_16x16x64_bf16 v[88:91], v[68:71], a[208:215], v8
  v_mul_f32 v113, s67, v113
  v_smfmac_f32_16x16x64_bf16 v[88:91], v[72:75], a[224:231], v8
  v_add_f32 v114, v82, v83
  v_smfmac_f32_16x16x64_bf16 v[88:91], v[76:79], a[240:247], v8
  v_mul_f32 v114, s67, v114
  v_smfmac_f32_16x16x64_bf16 v[92:95], v[48:51], a[136:143], v8
  v_add_f32 v115, v86, v87
  v_smfmac_f32_16x16x64_bf16 v[92:95], v[52:55], a[152:159], v8
  v_mul_f32 v115, s67, v115
  v_smfmac_f32_16x16x64_bf16 v[92:95], v[56:59], a[168:175], v8
  v_cvt_pk_bf16_f32 v112, v112, v113
  v_smfmac_f32_16x16x64_bf16 v[92:95], v[60:63], a[184:191], v8
  v_cvt_pk_bf16_f32 v113, v114, v115
  v_smfmac_f32_16x16x64_bf16 v[92:95], v[64:67], a[200:207], v8
  ds_write2_b32 v6, v112, v113 offset0:0 offset1:4
  v_smfmac_f32_16x16x64_bf16 v[92:95], v[68:71], a[216:223], v8
  v_smfmac_f32_16x16x64_bf16 v[92:95], v[72:75], a[232:239], v8
  v_smfmac_f32_16x16x64_bf16 v[92:95], v[76:79], a[248:255], v8
  v_smfmac_f32_16x16x64_bf16 v[96:99], v[48:51], v[128:135], v8
  v_smfmac_f32_16x16x64_bf16 v[96:99], v[52:55], v[144:151], v8
  v_add_f32 v116, v88, v89
  v_smfmac_f32_16x16x64_bf16 v[96:99], v[56:59], v[160:167], v8
  v_add_f32 v117, v92, v93
  v_smfmac_f32_16x16x64_bf16 v[96:99], v[60:63], v[176:183], v8
  v_add_f32 v118, v90, v91
  v_smfmac_f32_16x16x64_bf16 v[96:99], v[64:67], v[192:199], v8
  v_add_f32 v119, v94, v95
  v_smfmac_f32_16x16x64_bf16 v[96:99], v[68:71], v[208:215], v8
  v_cvt_pk_bf16_f32 v116, v116, v117
  v_smfmac_f32_16x16x64_bf16 v[96:99], v[72:75], v[224:231], v8
  v_cvt_pk_bf16_f32 v117, v118, v119
  v_smfmac_f32_16x16x64_bf16 v[96:99], v[76:79], v[240:247], v8
  ds_write2_b32 v6, v116, v117 offset0:128 offset1:132
  v_smfmac_f32_16x16x64_bf16 v[100:103], v[48:51], v[136:143], v8
  v_smfmac_f32_16x16x64_bf16 v[100:103], v[52:55], v[152:159], v8
  v_smfmac_f32_16x16x64_bf16 v[100:103], v[56:59], v[168:175], v8
  v_smfmac_f32_16x16x64_bf16 v[100:103], v[60:63], v[184:191], v8
  s_waitcnt lgkmcnt(0)
  s_barrier
  v_smfmac_f32_16x16x64_bf16 v[100:103], v[64:67], v[200:207], v8
  ds_read_b128 v[48:51], v127 offset:0
  v_smfmac_f32_16x16x64_bf16 v[100:103], v[68:71], v[216:223], v8
  ds_read_b128 v[52:55], v127 offset:1024
  v_smfmac_f32_16x16x64_bf16 v[100:103], v[72:75], v[232:239], v8
  ds_read_b128 v[56:59], v127 offset:2048
  v_smfmac_f32_16x16x64_bf16 v[100:103], v[76:79], v[248:255], v8
  ds_read_b128 v[60:63], v127 offset:3072
  ds_read_b128 v[64:67], v127 offset:512
  ds_read_b128 v[68:71], v127 offset:1536
  ds_read_b128 v[72:75], v127 offset:2560
  ds_read_b128 v[76:79], v127 offset:3584
  v_cvt_pk_bf16_f32 v96, v96, v97
  v_cvt_pk_bf16_f32 v97, v98, v99
  v_mov_b32 v15, 0
  v_cvt_pk_bf16_f32 v100, v100, v101
  v_cvt_pk_bf16_f32 v101, v102, v103
  s_waitcnt lgkmcnt(7)
  v_mfma_f32_16x16x32_bf16 v[112:115], v[16:19], v[48:51], 0
  s_waitcnt lgkmcnt(6)
  v_mfma_f32_16x16x32_bf16 v[112:115], v[24:27], v[52:55], v[112:115]
  s_waitcnt lgkmcnt(5)
  v_mfma_f32_16x16x32_bf16 v[112:115], v[32:35], v[56:59], v[112:115]
  s_waitcnt lgkmcnt(4)
  v_mfma_f32_16x16x32_bf16 v[112:115], v[40:43], v[60:63], v[112:115]
  v_mfma_f32_16x16x32_bf16 v[116:119], v[20:23], v[48:51], 0
  v_mfma_f32_16x16x32_bf16 v[116:119], v[28:31], v[52:55], v[116:119]
  v_mfma_f32_16x16x32_bf16 v[116:119], v[36:39], v[56:59], v[116:119]
  v_mfma_f32_16x16x32_bf16 v[116:119], v[44:47], v[60:63], v[116:119]
  s_waitcnt lgkmcnt(3)
  v_mfma_f32_16x16x32_bf16 v[120:123], v[64:67], v[48:51], 0
  s_waitcnt lgkmcnt(2)
  v_mfma_f32_16x16x32_bf16 v[120:123], v[68:71], v[52:55], v[120:123]
  s_waitcnt lgkmcnt(1)
  v_mfma_f32_16x16x32_bf16 v[120:123], v[72:75], v[56:59], v[120:123]
  s_waitcnt lgkmcnt(0)
  v_mfma_f32_16x16x32_bf16 v[120:123], v[76:79], v[60:63], v[120:123]
  v_max_f32 v124, v112, v116
  v_max3_f32 v124, v124, v113, v117
  v_max3_f32 v124, v124, v114, v118
  v_max3_f32 v124, v124, v115, v119
  v_mov_b32 v15, 0
  v_mov_b32 v15, 0
  v_mov_b32 v15, 0
  v_max3_f32 v124, v124, v120, v122
  v_mov_b32 v126, v124
  v_mov_b32 v15, 0
  v_mov_b32 v15, 0
  v_permlane32_swap_b32 v124, v126
  v_max_f32 v124, v124, v126
  v_mov_b32 v126, v124
  v_mov_b32 v15, 0
  v_mov_b32 v15, 0
  v_permlane16_swap_b32 v124, v126
  v_max_f32 v124, v124, v126
  v_sub_f32 v112, v112, v124
  v_sub_f32 v116, v116, v124
  v_sub_f32 v113, v113, v124
  v_sub_f32 v117, v117, v124
  v_sub_f32 v114, v114, v124
  v_sub_f32 v118, v118, v124
  v_sub_f32 v115, v115, v124
  v_sub_f32 v119, v119, v124
  v_sub_f32 v120, v120, v124
  v_sub_f32 v122, v122, v124
  v_exp_f32 v112, v112
  v_exp_f32 v116, v116
  v_exp_f32 v113, v113
  v_exp_f32 v117, v117
  v_exp_f32 v114, v114
  v_exp_f32 v118, v118
  v_exp_f32 v115, v115
  v_exp_f32 v119, v119
  v_exp_f32 v120, v120
  v_exp_f32 v122, v122
  v_cvt_pk_bf16_f32 v80, v112, v116
  v_cvt_pk_bf16_f32 v81, v113, v117
  v_cvt_pk_bf16_f32 v82, v114, v118
  v_cvt_pk_bf16_f32 v83, v115, v119
  v_cvt_pk_bf16_f32 v84, v120, v120
  v_cvt_pk_bf16_f32 v85, v122, v122
  v_mfma_f32_16x16x32_bf16 v[88:91], v[104:107], v[80:83], 0
  v_mfma_f32_16x16x32_bf16 v[92:95], v[108:111], v[80:83], 0
  v_mfma_f32_16x16x16_bf16 v[88:91], v[96:97], v[84:85], v[88:91]
  v_mfma_f32_16x16x16_bf16 v[92:95], v[100:101], v[84:85], v[92:95]
  v_add_f32 v125, v112, v116
  v_add_f32 v125, v125, v113
  v_add_f32 v125, v125, v117
  v_add_f32 v125, v125, v114
  v_add_f32 v125, v125, v118
  v_add_f32 v125, v125, v115
  v_add_f32 v125, v125, v119
  v_add_f32 v125, v125, v120
  v_add_f32 v125, v125, v122
  v_mov_b32 v126, v125
  v_mov_b32 v15, 0
  v_mov_b32 v15, 0
  v_permlane32_swap_b32 v125, v126
  v_add_f32 v125, v125, v126
  v_mov_b32 v126, v125
  v_mov_b32 v15, 0
  v_mov_b32 v15, 0
  v_permlane16_swap_b32 v125, v126
  v_add_f32 v125, v125, v126
  v_rcp_f32 v125, v125
  v_mov_b32 v15, 0
  v_mul_f32 v88, v88, v125
  v_mul_f32 v89, v89, v125
  v_mul_f32 v90, v90, v125
  v_mul_f32 v91, v91, v125
  v_mul_f32 v92, v92, v125
  v_mul_f32 v93, v93, v125
  v_mul_f32 v94, v94, v125
  v_mul_f32 v95, v95, v125
  v_cvt_pk_bf16_f32 v80, v88, v89
  v_cvt_pk_bf16_f32 v81, v90, v91
  v_cvt_pk_bf16_f32 v82, v92, v93
  v_cvt_pk_bf16_f32 v83, v94, v95
  v_min_u32 v80, -2, v80
  s_lshl_b32 s78, s64, 2
  s_add_u32 s78, s78, s34
  s_lshl_b32 s78, s78, 10
  s_add_u32 s78, s78, 0x540000
  buffer_store_dwordx4 v[80:83], v2, s[36:39], s78 offen sc1
  ds_read_b128 v[64:67], v3 offset:0
  ds_read_b128 v[68:71], v3 offset:1024
  ds_read_b128 v[72:75], v3 offset:2048
  ds_read_b128 v[76:79], v3 offset:3072
  s_waitcnt lgkmcnt(3)
  v_mfma_f32_16x16x32_bf16 v[16:19], a[0:3], v[64:67], 0
  ds_read_b128 v[80:83], v3 offset:4096
  s_waitcnt lgkmcnt(2)
  v_mfma_f32_16x16x32_bf16 v[16:19], a[4:7], v[72:75], v[16:19]
  ds_read_b128 v[84:87], v3 offset:5120
  v_mfma_f32_16x16x32_bf16 v[24:27], a[0:3], v[68:71], 0
  ds_read_b128 v[88:91], v3 offset:6144
  s_waitcnt lgkmcnt(3)
  v_mfma_f32_16x16x32_bf16 v[24:27], a[4:7], v[76:79], v[24:27]
  ds_read_b128 v[92:95], v3 offset:7168
  v_mfma_f32_16x16x32_bf16 v[20:23], a[8:11], v[64:67], 0
  v_mfma_f32_16x16x32_bf16 v[20:23], a[12:15], v[72:75], v[20:23]
  v_mfma_f32_16x16x32_bf16 v[28:31], a[8:11], v[68:71], 0
  v_mfma_f32_16x16x32_bf16 v[28:31], a[12:15], v[76:79], v[28:31]
  s_waitcnt lgkmcnt(3)
  v_mfma_f32_16x16x32_bf16 v[16:19], a[16:19], v[80:83], v[16:19]
  ds_read_b128 v[64:67], v3 offset:8192
  s_waitcnt lgkmcnt(2)
  v_mfma_f32_16x16x32_bf16 v[16:19], a[20:23], v[88:91], v[16:19]
  ds_read_b128 v[68:71], v3 offset:9216
  v_mfma_f32_16x16x32_bf16 v[24:27], a[16:19], v[84:87], v[24:27]
  ds_read_b128 v[72:75], v3 offset:10240
  s_waitcnt lgkmcnt(3)
  v_mfma_f32_16x16x32_bf16 v[24:27], a[20:23], v[92:95], v[24:27]
  ds_read_b128 v[76:79], v3 offset:11264
  v_mfma_f32_16x16x32_bf16 v[20:23], a[24:27], v[80:83], v[20:23]
  v_mfma_f32_16x16x32_bf16 v[20:23], a[28:31], v[88:91], v[20:23]
  v_mfma_f32_16x16x32_bf16 v[28:31], a[24:27], v[84:87], v[28:31]
  v_mfma_f32_16x16x32_bf16 v[28:31], a[28:31], v[92:95], v[28:31]
  s_waitcnt lgkmcnt(3)
  v_mfma_f32_16x16x32_bf16 v[16:19], a[32:35], v[64:67], v[16:19]
  ds_read_b128 v[80:83], v3 offset:12288
  s_waitcnt lgkmcnt(2)
  v_mfma_f32_16x16x32_bf16 v[16:19], a[36:39], v[72:75], v[16:19]
  ds_read_b128 v[84:87], v3 offset:13312
  v_mfma_f32_16x16x32_bf16 v[24:27], a[32:35], v[68:71], v[24:27]
  ds_read_b128 v[88:91], v3 offset:14336
  s_waitcnt lgkmcnt(3)
  v_mfma_f32_16x16x32_bf16 v[24:27], a[36:39], v[76:79], v[24:27]
  ds_read_b128 v[92:95], v3 offset:15360
  v_mfma_f32_16x16x32_bf16 v[20:23], a[40:43], v[64:67], v[20:23]
  v_mfma_f32_16x16x32_bf16 v[20:23], a[44:47], v[72:75], v[20:23]
  v_mfma_f32_16x16x32_bf16 v[28:31], a[40:43], v[68:71], v[28:31]
  v_mfma_f32_16x16x32_bf16 v[28:31], a[44:47], v[76:79], v[28:31]
  s_waitcnt lgkmcnt(3)
  v_mfma_f32_16x16x32_bf16 v[16:19], a[48:51], v[80:83], v[16:19]
  ds_read_b128 v[64:67], v3 offset:16384
  s_waitcnt lgkmcnt(2)
  v_mfma_f32_16x16x32_bf16 v[16:19], a[52:55], v[88:91], v[16:19]
  ds_read_b128 v[68:71], v3 offset:17408
  v_mfma_f32_16x16x32_bf16 v[24:27], a[48:51], v[84:87], v[24:27]
  ds_read_b128 v[72:75], v3 offset:18432
  s_waitcnt lgkmcnt(3)
  v_mfma_f32_16x16x32_bf16 v[24:27], a[52:55], v[92:95], v[24:27]
  ds_read_b128 v[76:79], v3 offset:19456
  v_mfma_f32_16x16x32_bf16 v[20:23], a[56:59], v[80:83], v[20:23]
  v_mfma_f32_16x16x32_bf16 v[20:23], a[60:63], v[88:91], v[20:23]
  v_mfma_f32_16x16x32_bf16 v[28:31], a[56:59], v[84:87], v[28:31]
  v_mfma_f32_16x16x32_bf16 v[28:31], a[60:63], v[92:95], v[28:31]
  s_waitcnt lgkmcnt(3)
  v_mfma_f32_16x16x32_bf16 v[16:19], a[64:67], v[64:67], v[16:19]
  ds_read_b128 v[80:83], v3 offset:20480
  s_waitcnt lgkmcnt(2)
  v_mfma_f32_16x16x32_bf16 v[16:19], a[68:71], v[72:75], v[16:19]
  ds_read_b128 v[84:87], v3 offset:21504
  v_mfma_f32_16x16x32_bf16 v[24:27], a[64:67], v[68:71], v[24:27]
  ds_read_b128 v[88:91], v3 offset:22528
  s_waitcnt lgkmcnt(3)
  v_mfma_f32_16x16x32_bf16 v[24:27], a[68:71], v[76:79], v[24:27]
  ds_read_b128 v[92:95], v3 offset:23552
  v_mfma_f32_16x16x32_bf16 v[20:23], a[72:75], v[64:67], v[20:23]
  v_mfma_f32_16x16x32_bf16 v[20:23], a[76:79], v[72:75], v[20:23]
  v_mfma_f32_16x16x32_bf16 v[28:31], a[72:75], v[68:71], v[28:31]
  v_mfma_f32_16x16x32_bf16 v[28:31], a[76:79], v[76:79], v[28:31]
  s_waitcnt lgkmcnt(3)
  v_mfma_f32_16x16x32_bf16 v[16:19], a[80:83], v[80:83], v[16:19]
  ds_read_b128 v[64:67], v3 offset:24576
  s_waitcnt lgkmcnt(2)
  v_mfma_f32_16x16x32_bf16 v[16:19], a[84:87], v[88:91], v[16:19]
  ds_read_b128 v[68:71], v3 offset:25600
  v_mfma_f32_16x16x32_bf16 v[24:27], a[80:83], v[84:87], v[24:27]
  ds_read_b128 v[72:75], v3 offset:26624
  s_waitcnt lgkmcnt(3)
  v_mfma_f32_16x16x32_bf16 v[24:27], a[84:87], v[92:95], v[24:27]
  ds_read_b128 v[76:79], v3 offset:27648
  v_mfma_f32_16x16x32_bf16 v[20:23], a[88:91], v[80:83], v[20:23]
  v_mfma_f32_16x16x32_bf16 v[20:23], a[92:95], v[88:91], v[20:23]
  v_mfma_f32_16x16x32_bf16 v[28:31], a[88:91], v[84:87], v[28:31]
  v_mfma_f32_16x16x32_bf16 v[28:31], a[92:95], v[92:95], v[28:31]
  s_waitcnt lgkmcnt(3)
  v_mfma_f32_16x16x32_bf16 v[16:19], a[96:99], v[64:67], v[16:19]
  ds_read_b128 v[80:83], v3 offset:28672
  s_waitcnt lgkmcnt(2)
  v_mfma_f32_16x16x32_bf16 v[16:19], a[100:103], v[72:75], v[16:19]
  ds_read_b128 v[84:87], v3 offset:29696
  v_mfma_f32_16x16x32_bf16 v[24:27], a[96:99], v[68:71], v[24:27]
  ds_read_b128 v[88:91], v3 offset:30720
  s_waitcnt lgkmcnt(3)
  v_mfma_f32_16x16x32_bf16 v[24:27], a[100:103], v[76:79], v[24:27]
  ds_read_b128 v[92:95], v3 offset:31744
  v_mfma_f32_16x16x32_bf16 v[20:23], a[104:107], v[64:67], v[20:23]
  v_mfma_f32_16x16x32_bf16 v[20:23], a[108:111], v[72:75], v[20:23]
  v_mfma_f32_16x16x32_bf16 v[28:31], a[104:107], v[68:71], v[28:31]
  v_mfma_f32_16x16x32_bf16 v[28:31], a[108:111], v[76:79], v[28:31]
  s_waitcnt lgkmcnt(3)
  v_mfma_f32_16x16x32_bf16 v[16:19], a[112:115], v[80:83], v[16:19]
  s_waitcnt lgkmcnt(1)
  v_mfma_f32_16x16x32_bf16 v[16:19], a[116:119], v[88:91], v[16:19]
  v_mfma_f32_16x16x32_bf16 v[24:27], a[112:115], v[84:87], v[24:27]
  s_waitcnt lgkmcnt(0)
  v_mfma_f32_16x16x32_bf16 v[24:27], a[116:119], v[92:95], v[24:27]
  v_mfma_f32_16x16x32_bf16 v[20:23], a[120:123], v[80:83], v[20:23]
  v_mfma_f32_16x16x32_bf16 v[20:23], a[124:127], v[88:91], v[20:23]
  v_mfma_f32_16x16x32_bf16 v[28:31], a[120:123], v[84:87], v[28:31]
  v_mfma_f32_16x16x32_bf16 v[28:31], a[124:127], v[92:95], v[28:31]
  s_nop 7
  s_branch L_head_q
L_hid:
  s_cmp_ge_u32 s35, 28
  s_cbranch_scc1 L_final
  s_lshr_b32 s64, s35, 2
  s_and_b32 s65, s35, 3
  s_getpc_b64 s[62:63]
L_pc_131:
  s_lshl_b32 s61, s34, 12
  v_lshl_add_u32 v122, v0, 6, s61
  v_min_u32 v123, L_final-L_pc_131-4, v122
  v_mov_b32 v121, s63
  v_add_co_u32 v120, vcc, s62, v123
  s_nop 1
  v_addc_co_u32 v121, vcc, 0, v121, vcc
  global_load_dword v124, v[120:121], off
  s_mov_b32 s44, s20
  s_mov_b32 s45, s21
  s_mov_b32 s46, 0x1c0000
  s_mov_b32 s47, 0x20000
  s_mov_b32 s48, s22
  s_mov_b32 s49, s23
  s_mov_b32 s50, 0xe00
  s_mov_b32 s51, 0x20000
  v_lshlrev_b32 v1, 4, v0
  v_mov_b32 v4, 1
  v_lshrrev_b32 v8, 4, v0
  v_and_b32 v9, 15, v0
  v_mul_u32_u24 v2, 0x1c000, v8
  v_lshl_add_u32 v2, v9, 3, v2
  s_lshl_b32 s18, s64, 9
  s_lshl_b32 s19, s34, 7
  s_add_u32 s18, s18, s19
  v_add_u32 v2, s18, v2
  v_lshl_add_u32 v10, v8, 5, s18
  buffer_load_dwordx4 v[32:35], v10, s[48:51], 0 offen
  buffer_load_dwordx4 v[36:39], v10, s[48:51], 0 offen offset:16
  s_mov_b32 s63, 0x0
  buffer_load_dwordx2 v[128:129], v2, s[44:47], s63 offen offset:0
  buffer_load_dwordx2 v[130:131], v2, s[44:47], s63 offen offset:3584
  s_mov_b32 s63, 0x7000
  buffer_load_dwordx2 v[132:133], v2, s[44:47], s63 offen offset:0
  buffer_load_dwordx2 v[134:135], v2, s[44:47], s63 offen offset:3584
  s_mov_b32 s63, 0xe000
  buffer_load_dwordx2 v[136:137], v2, s[44:47], s63 offen offset:0
  buffer_load_dwordx2 v[138:139], v2, s[44:47], s63 offen offset:3584
  s_mov_b32 s63, 0x15000
  buffer_load_dwordx2 v[140:141], v2, s[44:47], s63 offen offset:0
  buffer_load_dwordx2 v[142:143], v2, s[44:47], s63 offen offset:3584
  s_mov_b32 s63, 0x70000
  buffer_load_dwordx2 v[144:145], v2, s[44:47], s63 offen offset:0
  buffer_load_dwordx2 v[146:147], v2, s[44:47], s63 offen offset:3584
  s_mov_b32 s63, 0x77000
  buffer_load_dwordx2 v[148:149], v2, s[44:47], s63 offen offset:0
  buffer_load_dwordx2 v[150:151], v2, s[44:47], s63 offen offset:3584
  s_mov_b32 s63, 0x7e000
  buffer_load_dwordx2 v[152:153], v2, s[44:47], s63 offen offset:0
  buffer_load_dwordx2 v[154:155], v2, s[44:47], s63 offen offset:3584
  s_mov_b32 s63, 0x85000
  buffer_load_dwordx2 v[156:157], v2, s[44:47], s63 offen offset:0
  buffer_load_dwordx2 v[158:159], v2, s[44:47], s63 offen offset:3584
  s_mov_b32 s63, 0xe0000
  buffer_load_dwordx2 v[160:161], v2, s[44:47], s63 offen offset:0
  buffer_load_dwordx2 v[162:163], v2, s[44:47], s63 offen offset:3584
  s_mov_b32 s63, 0xe7000
  buffer_load_dwordx2 v[164:165], v2, s[44:47], s63 offen offset:0
  buffer_load_dwordx2 v[166:167], v2, s[44:47], s63 offen offset:3584
  s_mov_b32 s63, 0xee000
  buffer_load_dwordx2 v[168:169], v2, s[44:47], s63 offen offset:0
  buffer_load_dwordx2 v[170:171], v2, s[44:47], s63 offen offset:3584
  s_mov_b32 s63, 0xf5000
  buffer_load_dwordx2 v[172:173], v2, s[44:47], s63 offen offset:0
  buffer_load_dwordx2 v[174:175], v2, s[44:47], s63 offen offset:3584
  s_mov_b32 s63, 0x150000
  buffer_load_dwordx2 v[176:177], v2, s[44:47], s63 offen offset:0
  buffer_load_dwordx2 v[178:179], v2, s[44:47], s63 offen offset:3584
  s_mov_b32 s63, 0x157000
  buffer_load_dwordx2 v[180:181], v2, s[44:47], s63 offen offset:0
  buffer_load_dwordx2 v[182:183], v2, s[44:47], s63 offen offset:3584
  s_mov_b32 s63, 0x15e000
  buffer_load_dwordx2 v[184:185], v2, s[44:47], s63 offen offset:0
  buffer_load_dwordx2 v[186:187], v2, s[44:47], s63 offen offset:3584
  s_mov_b32 s63, 0x165000
  buffer_load_dwordx2 v[188:189], v2, s[44:47], s63 offen offset:0
  buffer_load_dwordx2 v[190:191], v2, s[44:47], s63 offen offset:3584
  s_mov_b32 s63, 0x1c00
  buffer_load_dwordx2 v[192:193], v2, s[44:47], s63 offen offset:0
  buffer_load_dwordx2 v[194:195], v2, s[44:47], s63 offen offset:3584
  s_mov_b32 s63, 0x8c00
  buffer_load_dwordx2 v[196:197], v2, s[44:47], s63 offen offset:0
  buffer_load_dwordx2 v[198:199], v2, s[44:47], s63 offen offset:3584
  s_mov_b32 s63, 0xfc00
  buffer_load_dwordx2 v[200:201], v2, s[44:47], s63 offen offset:0
  buffer_load_dwordx2 v[202:203], v2, s[44:47], s63 offen offset:3584
  s_mov_b32 s63, 0x16c00
  buffer_load_dwordx2 v[204:205], v2, s[44:47], s63 offen offset:0
  buffer_load_dwordx2 v[206:207], v2, s[44:47], s63 offen offset:3584
  s_mov_b32 s63, 0x71c00
  buffer_load_dwordx2 v[208:209], v2, s[44:47], s63 offen offset:0
  buffer_load_dwordx2 v[210:211], v2, s[44:47], s63 offen offset:3584
  s_mov_b32 s63, 0x78c00
  buffer_load_dwordx2 v[212:213], v2, s[44:47], s63 offen offset:0
  buffer_load_dwordx2 v[214:215], v2, s[44:47], s63 offen offset:3584
  s_mov_b32 s63, 0x7fc00
  buffer_load_dwordx2 v[216:217], v2, s[44:47], s63 offen offset:0
  buffer_load_dwordx2 v[218:219], v2, s[44:47], s63 offen offset:3584
  s_mov_b32 s63, 0x86c00
  buffer_load_dwordx2 v[220:221], v2, s[44:47], s63 offen offset:0
  buffer_load_dwordx2 v[222:223], v2, s[44:47], s63 offen offset:3584
  s_mov_b32 s63, 0xe1c00
  buffer_load_dwordx2 v[224:225], v2, s[44:47], s63 offen offset:0
  buffer_load_dwordx2 v[226:227], v2, s[44:47], s63 offen offset:3584
  s_mov_b32 s63, 0xe8c00
  buffer_load_dwordx2 v[228:229], v2, s[44:47], s63 offen offset:0
  buffer_load_dwordx2 v[230:231], v2, s[44:47], s63 offen offset:3584
  s_mov_b32 s63, 0xefc00
  buffer_load_dwordx2 v[232:233], v2, s[44:47], s63 offen offset:0
  buffer_load_dwordx2 v[234:235], v2, s[44:47], s63 offen offset:3584
  s_mov_b32 s63, 0xf6c00
  buffer_load_dwordx2 v[236:237], v2, s[44:47], s63 offen offset:0
  buffer_load_dwordx2 v[238:239], v2, s[44:47], s63 offen offset:3584
  s_waitcnt vmcnt(57)
  v_lshlrev_b32 v16, 16, v32
  v_and_b32 v20, 0xffff0000, v32
  v_lshlrev_b32 v24, 16, v33
  v_and_b32 v28, 0xffff0000, v33
  v_lshlrev_b32 v17, 16, v34
  v_and_b32 v21, 0xffff0000, v34
  v_lshlrev_b32 v25, 16, v35
  v_and_b32 v29, 0xffff0000, v35
  s_waitcnt vmcnt(56)
  v_lshlrev_b32 v18, 16, v36
  v_and_b32 v22, 0xffff0000, v36
  v_lshlrev_b32 v26, 16, v37
  v_and_b32 v30, 0xffff0000, v37
  v_lshlrev_b32 v19, 16, v38
  v_and_b32 v23, 0xffff0000, v38
  v_lshlrev_b32 v27, 16, v39
  v_and_b32 v31, 0xffff0000, v39
  s_waitcnt vmcnt(54)
  v_perm_b32 v40, v130, v128, s16
  s_waitcnt vmcnt(52)
  v_perm_b32 v41, v134, v132, s16
  s_waitcnt vmcnt(50)
  v_perm_b32 v42, v138, v136, s16
  s_waitcnt vmcnt(48)
  v_perm_b32 v43, v142, v140, s16
  v_perm_b32 v44, v130, v128, s17
  v_perm_b32 v45, v134, v132, s17
  v_perm_b32 v46, v138, v136, s17
  v_perm_b32 v47, v142, v140, s17
  v_perm_b32 v48, v131, v129, s16
  v_perm_b32 v49, v135, v133, s16
  v_perm_b32 v50, v139, v137, s16
  v_perm_b32 v51, v143, v141, s16
  v_perm_b32 v52, v131, v129, s17
  v_perm_b32 v53, v135, v133, s17
  v_perm_b32 v54, v139, v137, s17
  v_perm_b32 v55, v143, v141, s17
  v_accvgpr_write_b32 a0, v40
  v_accvgpr_write_b32 a1, v41
  v_accvgpr_write_b32 a2, v42
  v_accvgpr_write_b32 a3, v43
  v_accvgpr_write_b32 a4, v44
  v_accvgpr_write_b32 a5, v45
  v_accvgpr_write_b32 a6, v46
  v_accvgpr_write_b32 a7, v47
  v_accvgpr_write_b32 a8, v48
  v_accvgpr_write_b32 a9, v49
  v_accvgpr_write_b32 a10, v50
  v_accvgpr_write_b32 a11, v51
  v_accvgpr_write_b32 a12, v52
  v_accvgpr_write_b32 a13, v53
  v_accvgpr_write_b32 a14, v54
  v_accvgpr_write_b32 a15, v55
  s_mov_b32 s63, 0x151c00
  buffer_load_dwordx2 v[128:129], v2, s[44:47], s63 offen offset:0
  buffer_load_dwordx2 v[130:131], v2, s[44:47], s63 offen offset:3584
  s_mov_b32 s63, 0x158c00
  buffer_load_dwordx2 v[132:133], v2, s[44:47], s63 offen offset:0
  buffer_load_dwordx2 v[134:135], v2, s[44:47], s63 offen offset:3584
  s_mov_b32 s63, 0x15fc00
  buffer_load_dwordx2 v[136:137], v2, s[44:47], s63 offen offset:0
  buffer_load_dwordx2 v[138:139], v2, s[44:47], s63 offen offset:3584
  s_mov_b32 s63, 0x166c00
  buffer_load_dwordx2 v[140:141], v2, s[44:47], s63 offen offset:0
  buffer_load_dwordx2 v[142:143], v2, s[44:47], s63 offen offset:3584
  s_waitcnt vmcnt(54)
  v_perm_b32 v40, v146, v144, s16
  s_waitcnt vmcnt(52)
  v_perm_b32 v41, v150, v148, s16
  s_waitcnt vmcnt(50)
  v_perm_b32 v42, v154, v152, s16
  s_waitcnt vmcnt(48)
  v_perm_b32 v43, v158, v156, s16
  v_perm_b32 v44, v146, v144, s17
  v_perm_b32 v45, v150, v148, s17
  v_perm_b32 v46, v154, v152, s17
  v_perm_b32 v47, v158, v156, s17
  v_perm_b32 v48, v147, v145, s16
  v_perm_b32 v49, v151, v149, s16
  v_perm_b32 v50, v155, v153, s16
  v_perm_b32 v51, v159, v157, s16
  v_perm_b32 v52, v147, v145, s17
  v_perm_b32 v53, v151, v149, s17
  v_perm_b32 v54, v155, v153, s17
  v_perm_b32 v55, v159, v157, s17
  v_accvgpr_write_b32 a16, v40
  v_accvgpr_write_b32 a17, v41
  v_accvgpr_write_b32 a18, v42
  v_accvgpr_write_b32 a19, v43
  v_accvgpr_write_b32 a20, v44
  v_accvgpr_write_b32 a21, v45
  v_accvgpr_write_b32 a22, v46
  v_accvgpr_write_b32 a23, v47
  v_accvgpr_write_b32 a24, v48
  v_accvgpr_write_b32 a25, v49
  v_accvgpr_write_b32 a26, v50
  v_accvgpr_write_b32 a27, v51
  v_accvgpr_write_b32 a28, v52
  v_accvgpr_write_b32 a29, v53
  v_accvgpr_write_b32 a30, v54
  v_accvgpr_write_b32 a31, v55
  s_mov_b32 s63, 0x3800
  buffer_load_dwordx2 v[144:145], v2, s[44:47], s63 offen offset:0
  buffer_load_dwordx2 v[146:147], v2, s[44:47], s63 offen offset:3584
  s_mov_b32 s63, 0xa800
  buffer_load_dwordx2 v[148:149], v2, s[44:47], s63 offen offset:0
  buffer_load_dwordx2 v[150:151], v2, s[44:47], s63 offen offset:3584
  s_mov_b32 s63, 0x11800
  buffer_load_dwordx2 v[152:153], v2, s[44:47], s63 offen offset:0
  buffer_load_dwordx2 v[154:155], v2, s[44:47], s63 offen offset:3584
  s_mov_b32 s63, 0x18800
  buffer_load_dwordx2 v[156:157], v2, s[44:47], s63 offen offset:0
  buffer_load_dwordx2 v[158:159], v2, s[44:47], s63 offen offset:3584
  s_waitcnt vmcnt(54)
  v_perm_b32 v40, v162, v160, s16
  s_waitcnt vmcnt(52)
  v_perm_b32 v41, v166, v164, s16
  s_waitcnt vmcnt(50)
  v_perm_b32 v42, v170, v168, s16
  s_waitcnt vmcnt(48)
  v_perm_b32 v43, v174, v172, s16
  v_perm_b32 v44, v162, v160, s17
  v_perm_b32 v45, v166, v164, s17
  v_perm_b32 v46, v170, v168, s17
  v_perm_b32 v47, v174, v172, s17
  v_perm_b32 v48, v163, v161, s16
  v_perm_b32 v49, v167, v165, s16
  v_perm_b32 v50, v171, v169, s16
  v_perm_b32 v51, v175, v173, s16
  v_perm_b32 v52, v163, v161, s17
  v_perm_b32 v53, v167, v165, s17
  v_perm_b32 v54, v171, v169, s17
  v_perm_b32 v55, v175, v173, s17
  v_accvgpr_write_b32 a32, v40
  v_accvgpr_write_b32 a33, v41
  v_accvgpr_write_b32 a34, v42
  v_accvgpr_write_b32 a35, v43
  v_accvgpr_write_b32 a36, v44
  v_accvgpr_write_b32 a37, v45
  v_accvgpr_write_b32 a38, v46
  v_accvgpr_write_b32 a39, v47
  v_accvgpr_write_b32 a40, v48
  v_accvgpr_write_b32 a41, v49
  v_accvgpr_write_b32 a42, v50
  v_accvgpr_write_b32 a43, v51
  v_accvgpr_write_b32 a44, v52
  v_accvgpr_write_b32 a45, v53
  v_accvgpr_write_b32 a46, v54
  v_accvgpr_write_b32 a47, v55
  s_mov_b32 s63, 0x73800
  buffer_load_dwordx2 v[160:161], v2, s[44:47], s63 offen offset:0
  buffer_load_dwordx2 v[162:163], v2, s[44:47], s63 offen offset:3584
  s_mov_b32 s63, 0x7a800
  buffer_load_dwordx2 v[164:165], v2, s[44:47], s63 offen offset:0
  buffer_load_dwordx2 v[166:167], v2, s[44:47], s63 offen offset:3584
  s_mov_b32 s63, 0x81800
  buffer_load_dwordx2 v[168:169], v2, s[44:47], s63 offen offset:0
  buffer_load_dwordx2 v[170:171], v2, s[44:47], s63 offen offset:3584
  s_mov_b32 s63, 0x88800
  buffer_load_dwordx2 v[172:173], v2, s[44:47], s63 offen offset:0
  buffer_load_dwordx2 v[174:175], v2, s[44:47], s63 offen offset:3584
  s_waitcnt vmcnt(54)
  v_perm_b32 v40, v178, v176, s16
  s_waitcnt vmcnt(52)
  v_perm_b32 v41, v182, v180, s16
  s_waitcnt vmcnt(50)
  v_perm_b32 v42, v186, v184, s16
  s_waitcnt vmcnt(48)
  v_perm_b32 v43, v190, v188, s16
  v_perm_b32 v44, v178, v176, s17
  v_perm_b32 v45, v182, v180, s17
  v_perm_b32 v46, v186, v184, s17
  v_perm_b32 v47, v190, v188, s17
  v_perm_b32 v48, v179, v177, s16
  v_perm_b32 v49, v183, v181, s16
  v_perm_b32 v50, v187, v185, s16
  v_perm_b32 v51, v191, v189, s16
  v_perm_b32 v52, v179, v177, s17
  v_perm_b32 v53, v183, v181, s17
  v_perm_b32 v54, v187, v185, s17
  v_perm_b32 v55, v191, v189, s17
  v_accvgpr_write_b32 a48, v40
  v_accvgpr_write_b32 a49, v41
  v_accvgpr_write_b32 a50, v42
  v_accvgpr_write_b32 a51, v43
  v_accvgpr_write_b32 a52, v44
  v_accvgpr_write_b32 a53, v45
  v_accvgpr_write_b32 a54, v46
  v_accvgpr_write_b32 a55, v47
  v_accvgpr_write_b32 a56, v48
  v_accvgpr_write_b32 a57, v49
  v_accvgpr_write_b32 a58, v50
  v_accvgpr_write_b32 a59, v51
  v_accvgpr_write_b32 a60, v52
  v_accvgpr_write_b32 a61, v53
  v_accvgpr_write_b32 a62, v54
  v_accvgpr_write_b32 a63, v55
  s_mov_b32 s63, 0xe3800
  buffer_load_dwordx2 v[176:177], v2, s[44:47], s63 offen offset:0
  buffer_load_dwordx2 v[178:179], v2, s[44:47], s63 offen offset:3584
  s_mov_b32 s63, 0xea800
  buffer_load_dwordx2 v[180:181], v2, s[44:47], s63 offen offset:0
  buffer_load_dwordx2 v[182:183], v2, s[44:47], s63 offen offset:3584
  s_mov_b32 s63, 0xf1800
  buffer_load_dwordx2 v[184:185], v2, s[44:47], s63 offen offset:0
  buffer_load_dwordx2 v[186:187], v2, s[44:47], s63 offen offset:3584
  s_mov_b32 s63, 0xf8800
  buffer_load_dwordx2 v[188:189], v2, s[44:47], s63 offen offset:0
  buffer_load_dwordx2 v[190:191], v2, s[44:47], s63 offen offset:3584
  s_waitcnt vmcnt(54)
  v_perm_b32 v40, v194, v192, s16
  s_waitcnt vmcnt(52)
  v_perm_b32 v41, v198, v196, s16
  s_waitcnt vmcnt(50)
  v_perm_b32 v42, v202, v200, s16
  s_waitcnt vmcnt(48)
  v_perm_b32 v43, v206, v204, s16
  v_perm_b32 v44, v194, v192, s17
  v_perm_b32 v45, v198, v196, s17
  v_perm_b32 v46, v202, v200, s17
  v_perm_b32 v47, v206, v204, s17
  v_perm_b32 v48, v195, v193, s16
  v_perm_b32 v49, v199, v197, s16
  v_perm_b32 v50, v203, v201, s16
  v_perm_b32 v51, v207, v205, s16
  v_perm_b32 v52, v195, v193, s17
  v_perm_b32 v53, v199, v197, s17
  v_perm_b32 v54, v203, v201, s17
  v_perm_b32 v55, v207, v205, s17
  v_accvgpr_write_b32 a64, v40
  v_accvgpr_write_b32 a65, v41
  v_accvgpr_write_b32 a66, v42
  v_accvgpr_write_b32 a67, v43
  v_accvgpr_write_b32 a68, v44
  v_accvgpr_write_b32 a69, v45
  v_accvgpr_write_b32 a70, v46
  v_accvgpr_write_b32 a71, v47
  v_accvgpr_write_b32 a72, v48
  v_accvgpr_write_b32 a73, v49
  v_accvgpr_write_b32 a74, v50
  v_accvgpr_write_b32 a75, v51
  v_accvgpr_write_b32 a76, v52
  v_accvgpr_write_b32 a77, v53
  v_accvgpr_write_b32 a78, v54
  v_accvgpr_write_b32 a79, v55
  s_mov_b32 s63, 0x153800
  buffer_load_dwordx2 v[192:193], v2, s[44:47], s63 offen offset:0
  buffer_load_dwordx2 v[194:195], v2, s[44:47], s63 offen offset:3584
  s_mov_b32 s63, 0x15a800
  buffer_load_dwordx2 v[196:197], v2, s[44:47], s63 offen offset:0
  buffer_load_dwordx2 v[198:199], v2, s[44:47], s63 offen offset:3584
  s_mov_b32 s63, 0x161800
  buffer_load_dwordx2 v[200:201], v2, s[44:47], s63 offen offset:0
  buffer_load_dwordx2 v[202:203], v2, s[44:47], s63 offen offset:3584
  s_mov_b32 s63, 0x168800
  buffer_load_dwordx2 v[204:205], v2, s[44:47], s63 offen offset:0
  buffer_load_dwordx2 v[206:207], v2, s[44:47], s63 offen offset:3584
  s_waitcnt vmcnt(54)
  v_perm_b32 v40, v210, v208, s16
  s_waitcnt vmcnt(52)
  v_perm_b32 v41, v214, v212, s16
  s_waitcnt vmcnt(50)
  v_perm_b32 v42, v218, v216, s16
  s_waitcnt vmcnt(48)
  v_perm_b32 v43, v222, v220, s16
  v_perm_b32 v44, v210, v208, s17
  v_perm_b32 v45, v214, v212, s17
  v_perm_b32 v46, v218, v216, s17
  v_perm_b32 v47, v222, v220, s17
  v_perm_b32 v48, v211, v209, s16
  v_perm_b32 v49, v215, v213, s16
  v_perm_b32 v50, v219, v217, s16
  v_perm_b32 v51, v223, v221, s16
  v_perm_b32 v52, v211, v209, s17
  v_perm_b32 v53, v215, v213, s17
  v_perm_b32 v54, v219, v217, s17
  v_perm_b32 v55, v223, v221, s17
  v_accvgpr_write_b32 a80, v40
  v_accvgpr_write_b32 a81, v41
  v_accvgpr_write_b32 a82, v42
  v_accvgpr_write_b32 a83, v43
  v_accvgpr_write_b32 a84, v44
  v_accvgpr_write_b32 a85, v45
  v_accvgpr_write_b32 a86, v46
  v_accvgpr_write_b32 a87, v47
  v_accvgpr_write_b32 a88, v48
  v_accvgpr_write_b32 a89, v49
  v_accvgpr_write_b32 a90, v50
  v_accvgpr_write_b32 a91, v51
  v_accvgpr_write_b32 a92, v52
  v_accvgpr_write_b32 a93, v53
  v_accvgpr_write_b32 a94, v54
  v_accvgpr_write_b32 a95, v55
  s_mov_b32 s63, 0x5400
  buffer_load_dwordx2 v[208:209], v2, s[44:47], s63 offen offset:0
  buffer_load_dwordx2 v[210:211], v2, s[44:47], s63 offen offset:3584
  s_mov_b32 s63, 0xc400
  buffer_load_dwordx2 v[212:213], v2, s[44:47], s63 offen offset:0
  buffer_load_dwordx2 v[214:215], v2, s[44:47], s63 offen offset:3584
  s_mov_b32 s63, 0x13400
  buffer_load_dwordx2 v[216:217], v2, s[44:47], s63 offen offset:0
  buffer_load_dwordx2 v[218:219], v2, s[44:47], s63 offen offset:3584
  s_mov_b32 s63, 0x1a400
  buffer_load_dwordx2 v[220:221], v2, s[44:47], s63 offen offset:0
  buffer_load_dwordx2 v[222:223], v2, s[44:47], s63 offen offset:3584
  s_waitcnt vmcnt(54)
  v_perm_b32 v40, v226, v224, s16
  s_waitcnt vmcnt(52)
  v_perm_b32 v41, v230, v228, s16
  s_waitcnt vmcnt(50)
  v_perm_b32 v42, v234, v232, s16
  s_waitcnt vmcnt(48)
  v_perm_b32 v43, v238, v236, s16
  v_perm_b32 v44, v226, v224, s17
  v_perm_b32 v45, v230, v228, s17
  v_perm_b32 v46, v234, v232, s17
  v_perm_b32 v47, v238, v236, s17
  v_perm_b32 v48, v227, v225, s16
  v_perm_b32 v49, v231, v229, s16
  v_perm_b32 v50, v235, v233, s16
  v_perm_b32 v51, v239, v237, s16
  v_perm_b32 v52, v227, v225, s17
  v_perm_b32 v53, v231, v229, s17
  v_perm_b32 v54, v235, v233, s17
  v_perm_b32 v55, v239, v237, s17
  v_accvgpr_write_b32 a96, v40
  v_accvgpr_write_b32 a97, v41
  v_accvgpr_write_b32 a98, v42
  v_accvgpr_write_b32 a99, v43
  v_accvgpr_write_b32 a100, v44
  v_accvgpr_write_b32 a101, v45
  v_accvgpr_write_b32 a102, v46
  v_accvgpr_write_b32 a103, v47
  v_accvgpr_write_b32 a104, v48
  v_accvgpr_write_b32 a105, v49
  v_accvgpr_write_b32 a106, v50
  v_accvgpr_write_b32 a107, v51
  v_accvgpr_write_b32 a108, v52
  v_accvgpr_write_b32 a109, v53
  v_accvgpr_write_b32 a110, v54
  v_accvgpr_write_b32 a111, v55
  s_mov_b32 s63, 0x75400
  buffer_load_dwordx2 v[224:225], v2, s[44:47], s63 offen offset:0
  buffer_load_dwordx2 v[226:227], v2, s[44:47], s63 offen offset:3584
  s_mov_b32 s63, 0x7c400
  buffer_load_dwordx2 v[228:229], v2, s[44:47], s63 offen offset:0
  buffer_load_dwordx2 v[230:231], v2, s[44:47], s63 offen offset:3584
  s_mov_b32 s63, 0x83400
  buffer_load_dwordx2 v[232:233], v2, s[44:47], s63 offen offset:0
  buffer_load_dwordx2 v[234:235], v2, s[44:47], s63 offen offset:3584
  s_mov_b32 s63, 0x8a400
  buffer_load_dwordx2 v[236:237], v2, s[44:47], s63 offen offset:0
  buffer_load_dwordx2 v[238:239], v2, s[44:47], s63 offen offset:3584
  s_waitcnt vmcnt(54)
  v_perm_b32 v40, v130, v128, s16
  s_waitcnt vmcnt(52)
  v_perm_b32 v41, v134, v132, s16
  s_waitcnt vmcnt(50)
  v_perm_b32 v42, v138, v136, s16
  s_waitcnt vmcnt(48)
  v_perm_b32 v43, v142, v140, s16
  v_perm_b32 v44, v130, v128, s17
  v_perm_b32 v45, v134, v132, s17
  v_perm_b32 v46, v138, v136, s17
  v_perm_b32 v47, v142, v140, s17
  v_perm_b32 v48, v131, v129, s16
  v_perm_b32 v49, v135, v133, s16
  v_perm_b32 v50, v139, v137, s16
  v_perm_b32 v51, v143, v141, s16
  v_perm_b32 v52, v131, v129, s17
  v_perm_b32 v53, v135, v133, s17
  v_perm_b32 v54, v139, v137, s17
  v_perm_b32 v55, v143, v141, s17
  v_accvgpr_write_b32 a112, v40
  v_accvgpr_write_b32 a113, v41
  v_accvgpr_write_b32 a114, v42
  v_accvgpr_write_b32 a115, v43
  v_accvgpr_write_b32 a116, v44
  v_accvgpr_write_b32 a117, v45
  v_accvgpr_write_b32 a118, v46
  v_accvgpr_write_b32 a119, v47
  v_accvgpr_write_b32 a120, v48
  v_accvgpr_write_b32 a121, v49
  v_accvgpr_write_b32 a122, v50
  v_accvgpr_write_b32 a123, v51
  v_accvgpr_write_b32 a124, v52
  v_accvgpr_write_b32 a125, v53
  v_accvgpr_write_b32 a126, v54
  v_accvgpr_write_b32 a127, v55
  s_mov_b32 s63, 0xe5400
  buffer_load_dwordx2 v[128:129], v2, s[44:47], s63 offen offset:0
  buffer_load_dwordx2 v[130:131], v2, s[44:47], s63 offen offset:3584
  s_mov_b32 s63, 0xec400
  buffer_load_dwordx2 v[132:133], v2, s[44:47], s63 offen offset:0
  buffer_load_dwordx2 v[134:135], v2, s[44:47], s63 offen offset:3584
  s_mov_b32 s63, 0xf3400
  buffer_load_dwordx2 v[136:137], v2, s[44:47], s63 offen offset:0
  buffer_load_dwordx2 v[138:139], v2, s[44:47], s63 offen offset:3584
  s_mov_b32 s63, 0xfa400
  buffer_load_dwordx2 v[140:141], v2, s[44:47], s63 offen offset:0
  buffer_load_dwordx2 v[142:143], v2, s[44:47], s63 offen offset:3584
  s_waitcnt vmcnt(54)
  v_perm_b32 v40, v146, v144, s16
  s_waitcnt vmcnt(52)
  v_perm_b32 v41, v150, v148, s16
  s_waitcnt vmcnt(50)
  v_perm_b32 v42, v154, v152, s16
  s_waitcnt vmcnt(48)
  v_perm_b32 v43, v158, v156, s16
  v_perm_b32 v44, v146, v144, s17
  v_perm_b32 v45, v150, v148, s17
  v_perm_b32 v46, v154, v152, s17
  v_perm_b32 v47, v158, v156, s17
  v_perm_b32 v48, v147, v145, s16
  v_perm_b32 v49, v151, v149, s16
  v_perm_b32 v50, v155, v153, s16
  v_perm_b32 v51, v159, v157, s16
  v_perm_b32 v52, v147, v145, s17
  v_perm_b32 v53, v151, v149, s17
  v_perm_b32 v54, v155, v153, s17
  v_perm_b32 v55, v159, v157, s17
  v_accvgpr_write_b32 a128, v40
  v_accvgpr_write_b32 a129, v41
  v_accvgpr_write_b32 a130, v42
  v_accvgpr_write_b32 a131, v43
  v_accvgpr_write_b32 a132, v44
  v_accvgpr_write_b32 a133, v45
  v_accvgpr_write_b32 a134, v46
  v_accvgpr_write_b32 a135, v47
  v_accvgpr_write_b32 a136, v48
  v_accvgpr_write_b32 a137, v49
  v_accvgpr_write_b32 a138, v50
  v_accvgpr_write_b32 a139, v51
  v_accvgpr_write_b32 a140, v52
  v_accvgpr_write_b32 a141, v53
  v_accvgpr_write_b32 a142, v54
  v_accvgpr_write_b32 a143, v55
  s_mov_b32 s63, 0x155400
  buffer_load_dwordx2 v[144:145], v2, s[44:47], s63 offen offset:0
  buffer_load_dwordx2 v[146:147], v2, s[44:47], s63 offen offset:3584
  s_mov_b32 s63, 0x15c400
  buffer_load_dwordx2 v[148:149], v2, s[44:47], s63 offen offset:0
  buffer_load_dwordx2 v[150:151], v2, s[44:47], s63 offen offset:3584
  s_mov_b32 s63, 0x163400
  buffer_load_dwordx2 v[152:153], v2, s[44:47], s63 offen offset:0
  buffer_load_dwordx2 v[154:155], v2, s[44:47], s63 offen offset:3584
  s_mov_b32 s63, 0x16a400
  buffer_load_dwordx2 v[156:157], v2, s[44:47], s63 offen offset:0
  buffer_load_dwordx2 v[158:159], v2, s[44:47], s63 offen offset:3584
  s_waitcnt vmcnt(54)
  v_perm_b32 v40, v162, v160, s16
  s_waitcnt vmcnt(52)
  v_perm_b32 v41, v166, v164, s16
  s_waitcnt vmcnt(50)
  v_perm_b32 v42, v170, v168, s16
  s_waitcnt vmcnt(48)
  v_perm_b32 v43, v174, v172, s16
  v_perm_b32 v44, v162, v160, s17
  v_perm_b32 v45, v166, v164, s17
  v_perm_b32 v46, v170, v168, s17
  v_perm_b32 v47, v174, v172, s17
  v_perm_b32 v48, v163, v161, s16
  v_perm_b32 v49, v167, v165, s16
  v_perm_b32 v50, v171, v169, s16
  v_perm_b32 v51, v175, v173, s16
  v_perm_b32 v52, v163, v161, s17
  v_perm_b32 v53, v167, v165, s17
  v_perm_b32 v54, v171, v169, s17
  v_perm_b32 v55, v175, v173, s17
  v_accvgpr_write_b32 a144, v40
  v_accvgpr_write_b32 a145, v41
  v_accvgpr_write_b32 a146, v42
  v_accvgpr_write_b32 a147, v43
  v_accvgpr_write_b32 a148, v44
  v_accvgpr_write_b32 a149, v45
  v_accvgpr_write_b32 a150, v46
  v_accvgpr_write_b32 a151, v47
  v_accvgpr_write_b32 a152, v48
  v_accvgpr_write_b32 a153, v49
  v_accvgpr_write_b32 a154, v50
  v_accvgpr_write_b32 a155, v51
  v_accvgpr_write_b32 a156, v52
  v_accvgpr_write_b32 a157, v53
  v_accvgpr_write_b32 a158, v54
  v_accvgpr_write_b32 a159, v55
  s_waitcnt vmcnt(46)
  v_perm_b32 v40, v178, v176, s16
  s_waitcnt vmcnt(44)
  v_perm_b32 v41, v182, v180, s16
  s_waitcnt vmcnt(42)
  v_perm_b32 v42, v186, v184, s16
  s_waitcnt vmcnt(40)
  v_perm_b32 v43, v190, v188, s16
  v_perm_b32 v44, v178, v176, s17
  v_perm_b32 v45, v182, v180, s17
  v_perm_b32 v46, v186, v184, s17
  v_perm_b32 v47, v190, v188, s17
  v_perm_b32 v48, v179, v177, s16
  v_perm_b32 v49, v183, v181, s16
  v_perm_b32 v50, v187, v185, s16
  v_perm_b32 v51, v191, v189, s16
  v_perm_b32 v52, v179, v177, s17
  v_perm_b32 v53, v183, v181, s17
  v_perm_b32 v54, v187, v185, s17
  v_perm_b32 v55, v191, v189, s17
  v_accvgpr_write_b32 a160, v40
  v_accvgpr_write_b32 a161, v41
  v_accvgpr_write_b32 a162, v42
  v_accvgpr_write_b32 a163, v43
  v_accvgpr_write_b32 a164, v44
  v_accvgpr_write_b32 a165, v45
  v_accvgpr_write_b32 a166, v46
  v_accvgpr_write_b32 a167, v47
  v_accvgpr_write_b32 a168, v48
  v_accvgpr_write_b32 a169, v49
  v_accvgpr_write_b32 a170, v50
  v_accvgpr_write_b32 a171, v51
  v_accvgpr_write_b32 a172, v52
  v_accvgpr_write_b32 a173, v53
  v_accvgpr_write_b32 a174, v54
  v_accvgpr_write_b32 a175, v55
  s_waitcnt vmcnt(38)
  v_perm_b32 v40, v194, v192, s16
  s_waitcnt vmcnt(36)
  v_perm_b32 v41, v198, v196, s16
  s_waitcnt vmcnt(34)
  v_perm_b32 v42, v202, v200, s16
  s_waitcnt vmcnt(32)
  v_perm_b32 v43, v206, v204, s16
  v_perm_b32 v44, v194, v192, s17
  v_perm_b32 v45, v198, v196, s17
  v_perm_b32 v46, v202, v200, s17
  v_perm_b32 v47, v206, v204, s17
  v_perm_b32 v48, v195, v193, s16
  v_perm_b32 v49, v199, v197, s16
  v_perm_b32 v50, v203, v201, s16
  v_perm_b32 v51, v207, v205, s16
  v_perm_b32 v52, v195, v193, s17
  v_perm_b32 v53, v199, v197, s17
  v_perm_b32 v54, v203, v201, s17
  v_perm_b32 v55, v207, v205, s17
  v_accvgpr_write_b32 a176, v40
  v_accvgpr_write_b32 a177, v41
  v_accvgpr_write_b32 a178, v42
  v_accvgpr_write_b32 a179, v43
  v_accvgpr_write_b32 a180, v44
  v_accvgpr_write_b32 a181, v45
  v_accvgpr_write_b32 a182, v46
  v_accvgpr_write_b32 a183, v47
  v_accvgpr_write_b32 a184, v48
  v_accvgpr_write_b32 a185, v49
  v_accvgpr_write_b32 a186, v50
  v_accvgpr_write_b32 a187, v51
  v_accvgpr_write_b32 a188, v52
  v_accvgpr_write_b32 a189, v53
  v_accvgpr_write_b32 a190, v54
  v_accvgpr_write_b32 a191, v55
  s_waitcnt vmcnt(30)
  v_perm_b32 v40, v210, v208, s16
  s_waitcnt vmcnt(28)
  v_perm_b32 v41, v214, v212, s16
  s_waitcnt vmcnt(26)
  v_perm_b32 v42, v218, v216, s16
  s_waitcnt vmcnt(24)
  v_perm_b32 v43, v222, v220, s16
  v_perm_b32 v44, v210, v208, s17
  v_perm_b32 v45, v214, v212, s17
  v_perm_b32 v46, v218, v216, s17
  v_perm_b32 v47, v222, v220, s17
  v_perm_b32 v48, v211, v209, s16
  v_perm_b32 v49, v215, v213, s16
  v_perm_b32 v50, v219, v217, s16
  v_perm_b32 v51, v223, v221, s16
  v_perm_b32 v52, v211, v209, s17
  v_perm_b32 v53, v215, v213, s17
  v_perm_b32 v54, v219, v217, s17
  v_perm_b32 v55, v223, v221, s17
  v_accvgpr_write_b32 a192, v40
  v_accvgpr_write_b32 a193, v41
  v_accvgpr_write_b32 a194, v42
  v_accvgpr_write_b32 a195, v43
  v_accvgpr_write_b32 a196, v44
  v_accvgpr_write_b32 a197, v45
  v_accvgpr_write_b32 a198, v46
  v_accvgpr_write_b32 a199, v47
  v_accvgpr_write_b32 a200, v48
  v_accvgpr_write_b32 a201, v49
  v_accvgpr_write_b32 a202, v50
  v_accvgpr_write_b32 a203, v51
  v_accvgpr_write_b32 a204, v52
  v_accvgpr_write_b32 a205, v53
  v_accvgpr_write_b32 a206, v54
  v_accvgpr_write_b32 a207, v55
  s_waitcnt vmcnt(22)
  v_perm_b32 v40, v226, v224, s16
  s_waitcnt vmcnt(20)
  v_perm_b32 v41, v230, v228, s16
  s_waitcnt vmcnt(18)
  v_perm_b32 v42, v234, v232, s16
  s_waitcnt vmcnt(16)
  v_perm_b32 v43, v238, v236, s16
  v_perm_b32 v44, v226, v224, s17
  v_perm_b32 v45, v230, v228, s17
  v_perm_b32 v46, v234, v232, s17
  v_perm_b32 v47, v238, v236, s17
  v_perm_b32 v48, v227, v225, s16
  v_perm_b32 v49, v231, v229, s16
  v_perm_b32 v50, v235, v233, s16
  v_perm_b32 v51, v239, v237, s16
  v_perm_b32 v52, v227, v225, s17
  v_perm_b32 v53, v231, v229, s17
  v_perm_b32 v54, v235, v233, s17
  v_perm_b32 v55, v239, v237, s17
  v_accvgpr_write_b32 a208, v40
  v_accvgpr_write_b32 a209, v41
  v_accvgpr_write_b32 a210, v42
  v_accvgpr_write_b32 a211, v43
  v_accvgpr_write_b32 a212, v44
  v_accvgpr_write_b32 a213, v45
  v_accvgpr_write_b32 a214, v46
  v_accvgpr_write_b32 a215, v47
  v_accvgpr_write_b32 a216, v48
  v_accvgpr_write_b32 a217, v49
  v_accvgpr_write_b32 a218, v50
  v_accvgpr_write_b32 a219, v51
  v_accvgpr_write_b32 a220, v52
  v_accvgpr_write_b32 a221, v53
  v_accvgpr_write_b32 a222, v54
  v_accvgpr_write_b32 a223, v55
  s_waitcnt vmcnt(14)
  v_perm_b32 v40, v130, v128, s16
  s_waitcnt vmcnt(12)
  v_perm_b32 v41, v134, v132, s16
  s_waitcnt vmcnt(10)
  v_perm_b32 v42, v138, v136, s16
  s_waitcnt vmcnt(8)
  v_perm_b32 v43, v142, v140, s16
  v_perm_b32 v44, v130, v128, s17
  v_perm_b32 v45, v134, v132, s17
  v_perm_b32 v46, v138, v136, s17
  v_perm_b32 v47, v142, v140, s17
  v_perm_b32 v48, v131, v129, s16
  v_perm_b32 v49, v135, v133, s16
  v_perm_b32 v50, v139, v137, s16
  v_perm_b32 v51, v143, v141, s16
  v_perm_b32 v52, v131, v129, s17
  v_perm_b32 v53, v135, v133, s17
  v_perm_b32 v54, v139, v137, s17
  v_perm_b32 v55, v143, v141, s17
  v_accvgpr_write_b32 a224, v40
  v_accvgpr_write_b32 a225, v41
  v_accvgpr_write_b32 a226, v42
  v_accvgpr_write_b32 a227, v43
  v_accvgpr_write_b32 a228, v44
  v_accvgpr_write_b32 a229, v45
  v_accvgpr_write_b32 a230, v46
  v_accvgpr_write_b32 a231, v47
  v_accvgpr_write_b32 a232, v48
  v_accvgpr_write_b32 a233, v49
  v_accvgpr_write_b32 a234, v50
  v_accvgpr_write_b32 a235, v51
  v_accvgpr_write_b32 a236, v52
  v_accvgpr_write_b32 a237, v53
  v_accvgpr_write_b32 a238, v54
  v_accvgpr_write_b32 a239, v55
  s_waitcnt vmcnt(6)
  v_perm_b32 v40, v146, v144, s16
  s_waitcnt vmcnt(4)
  v_perm_b32 v41, v150, v148, s16
  s_waitcnt vmcnt(2)
  v_perm_b32 v42, v154, v152, s16
  s_waitcnt vmcnt(0)
  v_perm_b32 v43, v158, v156, s16
  v_perm_b32 v44, v146, v144, s17
  v_perm_b32 v45, v150, v148, s17
  v_perm_b32 v46, v154, v152, s17
  v_perm_b32 v47, v158, v156, s17
  v_perm_b32 v48, v147, v145, s16
  v_perm_b32 v49, v151, v149, s16
  v_perm_b32 v50, v155, v153, s16
  v_perm_b32 v51, v159, v157, s16
  v_perm_b32 v52, v147, v145, s17
  v_perm_b32 v53, v151, v149, s17
  v_perm_b32 v54, v155, v153, s17
  v_perm_b32 v55, v159, v157, s17
  v_accvgpr_write_b32 a240, v40
  v_accvgpr_write_b32 a241, v41
  v_accvgpr_write_b32 a242, v42
  v_accvgpr_write_b32 a243, v43
  v_accvgpr_write_b32 a244, v44
  v_accvgpr_write_b32 a245, v45
  v_accvgpr_write_b32 a246, v46
  v_accvgpr_write_b32 a247, v47
  v_accvgpr_write_b32 a248, v48
  v_accvgpr_write_b32 a249, v49
  v_accvgpr_write_b32 a250, v50
  v_accvgpr_write_b32 a251, v51
  v_accvgpr_write_b32 a252, v52
  v_accvgpr_write_b32 a253, v53
  v_accvgpr_write_b32 a254, v54
  v_accvgpr_write_b32 a255, v55
  buffer_load_dword v8, off, s[40:43], 0 offset:4 sc1
  s_waitcnt vmcnt(0)
  v_readfirstlane_b32 s18, v8
L_rot_132:
  s_cmp_eq_u32 s18, s100
  s_cbranch_scc1 L_rotok_133
  s_cmp_lg_u32 s18, 0
  s_cbranch_scc1 L_restart
  s_sub_u32 s3, s3, 1
  s_cbranch_scc1 L_end
  buffer_load_dword v8, off, s[40:43], 0 offset:4 sc1
  s_waitcnt vmcnt(0)
  v_readfirstlane_b32 s18, v8
  s_branch L_rot_132
L_rotok_133:
L_spin_134:
  buffer_load_dword v8, off, s[40:43], 0 offset:8 sc1
  s_waitcnt vmcnt(0)
  v_cmp_ne_u32 vcc, 64, v8
  s_cbranch_vccz L_ok_135
  s_sub_u32 s3, s3, 1
  s_cbranch_scc1 L_end
  s_sleep 8
  s_branch L_spin_134
L_ok_135:
  s_mov_b32 s66, 0
  s_mov_b32 s67, 0xbdd2d3e8
  v_mov_b32 v5, 0xc0135761
  s_lshl_b32 s78, s65, 15
  s_lshl_b32 s79, s34, 13
  s_add_u32 s78, s78, s79
  s_add_u32 s78, s78, 0x200000
  s_lshl_b32 s80, s66, 15
  s_add_u32 s79, s79, s80
  s_add_u32 m0, s79, 0
  s_nop 0
  buffer_load_dwordx4 v1, s[36:39], s78 offen offset:0 sc1 lds
  buffer_load_dwordx4 v1, s[36:39], s78 offen offset:1024 sc1 lds
  buffer_load_dwordx4 v1, s[36:39], s78 offen offset:2048 sc1 lds
  buffer_load_dwordx4 v1, s[36:39], s78 offen offset:3072 sc1 lds
  s_add_u32 s78, s78, 4096
  s_add_u32 m0, s79, 4096
  s_nop 0
  buffer_load_dwordx4 v1, s[36:39], s78 offen offset:0 sc1 lds
  buffer_load_dwordx4 v1, s[36:39], s78 offen offset:1024 sc1 lds
  buffer_load_dwordx4 v1, s[36:39], s78 offen offset:2048 sc1 lds
  buffer_load_dwordx4 v1, s[36:39], s78 offen offset:3072 sc1 lds
  s_waitcnt vmcnt(0)
L_hid_loop:
  s_barrier
  s_cmp_ge_u32 s65, 60
  s_cbranch_scc1 L_nopf_136
  s_add_u32 s81, s65, 4
  s_xor_b32 s82, s66, 1
  s_lshl_b32 s78, s81, 15
  s_lshl_b32 s79, s34, 13
  s_add_u32 s78, s78, s79
  s_add_u32 s78, s78, 0x200000
  s_lshl_b32 s80, s82, 15
  s_add_u32 s79, s79, s80
  s_add_u32 m0, s79, 0
  s_nop 0
  buffer_load_dwordx4 v1, s[36:39], s78 offen offset:0 sc1 lds
  buffer_load_dwordx4 v1, s[36:39], s78 offen offset:1024 sc1 lds
  buffer_load_dwordx4 v1, s[36:39], s78 offen offset:2048 sc1 lds
  buffer_load_dwordx4 v1, s[36:39], s78 offen offset:3072 sc1 lds
  s_add_u32 s78, s78, 4096
  s_add_u32 m0, s79, 4096
  s_nop 0
  buffer_load_dwordx4 v1, s[36:39], s78 offen offset:0 sc1 lds
  buffer_load_dwordx4 v1, s[36:39], s78 offen offset:1024 sc1 lds
  buffer_load_dwordx4 v1, s[36:39], s78 offen offset:2048 sc1 lds
  buffer_load_dwordx4 v1, s[36:39], s78 offen offset:3072 sc1 lds
L_nopf_136:
  s_lshl_b32 s18, s66, 15
  v_add_u32 v3, s18, v1
  ds_read_b128 v[64:67], v3 offset:0
  ds_read_b128 v[68:71], v3 offset:1024
  ds_read_b128 v[72:75], v3 offset:2048
  ds_read_b128 v[76:79], v3 offset:3072
  ds_read_b128 v[80:83], v3 offset:4096
  ds_read_b128 v[84:87], v3 offset:5120
  s_waitcnt lgkmcnt(5)
  v_mfma_f32_16x16x32_bf16 v[32:35], a[0:3], v[64:67], v[16:19]
  s_waitcnt lgkmcnt(4)
  v_mfma_f32_16x16x32_bf16 v[48:51], a[0:3], v[68:71], v[16:19]
  ds_read_b128 v[88:91], v3 offset:6144
  ds_read_b128 v[92:95], v3 offset:7168
  v_mfma_f32_16x16x32_bf16 v[36:39], a[4:7], v[64:67], v[20:23]
  v_mfma_f32_16x16x32_bf16 v[52:55], a[4:7], v[68:71], v[20:23]
  v_mfma_f32_16x16x32_bf16 v[40:43], a[8:11], v[64:67], v[24:27]
  v_mfma_f32_16x16x32_bf16 v[56:59], a[8:11], v[68:71], v[24:27]
  v_mfma_f32_16x16x32_bf16 v[44:47], a[12:15], v[64:67], v[28:31]
  v_mfma_f32_16x16x32_bf16 v[60:63], a[12:15], v[68:71], v[28:31]
  s_waitcnt lgkmcnt(5)
  v_mfma_f32_16x16x32_bf16 v[32:35], a[16:19], v[72:75], v[32:35]
  s_waitcnt lgkmcnt(4)
  v_mfma_f32_16x16x32_bf16 v[48:51], a[16:19], v[76:79], v[48:51]
  ds_read_b128 v[64:67], v3 offset:8192
  ds_read_b128 v[68:71], v3 offset:9216
  v_mfma_f32_16x16x32_bf16 v[36:39], a[20:23], v[72:75], v[36:39]
  v_mfma_f32_16x16x32_bf16 v[52:55], a[20:23], v[76:79], v[52:55]
  v_mfma_f32_16x16x32_bf16 v[40:43], a[24:27], v[72:75], v[40:43]
  v_mfma_f32_16x16x32_bf16 v[56:59], a[24:27], v[76:79], v[56:59]
  v_mfma_f32_16x16x32_bf16 v[44:47], a[28:31], v[72:75], v[44:47]
  v_mfma_f32_16x16x32_bf16 v[60:63], a[28:31], v[76:79], v[60:63]
  s_waitcnt lgkmcnt(5)
  v_mfma_f32_16x16x32_bf16 v[32:35], a[32:35], v[80:83], v[32:35]
  s_waitcnt lgkmcnt(4)
  v_mfma_f32_16x16x32_bf16 v[48:51], a[32:35], v[84:87], v[48:51]
  ds_read_b128 v[72:75], v3 offset:10240
  ds_read_b128 v[76:79], v3 offset:11264
  v_mfma_f32_16x16x32_bf16 v[36:39], a[36:39], v[80:83], v[36:39]
  v_mfma_f32_16x16x32_bf16 v[52:55], a[36:39], v[84:87], v[52:55]
  v_mfma_f32_16x16x32_bf16 v[40:43], a[40:43], v[80:83], v[40:43]
  v_mfma_f32_16x16x32_bf16 v[56:59], a[40:43], v[84:87], v[56:59]
  v_mfma_f32_16x16x32_bf16 v[44:47], a[44:47], v[80:83], v[44:47]
  v_mfma_f32_16x16x32_bf16 v[60:63], a[44:47], v[84:87], v[60:63]
  s_waitcnt lgkmcnt(5)
  v_mfma_f32_16x16x32_bf16 v[32:35], a[48:51], v[88:91], v[32:35]
  s_waitcnt lgkmcnt(4)
  v_mfma_f32_16x16x32_bf16 v[48:51], a[48:51], v[92:95], v[48:51]
  ds_read_b128 v[80:83], v3 offset:12288
  ds_read_b128 v[84:87], v3 offset:13312
  v_mfma_f32_16x16x32_bf16 v[36:39], a[52:55], v[88:91], v[36:39]
  v_mfma_f32_16x16x32_bf16 v[52:55], a[52:55], v[92:95], v[52:55]
  v_mfma_f32_16x16x32_bf16 v[40:43], a[56:59], v[88:91], v[40:43]
  v_mfma_f32_16x16x32_bf16 v[56:59], a[56:59], v[92:95], v[56:59]
  v_mfma_f32_16x16x32_bf16 v[44:47], a[60:63], v[88:91], v[44:47]
  v_mfma_f32_16x16x32_bf16 v[60:63], a[60:63], v[92:95], v[60:63]
  s_waitcnt lgkmcnt(5)
  v_mfma_f32_16x16x32_bf16 v[32:35], a[64:67], v[64:67], v[32:35]
  s_waitcnt lgkmcnt(4)
  v_mfma_f32_16x16x32_bf16 v[48:51], a[64:67], v[68:71], v[48:51]
  ds_read_b128 v[88:91], v3 offset:14336
  ds_read_b128 v[92:95], v3 offset:15360
  v_mfma_f32_16x16x32_bf16 v[36:39], a[68:71], v[64:67], v[36:39]
  v_mfma_f32_16x16x32_bf16 v[52:55], a[68:71], v[68:71], v[52:55]
  v_mfma_f32_16x16x32_bf16 v[40:43], a[72:75], v[64:67], v[40:43]
  v_mfma_f32_16x16x32_bf16 v[56:59], a[72:75], v[68:71], v[56:59]
  v_mfma_f32_16x16x32_bf16 v[44:47], a[76:79], v[64:67], v[44:47]
  v_mfma_f32_16x16x32_bf16 v[60:63], a[76:79], v[68:71], v[60:63]
  s_waitcnt lgkmcnt(5)
  v_mfma_f32_16x16x32_bf16 v[32:35], a[80:83], v[72:75], v[32:35]
  s_waitcnt lgkmcnt(4)
  v_mfma_f32_16x16x32_bf16 v[48:51], a[80:83], v[76:79], v[48:51]
  ds_read_b128 v[64:67], v3 offset:16384
  ds_read_b128 v[68:71], v3 offset:17408
  v_mfma_f32_16x16x32_bf16 v[36:39], a[84:87], v[72:75], v[36:39]
  v_mfma_f32_16x16x32_bf16 v[52:55], a[84:87], v[76:79], v[52:55]
  v_mfma_f32_16x16x32_bf16 v[40:43], a[88:91], v[72:75], v[40:43]
  v_mfma_f32_16x16x32_bf16 v[56:59], a[88:91], v[76:79], v[56:59]
  v_mfma_f32_16x16x32_bf16 v[44:47], a[92:95], v[72:75], v[44:47]
  v_mfma_f32_16x16x32_bf16 v[60:63], a[92:95], v[76:79], v[60:63]
  s_waitcnt lgkmcnt(5)
  v_mfma_f32_16x16x32_bf16 v[32:35], a[96:99], v[80:83], v[32:35]
  s_waitcnt lgkmcnt(4)
  v_mfma_f32_16x16x32_bf16 v[48:51], a[96:99], v[84:87], v[48:51]
  ds_read_b128 v[72:75], v3 offset:18432
  ds_read_b128 v[76:79], v3 offset:19456
  v_mfma_f32_16x16x32_bf16 v[36:39], a[100:103], v[80:83], v[36:39]
  v_mfma_f32_16x16x32_bf16 v[52:55], a[100:103], v[84:87], v[52:55]
  v_mfma_f32_16x16x32_bf16 v[40:43], a[104:107], v[80:83], v[40:43]
  v_mfma_f32_16x16x32_bf16 v[56:59], a[104:107], v[84:87], v[56:59]
  v_mfma_f32_16x16x32_bf16 v[44:47], a[108:111], v[80:83], v[44:47]
  v_mfma_f32_16x16x32_bf16 v[60:63], a[108:111], v[84:87], v[60:63]
  s_waitcnt lgkmcnt(5)
  v_mfma_f32_16x16x32_bf16 v[32:35], a[112:115], v[88:91], v[32:35]
  s_waitcnt lgkmcnt(4)
  v_mfma_f32_16x16x32_bf16 v[48:51], a[112:115], v[92:95], v[48:51]
  ds_read_b128 v[80:83], v3 offset:20480
  ds_read_b128 v[84:87], v3 offset:21504
  v_mfma_f32_16x16x32_bf16 v[36:39], a[116:119], v[88:91], v[36:39]
  v_mfma_f32_16x16x32_bf16 v[52:55], a[116:119], v[92:95], v[52:55]
  v_mfma_f32_16x16x32_bf16 v[40:43], a[120:123], v[88:91], v[40:43]
  v_mfma_f32_16x16x32_bf16 v[56:59], a[120:123], v[92:95], v[56:59]
  v_mfma_f32_16x16x32_bf16 v[44:47], a[124:127], v[88:91], v[44:47]
  v_mfma_f32_16x16x32_bf16 v[60:63], a[124:127], v[92:95], v[60:63]
  s_waitcnt lgkmcnt(5)
  v_mfma_f32_16x16x32_bf16 v[32:35], a[128:131], v[64:67], v[32:35]
  s_waitcnt lgkmcnt(4)
  v_mfma_f32_16x16x32_bf16 v[48:51], a[128:131], v[68:71], v[48:51]
  ds_read_b128 v[88:91], v3 offset:22528
  ds_read_b128 v[92:95], v3 offset:23552
  v_mfma_f32_16x16x32_bf16 v[36:39], a[132:135], v[64:67], v[36:39]
  v_mfma_f32_16x16x32_bf16 v[52:55], a[132:135], v[68:71], v[52:55]
  v_mfma_f32_16x16x32_bf16 v[40:43], a[136:139], v[64:67], v[40:43]
  v_mfma_f32_16x16x32_bf16 v[56:59], a[136:139], v[68:71], v[56:59]
  v_mfma_f32_16x16x32_bf16 v[44:47], a[140:143], v[64:67], v[44:47]
  v_mfma_f32_16x16x32_bf16 v[60:63], a[140:143], v[68:71], v[60:63]
  s_waitcnt lgkmcnt(5)
  v_mfma_f32_16x16x32_bf16 v[32:35], a[144:147], v[72:75], v[32:35]
  s_waitcnt lgkmcnt(4)
  v_mfma_f32_16x16x32_bf16 v[48:51], a[144:147], v[76:79], v[48:51]
  ds_read_b128 v[64:67], v3 offset:24576
  ds_read_b128 v[68:71], v3 offset:25600
  v_mfma_f32_16x16x32_bf16 v[36:39], a[148:151], v[72:75], v[36:39]
  v_mfma_f32_16x16x32_bf16 v[52:55], a[148:151], v[76:79], v[52:55]
  v_mfma_f32_16x16x32_bf16 v[40:43], a[152:155], v[72:75], v[40:43]
  v_mfma_f32_16x16x32_bf16 v[56:59], a[152:155], v[76:79], v[56:59]
  v_mfma_f32_16x16x32_bf16 v[44:47], a[156:159], v[72:75], v[44:47]
  v_mfma_f32_16x16x32_bf16 v[60:63], a[156:159], v[76:79], v[60:63]
  s_waitcnt lgkmcnt(5)
  v_mfma_f32_16x16x32_bf16 v[32:35], a[160:163], v[80:83], v[32:35]
  s_waitcnt lgkmcnt(4)
  v_mfma_f32_16x16x32_bf16 v[48:51], a[160:163], v[84:87], v[48:51]
  ds_read_b128 v[72:75], v3 offset:26624
  ds_read_b128 v[76:79], v3 offset:27648
  v_mfma_f32_16x16x32_bf16 v[36:39], a[164:167], v[80:83], v[36:39]
  v_mfma_f32_16x16x32_bf16 v[52:55], a[164:167], v[84:87], v[52:55]
  v_mfma_f32_16x16x32_bf16 v[40:43], a[168:171], v[80:83], v[40:43]
  v_mfma_f32_16x16x32_bf16 v[56:59], a[168:171], v[84:87], v[56:59]
  v_mfma_f32_16x16x32_bf16 v[44:47], a[172:175], v[80:83], v[44:47]
  v_mfma_f32_16x16x32_bf16 v[60:63], a[172:175], v[84:87], v[60:63]
  s_waitcnt lgkmcnt(5)
  v_mfma_f32_16x16x32_bf16 v[32:35], a[176:179], v[88:91], v[32:35]
  s_waitcnt lgkmcnt(4)
  v_mfma_f32_16x16x32_bf16 v[48:51], a[176:179], v[92:95], v[48:51]
  ds_read_b128 v[80:83], v3 offset:28672
  ds_read_b128 v[84:87], v3 offset:29696
  v_mfma_f32_16x16x32_bf16 v[36:39], a[180:183], v[88:91], v[36:39]
  v_mfma_f32_16x16x32_bf16 v[52:55], a[180:183], v[92:95], v[52:55]
  v_mfma_f32_16x16x32_bf16 v[40:43], a[184:187], v[88:91], v[40:43]
  v_mfma_f32_16x16x32_bf16 v[56:59], a[184:187], v[92:95], v[56:59]
  v_mfma_f32_16x16x32_bf16 v[44:47], a[188:191], v[88:91], v[44:47]
  v_mfma_f32_16x16x32_bf16 v[60:63], a[188:191], v[92:95], v[60:63]
  s_waitcnt lgkmcnt(5)
  v_mfma_f32_16x16x32_bf16 v[32:35], a[192:195], v[64:67], v[32:35]
  s_waitcnt lgkmcnt(4)
  v_mfma_f32_16x16x32_bf16 v[48:51], a[192:195], v[68:71], v[48:51]
  ds_read_b128 v[88:91], v3 offset:30720
  ds_read_b128 v[92:95], v3 offset:31744
  v_mfma_f32_16x16x32_bf16 v[36:39], a[196:199], v[64:67], v[36:39]
  v_mfma_f32_16x16x32_bf16 v[52:55], a[196:199], v[68:71], v[52:55]
  v_mfma_f32_16x16x32_bf16 v[40:43], a[200:203], v[64:67], v[40:43]
  v_mfma_f32_16x16x32_bf16 v[56:59], a[200:203], v[68:71], v[56:59]
  v_mfma_f32_16x16x32_bf16 v[44:47], a[204:207], v[64:67], v[44:47]
  v_mfma_f32_16x16x32_bf16 v[60:63], a[204:207], v[68:71], v[60:63]
  s_waitcnt lgkmcnt(5)
  v_mfma_f32_16x16x32_bf16 v[32:35], a[208:211], v[72:75], v[32:35]
  s_waitcnt lgkmcnt(4)
  v_mfma_f32_16x16x32_bf16 v[48:51], a[208:211], v[76:79], v[48:51]
  v_mfma_f32_16x16x32_bf16 v[36:39], a[212:215], v[72:75], v[36:39]
  v_mfma_f32_16x16x32_bf16 v[52:55], a[212:215], v[76:79], v[52:55]
  v_mfma_f32_16x16x32_bf16 v[40:43], a[216:219], v[72:75], v[40:43]
  v_mfma_f32_16x16x32_bf16 v[56:59], a[216:219], v[76:79], v[56:59]
  v_mfma_f32_16x16x32_bf16 v[44:47], a[220:223], v[72:75], v[44:47]
  v_mfma_f32_16x16x32_bf16 v[60:63], a[220:223], v[76:79], v[60:63]
  s_waitcnt lgkmcnt(3)
  v_mfma_f32_16x16x32_bf16 v[32:35], a[224:227], v[80:83], v[32:35]
  s_waitcnt lgkmcnt(2)
  v_mfma_f32_16x16x32_bf16 v[48:51], a[224:227], v[84:87], v[48:51]
  v_mfma_f32_16x16x32_bf16 v[36:39], a[228:231], v[80:83], v[36:39]
  v_mfma_f32_16x16x32_bf16 v[52:55], a[228:231], v[84:87], v[52:55]
  v_mfma_f32_16x16x32_bf16 v[40:43], a[232:235], v[80:83], v[40:43]
  v_mfma_f32_16x16x32_bf16 v[56:59], a[232:235], v[84:87], v[56:59]
  v_mfma_f32_16x16x32_bf16 v[44:47], a[236:239], v[80:83], v[44:47]
  v_mfma_f32_16x16x32_bf16 v[60:63], a[236:239], v[84:87], v[60:63]
  s_waitcnt lgkmcnt(1)
  v_mfma_f32_16x16x32_bf16 v[32:35], a[240:243], v[88:91], v[32:35]
  s_waitcnt lgkmcnt(0)
  v_mfma_f32_16x16x32_bf16 v[48:51], a[240:243], v[92:95], v[48:51]
  v_mfma_f32_16x16x32_bf16 v[36:39], a[244:247], v[88:91], v[36:39]
  v_mfma_f32_16x16x32_bf16 v[52:55], a[244:247], v[92:95], v[52:55]
  v_mfma_f32_16x16x32_bf16 v[40:43], a[248:251], v[88:91], v[40:43]
  v_mfma_f32_16x16x32_bf16 v[56:59], a[248:251], v[92:95], v[56:59]
  v_mfma_f32_16x16x32_bf16 v[44:47], a[252:255], v[88:91], v[44:47]
  v_mfma_f32_16x16x32_bf16 v[60:63], a[252:255], v[92:95], v[60:63]
  s_mul_i32 s78, s65, 112
  s_lshl_b32 s79, s64, 2
  s_add_u32 s79, s79, s34
  s_lshl_b32 s80, s79, 1
  s_add_u32 s78, s78, s80
  s_lshl_b32 s78, s78, 10
  s_add_u32 s78, s78, 0x600000
  s_add_u32 s80, s78, 57344
  v_mul_f32 v64, v32, v32
  v_mul_f32 v65, v33, v33
  v_mul_f32 v66, v34, v34
  v_mul_f32 v67, v35, v35
  v_mul_f32 v68, v36, v36
  v_mul_f32 v69, v37, v37
  v_mul_f32 v70, v38, v38
  v_mul_f32 v71, v39, v39
  v_mul_f32 v72, v40, v40
  v_mul_f32 v73, v41, v41
  v_mul_f32 v74, v42, v42
  v_mul_f32 v75, v43, v43
  v_mul_f32 v76, v44, v44
  v_mul_f32 v77, v45, v45
  v_mul_f32 v78, v46, v46
  v_mul_f32 v79, v47, v47
  v_fma_f32 v64, v64, s67, v5
  v_fma_f32 v65, v65, s67, v5
  v_fma_f32 v66, v66, s67, v5
  v_fma_f32 v67, v67, s67, v5
  v_fma_f32 v68, v68, s67, v5
  v_fma_f32 v69, v69, s67, v5
  v_fma_f32 v70, v70, s67, v5
  v_fma_f32 v71, v71, s67, v5
  v_fma_f32 v72, v72, s67, v5
  v_fma_f32 v73, v73, s67, v5
  v_fma_f32 v74, v74, s67, v5
  v_fma_f32 v75, v75, s67, v5
  v_fma_f32 v76, v76, s67, v5
  v_fma_f32 v77, v77, s67, v5
  v_fma_f32 v78, v78, s67, v5
  v_fma_f32 v79, v79, s67, v5
  v_mul_f32 v64, v64, v32
  v_mul_f32 v65, v65, v33
  v_mul_f32 v66, v66, v34
  v_mul_f32 v67, v67, v35
  v_mul_f32 v68, v68, v36
  v_mul_f32 v69, v69, v37
  v_mul_f32 v70, v70, v38
  v_mul_f32 v71, v71, v39
  v_mul_f32 v72, v72, v40
  v_mul_f32 v73, v73, v41
  v_mul_f32 v74, v74, v42
  v_mul_f32 v75, v75, v43
  v_mul_f32 v76, v76, v44
  v_mul_f32 v77, v77, v45
  v_mul_f32 v78, v78, v46
  v_mul_f32 v79, v79, v47
  v_exp_f32 v64, v64
  v_exp_f32 v65, v65
  v_exp_f32 v66, v66
  v_exp_f32 v67, v67
  v_exp_f32 v68, v68
  v_exp_f32 v69, v69
  v_exp_f32 v70, v70
  v_exp_f32 v71, v71
  v_exp_f32 v72, v72
  v_exp_f32 v73, v73
  v_exp_f32 v74, v74
  v_exp_f32 v75, v75
  v_exp_f32 v76, v76
  v_exp_f32 v77, v77
  v_exp_f32 v78, v78
  v_exp_f32 v79, v79
  v_add_f32 v64, 1.0, v64
  v_add_f32 v65, 1.0, v65
  v_add_f32 v66, 1.0, v66
  v_add_f32 v67, 1.0, v67
  v_add_f32 v68, 1.0, v68
  v_add_f32 v69, 1.0, v69
  v_add_f32 v70, 1.0, v70
  v_add_f32 v71, 1.0, v71
  v_add_f32 v72, 1.0, v72
  v_add_f32 v73, 1.0, v73
  v_add_f32 v74, 1.0, v74
  v_add_f32 v75, 1.0, v75
  v_add_f32 v76, 1.0, v76
  v_add_f32 v77, 1.0, v77
  v_add_f32 v78, 1.0, v78
  v_add_f32 v79, 1.0, v79
  v_rcp_f32 v64, v64
  v_rcp_f32 v65, v65
  v_rcp_f32 v66, v66
  v_rcp_f32 v67, v67
  v_rcp_f32 v68, v68
  v_rcp_f32 v69, v69
  v_rcp_f32 v70, v70
  v_rcp_f32 v71, v71
  v_rcp_f32 v72, v72
  v_rcp_f32 v73, v73
  v_rcp_f32 v74, v74
  v_rcp_f32 v75, v75
  v_rcp_f32 v76, v76
  v_rcp_f32 v77, v77
  v_rcp_f32 v78, v78
  v_rcp_f32 v79, v79
  v_mul_f32 v32, v64, v32
  v_mul_f32 v33, v65, v33
  v_mul_f32 v34, v66, v34
  v_mul_f32 v35, v67, v35
  v_mul_f32 v36, v68, v36
  v_mul_f32 v37, v69, v37
  v_mul_f32 v38, v70, v38
  v_mul_f32 v39, v71, v39
  v_mul_f32 v40, v72, v40
  v_mul_f32 v41, v73, v41
  v_mul_f32 v42, v74, v42
  v_mul_f32 v43, v75, v43
  v_mul_f32 v44, v76, v44
  v_mul_f32 v45, v77, v45
  v_mul_f32 v46, v78, v46
  v_mul_f32 v47, v79, v47
  v_cvt_pk_bf16_f32 v96, v32, v36
  v_cvt_pk_bf16_f32 v97, v40, v44
  v_cvt_pk_bf16_f32 v98, v33, v37
  v_cvt_pk_bf16_f32 v99, v41, v45
  buffer_store_dwordx4 v[96:99], v1, s[36:39], s78 offen offset:0 sc1
  v_cvt_pk_bf16_f32 v100, v34, v38
  v_cvt_pk_bf16_f32 v101, v42, v46
  v_cvt_pk_bf16_f32 v102, v35, v39
  v_cvt_pk_bf16_f32 v103, v43, v47
  buffer_store_dwordx4 v[100:103], v1, s[36:39], s78 offen offset:1024 sc1
  v_mul_f32 v64, v48, v48
  v_mul_f32 v65, v49, v49
  v_mul_f32 v66, v50, v50
  v_mul_f32 v67, v51, v51
  v_mul_f32 v68, v52, v52
  v_mul_f32 v69, v53, v53
  v_mul_f32 v70, v54, v54
  v_mul_f32 v71, v55, v55
  v_mul_f32 v72, v56, v56
  v_mul_f32 v73, v57, v57
  v_mul_f32 v74, v58, v58
  v_mul_f32 v75, v59, v59
  v_mul_f32 v76, v60, v60
  v_mul_f32 v77, v61, v61
  v_mul_f32 v78, v62, v62
  v_mul_f32 v79, v63, v63
  v_fma_f32 v64, v64, s67, v5
  v_fma_f32 v65, v65, s67, v5
  v_fma_f32 v66, v66, s67, v5
  v_fma_f32 v67, v67, s67, v5
  v_fma_f32 v68, v68, s67, v5
  v_fma_f32 v69, v69, s67, v5
  v_fma_f32 v70, v70, s67, v5
  v_fma_f32 v71, v71, s67, v5
  v_fma_f32 v72, v72, s67, v5
  v_fma_f32 v73, v73, s67, v5
  v_fma_f32 v74, v74, s67, v5
  v_fma_f32 v75, v75, s67, v5
  v_fma_f32 v76, v76, s67, v5
  v_fma_f32 v77, v77, s67, v5
  v_fma_f32 v78, v78, s67, v5
  v_fma_f32 v79, v79, s67, v5
  v_mul_f32 v64, v64, v48
  v_mul_f32 v65, v65, v49
  v_mul_f32 v66, v66, v50
  v_mul_f32 v67, v67, v51
  v_mul_f32 v68, v68, v52
  v_mul_f32 v69, v69, v53
  v_mul_f32 v70, v70, v54
  v_mul_f32 v71, v71, v55
  v_mul_f32 v72, v72, v56
  v_mul_f32 v73, v73, v57
  v_mul_f32 v74, v74, v58
  v_mul_f32 v75, v75, v59
  v_mul_f32 v76, v76, v60
  v_mul_f32 v77, v77, v61
  v_mul_f32 v78, v78, v62
  v_mul_f32 v79, v79, v63
  v_exp_f32 v64, v64
  v_exp_f32 v65, v65
  v_exp_f32 v66, v66
  v_exp_f32 v67, v67
  v_exp_f32 v68, v68
  v_exp_f32 v69, v69
  v_exp_f32 v70, v70
  v_exp_f32 v71, v71
  v_exp_f32 v72, v72
  v_exp_f32 v73, v73
  v_exp_f32 v74, v74
  v_exp_f32 v75, v75
  v_exp_f32 v76, v76
  v_exp_f32 v77, v77
  v_exp_f32 v78, v78
  v_exp_f32 v79, v79
  v_add_f32 v64, 1.0, v64
  v_add_f32 v65, 1.0, v65
  v_add_f32 v66, 1.0, v66
  v_add_f32 v67, 1.0, v67
  v_add_f32 v68, 1.0, v68
  v_add_f32 v69, 1.0, v69
  v_add_f32 v70, 1.0, v70
  v_add_f32 v71, 1.0, v71
  v_add_f32 v72, 1.0, v72
  v_add_f32 v73, 1.0, v73
  v_add_f32 v74, 1.0, v74
  v_add_f32 v75, 1.0, v75
  v_add_f32 v76, 1.0, v76
  v_add_f32 v77, 1.0, v77
  v_add_f32 v78, 1.0, v78
  v_add_f32 v79, 1.0, v79
  v_rcp_f32 v64, v64
  v_rcp_f32 v65, v65
  v_rcp_f32 v66, v66
  v_rcp_f32 v67, v67
  v_rcp_f32 v68, v68
  v_rcp_f32 v69, v69
  v_rcp_f32 v70, v70
  v_rcp_f32 v71, v71
  v_rcp_f32 v72, v72
  v_rcp_f32 v73, v73
  v_rcp_f32 v74, v74
  v_rcp_f32 v75, v75
  v_rcp_f32 v76, v76
  v_rcp_f32 v77, v77
  v_rcp_f32 v78, v78
  v_rcp_f32 v79, v79
  v_mul_f32 v48, v64, v48
  v_mul_f32 v49, v65, v49
  v_mul_f32 v50, v66, v50
  v_mul_f32 v51, v67, v51
  v_mul_f32 v52, v68, v52
  v_mul_f32 v53, v69, v53
  v_mul_f32 v54, v70, v54
  v_mul_f32 v55, v71, v55
  v_mul_f32 v56, v72, v56
  v_mul_f32 v57, v73, v57
  v_mul_f32 v58, v74, v58
  v_mul_f32 v59, v75, v59
  v_mul_f32 v60, v76, v60
  v_mul_f32 v61, v77, v61
  v_mul_f32 v62, v78, v62
  v_mul_f32 v63, v79, v63
  v_cvt_pk_bf16_f32 v104, v48, v52
  v_cvt_pk_bf16_f32 v105, v56, v60
  v_cvt_pk_bf16_f32 v106, v49, v53
  v_cvt_pk_bf16_f32 v107, v57, v61
  buffer_store_dwordx4 v[104:107], v1, s[36:39], s80 offen offset:0 sc1
  v_cvt_pk_bf16_f32 v108, v50, v54
  v_cvt_pk_bf16_f32 v109, v58, v62
  v_cvt_pk_bf16_f32 v110, v51, v55
  v_cvt_pk_bf16_f32 v111, v59, v63
  buffer_store_dwordx4 v[108:111], v1, s[36:39], s80 offen offset:1024 sc1
  s_lshl_b32 s78, s65, 11
  s_lshl_b32 s79, s79, 2
  s_add_u32 s78, s78, s79
  s_add_u32 s78, s78, 0x580400
  s_waitcnt vmcnt(0)
  s_mov_b64 exec, 1
  buffer_store_dword v4, off, s[36:39], s78 sc1
  s_mov_b64 exec, -1
  s_add_u32 s65, s65, 4
  s_xor_b32 s66, s66, 1
  s_cmp_lt_u32 s65, 64
  s_cbranch_scc1 L_hid_loop
  s_waitcnt vmcnt(0)
  s_barrier
L_final:
  s_getpc_b64 s[62:63]
L_pc_137:
  s_lshl_b32 s61, s34, 12
  v_lshl_add_u32 v132, v0, 6, s61
  v_min_u32 v133, L_last-L_pc_137-4, v132
  v_mov_b32 v131, s63
  v_add_co_u32 v130, vcc, s62, v133
  s_nop 1
  v_addc_co_u32 v131, vcc, 0, v131, vcc
  global_load_dword v134, v[130:131], off
  v_add_u32 v132, 0x4000, v132
  v_min_u32 v133, L_last-L_pc_137-4, v132
  v_mov_b32 v131, s63
  v_add_co_u32 v130, vcc, s62, v133
  s_nop 1
  v_addc_co_u32 v131, vcc, 0, v131, vcc
  global_load_dword v134, v[130:131], off
  s_sub_u32 s67, s60, 6
  s_mul_i32 s64, s35, 3
  s_min_u32 s18, s67, 2
  s_add_u32 s64, s64, s18
  s_lshr_b32 s65, s35, 1
  s_and_b32 s66, s35, 1
  s_mov_b32 s44, s4
  s_mov_b32 s45, s5
  s_mov_b32 s46, 0x200000
  s_mov_b32 s47, 0x20000
  s_mov_b32 s48, s6
  s_mov_b32 s49, s7
  s_mov_b32 s50, 0x2000
  s_mov_b32 s51, 0x20000
  v_lshrrev_b32 v1, 4, v0
  v_and_b32 v2, 15, v0
  v_lshlrev_b32 v6, 4, v0
  s_lshr_b32 s18, s34, 1
  s_lshl_b32 s18, s18, 12
  s_and_b32 s19, s34, 1
  s_lshl_b32 s19, s19, 7
  s_add_u32 s18, s18, s19
  v_lshrrev_b32 v3, 3, v0
  v_lshl_add_u32 v5, v3, 8, s18
  v_and_b32 v3, 7, v0
  v_lshl_add_u32 v5, v3, 4, v5
  v_lshlrev_b32 v3, 10, v1
  v_lshl_add_u32 v3, v2, 6, v3
  s_lshl_b32 s68, s64, 15
  s_lshl_b32 s69, s34, 13
  s_add_u32 s69, s69, s68
  s_add_u32 s70, s69, 4096
  buffer_load_dwordx4 v[16:19], v3, s[44:47], s69 offen offset:0
  buffer_load_dwordx4 v[20:23], v3, s[44:47], s69 offen offset:16
  buffer_load_dwordx4 v[24:27], v3, s[44:47], s69 offen offset:32
  buffer_load_dwordx4 v[28:31], v3, s[44:47], s69 offen offset:48
  buffer_load_dwordx4 v[32:35], v3, s[44:47], s70 offen offset:0
  buffer_load_dwordx4 v[36:39], v3, s[44:47], s70 offen offset:16
  buffer_load_dwordx4 v[40:43], v3, s[44:47], s70 offen offset:32
  buffer_load_dwordx4 v[44:47], v3, s[44:47], s70 offen offset:48
  buffer_load_dword v48, off, s[40:43], 0 offset:4 sc1
  s_waitcnt vmcnt(0)
  v_readfirstlane_b32 s18, v48
L_rot_138:
  s_cmp_eq_u32 s18, s100
  s_cbranch_scc1 L_rotok_139
  s_cmp_lg_u32 s18, 0
  s_cbranch_scc1 L_restart
  s_sub_u32 s3, s3, 1
  s_cbranch_scc1 L_end
  buffer_load_dword v48, off, s[40:43], 0 offset:4 sc1
  s_waitcnt vmcnt(0)
  v_readfirstlane_b32 s18, v48
  s_branch L_rot_138
L_rotok_139:
  s_cmp_eq_u32 s101, 1
  s_cbranch_scc1 L_final_w
  s_cmp_ge_u32 s64, 64
  s_cbranch_scc1 L_final_w
  v_mov_b64 v[48:49], 0
  s_lshl_b32 s71, s64, 11
  s_lshl_b32 s72, s34, 9
  s_add_u32 s71, s71, s72
  s_add_u32 s71, s71, 0x580000
  v_lshlrev_b32 v4, 3, v0
  buffer_store_dwordx2 v[48:49], v4, s[36:39], s71 offen sc1
  v_mov_b64 v[52:53], -1
  v_mov_b64 v[54:55], -1
  v_mov_b64 v[56:57], -1
  v_mov_b64 v[58:59], -1
  s_lshl_b32 s71, s64, 12
  s_lshl_b32 s72, s34, 10
  s_add_u32 s71, s71, s72
  s_add_u32 s71, s71, 0x540000
  buffer_store_dwordx4 v[52:55], v6, s[36:39], s71 offen sc1
  s_cmp_lg_u32 s64, 0
  s_cbranch_scc1 L_notzero_140
  v_lshrrev_b32 v50, 1, v2
  v_lshlrev_b32 v50, 10, v50
  v_lshl_add_u32 v50, v1, 7, v50
  v_and_b32 v51, 1, v0
  v_lshl_add_u32 v50, v51, 4, v50
  s_lshl_b32 s72, s34, 2
  buffer_load_dword v52, v50, s[48:51], s72 offen offset:0
  buffer_load_dword v53, v50, s[48:51], s72 offen offset:32
  buffer_load_dword v54, v50, s[48:51], s72 offen offset:64
  buffer_load_dword v55, v50, s[48:51], s72 offen offset:96
  buffer_load_dword v56, v50, s[48:51], s72 offen offset:512
  buffer_load_dword v57, v50, s[48:51], s72 offen offset:544
  buffer_load_dword v58, v50, s[48:51], s72 offen offset:576
  buffer_load_dword v59, v50, s[48:51], s72 offen offset:608
  s_waitcnt vmcnt(0)
  v_min_u32 v52, -2, v52
  v_min_u32 v53, -2, v53
  v_min_u32 v54, -2, v54
  v_min_u32 v55, -2, v55
  v_min_u32 v56, -2, v56
  v_min_u32 v57, -2, v57
  v_min_u32 v58, -2, v58
  v_min_u32 v59, -2, v59
L_notzero_140:
  s_lshl_b32 s71, s64, 13
  s_add_u32 s71, s71, 0x400000
  buffer_store_dwordx4 v[52:55], v5, s[36:39], s71 offen sc1
  buffer_store_dwordx4 v[56:59], v5, s[36:39], s71 offen offset:2048 sc1
  v_lshrrev_b32 v4, 2, v2
  v_lshlrev_b32 v4, 11, v4
  v_and_b32 v50, 3, v0
  v_lshl_add_u32 v4, v50, 8, v4
  v_lshl_add_u32 v4, v1, 4, v4
  s_lshr_b32 s18, s34, 1
  s_lshl_b32 s18, s18, 10
  s_and_b32 s19, s34, 1
  s_lshl_b32 s19, s19, 7
  s_add_u32 s18, s18, s19
  s_add_u32 s18, s18, s68
  v_add_u32 v4, s18, v4
  v_and_b32 v65, 0xffff0000, v16
  v_lshlrev_b32 v64, 16, v16
  v_and_b32 v67, 0xffff0000, v17
  v_lshlrev_b32 v66, 16, v17
  v_and_b32 v69, 0xffff0000, v18
  v_lshlrev_b32 v68, 16, v18
  v_and_b32 v71, 0xffff0000, v19
  v_lshlrev_b32 v70, 16, v19
  v_and_b32 v73, 0xffff0000, v20
  v_lshlrev_b32 v72, 16, v20
  v_and_b32 v75, 0xffff0000, v21
  v_lshlrev_b32 v74, 16, v21
  v_and_b32 v77, 0xffff0000, v22
  v_lshlrev_b32 v76, 16, v22
  v_and_b32 v79, 0xffff0000, v23
  v_lshlrev_b32 v78, 16, v23
  v_and_b32 v81, 0xffff0000, v24
  v_lshlrev_b32 v80, 16, v24
  v_and_b32 v83, 0xffff0000, v25
  v_lshlrev_b32 v82, 16, v25
  v_and_b32 v85, 0xffff0000, v26
  v_lshlrev_b32 v84, 16, v26
  v_and_b32 v87, 0xffff0000, v27
  v_lshlrev_b32 v86, 16, v27
  v_and_b32 v89, 0xffff0000, v28
  v_lshlrev_b32 v88, 16, v28
  v_and_b32 v91, 0xffff0000, v29
  v_lshlrev_b32 v90, 16, v29
  v_and_b32 v93, 0xffff0000, v30
  v_lshlrev_b32 v92, 16, v30
  v_and_b32 v95, 0xffff0000, v31
  v_lshlrev_b32 v94, 16, v31
  v_pk_add_f32 v[8:9], v[64:65], v[66:67]
  v_pk_add_f32 v[8:9], v[8:9], v[68:69]
  v_pk_add_f32 v[8:9], v[8:9], v[70:71]
  v_pk_add_f32 v[8:9], v[8:9], v[72:73]
  v_pk_add_f32 v[8:9], v[8:9], v[74:75]
  v_pk_add_f32 v[8:9], v[8:9], v[76:77]
  v_pk_add_f32 v[8:9], v[8:9], v[78:79]
  v_pk_add_f32 v[8:9], v[8:9], v[80:81]
  v_pk_add_f32 v[8:9], v[8:9], v[82:83]
  v_pk_add_f32 v[8:9], v[8:9], v[84:85]
  v_pk_add_f32 v[8:9], v[8:9], v[86:87]
  v_pk_add_f32 v[8:9], v[8:9], v[88:89]
  v_pk_add_f32 v[8:9], v[8:9], v[90:91]
  v_pk_add_f32 v[8:9], v[8:9], v[92:93]
  v_pk_add_f32 v[8:9], v[8:9], v[94:95]
  v_add_f32 v8, v8, v9
  s_nop 1
  v_add_f32_dpp v8, v8, v8 row_ror:8 row_mask:0xf bank_mask:0xf
  s_nop 1
  v_add_f32_dpp v8, v8, v8 row_ror:4 row_mask:0xf bank_mask:0xf
  s_nop 1
  v_add_f32_dpp v8, v8, v8 row_ror:2 row_mask:0xf bank_mask:0xf
  s_nop 1
  v_add_f32_dpp v8, v8, v8 row_ror:1 row_mask:0xf bank_mask:0xf
  v_mul_f32 v8, 0xbb000000, v8
  v_mov_b32 v9, v8
  v_mov_b64 v[12:13], 0
  v_pk_add_f32 v[10:11], v[64:65], v[8:9]
  v_pk_fma_f32 v[12:13], v[10:11], v[10:11], v[12:13]
  v_pk_add_f32 v[10:11], v[66:67], v[8:9]
  v_pk_fma_f32 v[12:13], v[10:11], v[10:11], v[12:13]
  v_pk_add_f32 v[10:11], v[68:69], v[8:9]
  v_pk_fma_f32 v[12:13], v[10:11], v[10:11], v[12:13]
  v_pk_add_f32 v[10:11], v[70:71], v[8:9]
  v_pk_fma_f32 v[12:13], v[10:11], v[10:11], v[12:13]
  v_pk_add_f32 v[10:11], v[72:73], v[8:9]
  v_pk_fma_f32 v[12:13], v[10:11], v[10:11], v[12:13]
  v_pk_add_f32 v[10:11], v[74:75], v[8:9]
  v_pk_fma_f32 v[12:13], v[10:11], v[10:11], v[12:13]
  v_pk_add_f32 v[10:11], v[76:77], v[8:9]
  v_pk_fma_f32 v[12:13], v[10:11], v[10:11], v[12:13]
  v_pk_add_f32 v[10:11], v[78:79], v[8:9]
  v_pk_fma_f32 v[12:13], v[10:11], v[10:11], v[12:13]
  v_pk_add_f32 v[10:11], v[80:81], v[8:9]
  v_pk_fma_f32 v[12:13], v[10:11], v[10:11], v[12:13]
  v_pk_add_f32 v[10:11], v[82:83], v[8:9]
  v_pk_fma_f32 v[12:13], v[10:11], v[10:11], v[12:13]
  v_pk_add_f32 v[10:11], v[84:85], v[8:9]
  v_pk_fma_f32 v[12:13], v[10:11], v[10:11], v[12:13]
  v_pk_add_f32 v[10:11], v[86:87], v[8:9]
  v_pk_fma_f32 v[12:13], v[10:11], v[10:11], v[12:13]
  v_pk_add_f32 v[10:11], v[88:89], v[8:9]
  v_pk_fma_f32 v[12:13], v[10:11], v[10:11], v[12:13]
  v_pk_add_f32 v[10:11], v[90:91], v[8:9]
  v_pk_fma_f32 v[12:13], v[10:11], v[10:11], v[12:13]
  v_pk_add_f32 v[10:11], v[92:93], v[8:9]
  v_pk_fma_f32 v[12:13], v[10:11], v[10:11], v[12:13]
  v_pk_add_f32 v[10:11], v[94:95], v[8:9]
  v_pk_fma_f32 v[12:13], v[10:11], v[10:11], v[12:13]
  v_add_f32 v12, v12, v13
  s_nop 1
  v_add_f32_dpp v12, v12, v12 row_ror:8 row_mask:0xf bank_mask:0xf
  s_nop 1
  v_add_f32_dpp v12, v12, v12 row_ror:4 row_mask:0xf bank_mask:0xf
  s_nop 1
  v_add_f32_dpp v12, v12, v12 row_ror:2 row_mask:0xf bank_mask:0xf
  s_nop 1
  v_add_f32_dpp v12, v12, v12 row_ror:1 row_mask:0xf bank_mask:0xf
  v_mul_f32 v12, 0x3b000000, v12
  v_cvt_pk_bf16_f32 v10, v8, v12
  v_lshlrev_b32 v8, 16, v10
  v_mov_b32 v9, v8
  v_and_b32 v12, 0xffff0000, v10
  v_add_f32 v12, 0x3727c5ac, v12
  v_cvt_pk_bf16_f32 v12, v12, v12
  v_lshlrev_b32 v12, 16, v12
  v_sqrt_f32 v12, v12
  s_nop 0
  v_cvt_pk_bf16_f32 v12, v12, v12
  v_lshlrev_b32 v12, 16, v12
  v_rcp_f32 v12, v12
  s_nop 0
  v_mov_b32 v13, v12
  v_pk_add_f32 v[64:65], v[64:65], v[8:9]
  v_cvt_pk_bf16_f32 v96, v64, v65
  v_pk_add_f32 v[66:67], v[66:67], v[8:9]
  v_cvt_pk_bf16_f32 v100, v66, v67
  v_pk_add_f32 v[68:69], v[68:69], v[8:9]
  v_cvt_pk_bf16_f32 v104, v68, v69
  v_pk_add_f32 v[70:71], v[70:71], v[8:9]
  v_cvt_pk_bf16_f32 v108, v70, v71
  v_pk_add_f32 v[72:73], v[72:73], v[8:9]
  v_cvt_pk_bf16_f32 v97, v72, v73
  v_pk_add_f32 v[74:75], v[74:75], v[8:9]
  v_cvt_pk_bf16_f32 v101, v74, v75
  v_pk_add_f32 v[76:77], v[76:77], v[8:9]
  v_cvt_pk_bf16_f32 v105, v76, v77
  v_pk_add_f32 v[78:79], v[78:79], v[8:9]
  v_cvt_pk_bf16_f32 v109, v78, v79
  v_pk_add_f32 v[80:81], v[80:81], v[8:9]
  v_cvt_pk_bf16_f32 v98, v80, v81
  v_pk_add_f32 v[82:83], v[82:83], v[8:9]
  v_cvt_pk_bf16_f32 v102, v82, v83
  v_pk_add_f32 v[84:85], v[84:85], v[8:9]
  v_cvt_pk_bf16_f32 v106, v84, v85
  v_pk_add_f32 v[86:87], v[86:87], v[8:9]
  v_cvt_pk_bf16_f32 v110, v86, v87
  v_pk_add_f32 v[88:89], v[88:89], v[8:9]
  v_cvt_pk_bf16_f32 v99, v88, v89
  v_pk_add_f32 v[90:91], v[90:91], v[8:9]
  v_cvt_pk_bf16_f32 v103, v90, v91
  v_pk_add_f32 v[92:93], v[92:93], v[8:9]
  v_cvt_pk_bf16_f32 v107, v92, v93
  v_pk_add_f32 v[94:95], v[94:95], v[8:9]
  v_cvt_pk_bf16_f32 v111, v94, v95
  v_and_b32 v65, 0xffff0000, v96
  v_lshlrev_b32 v64, 16, v96
  v_and_b32 v67, 0xffff0000, v100
  v_lshlrev_b32 v66, 16, v100
  v_and_b32 v69, 0xffff0000, v104
  v_lshlrev_b32 v68, 16, v104
  v_and_b32 v71, 0xffff0000, v108
  v_lshlrev_b32 v70, 16, v108
  v_and_b32 v73, 0xffff0000, v97
  v_lshlrev_b32 v72, 16, v97
  v_and_b32 v75, 0xffff0000, v101
  v_lshlrev_b32 v74, 16, v101
  v_and_b32 v77, 0xffff0000, v105
  v_lshlrev_b32 v76, 16, v105
  v_and_b32 v79, 0xffff0000, v109
  v_lshlrev_b32 v78, 16, v109
  v_and_b32 v81, 0xffff0000, v98
  v_lshlrev_b32 v80, 16, v98
  v_and_b32 v83, 0xffff0000, v102
  v_lshlrev_b32 v82, 16, v102
  v_and_b32 v85, 0xffff0000, v106
  v_lshlrev_b32 v84, 16, v106
  v_and_b32 v87, 0xffff0000, v110
  v_lshlrev_b32 v86, 16, v110
  v_and_b32 v89, 0xffff0000, v99
  v_lshlrev_b32 v88, 16, v99
  v_and_b32 v91, 0xffff0000, v103
  v_lshlrev_b32 v90, 16, v103
  v_and_b32 v93, 0xffff0000, v107
  v_lshlrev_b32 v92, 16, v107
  v_and_b32 v95, 0xffff0000, v111
  v_lshlrev_b32 v94, 16, v111
  v_pk_mul_f32 v[64:65], v[64:65], v[12:13]
  v_cvt_pk_bf16_f32 v96, v64, v65
  v_pk_mul_f32 v[66:67], v[66:67], v[12:13]
  v_cvt_pk_bf16_f32 v100, v66, v67
  v_pk_mul_f32 v[68:69], v[68:69], v[12:13]
  v_cvt_pk_bf16_f32 v104, v68, v69
  v_pk_mul_f32 v[70:71], v[70:71], v[12:13]
  v_cvt_pk_bf16_f32 v108, v70, v71
  v_pk_mul_f32 v[72:73], v[72:73], v[12:13]
  v_cvt_pk_bf16_f32 v97, v72, v73
  v_pk_mul_f32 v[74:75], v[74:75], v[12:13]
  v_cvt_pk_bf16_f32 v101, v74, v75
  v_pk_mul_f32 v[76:77], v[76:77], v[12:13]
  v_cvt_pk_bf16_f32 v105, v76, v77
  v_pk_mul_f32 v[78:79], v[78:79], v[12:13]
  v_cvt_pk_bf16_f32 v109, v78, v79
  v_pk_mul_f32 v[80:81], v[80:81], v[12:13]
  v_cvt_pk_bf16_f32 v98, v80, v81
  v_pk_mul_f32 v[82:83], v[82:83], v[12:13]
  v_cvt_pk_bf16_f32 v102, v82, v83
  v_pk_mul_f32 v[84:85], v[84:85], v[12:13]
  v_cvt_pk_bf16_f32 v106, v84, v85
  v_pk_mul_f32 v[86:87], v[86:87], v[12:13]
  v_cvt_pk_bf16_f32 v110, v86, v87
  v_pk_mul_f32 v[88:89], v[88:89], v[12:13]
  v_cvt_pk_bf16_f32 v99, v88, v89
  v_pk_mul_f32 v[90:91], v[90:91], v[12:13]
  v_cvt_pk_bf16_f32 v103, v90, v91
  v_pk_mul_f32 v[92:93], v[92:93], v[12:13]
  v_cvt_pk_bf16_f32 v107, v92, v93
  v_pk_mul_f32 v[94:95], v[94:95], v[12:13]
  v_cvt_pk_bf16_f32 v111, v94, v95
  s_mov_b32 s63, 0x0
  buffer_store_dwordx4 v[96:99], v4, s[36:39], s63 offen offset:0 sc1
  s_mov_b32 s63, 0x2000
  buffer_store_dwordx4 v[100:103], v4, s[36:39], s63 offen offset:0 sc1
  s_mov_b32 s63, 0x4000
  buffer_store_dwordx4 v[104:107], v4, s[36:39], s63 offen offset:0 sc1
  s_mov_b32 s63, 0x6000
  buffer_store_dwordx4 v[108:111], v4, s[36:39], s63 offen offset:0 sc1
  v_and_b32 v65, 0xffff0000, v32
  v_lshlrev_b32 v64, 16, v32
  v_and_b32 v67, 0xffff0000, v33
  v_lshlrev_b32 v66, 16, v33
  v_and_b32 v69, 0xffff0000, v34
  v_lshlrev_b32 v68, 16, v34
  v_and_b32 v71, 0xffff0000, v35
  v_lshlrev_b32 v70, 16, v35
  v_and_b32 v73, 0xffff0000, v36
  v_lshlrev_b32 v72, 16, v36
  v_and_b32 v75, 0xffff0000, v37
  v_lshlrev_b32 v74, 16, v37
  v_and_b32 v77, 0xffff0000, v38
  v_lshlrev_b32 v76, 16, v38
  v_and_b32 v79, 0xffff0000, v39
  v_lshlrev_b32 v78, 16, v39
  v_and_b32 v81, 0xffff0000, v40
  v_lshlrev_b32 v80, 16, v40
  v_and_b32 v83, 0xffff0000, v41
  v_lshlrev_b32 v82, 16, v41
  v_and_b32 v85, 0xffff0000, v42
  v_lshlrev_b32 v84, 16, v42
  v_and_b32 v87, 0xffff0000, v43
  v_lshlrev_b32 v86, 16, v43
  v_and_b32 v89, 0xffff0000, v44
  v_lshlrev_b32 v88, 16, v44
  v_and_b32 v91, 0xffff0000, v45
  v_lshlrev_b32 v90, 16, v45
  v_and_b32 v93, 0xffff0000, v46
  v_lshlrev_b32 v92, 16, v46
  v_and_b32 v95, 0xffff0000, v47
  v_lshlrev_b32 v94, 16, v47
  v_pk_add_f32 v[8:9], v[64:65], v[66:67]
  v_pk_add_f32 v[8:9], v[8:9], v[68:69]
  v_pk_add_f32 v[8:9], v[8:9], v[70:71]
  v_pk_add_f32 v[8:9], v[8:9], v[72:73]
  v_pk_add_f32 v[8:9], v[8:9], v[74:75]
  v_pk_add_f32 v[8:9], v[8:9], v[76:77]
  v_pk_add_f32 v[8:9], v[8:9], v[78:79]
  v_pk_add_f32 v[8:9], v[8:9], v[80:81]
  v_pk_add_f32 v[8:9], v[8:9], v[82:83]
  v_pk_add_f32 v[8:9], v[8:9], v[84:85]
  v_pk_add_f32 v[8:9], v[8:9], v[86:87]
  v_pk_add_f32 v[8:9], v[8:9], v[88:89]
  v_pk_add_f32 v[8:9], v[8:9], v[90:91]
  v_pk_add_f32 v[8:9], v[8:9], v[92:93]
  v_pk_add_f32 v[8:9], v[8:9], v[94:95]
  v_add_f32 v8, v8, v9
  s_nop 1
  v_add_f32_dpp v8, v8, v8 row_ror:8 row_mask:0xf bank_mask:0xf
  s_nop 1
  v_add_f32_dpp v8, v8, v8 row_ror:4 row_mask:0xf bank_mask:0xf
  s_nop 1
  v_add_f32_dpp v8, v8, v8 row_ror:2 row_mask:0xf bank_mask:0xf
  s_nop 1
  v_add_f32_dpp v8, v8, v8 row_ror:1 row_mask:0xf bank_mask:0xf
  v_mul_f32 v8, 0xbb000000, v8
  v_mov_b32 v9, v8
  v_mov_b64 v[12:13], 0
  v_pk_add_f32 v[10:11], v[64:65], v[8:9]
  v_pk_fma_f32 v[12:13], v[10:11], v[10:11], v[12:13]
  v_pk_add_f32 v[10:11], v[66:67], v[8:9]
  v_pk_fma_f32 v[12:13], v[10:11], v[10:11], v[12:13]
  v_pk_add_f32 v[10:11], v[68:69], v[8:9]
  v_pk_fma_f32 v[12:13], v[10:11], v[10:11], v[12:13]
  v_pk_add_f32 v[10:11], v[70:71], v[8:9]
  v_pk_fma_f32 v[12:13], v[10:11], v[10:11], v[12:13]
  v_pk_add_f32 v[10:11], v[72:73], v[8:9]
  v_pk_fma_f32 v[12:13], v[10:11], v[10:11], v[12:13]
  v_pk_add_f32 v[10:11], v[74:75], v[8:9]
  v_pk_fma_f32 v[12:13], v[10:11], v[10:11], v[12:13]
  v_pk_add_f32 v[10:11], v[76:77], v[8:9]
  v_pk_fma_f32 v[12:13], v[10:11], v[10:11], v[12:13]
  v_pk_add_f32 v[10:11], v[78:79], v[8:9]
  v_pk_fma_f32 v[12:13], v[10:11], v[10:11], v[12:13]
  v_pk_add_f32 v[10:11], v[80:81], v[8:9]
  v_pk_fma_f32 v[12:13], v[10:11], v[10:11], v[12:13]
  v_pk_add_f32 v[10:11], v[82:83], v[8:9]
  v_pk_fma_f32 v[12:13], v[10:11], v[10:11], v[12:13]
  v_pk_add_f32 v[10:11], v[84:85], v[8:9]
  v_pk_fma_f32 v[12:13], v[10:11], v[10:11], v[12:13]
  v_pk_add_f32 v[10:11], v[86:87], v[8:9]
  v_pk_fma_f32 v[12:13], v[10:11], v[10:11], v[12:13]
  v_pk_add_f32 v[10:11], v[88:89], v[8:9]
  v_pk_fma_f32 v[12:13], v[10:11], v[10:11], v[12:13]
  v_pk_add_f32 v[10:11], v[90:91], v[8:9]
  v_pk_fma_f32 v[12:13], v[10:11], v[10:11], v[12:13]
  v_pk_add_f32 v[10:11], v[92:93], v[8:9]
  v_pk_fma_f32 v[12:13], v[10:11], v[10:11], v[12:13]
  v_pk_add_f32 v[10:11], v[94:95], v[8:9]
  v_pk_fma_f32 v[12:13], v[10:11], v[10:11], v[12:13]
  v_add_f32 v12, v12, v13
  s_nop 1
  v_add_f32_dpp v12, v12, v12 row_ror:8 row_mask:0xf bank_mask:0xf
  s_nop 1
  v_add_f32_dpp v12, v12, v12 row_ror:4 row_mask:0xf bank_mask:0xf
  s_nop 1
  v_add_f32_dpp v12, v12, v12 row_ror:2 row_mask:0xf bank_mask:0xf
  s_nop 1
  v_add_f32_dpp v12, v12, v12 row_ror:1 row_mask:0xf bank_mask:0xf
  v_mul_f32 v12, 0x3b000000, v12
  v_cvt_pk_bf16_f32 v10, v8, v12
  v_lshlrev_b32 v8, 16, v10
  v_mov_b32 v9, v8
  v_and_b32 v12, 0xffff0000, v10
  v_add_f32 v12, 0x3727c5ac, v12
  v_cvt_pk_bf16_f32 v12, v12, v12
  v_lshlrev_b32 v12, 16, v12
  v_sqrt_f32 v12, v12
  s_nop 0
  v_cvt_pk_bf16_f32 v12, v12, v12
  v_lshlrev_b32 v12, 16, v12
  v_rcp_f32 v12, v12
  s_nop 0
  v_mov_b32 v13, v12
  v_pk_add_f32 v[64:65], v[64:65], v[8:9]
  v_cvt_pk_bf16_f32 v112, v64, v65
  v_pk_add_f32 v[66:67], v[66:67], v[8:9]
  v_cvt_pk_bf16_f32 v116, v66, v67
  v_pk_add_f32 v[68:69], v[68:69], v[8:9]
  v_cvt_pk_bf16_f32 v120, v68, v69
  v_pk_add_f32 v[70:71], v[70:71], v[8:9]
  v_cvt_pk_bf16_f32 v124, v70, v71
  v_pk_add_f32 v[72:73], v[72:73], v[8:9]
  v_cvt_pk_bf16_f32 v113, v72, v73
  v_pk_add_f32 v[74:75], v[74:75], v[8:9]
  v_cvt_pk_bf16_f32 v117, v74, v75
  v_pk_add_f32 v[76:77], v[76:77], v[8:9]
  v_cvt_pk_bf16_f32 v121, v76, v77
  v_pk_add_f32 v[78:79], v[78:79], v[8:9]
  v_cvt_pk_bf16_f32 v125, v78, v79
  v_pk_add_f32 v[80:81], v[80:81], v[8:9]
  v_cvt_pk_bf16_f32 v114, v80, v81
  v_pk_add_f32 v[82:83], v[82:83], v[8:9]
  v_cvt_pk_bf16_f32 v118, v82, v83
  v_pk_add_f32 v[84:85], v[84:85], v[8:9]
  v_cvt_pk_bf16_f32 v122, v84, v85
  v_pk_add_f32 v[86:87], v[86:87], v[8:9]
  v_cvt_pk_bf16_f32 v126, v86, v87
  v_pk_add_f32 v[88:89], v[88:89], v[8:9]
  v_cvt_pk_bf16_f32 v115, v88, v89
  v_pk_add_f32 v[90:91], v[90:91], v[8:9]
  v_cvt_pk_bf16_f32 v119, v90, v91
  v_pk_add_f32 v[92:93], v[92:93], v[8:9]
  v_cvt_pk_bf16_f32 v123, v92, v93
  v_pk_add_f32 v[94:95], v[94:95], v[8:9]
  v_cvt_pk_bf16_f32 v127, v94, v95
  v_and_b32 v65, 0xffff0000, v112
  v_lshlrev_b32 v64, 16, v112
  v_and_b32 v67, 0xffff0000, v116
  v_lshlrev_b32 v66, 16, v116
  v_and_b32 v69, 0xffff0000, v120
  v_lshlrev_b32 v68, 16, v120
  v_and_b32 v71, 0xffff0000, v124
  v_lshlrev_b32 v70, 16, v124
  v_and_b32 v73, 0xffff0000, v113
  v_lshlrev_b32 v72, 16, v113
  v_and_b32 v75, 0xffff0000, v117
  v_lshlrev_b32 v74, 16, v117
  v_and_b32 v77, 0xffff0000, v121
  v_lshlrev_b32 v76, 16, v121
  v_and_b32 v79, 0xffff0000, v125
  v_lshlrev_b32 v78, 16, v125
  v_and_b32 v81, 0xffff0000, v114
  v_lshlrev_b32 v80, 16, v114
  v_and_b32 v83, 0xffff0000, v118
  v_lshlrev_b32 v82, 16, v118
  v_and_b32 v85, 0xffff0000, v122
  v_lshlrev_b32 v84, 16, v122
  v_and_b32 v87, 0xffff0000, v126
  v_lshlrev_b32 v86, 16, v126
  v_and_b32 v89, 0xffff0000, v115
  v_lshlrev_b32 v88, 16, v115
  v_and_b32 v91, 0xffff0000, v119
  v_lshlrev_b32 v90, 16, v119
  v_and_b32 v93, 0xffff0000, v123
  v_lshlrev_b32 v92, 16, v123
  v_and_b32 v95, 0xffff0000, v127
  v_lshlrev_b32 v94, 16, v127
  v_pk_mul_f32 v[64:65], v[64:65], v[12:13]
  v_cvt_pk_bf16_f32 v112, v64, v65
  v_pk_mul_f32 v[66:67], v[66:67], v[12:13]
  v_cvt_pk_bf16_f32 v116, v66, v67
  v_pk_mul_f32 v[68:69], v[68:69], v[12:13]
  v_cvt_pk_bf16_f32 v120, v68, v69
  v_pk_mul_f32 v[70:71], v[70:71], v[12:13]
  v_cvt_pk_bf16_f32 v124, v70, v71
  v_pk_mul_f32 v[72:73], v[72:73], v[12:13]
  v_cvt_pk_bf16_f32 v113, v72, v73
  v_pk_mul_f32 v[74:75], v[74:75], v[12:13]
  v_cvt_pk_bf16_f32 v117, v74, v75
  v_pk_mul_f32 v[76:77], v[76:77], v[12:13]
  v_cvt_pk_bf16_f32 v121, v76, v77
  v_pk_mul_f32 v[78:79], v[78:79], v[12:13]
  v_cvt_pk_bf16_f32 v125, v78, v79
  v_pk_mul_f32 v[80:81], v[80:81], v[12:13]
  v_cvt_pk_bf16_f32 v114, v80, v81
  v_pk_mul_f32 v[82:83], v[82:83], v[12:13]
  v_cvt_pk_bf16_f32 v118, v82, v83
  v_pk_mul_f32 v[84:85], v[84:85], v[12:13]
  v_cvt_pk_bf16_f32 v122, v84, v85
  v_pk_mul_f32 v[86:87], v[86:87], v[12:13]
  v_cvt_pk_bf16_f32 v126, v86, v87
  v_pk_mul_f32 v[88:89], v[88:89], v[12:13]
  v_cvt_pk_bf16_f32 v115, v88, v89
  v_pk_mul_f32 v[90:91], v[90:91], v[12:13]
  v_cvt_pk_bf16_f32 v119, v90, v91
  v_pk_mul_f32 v[92:93], v[92:93], v[12:13]
  v_cvt_pk_bf16_f32 v123, v92, v93
  v_pk_mul_f32 v[94:95], v[94:95], v[12:13]
  v_cvt_pk_bf16_f32 v127, v94, v95
  s_mov_b32 s63, 0x0
  buffer_store_dwordx4 v[112:115], v4, s[36:39], s63 offen offset:64 sc1
  s_mov_b32 s63, 0x2000
  buffer_store_dwordx4 v[116:119], v4, s[36:39], s63 offen offset:64 sc1
  s_mov_b32 s63, 0x4000
  buffer_store_dwordx4 v[120:123], v4, s[36:39], s63 offen offset:64 sc1
  s_mov_b32 s63, 0x6000
  buffer_store_dwordx4 v[124:127], v4, s[36:39], s63 offen offset:64 sc1
  s_waitcnt vmcnt(0)
  s_barrier
  s_cmp_lg_u32 s34, 0
  s_cbranch_scc1 L_noinit_141
  v_mov_b32 v8, 1
  s_mov_b64 exec, 1
  s_lshl_b32 s63, s64, 2
  s_cmp_lt_u32 s64, 4
  s_cselect_b32 s63, s63, 0x1000
  buffer_store_dword v8, off, s[40:43], s63 offset:32 sc1
  buffer_atomic_add v8, off, s[40:43], 0 offset:240 sc0 sc1
  s_waitcnt vmcnt(0)
  v_readfirstlane_b32 s18, v8
  v_mov_b32 v8, 64
  s_cmp_eq_u32 s18, 63
  s_cselect_b32 s18, 0, 0x1000
  s_nop 1
  buffer_store_dword v8, off, s[40:43], s18 sc1
  s_mov_b64 exec, -1
L_noinit_141:
  v_and_b32 v65, 0xffff0000, v96
  v_lshlrev_b32 v64, 16, v96
  v_and_b32 v67, 0xffff0000, v97
  v_lshlrev_b32 v66, 16, v97
  v_and_b32 v69, 0xffff0000, v98
  v_lshlrev_b32 v68, 16, v98
  v_and_b32 v71, 0xffff0000, v99
  v_lshlrev_b32 v70, 16, v99
  v_and_b32 v73, 0xffff0000, v100
  v_lshlrev_b32 v72, 16, v100
  v_and_b32 v75, 0xffff0000, v101
  v_lshlrev_b32 v74, 16, v101
  v_and_b32 v77, 0xffff0000, v102
  v_lshlrev_b32 v76, 16, v102
  v_and_b32 v79, 0xffff0000, v103
  v_lshlrev_b32 v78, 16, v103
  v_and_b32 v81, 0xffff0000, v104
  v_lshlrev_b32 v80, 16, v104
  v_and_b32 v83, 0xffff0000, v105
  v_lshlrev_b32 v82, 16, v105
  v_and_b32 v85, 0xffff0000, v106
  v_lshlrev_b32 v84, 16, v106
  v_and_b32 v87, 0xffff0000, v107
  v_lshlrev_b32 v86, 16, v107
  v_and_b32 v89, 0xffff0000, v108
  v_lshlrev_b32 v88, 16, v108
  v_and_b32 v91, 0xffff0000, v109
  v_lshlrev_b32 v90, 16, v109
  v_and_b32 v93, 0xffff0000, v110
  v_lshlrev_b32 v92, 16, v110
  v_and_b32 v95, 0xffff0000, v111
  v_lshlrev_b32 v94, 16, v111
  v_pk_add_f32 v[8:9], v[64:65], v[66:67]
  v_pk_add_f32 v[8:9], v[8:9], v[68:69]
  v_pk_add_f32 v[8:9], v[8:9], v[70:71]
  v_pk_add_f32 v[8:9], v[8:9], v[72:73]
  v_pk_add_f32 v[8:9], v[8:9], v[74:75]
  v_pk_add_f32 v[8:9], v[8:9], v[76:77]
  v_pk_add_f32 v[8:9], v[8:9], v[78:79]
  v_pk_add_f32 v[8:9], v[8:9], v[80:81]
  v_pk_add_f32 v[8:9], v[8:9], v[82:83]
  v_pk_add_f32 v[8:9], v[8:9], v[84:85]
  v_pk_add_f32 v[8:9], v[8:9], v[86:87]
  v_pk_add_f32 v[8:9], v[8:9], v[88:89]
  v_pk_add_f32 v[8:9], v[8:9], v[90:91]
  v_pk_add_f32 v[8:9], v[8:9], v[92:93]
  v_pk_add_f32 v[8:9], v[8:9], v[94:95]
  v_add_f32 v8, v8, v9
  s_nop 1
  v_add_f32_dpp v8, v8, v8 row_ror:8 row_mask:0xf bank_mask:0xf
  s_nop 1
  v_add_f32_dpp v8, v8, v8 row_ror:4 row_mask:0xf bank_mask:0xf
  s_nop 1
  v_add_f32_dpp v8, v8, v8 row_ror:2 row_mask:0xf bank_mask:0xf
  s_nop 1
  v_add_f32_dpp v8, v8, v8 row_ror:1 row_mask:0xf bank_mask:0xf
  v_mul_f32 v8, 0xbb000000, v8
  v_mov_b32 v9, v8
  v_mov_b64 v[12:13], 0
  v_pk_add_f32 v[10:11], v[64:65], v[8:9]
  v_pk_fma_f32 v[12:13], v[10:11], v[10:11], v[12:13]
  v_pk_add_f32 v[10:11], v[66:67], v[8:9]
  v_pk_fma_f32 v[12:13], v[10:11], v[10:11], v[12:13]
  v_pk_add_f32 v[10:11], v[68:69], v[8:9]
  v_pk_fma_f32 v[12:13], v[10:11], v[10:11], v[12:13]
  v_pk_add_f32 v[10:11], v[70:71], v[8:9]
  v_pk_fma_f32 v[12:13], v[10:11], v[10:11], v[12:13]
  v_pk_add_f32 v[10:11], v[72:73], v[8:9]
  v_pk_fma_f32 v[12:13], v[10:11], v[10:11], v[12:13]
  v_pk_add_f32 v[10:11], v[74:75], v[8:9]
  v_pk_fma_f32 v[12:13], v[10:11], v[10:11], v[12:13]
  v_pk_add_f32 v[10:11], v[76:77], v[8:9]
  v_pk_fma_f32 v[12:13], v[10:11], v[10:11], v[12:13]
  v_pk_add_f32 v[10:11], v[78:79], v[8:9]
  v_pk_fma_f32 v[12:13], v[10:11], v[10:11], v[12:13]
  v_pk_add_f32 v[10:11], v[80:81], v[8:9]
  v_pk_fma_f32 v[12:13], v[10:11], v[10:11], v[12:13]
  v_pk_add_f32 v[10:11], v[82:83], v[8:9]
  v_pk_fma_f32 v[12:13], v[10:11], v[10:11], v[12:13]
  v_pk_add_f32 v[10:11], v[84:85], v[8:9]
  v_pk_fma_f32 v[12:13], v[10:11], v[10:11], v[12:13]
  v_pk_add_f32 v[10:11], v[86:87], v[8:9]
  v_pk_fma_f32 v[12:13], v[10:11], v[10:11], v[12:13]
  v_pk_add_f32 v[10:11], v[88:89], v[8:9]
  v_pk_fma_f32 v[12:13], v[10:11], v[10:11], v[12:13]
  v_pk_add_f32 v[10:11], v[90:91], v[8:9]
  v_pk_fma_f32 v[12:13], v[10:11], v[10:11], v[12:13]
  v_pk_add_f32 v[10:11], v[92:93], v[8:9]
  v_pk_fma_f32 v[12:13], v[10:11], v[10:11], v[12:13]
  v_pk_add_f32 v[10:11], v[94:95], v[8:9]
  v_pk_fma_f32 v[12:13], v[10:11], v[10:11], v[12:13]
  v_add_f32 v12, v12, v13
  s_nop 1
  v_add_f32_dpp v12, v12, v12 row_ror:8 row_mask:0xf bank_mask:0xf
  s_nop 1
  v_add_f32_dpp v12, v12, v12 row_ror:4 row_mask:0xf bank_mask:0xf
  s_nop 1
  v_add_f32_dpp v12, v12, v12 row_ror:2 row_mask:0xf bank_mask:0xf
  s_nop 1
  v_add_f32_dpp v12, v12, v12 row_ror:1 row_mask:0xf bank_mask:0xf
  v_mul_f32 v12, 0x3b000000, v12
  v_cvt_pk_bf16_f32 v10, v8, v12
  v_lshlrev_b32 v8, 16, v10
  v_mov_b32 v9, v8
  v_and_b32 v12, 0xffff0000, v10
  v_add_f32 v12, 0x3727c5ac, v12
  v_cvt_pk_bf16_f32 v12, v12, v12
  v_lshlrev_b32 v12, 16, v12
  v_sqrt_f32 v12, v12
  s_nop 0
  v_cvt_pk_bf16_f32 v12, v12, v12
  v_lshlrev_b32 v12, 16, v12
  v_rcp_f32 v12, v12
  s_nop 0
  v_mov_b32 v13, v12
  v_pk_add_f32 v[64:65], v[64:65], v[8:9]
  v_cvt_pk_bf16_f32 v16, v64, v65
  v_pk_add_f32 v[66:67], v[66:67], v[8:9]
  v_cvt_pk_bf16_f32 v17, v66, v67
  v_pk_add_f32 v[68:69], v[68:69], v[8:9]
  v_cvt_pk_bf16_f32 v18, v68, v69
  v_pk_add_f32 v[70:71], v[70:71], v[8:9]
  v_cvt_pk_bf16_f32 v19, v70, v71
  v_pk_add_f32 v[72:73], v[72:73], v[8:9]
  v_cvt_pk_bf16_f32 v20, v72, v73
  v_pk_add_f32 v[74:75], v[74:75], v[8:9]
  v_cvt_pk_bf16_f32 v21, v74, v75
  v_pk_add_f32 v[76:77], v[76:77], v[8:9]
  v_cvt_pk_bf16_f32 v22, v76, v77
  v_pk_add_f32 v[78:79], v[78:79], v[8:9]
  v_cvt_pk_bf16_f32 v23, v78, v79
  v_pk_add_f32 v[80:81], v[80:81], v[8:9]
  v_cvt_pk_bf16_f32 v24, v80, v81
  v_pk_add_f32 v[82:83], v[82:83], v[8:9]
  v_cvt_pk_bf16_f32 v25, v82, v83
  v_pk_add_f32 v[84:85], v[84:85], v[8:9]
  v_cvt_pk_bf16_f32 v26, v84, v85
  v_pk_add_f32 v[86:87], v[86:87], v[8:9]
  v_cvt_pk_bf16_f32 v27, v86, v87
  v_pk_add_f32 v[88:89], v[88:89], v[8:9]
  v_cvt_pk_bf16_f32 v28, v88, v89
  v_pk_add_f32 v[90:91], v[90:91], v[8:9]
  v_cvt_pk_bf16_f32 v29, v90, v91
  v_pk_add_f32 v[92:93], v[92:93], v[8:9]
  v_cvt_pk_bf16_f32 v30, v92, v93
  v_pk_add_f32 v[94:95], v[94:95], v[8:9]
  v_cvt_pk_bf16_f32 v31, v94, v95
  v_and_b32 v65, 0xffff0000, v16
  v_lshlrev_b32 v64, 16, v16
  v_and_b32 v67, 0xffff0000, v17
  v_lshlrev_b32 v66, 16, v17
  v_and_b32 v69, 0xffff0000, v18
  v_lshlrev_b32 v68, 16, v18
  v_and_b32 v71, 0xffff0000, v19
  v_lshlrev_b32 v70, 16, v19
  v_and_b32 v73, 0xffff0000, v20
  v_lshlrev_b32 v72, 16, v20
  v_and_b32 v75, 0xffff0000, v21
  v_lshlrev_b32 v74, 16, v21
  v_and_b32 v77, 0xffff0000, v22
  v_lshlrev_b32 v76, 16, v22
  v_and_b32 v79, 0xffff0000, v23
  v_lshlrev_b32 v78, 16, v23
  v_and_b32 v81, 0xffff0000, v24
  v_lshlrev_b32 v80, 16, v24
  v_and_b32 v83, 0xffff0000, v25
  v_lshlrev_b32 v82, 16, v25
  v_and_b32 v85, 0xffff0000, v26
  v_lshlrev_b32 v84, 16, v26
  v_and_b32 v87, 0xffff0000, v27
  v_lshlrev_b32 v86, 16, v27
  v_and_b32 v89, 0xffff0000, v28
  v_lshlrev_b32 v88, 16, v28
  v_and_b32 v91, 0xffff0000, v29
  v_lshlrev_b32 v90, 16, v29
  v_and_b32 v93, 0xffff0000, v30
  v_lshlrev_b32 v92, 16, v30
  v_and_b32 v95, 0xffff0000, v31
  v_lshlrev_b32 v94, 16, v31
  v_pk_mul_f32 v[64:65], v[64:65], v[12:13]
  v_cvt_pk_bf16_f32 v16, v64, v65
  v_pk_mul_f32 v[66:67], v[66:67], v[12:13]
  v_cvt_pk_bf16_f32 v17, v66, v67
  v_pk_mul_f32 v[68:69], v[68:69], v[12:13]
  v_cvt_pk_bf16_f32 v18, v68, v69
  v_pk_mul_f32 v[70:71], v[70:71], v[12:13]
  v_cvt_pk_bf16_f32 v19, v70, v71
  v_pk_mul_f32 v[72:73], v[72:73], v[12:13]
  v_cvt_pk_bf16_f32 v20, v72, v73
  v_pk_mul_f32 v[74:75], v[74:75], v[12:13]
  v_cvt_pk_bf16_f32 v21, v74, v75
  v_pk_mul_f32 v[76:77], v[76:77], v[12:13]
  v_cvt_pk_bf16_f32 v22, v76, v77
  v_pk_mul_f32 v[78:79], v[78:79], v[12:13]
  v_cvt_pk_bf16_f32 v23, v78, v79
  v_pk_mul_f32 v[80:81], v[80:81], v[12:13]
  v_cvt_pk_bf16_f32 v24, v80, v81
  v_pk_mul_f32 v[82:83], v[82:83], v[12:13]
  v_cvt_pk_bf16_f32 v25, v82, v83
  v_pk_mul_f32 v[84:85], v[84:85], v[12:13]
  v_cvt_pk_bf16_f32 v26, v84, v85
  v_pk_mul_f32 v[86:87], v[86:87], v[12:13]
  v_cvt_pk_bf16_f32 v27, v86, v87
  v_pk_mul_f32 v[88:89], v[88:89], v[12:13]
  v_cvt_pk_bf16_f32 v28, v88, v89
  v_pk_mul_f32 v[90:91], v[90:91], v[12:13]
  v_cvt_pk_bf16_f32 v29, v90, v91
  v_pk_mul_f32 v[92:93], v[92:93], v[12:13]
  v_cvt_pk_bf16_f32 v30, v92, v93
  v_pk_mul_f32 v[94:95], v[94:95], v[12:13]
  v_cvt_pk_bf16_f32 v31, v94, v95
  s_mov_b32 s63, 0x200000
  buffer_store_dwordx4 v[16:19], v4, s[36:39], s63 offen offset:0 sc1
  s_mov_b32 s63, 0x202000
  buffer_store_dwordx4 v[20:23], v4, s[36:39], s63 offen offset:0 sc1
  s_mov_b32 s63, 0x204000
  buffer_store_dwordx4 v[24:27], v4, s[36:39], s63 offen offset:0 sc1
  s_mov_b32 s63, 0x206000
  buffer_store_dwordx4 v[28:31], v4, s[36:39], s63 offen offset:0 sc1
  v_and_b32 v65, 0xffff0000, v112
  v_lshlrev_b32 v64, 16, v112
  v_and_b32 v67, 0xffff0000, v113
  v_lshlrev_b32 v66, 16, v113
  v_and_b32 v69, 0xffff0000, v114
  v_lshlrev_b32 v68, 16, v114
  v_and_b32 v71, 0xffff0000, v115
  v_lshlrev_b32 v70, 16, v115
  v_and_b32 v73, 0xffff0000, v116
  v_lshlrev_b32 v72, 16, v116
  v_and_b32 v75, 0xffff0000, v117
  v_lshlrev_b32 v74, 16, v117
  v_and_b32 v77, 0xffff0000, v118
  v_lshlrev_b32 v76, 16, v118
  v_and_b32 v79, 0xffff0000, v119
  v_lshlrev_b32 v78, 16, v119
  v_and_b32 v81, 0xffff0000, v120
  v_lshlrev_b32 v80, 16, v120
  v_and_b32 v83, 0xffff0000, v121
  v_lshlrev_b32 v82, 16, v121
  v_and_b32 v85, 0xffff0000, v122
  v_lshlrev_b32 v84, 16, v122
  v_and_b32 v87, 0xffff0000, v123
  v_lshlrev_b32 v86, 16, v123
  v_and_b32 v89, 0xffff0000, v124
  v_lshlrev_b32 v88, 16, v124
  v_and_b32 v91, 0xffff0000, v125
  v_lshlrev_b32 v90, 16, v125
  v_and_b32 v93, 0xffff0000, v126
  v_lshlrev_b32 v92, 16, v126
  v_and_b32 v95, 0xffff0000, v127
  v_lshlrev_b32 v94, 16, v127
  v_pk_add_f32 v[8:9], v[64:65], v[66:67]
  v_pk_add_f32 v[8:9], v[8:9], v[68:69]
  v_pk_add_f32 v[8:9], v[8:9], v[70:71]
  v_pk_add_f32 v[8:9], v[8:9], v[72:73]
  v_pk_add_f32 v[8:9], v[8:9], v[74:75]
  v_pk_add_f32 v[8:9], v[8:9], v[76:77]
  v_pk_add_f32 v[8:9], v[8:9], v[78:79]
  v_pk_add_f32 v[8:9], v[8:9], v[80:81]
  v_pk_add_f32 v[8:9], v[8:9], v[82:83]
  v_pk_add_f32 v[8:9], v[8:9], v[84:85]
  v_pk_add_f32 v[8:9], v[8:9], v[86:87]
  v_pk_add_f32 v[8:9], v[8:9], v[88:89]
  v_pk_add_f32 v[8:9], v[8:9], v[90:91]
  v_pk_add_f32 v[8:9], v[8:9], v[92:93]
  v_pk_add_f32 v[8:9], v[8:9], v[94:95]
  v_add_f32 v8, v8, v9
  s_nop 1
  v_add_f32_dpp v8, v8, v8 row_ror:8 row_mask:0xf bank_mask:0xf
  s_nop 1
  v_add_f32_dpp v8, v8, v8 row_ror:4 row_mask:0xf bank_mask:0xf
  s_nop 1
  v_add_f32_dpp v8, v8, v8 row_ror:2 row_mask:0xf bank_mask:0xf
  s_nop 1
  v_add_f32_dpp v8, v8, v8 row_ror:1 row_mask:0xf bank_mask:0xf
  v_mul_f32 v8, 0xbb000000, v8
  v_mov_b32 v9, v8
  v_mov_b64 v[12:13], 0
  v_pk_add_f32 v[10:11], v[64:65], v[8:9]
  v_pk_fma_f32 v[12:13], v[10:11], v[10:11], v[12:13]
  v_pk_add_f32 v[10:11], v[66:67], v[8:9]
  v_pk_fma_f32 v[12:13], v[10:11], v[10:11], v[12:13]
  v_pk_add_f32 v[10:11], v[68:69], v[8:9]
  v_pk_fma_f32 v[12:13], v[10:11], v[10:11], v[12:13]
  v_pk_add_f32 v[10:11], v[70:71], v[8:9]
  v_pk_fma_f32 v[12:13], v[10:11], v[10:11], v[12:13]
  v_pk_add_f32 v[10:11], v[72:73], v[8:9]
  v_pk_fma_f32 v[12:13], v[10:11], v[10:11], v[12:13]
  v_pk_add_f32 v[10:11], v[74:75], v[8:9]
  v_pk_fma_f32 v[12:13], v[10:11], v[10:11], v[12:13]
  v_pk_add_f32 v[10:11], v[76:77], v[8:9]
  v_pk_fma_f32 v[12:13], v[10:11], v[10:11], v[12:13]
  v_pk_add_f32 v[10:11], v[78:79], v[8:9]
  v_pk_fma_f32 v[12:13], v[10:11], v[10:11], v[12:13]
  v_pk_add_f32 v[10:11], v[80:81], v[8:9]
  v_pk_fma_f32 v[12:13], v[10:11], v[10:11], v[12:13]
  v_pk_add_f32 v[10:11], v[82:83], v[8:9]
  v_pk_fma_f32 v[12:13], v[10:11], v[10:11], v[12:13]
  v_pk_add_f32 v[10:11], v[84:85], v[8:9]
  v_pk_fma_f32 v[12:13], v[10:11], v[10:11], v[12:13]
  v_pk_add_f32 v[10:11], v[86:87], v[8:9]
  v_pk_fma_f32 v[12:13], v[10:11], v[10:11], v[12:13]
  v_pk_add_f32 v[10:11], v[88:89], v[8:9]
  v_pk_fma_f32 v[12:13], v[10:11], v[10:11], v[12:13]
  v_pk_add_f32 v[10:11], v[90:91], v[8:9]
  v_pk_fma_f32 v[12:13], v[10:11], v[10:11], v[12:13]
  v_pk_add_f32 v[10:11], v[92:93], v[8:9]
  v_pk_fma_f32 v[12:13], v[10:11], v[10:11], v[12:13]
  v_pk_add_f32 v[10:11], v[94:95], v[8:9]
  v_pk_fma_f32 v[12:13], v[10:11], v[10:11], v[12:13]
  v_add_f32 v12, v12, v13
  s_nop 1
  v_add_f32_dpp v12, v12, v12 row_ror:8 row_mask:0xf bank_mask:0xf
  s_nop 1
  v_add_f32_dpp v12, v12, v12 row_ror:4 row_mask:0xf bank_mask:0xf
  s_nop 1
  v_add_f32_dpp v12, v12, v12 row_ror:2 row_mask:0xf bank_mask:0xf
  s_nop 1
  v_add_f32_dpp v12, v12, v12 row_ror:1 row_mask:0xf bank_mask:0xf
  v_mul_f32 v12, 0x3b000000, v12
  v_cvt_pk_bf16_f32 v10, v8, v12
  v_lshlrev_b32 v8, 16, v10
  v_mov_b32 v9, v8
  v_and_b32 v12, 0xffff0000, v10
  v_add_f32 v12, 0x3727c5ac, v12
  v_cvt_pk_bf16_f32 v12, v12, v12
  v_lshlrev_b32 v12, 16, v12
  v_sqrt_f32 v12, v12
  s_nop 0
  v_cvt_pk_bf16_f32 v12, v12, v12
  v_lshlrev_b32 v12, 16, v12
  v_rcp_f32 v12, v12
  s_nop 0
  v_mov_b32 v13, v12
  v_pk_add_f32 v[64:65], v[64:65], v[8:9]
  v_cvt_pk_bf16_f32 v32, v64, v65
  v_pk_add_f32 v[66:67], v[66:67], v[8:9]
  v_cvt_pk_bf16_f32 v33, v66, v67
  v_pk_add_f32 v[68:69], v[68:69], v[8:9]
  v_cvt_pk_bf16_f32 v34, v68, v69
  v_pk_add_f32 v[70:71], v[70:71], v[8:9]
  v_cvt_pk_bf16_f32 v35, v70, v71
  v_pk_add_f32 v[72:73], v[72:73], v[8:9]
  v_cvt_pk_bf16_f32 v36, v72, v73
  v_pk_add_f32 v[74:75], v[74:75], v[8:9]
  v_cvt_pk_bf16_f32 v37, v74, v75
  v_pk_add_f32 v[76:77], v[76:77], v[8:9]
  v_cvt_pk_bf16_f32 v38, v76, v77
  v_pk_add_f32 v[78:79], v[78:79], v[8:9]
  v_cvt_pk_bf16_f32 v39, v78, v79
  v_pk_add_f32 v[80:81], v[80:81], v[8:9]
  v_cvt_pk_bf16_f32 v40, v80, v81
  v_pk_add_f32 v[82:83], v[82:83], v[8:9]
  v_cvt_pk_bf16_f32 v41, v82, v83
  v_pk_add_f32 v[84:85], v[84:85], v[8:9]
  v_cvt_pk_bf16_f32 v42, v84, v85
  v_pk_add_f32 v[86:87], v[86:87], v[8:9]
  v_cvt_pk_bf16_f32 v43, v86, v87
  v_pk_add_f32 v[88:89], v[88:89], v[8:9]
  v_cvt_pk_bf16_f32 v44, v88, v89
  v_pk_add_f32 v[90:91], v[90:91], v[8:9]
  v_cvt_pk_bf16_f32 v45, v90, v91
  v_pk_add_f32 v[92:93], v[92:93], v[8:9]
  v_cvt_pk_bf16_f32 v46, v92, v93
  v_pk_add_f32 v[94:95], v[94:95], v[8:9]
  v_cvt_pk_bf16_f32 v47, v94, v95
  v_and_b32 v65, 0xffff0000, v32
  v_lshlrev_b32 v64, 16, v32
  v_and_b32 v67, 0xffff0000, v33
  v_lshlrev_b32 v66, 16, v33
  v_and_b32 v69, 0xffff0000, v34
  v_lshlrev_b32 v68, 16, v34
  v_and_b32 v71, 0xffff0000, v35
  v_lshlrev_b32 v70, 16, v35
  v_and_b32 v73, 0xffff0000, v36
  v_lshlrev_b32 v72, 16, v36
  v_and_b32 v75, 0xffff0000, v37
  v_lshlrev_b32 v74, 16, v37
  v_and_b32 v77, 0xffff0000, v38
  v_lshlrev_b32 v76, 16, v38
  v_and_b32 v79, 0xffff0000, v39
  v_lshlrev_b32 v78, 16, v39
  v_and_b32 v81, 0xffff0000, v40
  v_lshlrev_b32 v80, 16, v40
  v_and_b32 v83, 0xffff0000, v41
  v_lshlrev_b32 v82, 16, v41
  v_and_b32 v85, 0xffff0000, v42
  v_lshlrev_b32 v84, 16, v42
  v_and_b32 v87, 0xffff0000, v43
  v_lshlrev_b32 v86, 16, v43
  v_and_b32 v89, 0xffff0000, v44
  v_lshlrev_b32 v88, 16, v44
  v_and_b32 v91, 0xffff0000, v45
  v_lshlrev_b32 v90, 16, v45
  v_and_b32 v93, 0xffff0000, v46
  v_lshlrev_b32 v92, 16, v46
  v_and_b32 v95, 0xffff0000, v47
  v_lshlrev_b32 v94, 16, v47
  v_pk_mul_f32 v[64:65], v[64:65], v[12:13]
  v_cvt_pk_bf16_f32 v32, v64, v65
  v_pk_mul_f32 v[66:67], v[66:67], v[12:13]
  v_cvt_pk_bf16_f32 v33, v66, v67
  v_pk_mul_f32 v[68:69], v[68:69], v[12:13]
  v_cvt_pk_bf16_f32 v34, v68, v69
  v_pk_mul_f32 v[70:71], v[70:71], v[12:13]
  v_cvt_pk_bf16_f32 v35, v70, v71
  v_pk_mul_f32 v[72:73], v[72:73], v[12:13]
  v_cvt_pk_bf16_f32 v36, v72, v73
  v_pk_mul_f32 v[74:75], v[74:75], v[12:13]
  v_cvt_pk_bf16_f32 v37, v74, v75
  v_pk_mul_f32 v[76:77], v[76:77], v[12:13]
  v_cvt_pk_bf16_f32 v38, v76, v77
  v_pk_mul_f32 v[78:79], v[78:79], v[12:13]
  v_cvt_pk_bf16_f32 v39, v78, v79
  v_pk_mul_f32 v[80:81], v[80:81], v[12:13]
  v_cvt_pk_bf16_f32 v40, v80, v81
  v_pk_mul_f32 v[82:83], v[82:83], v[12:13]
  v_cvt_pk_bf16_f32 v41, v82, v83
  v_pk_mul_f32 v[84:85], v[84:85], v[12:13]
  v_cvt_pk_bf16_f32 v42, v84, v85
  v_pk_mul_f32 v[86:87], v[86:87], v[12:13]
  v_cvt_pk_bf16_f32 v43, v86, v87
  v_pk_mul_f32 v[88:89], v[88:89], v[12:13]
  v_cvt_pk_bf16_f32 v44, v88, v89
  v_pk_mul_f32 v[90:91], v[90:91], v[12:13]
  v_cvt_pk_bf16_f32 v45, v90, v91
  v_pk_mul_f32 v[92:93], v[92:93], v[12:13]
  v_cvt_pk_bf16_f32 v46, v92, v93
  v_pk_mul_f32 v[94:95], v[94:95], v[12:13]
  v_cvt_pk_bf16_f32 v47, v94, v95
  s_mov_b32 s63, 0x200000
  buffer_store_dwordx4 v[32:35], v4, s[36:39], s63 offen offset:64 sc1
  s_mov_b32 s63, 0x202000
  buffer_store_dwordx4 v[36:39], v4, s[36:39], s63 offen offset:64 sc1
  s_mov_b32 s63, 0x204000
  buffer_store_dwordx4 v[40:43], v4, s[36:39], s63 offen offset:64 sc1
  s_mov_b32 s63, 0x206000
  buffer_store_dwordx4 v[44:47], v4, s[36:39], s63 offen offset:64 sc1
  s_waitcnt vmcnt(0)
  s_barrier
  s_cmp_lg_u32 s34, 1
  s_cbranch_scc1 L_noinit_142
  v_mov_b32 v8, 1
  s_mov_b64 exec, 1
  buffer_atomic_add v8, off, s[40:43], 0 offset:244 sc0 sc1
  s_waitcnt vmcnt(0)
  v_readfirstlane_b32 s18, v8
  v_mov_b32 v8, 64
  s_cmp_eq_u32 s18, 63
  s_cselect_b32 s18, 8, 0x1000
  s_nop 1
  buffer_store_dword v8, off, s[40:43], s18 sc1
  s_mov_b64 exec, -1
L_noinit_142:
L_final_w:
  s_waitcnt vmcnt(0)
  s_lshl_b32 s18, s101, 3
  s_add_u32 s18, s18, s60
  s_mov_b32 s101, 1
  s_cmp_eq_u32 s18, 5
  s_cbranch_scc1 L_hid
  s_mov_b32 s48, s14
  s_mov_b32 s49, s15
  s_mov_b32 s50, 0x400000
  s_mov_b32 s51, 0x20000
  s_mov_b32 s52, s24
  s_mov_b32 s53, s25
  s_mov_b32 s54, 0x1c0000
  s_mov_b32 s55, 0x20000
  s_mov_b32 s56, s26
  s_mov_b32 s57, s27
  s_mov_b32 s58, 0x400
  s_mov_b32 s59, 0x20000
  s_lshl_b32 s68, s65, 6
  v_lshl_add_u32 v8, v2, 2, s68
  v_lshl_add_u32 v3, v1, 12, v8
  s_lshl_b32 s18, s34, 20
  v_add_u32 v3, s18, v3
  v_lshl_add_u32 v4, v1, 14, v8
  s_mul_i32 s18, s34, 0x70000
  v_add_u32 v4, s18, v4
  buffer_load_dword v9, v8, s[56:59], 0 offen
  s_and_b32 s77, s65, 15
  s_lshl_b32 s77, s77, 15
  s_mov_b32 s63, 0x0
  buffer_load_dword v16, v4, s[52:55], s63 offen offset:0
  buffer_load_dword v17, v4, s[52:55], s63 offen offset:1024
  buffer_load_dword v18, v4, s[52:55], s63 offen offset:2048
  buffer_load_dword v19, v4, s[52:55], s63 offen offset:3072
  s_mov_b32 s63, 0x1000
  buffer_load_dword v20, v4, s[52:55], s63 offen offset:0
  buffer_load_dword v21, v4, s[52:55], s63 offen offset:1024
  buffer_load_dword v22, v4, s[52:55], s63 offen offset:2048
  buffer_load_dword v23, v4, s[52:55], s63 offen offset:3072
  s_mov_b32 s63, 0x2000
  buffer_load_dword v24, v4, s[52:55], s63 offen offset:0
  buffer_load_dword v25, v4, s[52:55], s63 offen offset:1024
  buffer_load_dword v26, v4, s[52:55], s63 offen offset:2048
  buffer_load_dword v27, v4, s[52:55], s63 offen offset:3072
  s_mov_b32 s63, 0x3000
  buffer_load_dword v28, v4, s[52:55], s63 offen offset:0
  buffer_load_dword v29, v4, s[52:55], s63 offen offset:1024
  buffer_load_dword v30, v4, s[52:55], s63 offen offset:2048
  buffer_load_dword v31, v4, s[52:55], s63 offen offset:3072
  s_mov_b32 s63, 0x10000
  buffer_load_dword v32, v4, s[52:55], s63 offen offset:0
  buffer_load_dword v33, v4, s[52:55], s63 offen offset:1024
  buffer_load_dword v34, v4, s[52:55], s63 offen offset:2048
  buffer_load_dword v35, v4, s[52:55], s63 offen offset:3072
  s_mov_b32 s63, 0x11000
  buffer_load_dword v36, v4, s[52:55], s63 offen offset:0
  buffer_load_dword v37, v4, s[52:55], s63 offen offset:1024
  buffer_load_dword v38, v4, s[52:55], s63 offen offset:2048
  buffer_load_dword v39, v4, s[52:55], s63 offen offset:3072
  s_mov_b32 s63, 0x12000
  buffer_load_dword v40, v4, s[52:55], s63 offen offset:0
  buffer_load_dword v41, v4, s[52:55], s63 offen offset:1024
  buffer_load_dword v42, v4, s[52:55], s63 offen offset:2048
  buffer_load_dword v43, v4, s[52:55], s63 offen offset:3072
  s_mov_b32 s63, 0x13000
  buffer_load_dword v44, v4, s[52:55], s63 offen offset:0
  buffer_load_dword v45, v4, s[52:55], s63 offen offset:1024
  buffer_load_dword v46, v4, s[52:55], s63 offen offset:2048
  buffer_load_dword v47, v4, s[52:55], s63 offen offset:3072
  s_mov_b32 s63, 0x20000
  buffer_load_dword v48, v4, s[52:55], s63 offen offset:0
  buffer_load_dword v49, v4, s[52:55], s63 offen offset:1024
  buffer_load_dword v50, v4, s[52:55], s63 offen offset:2048
  buffer_load_dword v51, v4, s[52:55], s63 offen offset:3072
  s_mov_b32 s63, 0x21000
  buffer_load_dword v52, v4, s[52:55], s63 offen offset:0
  buffer_load_dword v53, v4, s[52:55], s63 offen offset:1024
  buffer_load_dword v54, v4, s[52:55], s63 offen offset:2048
  buffer_load_dword v55, v4, s[52:55], s63 offen offset:3072
  s_mov_b32 s63, 0x22000
  buffer_load_dword v56, v4, s[52:55], s63 offen offset:0
  buffer_load_dword v57, v4, s[52:55], s63 offen offset:1024
  buffer_load_dword v58, v4, s[52:55], s63 offen offset:2048
  buffer_load_dword v59, v4, s[52:55], s63 offen offset:3072
  s_mov_b32 s63, 0x23000
  buffer_load_dword v60, v4, s[52:55], s63 offen offset:0
  buffer_load_dword v61, v4, s[52:55], s63 offen offset:1024
  buffer_load_dword v62, v4, s[52:55], s63 offen offset:2048
  buffer_load_dword v63, v4, s[52:55], s63 offen offset:3072
  s_mov_b32 s63, 0x30000
  buffer_load_dword v64, v4, s[52:55], s63 offen offset:0
  buffer_load_dword v65, v4, s[52:55], s63 offen offset:1024
  buffer_load_dword v66, v4, s[52:55], s63 offen offset:2048
  buffer_load_dword v67, v4, s[52:55], s63 offen offset:3072
  s_mov_b32 s63, 0x31000
  buffer_load_dword v68, v4, s[52:55], s63 offen offset:0
  buffer_load_dword v69, v4, s[52:55], s63 offen offset:1024
  buffer_load_dword v70, v4, s[52:55], s63 offen offset:2048
  buffer_load_dword v71, v4, s[52:55], s63 offen offset:3072
  s_waitcnt vmcnt(56)
  v_lshlrev_b32 v14, 16, v9
  v_and_b32 v15, 0xffff0000, v9
  s_waitcnt vmcnt(54)
  v_perm_b32 v144, v17, v16, s16
  s_waitcnt vmcnt(52)
  v_perm_b32 v145, v19, v18, s16
  s_waitcnt vmcnt(50)
  v_perm_b32 v146, v21, v20, s16
  s_waitcnt vmcnt(48)
  v_perm_b32 v147, v23, v22, s16
  v_perm_b32 v148, v17, v16, s17
  v_perm_b32 v149, v19, v18, s17
  v_perm_b32 v150, v21, v20, s17
  v_perm_b32 v151, v23, v22, s17
  s_mov_b32 s63, 0x32000
  buffer_load_dword v16, v4, s[52:55], s63 offen offset:0
  buffer_load_dword v17, v4, s[52:55], s63 offen offset:1024
  buffer_load_dword v18, v4, s[52:55], s63 offen offset:2048
  buffer_load_dword v19, v4, s[52:55], s63 offen offset:3072
  s_mov_b32 s63, 0x33000
  buffer_load_dword v20, v4, s[52:55], s63 offen offset:0
  buffer_load_dword v21, v4, s[52:55], s63 offen offset:1024
  buffer_load_dword v22, v4, s[52:55], s63 offen offset:2048
  buffer_load_dword v23, v4, s[52:55], s63 offen offset:3072
  s_waitcnt vmcnt(54)
  v_perm_b32 v152, v25, v24, s16
  s_waitcnt vmcnt(52)
  v_perm_b32 v153, v27, v26, s16
  s_waitcnt vmcnt(50)
  v_perm_b32 v154, v29, v28, s16
  s_waitcnt vmcnt(48)
  v_perm_b32 v155, v31, v30, s16
  v_perm_b32 v156, v25, v24, s17
  v_perm_b32 v157, v27, v26, s17
  v_perm_b32 v158, v29, v28, s17
  v_perm_b32 v159, v31, v30, s17
  s_mov_b32 s63, 0x40000
  buffer_load_dword v24, v4, s[52:55], s63 offen offset:0
  buffer_load_dword v25, v4, s[52:55], s63 offen offset:1024
  buffer_load_dword v26, v4, s[52:55], s63 offen offset:2048
  buffer_load_dword v27, v4, s[52:55], s63 offen offset:3072
  s_mov_b32 s63, 0x41000
  buffer_load_dword v28, v4, s[52:55], s63 offen offset:0
  buffer_load_dword v29, v4, s[52:55], s63 offen offset:1024
  buffer_load_dword v30, v4, s[52:55], s63 offen offset:2048
  buffer_load_dword v31, v4, s[52:55], s63 offen offset:3072
  s_waitcnt vmcnt(54)
  v_perm_b32 v160, v33, v32, s16
  s_waitcnt vmcnt(52)
  v_perm_b32 v161, v35, v34, s16
  s_waitcnt vmcnt(50)
  v_perm_b32 v162, v37, v36, s16
  s_waitcnt vmcnt(48)
  v_perm_b32 v163, v39, v38, s16
  v_perm_b32 v164, v33, v32, s17
  v_perm_b32 v165, v35, v34, s17
  v_perm_b32 v166, v37, v36, s17
  v_perm_b32 v167, v39, v38, s17
  s_mov_b32 s63, 0x42000
  buffer_load_dword v32, v4, s[52:55], s63 offen offset:0
  buffer_load_dword v33, v4, s[52:55], s63 offen offset:1024
  buffer_load_dword v34, v4, s[52:55], s63 offen offset:2048
  buffer_load_dword v35, v4, s[52:55], s63 offen offset:3072
  s_mov_b32 s63, 0x43000
  buffer_load_dword v36, v4, s[52:55], s63 offen offset:0
  buffer_load_dword v37, v4, s[52:55], s63 offen offset:1024
  buffer_load_dword v38, v4, s[52:55], s63 offen offset:2048
  buffer_load_dword v39, v4, s[52:55], s63 offen offset:3072
  s_waitcnt vmcnt(54)
  v_perm_b32 v168, v41, v40, s16
  s_waitcnt vmcnt(52)
  v_perm_b32 v169, v43, v42, s16
  s_waitcnt vmcnt(50)
  v_perm_b32 v170, v45, v44, s16
  s_waitcnt vmcnt(48)
  v_perm_b32 v171, v47, v46, s16
  v_perm_b32 v172, v41, v40, s17
  v_perm_b32 v173, v43, v42, s17
  v_perm_b32 v174, v45, v44, s17
  v_perm_b32 v175, v47, v46, s17
  s_mov_b32 s63, 0x50000
  buffer_load_dword v40, v4, s[52:55], s63 offen offset:0
  buffer_load_dword v41, v4, s[52:55], s63 offen offset:1024
  buffer_load_dword v42, v4, s[52:55], s63 offen offset:2048
  buffer_load_dword v43, v4, s[52:55], s63 offen offset:3072
  s_mov_b32 s63, 0x51000
  buffer_load_dword v44, v4, s[52:55], s63 offen offset:0
  buffer_load_dword v45, v4, s[52:55], s63 offen offset:1024
  buffer_load_dword v46, v4, s[52:55], s63 offen offset:2048
  buffer_load_dword v47, v4, s[52:55], s63 offen offset:3072
  s_waitcnt vmcnt(54)
  v_perm_b32 v176, v49, v48, s16
  s_waitcnt vmcnt(52)
  v_perm_b32 v177, v51, v50, s16
  s_waitcnt vmcnt(50)
  v_perm_b32 v178, v53, v52, s16
  s_waitcnt vmcnt(48)
  v_perm_b32 v179, v55, v54, s16
  v_perm_b32 v180, v49, v48, s17
  v_perm_b32 v181, v51, v50, s17
  v_perm_b32 v182, v53, v52, s17
  v_perm_b32 v183, v55, v54, s17
  s_mov_b32 s63, 0x52000
  buffer_load_dword v48, v4, s[52:55], s63 offen offset:0
  buffer_load_dword v49, v4, s[52:55], s63 offen offset:1024
  buffer_load_dword v50, v4, s[52:55], s63 offen offset:2048
  buffer_load_dword v51, v4, s[52:55], s63 offen offset:3072
  s_mov_b32 s63, 0x53000
  buffer_load_dword v52, v4, s[52:55], s63 offen offset:0
  buffer_load_dword v53, v4, s[52:55], s63 offen offset:1024
  buffer_load_dword v54, v4, s[52:55], s63 offen offset:2048
  buffer_load_dword v55, v4, s[52:55], s63 offen offset:3072
  s_waitcnt vmcnt(54)
  v_perm_b32 v184, v57, v56, s16
  s_waitcnt vmcnt(52)
  v_perm_b32 v185, v59, v58, s16
  s_waitcnt vmcnt(50)
  v_perm_b32 v186, v61, v60, s16
  s_waitcnt vmcnt(48)
  v_perm_b32 v187, v63, v62, s16
  v_perm_b32 v188, v57, v56, s17
  v_perm_b32 v189, v59, v58, s17
  v_perm_b32 v190, v61, v60, s17
  v_perm_b32 v191, v63, v62, s17
  s_mov_b32 s63, 0x60000
  buffer_load_dword v56, v4, s[52:55], s63 offen offset:0
  buffer_load_dword v57, v4, s[52:55], s63 offen offset:1024
  buffer_load_dword v58, v4, s[52:55], s63 offen offset:2048
  buffer_load_dword v59, v4, s[52:55], s63 offen offset:3072
  s_mov_b32 s63, 0x61000
  buffer_load_dword v60, v4, s[52:55], s63 offen offset:0
  buffer_load_dword v61, v4, s[52:55], s63 offen offset:1024
  buffer_load_dword v62, v4, s[52:55], s63 offen offset:2048
  buffer_load_dword v63, v4, s[52:55], s63 offen offset:3072
  s_waitcnt vmcnt(54)
  v_perm_b32 v192, v65, v64, s16
  s_waitcnt vmcnt(52)
  v_perm_b32 v193, v67, v66, s16
  s_waitcnt vmcnt(50)
  v_perm_b32 v194, v69, v68, s16
  s_waitcnt vmcnt(48)
  v_perm_b32 v195, v71, v70, s16
  v_perm_b32 v196, v65, v64, s17
  v_perm_b32 v197, v67, v66, s17
  v_perm_b32 v198, v69, v68, s17
  v_perm_b32 v199, v71, v70, s17
  s_mov_b32 s63, 0x62000
  buffer_load_dword v64, v4, s[52:55], s63 offen offset:0
  buffer_load_dword v65, v4, s[52:55], s63 offen offset:1024
  buffer_load_dword v66, v4, s[52:55], s63 offen offset:2048
  buffer_load_dword v67, v4, s[52:55], s63 offen offset:3072
  s_mov_b32 s63, 0x63000
  buffer_load_dword v68, v4, s[52:55], s63 offen offset:0
  buffer_load_dword v69, v4, s[52:55], s63 offen offset:1024
  buffer_load_dword v70, v4, s[52:55], s63 offen offset:2048
  buffer_load_dword v71, v4, s[52:55], s63 offen offset:3072
  s_waitcnt vmcnt(54)
  v_perm_b32 v200, v17, v16, s16
  s_waitcnt vmcnt(52)
  v_perm_b32 v201, v19, v18, s16
  s_waitcnt vmcnt(50)
  v_perm_b32 v202, v21, v20, s16
  s_waitcnt vmcnt(48)
  v_perm_b32 v203, v23, v22, s16
  v_perm_b32 v204, v17, v16, s17
  v_perm_b32 v205, v19, v18, s17
  v_perm_b32 v206, v21, v20, s17
  v_perm_b32 v207, v23, v22, s17
  s_xor_b32 s63, s77, 0x0
  buffer_load_dword v16, v3, s[48:51], s63 offen offset:0
  buffer_load_dword v18, v3, s[48:51], s63 offen offset:1024
  buffer_load_dword v20, v3, s[48:51], s63 offen offset:2048
  buffer_load_dword v22, v3, s[48:51], s63 offen offset:3072
  s_xor_b32 s63, s77, 0x4000
  buffer_load_dword v17, v3, s[48:51], s63 offen offset:0
  buffer_load_dword v19, v3, s[48:51], s63 offen offset:1024
  buffer_load_dword v21, v3, s[48:51], s63 offen offset:2048
  buffer_load_dword v23, v3, s[48:51], s63 offen offset:3072
  s_waitcnt vmcnt(54)
  v_perm_b32 v208, v25, v24, s16
  s_waitcnt vmcnt(52)
  v_perm_b32 v209, v27, v26, s16
  s_waitcnt vmcnt(50)
  v_perm_b32 v210, v29, v28, s16
  s_waitcnt vmcnt(48)
  v_perm_b32 v211, v31, v30, s16
  v_perm_b32 v212, v25, v24, s17
  v_perm_b32 v213, v27, v26, s17
  v_perm_b32 v214, v29, v28, s17
  v_perm_b32 v215, v31, v30, s17
  s_xor_b32 s63, s77, 0x8000
  buffer_load_dword v24, v3, s[48:51], s63 offen offset:0
  buffer_load_dword v26, v3, s[48:51], s63 offen offset:1024
  buffer_load_dword v28, v3, s[48:51], s63 offen offset:2048
  buffer_load_dword v30, v3, s[48:51], s63 offen offset:3072
  s_xor_b32 s63, s77, 0xc000
  buffer_load_dword v25, v3, s[48:51], s63 offen offset:0
  buffer_load_dword v27, v3, s[48:51], s63 offen offset:1024
  buffer_load_dword v29, v3, s[48:51], s63 offen offset:2048
  buffer_load_dword v31, v3, s[48:51], s63 offen offset:3072
  s_waitcnt vmcnt(54)
  v_perm_b32 v216, v33, v32, s16
  s_waitcnt vmcnt(52)
  v_perm_b32 v217, v35, v34, s16
  s_waitcnt vmcnt(50)
  v_perm_b32 v218, v37, v36, s16
  s_waitcnt vmcnt(48)
  v_perm_b32 v219, v39, v38, s16
  v_perm_b32 v220, v33, v32, s17
  v_perm_b32 v221, v35, v34, s17
  v_perm_b32 v222, v37, v36, s17
  v_perm_b32 v223, v39, v38, s17
  s_xor_b32 s63, s77, 0x10000
  buffer_load_dword v32, v3, s[48:51], s63 offen offset:0
  buffer_load_dword v34, v3, s[48:51], s63 offen offset:1024
  buffer_load_dword v36, v3, s[48:51], s63 offen offset:2048
  buffer_load_dword v38, v3, s[48:51], s63 offen offset:3072
  s_xor_b32 s63, s77, 0x14000
  buffer_load_dword v33, v3, s[48:51], s63 offen offset:0
  buffer_load_dword v35, v3, s[48:51], s63 offen offset:1024
  buffer_load_dword v37, v3, s[48:51], s63 offen offset:2048
  buffer_load_dword v39, v3, s[48:51], s63 offen offset:3072
  s_waitcnt vmcnt(54)
  v_perm_b32 v224, v41, v40, s16
  s_waitcnt vmcnt(52)
  v_perm_b32 v225, v43, v42, s16
  s_waitcnt vmcnt(50)
  v_perm_b32 v226, v45, v44, s16
  s_waitcnt vmcnt(48)
  v_perm_b32 v227, v47, v46, s16
  v_perm_b32 v228, v41, v40, s17
  v_perm_b32 v229, v43, v42, s17
  v_perm_b32 v230, v45, v44, s17
  v_perm_b32 v231, v47, v46, s17
  s_xor_b32 s63, s77, 0x18000
  buffer_load_dword v40, v3, s[48:51], s63 offen offset:0
  buffer_load_dword v42, v3, s[48:51], s63 offen offset:1024
  buffer_load_dword v44, v3, s[48:51], s63 offen offset:2048
  buffer_load_dword v46, v3, s[48:51], s63 offen offset:3072
  s_xor_b32 s63, s77, 0x1c000
  buffer_load_dword v41, v3, s[48:51], s63 offen offset:0
  buffer_load_dword v43, v3, s[48:51], s63 offen offset:1024
  buffer_load_dword v45, v3, s[48:51], s63 offen offset:2048
  buffer_load_dword v47, v3, s[48:51], s63 offen offset:3072
  s_waitcnt vmcnt(54)
  v_perm_b32 v232, v49, v48, s16
  s_waitcnt vmcnt(52)
  v_perm_b32 v233, v51, v50, s16
  s_waitcnt vmcnt(50)
  v_perm_b32 v234, v53, v52, s16
  s_waitcnt vmcnt(48)
  v_perm_b32 v235, v55, v54, s16
  v_perm_b32 v236, v49, v48, s17
  v_perm_b32 v237, v51, v50, s17
  v_perm_b32 v238, v53, v52, s17
  v_perm_b32 v239, v55, v54, s17
  s_xor_b32 s63, s77, 0x20000
  buffer_load_dword v48, v3, s[48:51], s63 offen offset:0
  buffer_load_dword v50, v3, s[48:51], s63 offen offset:1024
  buffer_load_dword v52, v3, s[48:51], s63 offen offset:2048
  buffer_load_dword v54, v3, s[48:51], s63 offen offset:3072
  s_xor_b32 s63, s77, 0x24000
  buffer_load_dword v49, v3, s[48:51], s63 offen offset:0
  buffer_load_dword v51, v3, s[48:51], s63 offen offset:1024
  buffer_load_dword v53, v3, s[48:51], s63 offen offset:2048
  buffer_load_dword v55, v3, s[48:51], s63 offen offset:3072
  s_waitcnt vmcnt(54)
  v_perm_b32 v240, v57, v56, s16
  s_waitcnt vmcnt(52)
  v_perm_b32 v241, v59, v58, s16
  s_waitcnt vmcnt(50)
  v_perm_b32 v242, v61, v60, s16
  s_waitcnt vmcnt(48)
  v_perm_b32 v243, v63, v62, s16
  v_perm_b32 v244, v57, v56, s17
  v_perm_b32 v245, v59, v58, s17
  v_perm_b32 v246, v61, v60, s17
  v_perm_b32 v247, v63, v62, s17
  s_xor_b32 s63, s77, 0x28000
  buffer_load_dword v56, v3, s[48:51], s63 offen offset:0
  buffer_load_dword v58, v3, s[48:51], s63 offen offset:1024
  buffer_load_dword v60, v3, s[48:51], s63 offen offset:2048
  buffer_load_dword v62, v3, s[48:51], s63 offen offset:3072
  s_xor_b32 s63, s77, 0x2c000
  buffer_load_dword v57, v3, s[48:51], s63 offen offset:0
  buffer_load_dword v59, v3, s[48:51], s63 offen offset:1024
  buffer_load_dword v61, v3, s[48:51], s63 offen offset:2048
  buffer_load_dword v63, v3, s[48:51], s63 offen offset:3072
  s_waitcnt vmcnt(54)
  v_perm_b32 v248, v65, v64, s16
  s_waitcnt vmcnt(52)
  v_perm_b32 v249, v67, v66, s16
  s_waitcnt vmcnt(50)
  v_perm_b32 v250, v69, v68, s16
  s_waitcnt vmcnt(48)
  v_perm_b32 v251, v71, v70, s16
  v_perm_b32 v252, v65, v64, s17
  v_perm_b32 v253, v67, v66, s17
  v_perm_b32 v254, v69, v68, s17
  v_perm_b32 v255, v71, v70, s17
  s_xor_b32 s63, s77, 0x30000
  buffer_load_dword v64, v3, s[48:51], s63 offen offset:0
  buffer_load_dword v66, v3, s[48:51], s63 offen offset:1024
  buffer_load_dword v68, v3, s[48:51], s63 offen offset:2048
  buffer_load_dword v70, v3, s[48:51], s63 offen offset:3072
  s_xor_b32 s63, s77, 0x34000
  buffer_load_dword v65, v3, s[48:51], s63 offen offset:0
  buffer_load_dword v67, v3, s[48:51], s63 offen offset:1024
  buffer_load_dword v69, v3, s[48:51], s63 offen offset:2048
  buffer_load_dword v71, v3, s[48:51], s63 offen offset:3072
  s_waitcnt vmcnt(51)
  v_perm_b32 v80, v17, v16, s16
  s_waitcnt vmcnt(50)
  v_perm_b32 v81, v19, v18, s16
  s_waitcnt vmcnt(49)
  v_perm_b32 v82, v21, v20, s16
  s_waitcnt vmcnt(48)
  v_perm_b32 v83, v23, v22, s16
  v_perm_b32 v84, v17, v16, s17
  v_perm_b32 v85, v19, v18, s17
  v_perm_b32 v86, v21, v20, s17
  v_perm_b32 v87, v23, v22, s17
  v_accvgpr_write_b32 a0, v80
  v_accvgpr_write_b32 a1, v81
  v_accvgpr_write_b32 a2, v82
  v_accvgpr_write_b32 a3, v83
  v_accvgpr_write_b32 a4, v84
  v_accvgpr_write_b32 a5, v85
  v_accvgpr_write_b32 a6, v86
  v_accvgpr_write_b32 a7, v87
  s_xor_b32 s63, s77, 0x38000
  buffer_load_dword v16, v3, s[48:51], s63 offen offset:0
  buffer_load_dword v18, v3, s[48:51], s63 offen offset:1024
  buffer_load_dword v20, v3, s[48:51], s63 offen offset:2048
  buffer_load_dword v22, v3, s[48:51], s63 offen offset:3072
  s_xor_b32 s63, s77, 0x3c000
  buffer_load_dword v17, v3, s[48:51], s63 offen offset:0
  buffer_load_dword v19, v3, s[48:51], s63 offen offset:1024
  buffer_load_dword v21, v3, s[48:51], s63 offen offset:2048
  buffer_load_dword v23, v3, s[48:51], s63 offen offset:3072
  s_waitcnt vmcnt(51)
  v_perm_b32 v80, v25, v24, s16
  s_waitcnt vmcnt(50)
  v_perm_b32 v81, v27, v26, s16
  s_waitcnt vmcnt(49)
  v_perm_b32 v82, v29, v28, s16
  s_waitcnt vmcnt(48)
  v_perm_b32 v83, v31, v30, s16
  v_perm_b32 v84, v25, v24, s17
  v_perm_b32 v85, v27, v26, s17
  v_perm_b32 v86, v29, v28, s17
  v_perm_b32 v87, v31, v30, s17
  v_accvgpr_write_b32 a8, v80
  v_accvgpr_write_b32 a9, v81
  v_accvgpr_write_b32 a10, v82
  v_accvgpr_write_b32 a11, v83
  v_accvgpr_write_b32 a12, v84
  v_accvgpr_write_b32 a13, v85
  v_accvgpr_write_b32 a14, v86
  v_accvgpr_write_b32 a15, v87
  s_xor_b32 s63, s77, 0x40000
  buffer_load_dword v24, v3, s[48:51], s63 offen offset:0
  buffer_load_dword v26, v3, s[48:51], s63 offen offset:1024
  buffer_load_dword v28, v3, s[48:51], s63 offen offset:2048
  buffer_load_dword v30, v3, s[48:51], s63 offen offset:3072
  s_xor_b32 s63, s77, 0x44000
  buffer_load_dword v25, v3, s[48:51], s63 offen offset:0
  buffer_load_dword v27, v3, s[48:51], s63 offen offset:1024
  buffer_load_dword v29, v3, s[48:51], s63 offen offset:2048
  buffer_load_dword v31, v3, s[48:51], s63 offen offset:3072
  s_waitcnt vmcnt(51)
  v_perm_b32 v80, v33, v32, s16
  s_waitcnt vmcnt(50)
  v_perm_b32 v81, v35, v34, s16
  s_waitcnt vmcnt(49)
  v_perm_b32 v82, v37, v36, s16
  s_waitcnt vmcnt(48)
  v_perm_b32 v83, v39, v38, s16
  v_perm_b32 v84, v33, v32, s17
  v_perm_b32 v85, v35, v34, s17
  v_perm_b32 v86, v37, v36, s17
  v_perm_b32 v87, v39, v38, s17
  v_accvgpr_write_b32 a16, v80
  v_accvgpr_write_b32 a17, v81
  v_accvgpr_write_b32 a18, v82
  v_accvgpr_write_b32 a19, v83
  v_accvgpr_write_b32 a20, v84
  v_accvgpr_write_b32 a21, v85
  v_accvgpr_write_b32 a22, v86
  v_accvgpr_write_b32 a23, v87
  s_xor_b32 s63, s77, 0x48000
  buffer_load_dword v32, v3, s[48:51], s63 offen offset:0
  buffer_load_dword v34, v3, s[48:51], s63 offen offset:1024
  buffer_load_dword v36, v3, s[48:51], s63 offen offset:2048
  buffer_load_dword v38, v3, s[48:51], s63 offen offset:3072
  s_xor_b32 s63, s77, 0x4c000
  buffer_load_dword v33, v3, s[48:51], s63 offen offset:0
  buffer_load_dword v35, v3, s[48:51], s63 offen offset:1024
  buffer_load_dword v37, v3, s[48:51], s63 offen offset:2048
  buffer_load_dword v39, v3, s[48:51], s63 offen offset:3072
  s_waitcnt vmcnt(51)
  v_perm_b32 v80, v41, v40, s16
  s_waitcnt vmcnt(50)
  v_perm_b32 v81, v43, v42, s16
  s_waitcnt vmcnt(49)
  v_perm_b32 v82, v45, v44, s16
  s_waitcnt vmcnt(48)
  v_perm_b32 v83, v47, v46, s16
  v_perm_b32 v84, v41, v40, s17
  v_perm_b32 v85, v43, v42, s17
  v_perm_b32 v86, v45, v44, s17
  v_perm_b32 v87, v47, v46, s17
  v_accvgpr_write_b32 a24, v80
  v_accvgpr_write_b32 a25, v81
  v_accvgpr_write_b32 a26, v82
  v_accvgpr_write_b32 a27, v83
  v_accvgpr_write_b32 a28, v84
  v_accvgpr_write_b32 a29, v85
  v_accvgpr_write_b32 a30, v86
  v_accvgpr_write_b32 a31, v87
  s_xor_b32 s63, s77, 0x50000
  buffer_load_dword v40, v3, s[48:51], s63 offen offset:0
  buffer_load_dword v42, v3, s[48:51], s63 offen offset:1024
  buffer_load_dword v44, v3, s[48:51], s63 offen offset:2048
  buffer_load_dword v46, v3, s[48:51], s63 offen offset:3072
  s_xor_b32 s63, s77, 0x54000
  buffer_load_dword v41, v3, s[48:51], s63 offen offset:0
  buffer_load_dword v43, v3, s[48:51], s63 offen offset:1024
  buffer_load_dword v45, v3, s[48:51], s63 offen offset:2048
  buffer_load_dword v47, v3, s[48:51], s63 offen offset:3072
  s_waitcnt vmcnt(51)
  v_perm_b32 v80, v49, v48, s16
  s_waitcnt vmcnt(50)
  v_perm_b32 v81, v51, v50, s16
  s_waitcnt vmcnt(49)
  v_perm_b32 v82, v53, v52, s16
  s_waitcnt vmcnt(48)
  v_perm_b32 v83, v55, v54, s16
  v_perm_b32 v84, v49, v48, s17
  v_perm_b32 v85, v51, v50, s17
  v_perm_b32 v86, v53, v52, s17
  v_perm_b32 v87, v55, v54, s17
  v_accvgpr_write_b32 a32, v80
  v_accvgpr_write_b32 a33, v81
  v_accvgpr_write_b32 a34, v82
  v_accvgpr_write_b32 a35, v83
  v_accvgpr_write_b32 a36, v84
  v_accvgpr_write_b32 a37, v85
  v_accvgpr_write_b32 a38, v86
  v_accvgpr_write_b32 a39, v87
  s_xor_b32 s63, s77, 0x58000
  buffer_load_dword v48, v3, s[48:51], s63 offen offset:0
  buffer_load_dword v50, v3, s[48:51], s63 offen offset:1024
  buffer_load_dword v52, v3, s[48:51], s63 offen offset:2048
  buffer_load_dword v54, v3, s[48:51], s63 offen offset:3072
  s_xor_b32 s63, s77, 0x5c000
  buffer_load_dword v49, v3, s[48:51], s63 offen offset:0
  buffer_load_dword v51, v3, s[48:51], s63 offen offset:1024
  buffer_load_dword v53, v3, s[48:51], s63 offen offset:2048
  buffer_load_dword v55, v3, s[48:51], s63 offen offset:3072
  s_waitcnt vmcnt(51)
  v_perm_b32 v80, v57, v56, s16
  s_waitcnt vmcnt(50)
  v_perm_b32 v81, v59, v58, s16
  s_waitcnt vmcnt(49)
  v_perm_b32 v82, v61, v60, s16
  s_waitcnt vmcnt(48)
  v_perm_b32 v83, v63, v62, s16
  v_perm_b32 v84, v57, v56, s17
  v_perm_b32 v85, v59, v58, s17
  v_perm_b32 v86, v61, v60, s17
  v_perm_b32 v87, v63, v62, s17
  v_accvgpr_write_b32 a40, v80
  v_accvgpr_write_b32 a41, v81
  v_accvgpr_write_b32 a42, v82
  v_accvgpr_write_b32 a43, v83
  v_accvgpr_write_b32 a44, v84
  v_accvgpr_write_b32 a45, v85
  v_accvgpr_write_b32 a46, v86
  v_accvgpr_write_b32 a47, v87
  s_xor_b32 s63, s77, 0x60000
  buffer_load_dword v56, v3, s[48:51], s63 offen offset:0
  buffer_load_dword v58, v3, s[48:51], s63 offen offset:1024
  buffer_load_dword v60, v3, s[48:51], s63 offen offset:2048
  buffer_load_dword v62, v3, s[48:51], s63 offen offset:3072
  s_xor_b32 s63, s77, 0x64000
  buffer_load_dword v57, v3, s[48:51], s63 offen offset:0
  buffer_load_dword v59, v3, s[48:51], s63 offen offset:1024
  buffer_load_dword v61, v3, s[48:51], s63 offen offset:2048
  buffer_load_dword v63, v3, s[48:51], s63 offen offset:3072
  s_waitcnt vmcnt(51)
  v_perm_b32 v80, v65, v64, s16
  s_waitcnt vmcnt(50)
  v_perm_b32 v81, v67, v66, s16
  s_waitcnt vmcnt(49)
  v_perm_b32 v82, v69, v68, s16
  s_waitcnt vmcnt(48)
  v_perm_b32 v83, v71, v70, s16
  v_perm_b32 v84, v65, v64, s17
  v_perm_b32 v85, v67, v66, s17
  v_perm_b32 v86, v69, v68, s17
  v_perm_b32 v87, v71, v70, s17
  v_accvgpr_write_b32 a48, v80
  v_accvgpr_write_b32 a49, v81
  v_accvgpr_write_b32 a50, v82
  v_accvgpr_write_b32 a51, v83
  v_accvgpr_write_b32 a52, v84
  v_accvgpr_write_b32 a53, v85
  v_accvgpr_write_b32 a54, v86
  v_accvgpr_write_b32 a55, v87
  s_xor_b32 s63, s77, 0x68000
  buffer_load_dword v64, v3, s[48:51], s63 offen offset:0
  buffer_load_dword v66, v3, s[48:51], s63 offen offset:1024
  buffer_load_dword v68, v3, s[48:51], s63 offen offset:2048
  buffer_load_dword v70, v3, s[48:51], s63 offen offset:3072
  s_xor_b32 s63, s77, 0x6c000
  buffer_load_dword v65, v3, s[48:51], s63 offen offset:0
  buffer_load_dword v67, v3, s[48:51], s63 offen offset:1024
  buffer_load_dword v69, v3, s[48:51], s63 offen offset:2048
  buffer_load_dword v71, v3, s[48:51], s63 offen offset:3072
  s_waitcnt vmcnt(51)
  v_perm_b32 v80, v17, v16, s16
  s_waitcnt vmcnt(50)
  v_perm_b32 v81, v19, v18, s16
  s_waitcnt vmcnt(49)
  v_perm_b32 v82, v21, v20, s16
  s_waitcnt vmcnt(48)
  v_perm_b32 v83, v23, v22, s16
  v_perm_b32 v84, v17, v16, s17
  v_perm_b32 v85, v19, v18, s17
  v_perm_b32 v86, v21, v20, s17
  v_perm_b32 v87, v23, v22, s17
  v_accvgpr_write_b32 a56, v80
  v_accvgpr_write_b32 a57, v81
  v_accvgpr_write_b32 a58, v82
  v_accvgpr_write_b32 a59, v83
  v_accvgpr_write_b32 a60, v84
  v_accvgpr_write_b32 a61, v85
  v_accvgpr_write_b32 a62, v86
  v_accvgpr_write_b32 a63, v87
  s_xor_b32 s63, s77, 0x70000
  buffer_load_dword v16, v3, s[48:51], s63 offen offset:0
  buffer_load_dword v18, v3, s[48:51], s63 offen offset:1024
  buffer_load_dword v20, v3, s[48:51], s63 offen offset:2048
  buffer_load_dword v22, v3, s[48:51], s63 offen offset:3072
  s_xor_b32 s63, s77, 0x74000
  buffer_load_dword v17, v3, s[48:51], s63 offen offset:0
  buffer_load_dword v19, v3, s[48:51], s63 offen offset:1024
  buffer_load_dword v21, v3, s[48:51], s63 offen offset:2048
  buffer_load_dword v23, v3, s[48:51], s63 offen offset:3072
  s_waitcnt vmcnt(51)
  v_perm_b32 v80, v25, v24, s16
  s_waitcnt vmcnt(50)
  v_perm_b32 v81, v27, v26, s16
  s_waitcnt vmcnt(49)
  v_perm_b32 v82, v29, v28, s16
  s_waitcnt vmcnt(48)
  v_perm_b32 v83, v31, v30, s16
  v_perm_b32 v84, v25, v24, s17
  v_perm_b32 v85, v27, v26, s17
  v_perm_b32 v86, v29, v28, s17
  v_perm_b32 v87, v31, v30, s17
  v_accvgpr_write_b32 a64, v80
  v_accvgpr_write_b32 a65, v81
  v_accvgpr_write_b32 a66, v82
  v_accvgpr_write_b32 a67, v83
  v_accvgpr_write_b32 a68, v84
  v_accvgpr_write_b32 a69, v85
  v_accvgpr_write_b32 a70, v86
  v_accvgpr_write_b32 a71, v87
  s_xor_b32 s63, s77, 0x78000
  buffer_load_dword v24, v3, s[48:51], s63 offen offset:0
  buffer_load_dword v26, v3, s[48:51], s63 offen offset:1024
  buffer_load_dword v28, v3, s[48:51], s63 offen offset:2048
  buffer_load_dword v30, v3, s[48:51], s63 offen offset:3072
  s_xor_b32 s63, s77, 0x7c000
  buffer_load_dword v25, v3, s[48:51], s63 offen offset:0
  buffer_load_dword v27, v3, s[48:51], s63 offen offset:1024
  buffer_load_dword v29, v3, s[48:51], s63 offen offset:2048
  buffer_load_dword v31, v3, s[48:51], s63 offen offset:3072
  s_waitcnt vmcnt(51)
  v_perm_b32 v80, v33, v32, s16
  s_waitcnt vmcnt(50)
  v_perm_b32 v81, v35, v34, s16
  s_waitcnt vmcnt(49)
  v_perm_b32 v82, v37, v36, s16
  s_waitcnt vmcnt(48)
  v_perm_b32 v83, v39, v38, s16
  v_perm_b32 v84, v33, v32, s17
  v_perm_b32 v85, v35, v34, s17
  v_perm_b32 v86, v37, v36, s17
  v_perm_b32 v87, v39, v38, s17
  v_accvgpr_write_b32 a72, v80
  v_accvgpr_write_b32 a73, v81
  v_accvgpr_write_b32 a74, v82
  v_accvgpr_write_b32 a75, v83
  v_accvgpr_write_b32 a76, v84
  v_accvgpr_write_b32 a77, v85
  v_accvgpr_write_b32 a78, v86
  v_accvgpr_write_b32 a79, v87
  s_xor_b32 s63, s77, 0x80000
  buffer_load_dword v32, v3, s[48:51], s63 offen offset:0
  buffer_load_dword v34, v3, s[48:51], s63 offen offset:1024
  buffer_load_dword v36, v3, s[48:51], s63 offen offset:2048
  buffer_load_dword v38, v3, s[48:51], s63 offen offset:3072
  s_xor_b32 s63, s77, 0x84000
  buffer_load_dword v33, v3, s[48:51], s63 offen offset:0
  buffer_load_dword v35, v3, s[48:51], s63 offen offset:1024
  buffer_load_dword v37, v3, s[48:51], s63 offen offset:2048
  buffer_load_dword v39, v3, s[48:51], s63 offen offset:3072
  s_waitcnt vmcnt(51)
  v_perm_b32 v80, v41, v40, s16
  s_waitcnt vmcnt(50)
  v_perm_b32 v81, v43, v42, s16
  s_waitcnt vmcnt(49)
  v_perm_b32 v82, v45, v44, s16
  s_waitcnt vmcnt(48)
  v_perm_b32 v83, v47, v46, s16
  v_perm_b32 v84, v41, v40, s17
  v_perm_b32 v85, v43, v42, s17
  v_perm_b32 v86, v45, v44, s17
  v_perm_b32 v87, v47, v46, s17
  v_accvgpr_write_b32 a80, v80
  v_accvgpr_write_b32 a81, v81
  v_accvgpr_write_b32 a82, v82
  v_accvgpr_write_b32 a83, v83
  v_accvgpr_write_b32 a84, v84
  v_accvgpr_write_b32 a85, v85
  v_accvgpr_write_b32 a86, v86
  v_accvgpr_write_b32 a87, v87
  s_xor_b32 s63, s77, 0x88000
  buffer_load_dword v40, v3, s[48:51], s63 offen offset:0
  buffer_load_dword v42, v3, s[48:51], s63 offen offset:1024
  buffer_load_dword v44, v3, s[48:51], s63 offen offset:2048
  buffer_load_dword v46, v3, s[48:51], s63 offen offset:3072
  s_xor_b32 s63, s77, 0x8c000
  buffer_load_dword v41, v3, s[48:51], s63 offen offset:0
  buffer_load_dword v43, v3, s[48:51], s63 offen offset:1024
  buffer_load_dword v45, v3, s[48:51], s63 offen offset:2048
  buffer_load_dword v47, v3, s[48:51], s63 offen offset:3072
  s_waitcnt vmcnt(51)
  v_perm_b32 v80, v49, v48, s16
  s_waitcnt vmcnt(50)
  v_perm_b32 v81, v51, v50, s16
  s_waitcnt vmcnt(49)
  v_perm_b32 v82, v53, v52, s16
  s_waitcnt vmcnt(48)
  v_perm_b32 v83, v55, v54, s16
  v_perm_b32 v84, v49, v48, s17
  v_perm_b32 v85, v51, v50, s17
  v_perm_b32 v86, v53, v52, s17
  v_perm_b32 v87, v55, v54, s17
  v_accvgpr_write_b32 a88, v80
  v_accvgpr_write_b32 a89, v81
  v_accvgpr_write_b32 a90, v82
  v_accvgpr_write_b32 a91, v83
  v_accvgpr_write_b32 a92, v84
  v_accvgpr_write_b32 a93, v85
  v_accvgpr_write_b32 a94, v86
  v_accvgpr_write_b32 a95, v87
  s_xor_b32 s63, s77, 0x90000
  buffer_load_dword v48, v3, s[48:51], s63 offen offset:0
  buffer_load_dword v50, v3, s[48:51], s63 offen offset:1024
  buffer_load_dword v52, v3, s[48:51], s63 offen offset:2048
  buffer_load_dword v54, v3, s[48:51], s63 offen offset:3072
  s_xor_b32 s63, s77, 0x94000
  buffer_load_dword v49, v3, s[48:51], s63 offen offset:0
  buffer_load_dword v51, v3, s[48:51], s63 offen offset:1024
  buffer_load_dword v53, v3, s[48:51], s63 offen offset:2048
  buffer_load_dword v55, v3, s[48:51], s63 offen offset:3072
  s_waitcnt vmcnt(51)
  v_perm_b32 v80, v57, v56, s16
  s_waitcnt vmcnt(50)
  v_perm_b32 v81, v59, v58, s16
  s_waitcnt vmcnt(49)
  v_perm_b32 v82, v61, v60, s16
  s_waitcnt vmcnt(48)
  v_perm_b32 v83, v63, v62, s16
  v_perm_b32 v84, v57, v56, s17
  v_perm_b32 v85, v59, v58, s17
  v_perm_b32 v86, v61, v60, s17
  v_perm_b32 v87, v63, v62, s17
  v_accvgpr_write_b32 a96, v80
  v_accvgpr_write_b32 a97, v81
  v_accvgpr_write_b32 a98, v82
  v_accvgpr_write_b32 a99, v83
  v_accvgpr_write_b32 a100, v84
  v_accvgpr_write_b32 a101, v85
  v_accvgpr_write_b32 a102, v86
  v_accvgpr_write_b32 a103, v87
  s_xor_b32 s63, s77, 0x98000
  buffer_load_dword v56, v3, s[48:51], s63 offen offset:0
  buffer_load_dword v58, v3, s[48:51], s63 offen offset:1024
  buffer_load_dword v60, v3, s[48:51], s63 offen offset:2048
  buffer_load_dword v62, v3, s[48:51], s63 offen offset:3072
  s_xor_b32 s63, s77, 0x9c000
  buffer_load_dword v57, v3, s[48:51], s63 offen offset:0
  buffer_load_dword v59, v3, s[48:51], s63 offen offset:1024
  buffer_load_dword v61, v3, s[48:51], s63 offen offset:2048
  buffer_load_dword v63, v3, s[48:51], s63 offen offset:3072
  s_waitcnt vmcnt(51)
  v_perm_b32 v80, v65, v64, s16
  s_waitcnt vmcnt(50)
  v_perm_b32 v81, v67, v66, s16
  s_waitcnt vmcnt(49)
  v_perm_b32 v82, v69, v68, s16
  s_waitcnt vmcnt(48)
  v_perm_b32 v83, v71, v70, s16
  v_perm_b32 v84, v65, v64, s17
  v_perm_b32 v85, v67, v66, s17
  v_perm_b32 v86, v69, v68, s17
  v_perm_b32 v87, v71, v70, s17
  v_accvgpr_write_b32 a104, v80
  v_accvgpr_write_b32 a105, v81
  v_accvgpr_write_b32 a106, v82
  v_accvgpr_write_b32 a107, v83
  v_accvgpr_write_b32 a108, v84
  v_accvgpr_write_b32 a109, v85
  v_accvgpr_write_b32 a110, v86
  v_accvgpr_write_b32 a111, v87
  s_xor_b32 s63, s77, 0xa0000
  buffer_load_dword v64, v3, s[48:51], s63 offen offset:0
  buffer_load_dword v66, v3, s[48:51], s63 offen offset:1024
  buffer_load_dword v68, v3, s[48:51], s63 offen offset:2048
  buffer_load_dword v70, v3, s[48:51], s63 offen offset:3072
  s_xor_b32 s63, s77, 0xa4000
  buffer_load_dword v65, v3, s[48:51], s63 offen offset:0
  buffer_load_dword v67, v3, s[48:51], s63 offen offset:1024
  buffer_load_dword v69, v3, s[48:51], s63 offen offset:2048
  buffer_load_dword v71, v3, s[48:51], s63 offen offset:3072
  s_waitcnt vmcnt(51)
  v_perm_b32 v80, v17, v16, s16
  s_waitcnt vmcnt(50)
  v_perm_b32 v81, v19, v18, s16
  s_waitcnt vmcnt(49)
  v_perm_b32 v82, v21, v20, s16
  s_waitcnt vmcnt(48)
  v_perm_b32 v83, v23, v22, s16
  v_perm_b32 v84, v17, v16, s17
  v_perm_b32 v85, v19, v18, s17
  v_perm_b32 v86, v21, v20, s17
  v_perm_b32 v87, v23, v22, s17
  v_accvgpr_write_b32 a112, v80
  v_accvgpr_write_b32 a113, v81
  v_accvgpr_write_b32 a114, v82
  v_accvgpr_write_b32 a115, v83
  v_accvgpr_write_b32 a116, v84
  v_accvgpr_write_b32 a117, v85
  v_accvgpr_write_b32 a118, v86
  v_accvgpr_write_b32 a119, v87
  s_xor_b32 s63, s77, 0xa8000
  buffer_load_dword v16, v3, s[48:51], s63 offen offset:0
  buffer_load_dword v18, v3, s[48:51], s63 offen offset:1024
  buffer_load_dword v20, v3, s[48:51], s63 offen offset:2048
  buffer_load_dword v22, v3, s[48:51], s63 offen offset:3072
  s_xor_b32 s63, s77, 0xac000
  buffer_load_dword v17, v3, s[48:51], s63 offen offset:0
  buffer_load_dword v19, v3, s[48:51], s63 offen offset:1024
  buffer_load_dword v21, v3, s[48:51], s63 offen offset:2048
  buffer_load_dword v23, v3, s[48:51], s63 offen offset:3072
  s_waitcnt vmcnt(51)
  v_perm_b32 v80, v25, v24, s16
  s_waitcnt vmcnt(50)
  v_perm_b32 v81, v27, v26, s16
  s_waitcnt vmcnt(49)
  v_perm_b32 v82, v29, v28, s16
  s_waitcnt vmcnt(48)
  v_perm_b32 v83, v31, v30, s16
  v_perm_b32 v84, v25, v24, s17
  v_perm_b32 v85, v27, v26, s17
  v_perm_b32 v86, v29, v28, s17
  v_perm_b32 v87, v31, v30, s17
  v_accvgpr_write_b32 a120, v80
  v_accvgpr_write_b32 a121, v81
  v_accvgpr_write_b32 a122, v82
  v_accvgpr_write_b32 a123, v83
  v_accvgpr_write_b32 a124, v84
  v_accvgpr_write_b32 a125, v85
  v_accvgpr_write_b32 a126, v86
  v_accvgpr_write_b32 a127, v87
  s_xor_b32 s63, s77, 0xb0000
  buffer_load_dword v24, v3, s[48:51], s63 offen offset:0
  buffer_load_dword v26, v3, s[48:51], s63 offen offset:1024
  buffer_load_dword v28, v3, s[48:51], s63 offen offset:2048
  buffer_load_dword v30, v3, s[48:51], s63 offen offset:3072
  s_xor_b32 s63, s77, 0xb4000
  buffer_load_dword v25, v3, s[48:51], s63 offen offset:0
  buffer_load_dword v27, v3, s[48:51], s63 offen offset:1024
  buffer_load_dword v29, v3, s[48:51], s63 offen offset:2048
  buffer_load_dword v31, v3, s[48:51], s63 offen offset:3072
  s_waitcnt vmcnt(51)
  v_perm_b32 v80, v33, v32, s16
  s_waitcnt vmcnt(50)
  v_perm_b32 v81, v35, v34, s16
  s_waitcnt vmcnt(49)
  v_perm_b32 v82, v37, v36, s16
  s_waitcnt vmcnt(48)
  v_perm_b32 v83, v39, v38, s16
  v_perm_b32 v84, v33, v32, s17
  v_perm_b32 v85, v35, v34, s17
  v_perm_b32 v86, v37, v36, s17
  v_perm_b32 v87, v39, v38, s17
  v_accvgpr_write_b32 a128, v80
  v_accvgpr_write_b32 a129, v81
  v_accvgpr_write_b32 a130, v82
  v_accvgpr_write_b32 a131, v83
  v_accvgpr_write_b32 a132, v84
  v_accvgpr_write_b32 a133, v85
  v_accvgpr_write_b32 a134, v86
  v_accvgpr_write_b32 a135, v87
  s_xor_b32 s63, s77, 0xb8000
  buffer_load_dword v32, v3, s[48:51], s63 offen offset:0
  buffer_load_dword v34, v3, s[48:51], s63 offen offset:1024
  buffer_load_dword v36, v3, s[48:51], s63 offen offset:2048
  buffer_load_dword v38, v3, s[48:51], s63 offen offset:3072
  s_xor_b32 s63, s77, 0xbc000
  buffer_load_dword v33, v3, s[48:51], s63 offen offset:0
  buffer_load_dword v35, v3, s[48:51], s63 offen offset:1024
  buffer_load_dword v37, v3, s[48:51], s63 offen offset:2048
  buffer_load_dword v39, v3, s[48:51], s63 offen offset:3072
  s_waitcnt vmcnt(51)
  v_perm_b32 v80, v41, v40, s16
  s_waitcnt vmcnt(50)
  v_perm_b32 v81, v43, v42, s16
  s_waitcnt vmcnt(49)
  v_perm_b32 v82, v45, v44, s16
  s_waitcnt vmcnt(48)
  v_perm_b32 v83, v47, v46, s16
  v_perm_b32 v84, v41, v40, s17
  v_perm_b32 v85, v43, v42, s17
  v_perm_b32 v86, v45, v44, s17
  v_perm_b32 v87, v47, v46, s17
  v_accvgpr_write_b32 a136, v80
  v_accvgpr_write_b32 a137, v81
  v_accvgpr_write_b32 a138, v82
  v_accvgpr_write_b32 a139, v83
  v_accvgpr_write_b32 a140, v84
  v_accvgpr_write_b32 a141, v85
  v_accvgpr_write_b32 a142, v86
  v_accvgpr_write_b32 a143, v87
  s_xor_b32 s63, s77, 0xc0000
  buffer_load_dword v40, v3, s[48:51], s63 offen offset:0
  buffer_load_dword v42, v3, s[48:51], s63 offen offset:1024
  buffer_load_dword v44, v3, s[48:51], s63 offen offset:2048
  buffer_load_dword v46, v3, s[48:51], s63 offen offset:3072
  s_xor_b32 s63, s77, 0xc4000
  buffer_load_dword v41, v3, s[48:51], s63 offen offset:0
  buffer_load_dword v43, v3, s[48:51], s63 offen offset:1024
  buffer_load_dword v45, v3, s[48:51], s63 offen offset:2048
  buffer_load_dword v47, v3, s[48:51], s63 offen offset:3072
  s_waitcnt vmcnt(51)
  v_perm_b32 v80, v49, v48, s16
  s_waitcnt vmcnt(50)
  v_perm_b32 v81, v51, v50, s16
  s_waitcnt vmcnt(49)
  v_perm_b32 v82, v53, v52, s16
  s_waitcnt vmcnt(48)
  v_perm_b32 v83, v55, v54, s16
  v_perm_b32 v84, v49, v48, s17
  v_perm_b32 v85, v51, v50, s17
  v_perm_b32 v86, v53, v52, s17
  v_perm_b32 v87, v55, v54, s17
  v_accvgpr_write_b32 a144, v80
  v_accvgpr_write_b32 a145, v81
  v_accvgpr_write_b32 a146, v82
  v_accvgpr_write_b32 a147, v83
  v_accvgpr_write_b32 a148, v84
  v_accvgpr_write_b32 a149, v85
  v_accvgpr_write_b32 a150, v86
  v_accvgpr_write_b32 a151, v87
  s_xor_b32 s63, s77, 0xc8000
  buffer_load_dword v48, v3, s[48:51], s63 offen offset:0
  buffer_load_dword v50, v3, s[48:51], s63 offen offset:1024
  buffer_load_dword v52, v3, s[48:51], s63 offen offset:2048
  buffer_load_dword v54, v3, s[48:51], s63 offen offset:3072
  s_xor_b32 s63, s77, 0xcc000
  buffer_load_dword v49, v3, s[48:51], s63 offen offset:0
  buffer_load_dword v51, v3, s[48:51], s63 offen offset:1024
  buffer_load_dword v53, v3, s[48:51], s63 offen offset:2048
  buffer_load_dword v55, v3, s[48:51], s63 offen offset:3072
  s_waitcnt vmcnt(51)
  v_perm_b32 v80, v57, v56, s16
  s_waitcnt vmcnt(50)
  v_perm_b32 v81, v59, v58, s16
  s_waitcnt vmcnt(49)
  v_perm_b32 v82, v61, v60, s16
  s_waitcnt vmcnt(48)
  v_perm_b32 v83, v63, v62, s16
  v_perm_b32 v84, v57, v56, s17
  v_perm_b32 v85, v59, v58, s17
  v_perm_b32 v86, v61, v60, s17
  v_perm_b32 v87, v63, v62, s17
  v_accvgpr_write_b32 a152, v80
  v_accvgpr_write_b32 a153, v81
  v_accvgpr_write_b32 a154, v82
  v_accvgpr_write_b32 a155, v83
  v_accvgpr_write_b32 a156, v84
  v_accvgpr_write_b32 a157, v85
  v_accvgpr_write_b32 a158, v86
  v_accvgpr_write_b32 a159, v87
  s_xor_b32 s63, s77, 0xd0000
  buffer_load_dword v56, v3, s[48:51], s63 offen offset:0
  buffer_load_dword v58, v3, s[48:51], s63 offen offset:1024
  buffer_load_dword v60, v3, s[48:51], s63 offen offset:2048
  buffer_load_dword v62, v3, s[48:51], s63 offen offset:3072
  s_xor_b32 s63, s77, 0xd4000
  buffer_load_dword v57, v3, s[48:51], s63 offen offset:0
  buffer_load_dword v59, v3, s[48:51], s63 offen offset:1024
  buffer_load_dword v61, v3, s[48:51], s63 offen offset:2048
  buffer_load_dword v63, v3, s[48:51], s63 offen offset:3072
  s_waitcnt vmcnt(51)
  v_perm_b32 v80, v65, v64, s16
  s_waitcnt vmcnt(50)
  v_perm_b32 v81, v67, v66, s16
  s_waitcnt vmcnt(49)
  v_perm_b32 v82, v69, v68, s16
  s_waitcnt vmcnt(48)
  v_perm_b32 v83, v71, v70, s16
  v_perm_b32 v84, v65, v64, s17
  v_perm_b32 v85, v67, v66, s17
  v_perm_b32 v86, v69, v68, s17
  v_perm_b32 v87, v71, v70, s17
  v_accvgpr_write_b32 a160, v80
  v_accvgpr_write_b32 a161, v81
  v_accvgpr_write_b32 a162, v82
  v_accvgpr_write_b32 a163, v83
  v_accvgpr_write_b32 a164, v84
  v_accvgpr_write_b32 a165, v85
  v_accvgpr_write_b32 a166, v86
  v_accvgpr_write_b32 a167, v87
  s_xor_b32 s63, s77, 0xd8000
  buffer_load_dword v64, v3, s[48:51], s63 offen offset:0
  buffer_load_dword v66, v3, s[48:51], s63 offen offset:1024
  buffer_load_dword v68, v3, s[48:51], s63 offen offset:2048
  buffer_load_dword v70, v3, s[48:51], s63 offen offset:3072
  s_xor_b32 s63, s77, 0xdc000
  buffer_load_dword v65, v3, s[48:51], s63 offen offset:0
  buffer_load_dword v67, v3, s[48:51], s63 offen offset:1024
  buffer_load_dword v69, v3, s[48:51], s63 offen offset:2048
  buffer_load_dword v71, v3, s[48:51], s63 offen offset:3072
  s_waitcnt vmcnt(51)
  v_perm_b32 v80, v17, v16, s16
  s_waitcnt vmcnt(50)
  v_perm_b32 v81, v19, v18, s16
  s_waitcnt vmcnt(49)
  v_perm_b32 v82, v21, v20, s16
  s_waitcnt vmcnt(48)
  v_perm_b32 v83, v23, v22, s16
  v_perm_b32 v84, v17, v16, s17
  v_perm_b32 v85, v19, v18, s17
  v_perm_b32 v86, v21, v20, s17
  v_perm_b32 v87, v23, v22, s17
  v_accvgpr_write_b32 a168, v80
  v_accvgpr_write_b32 a169, v81
  v_accvgpr_write_b32 a170, v82
  v_accvgpr_write_b32 a171, v83
  v_accvgpr_write_b32 a172, v84
  v_accvgpr_write_b32 a173, v85
  v_accvgpr_write_b32 a174, v86
  v_accvgpr_write_b32 a175, v87
  s_xor_b32 s63, s77, 0xe0000
  buffer_load_dword v16, v3, s[48:51], s63 offen offset:0
  buffer_load_dword v18, v3, s[48:51], s63 offen offset:1024
  buffer_load_dword v20, v3, s[48:51], s63 offen offset:2048
  buffer_load_dword v22, v3, s[48:51], s63 offen offset:3072
  s_xor_b32 s63, s77, 0xe4000
  buffer_load_dword v17, v3, s[48:51], s63 offen offset:0
  buffer_load_dword v19, v3, s[48:51], s63 offen offset:1024
  buffer_load_dword v21, v3, s[48:51], s63 offen offset:2048
  buffer_load_dword v23, v3, s[48:51], s63 offen offset:3072
  s_waitcnt vmcnt(51)
  v_perm_b32 v80, v25, v24, s16
  s_waitcnt vmcnt(50)
  v_perm_b32 v81, v27, v26, s16
  s_waitcnt vmcnt(49)
  v_perm_b32 v82, v29, v28, s16
  s_waitcnt vmcnt(48)
  v_perm_b32 v83, v31, v30, s16
  v_perm_b32 v84, v25, v24, s17
  v_perm_b32 v85, v27, v26, s17
  v_perm_b32 v86, v29, v28, s17
  v_perm_b32 v87, v31, v30, s17
  v_accvgpr_write_b32 a176, v80
  v_accvgpr_write_b32 a177, v81
  v_accvgpr_write_b32 a178, v82
  v_accvgpr_write_b32 a179, v83
  v_accvgpr_write_b32 a180, v84
  v_accvgpr_write_b32 a181, v85
  v_accvgpr_write_b32 a182, v86
  v_accvgpr_write_b32 a183, v87
  s_xor_b32 s63, s77, 0xe8000
  buffer_load_dword v24, v3, s[48:51], s63 offen offset:0
  buffer_load_dword v26, v3, s[48:51], s63 offen offset:1024
  buffer_load_dword v28, v3, s[48:51], s63 offen offset:2048
  buffer_load_dword v30, v3, s[48:51], s63 offen offset:3072
  s_xor_b32 s63, s77, 0xec000
  buffer_load_dword v25, v3, s[48:51], s63 offen offset:0
  buffer_load_dword v27, v3, s[48:51], s63 offen offset:1024
  buffer_load_dword v29, v3, s[48:51], s63 offen offset:2048
  buffer_load_dword v31, v3, s[48:51], s63 offen offset:3072
  s_waitcnt vmcnt(51)
  v_perm_b32 v80, v33, v32, s16
  s_waitcnt vmcnt(50)
  v_perm_b32 v81, v35, v34, s16
  s_waitcnt vmcnt(49)
  v_perm_b32 v82, v37, v36, s16
  s_waitcnt vmcnt(48)
  v_perm_b32 v83, v39, v38, s16
  v_perm_b32 v84, v33, v32, s17
  v_perm_b32 v85, v35, v34, s17
  v_perm_b32 v86, v37, v36, s17
  v_perm_b32 v87, v39, v38, s17
  v_accvgpr_write_b32 a184, v80
  v_accvgpr_write_b32 a185, v81
  v_accvgpr_write_b32 a186, v82
  v_accvgpr_write_b32 a187, v83
  v_accvgpr_write_b32 a188, v84
  v_accvgpr_write_b32 a189, v85
  v_accvgpr_write_b32 a190, v86
  v_accvgpr_write_b32 a191, v87
  s_xor_b32 s63, s77, 0xf0000
  buffer_load_dword v32, v3, s[48:51], s63 offen offset:0
  buffer_load_dword v34, v3, s[48:51], s63 offen offset:1024
  buffer_load_dword v36, v3, s[48:51], s63 offen offset:2048
  buffer_load_dword v38, v3, s[48:51], s63 offen offset:3072
  s_xor_b32 s63, s77, 0xf4000
  buffer_load_dword v33, v3, s[48:51], s63 offen offset:0
  buffer_load_dword v35, v3, s[48:51], s63 offen offset:1024
  buffer_load_dword v37, v3, s[48:51], s63 offen offset:2048
  buffer_load_dword v39, v3, s[48:51], s63 offen offset:3072
  s_waitcnt vmcnt(51)
  v_perm_b32 v80, v41, v40, s16
  s_waitcnt vmcnt(50)
  v_perm_b32 v81, v43, v42, s16
  s_waitcnt vmcnt(49)
  v_perm_b32 v82, v45, v44, s16
  s_waitcnt vmcnt(48)
  v_perm_b32 v83, v47, v46, s16
  v_perm_b32 v84, v41, v40, s17
  v_perm_b32 v85, v43, v42, s17
  v_perm_b32 v86, v45, v44, s17
  v_perm_b32 v87, v47, v46, s17
  v_accvgpr_write_b32 a192, v80
  v_accvgpr_write_b32 a193, v81
  v_accvgpr_write_b32 a194, v82
  v_accvgpr_write_b32 a195, v83
  v_accvgpr_write_b32 a196, v84
  v_accvgpr_write_b32 a197, v85
  v_accvgpr_write_b32 a198, v86
  v_accvgpr_write_b32 a199, v87
  s_xor_b32 s63, s77, 0xf8000
  buffer_load_dword v40, v3, s[48:51], s63 offen offset:0
  buffer_load_dword v42, v3, s[48:51], s63 offen offset:1024
  buffer_load_dword v44, v3, s[48:51], s63 offen offset:2048
  buffer_load_dword v46, v3, s[48:51], s63 offen offset:3072
  s_xor_b32 s63, s77, 0xfc000
  buffer_load_dword v41, v3, s[48:51], s63 offen offset:0
  buffer_load_dword v43, v3, s[48:51], s63 offen offset:1024
  buffer_load_dword v45, v3, s[48:51], s63 offen offset:2048
  buffer_load_dword v47, v3, s[48:51], s63 offen offset:3072
  s_waitcnt vmcnt(51)
  v_perm_b32 v80, v49, v48, s16
  s_waitcnt vmcnt(50)
  v_perm_b32 v81, v51, v50, s16
  s_waitcnt vmcnt(49)
  v_perm_b32 v82, v53, v52, s16
  s_waitcnt vmcnt(48)
  v_perm_b32 v83, v55, v54, s16
  v_perm_b32 v84, v49, v48, s17
  v_perm_b32 v85, v51, v50, s17
  v_perm_b32 v86, v53, v52, s17
  v_perm_b32 v87, v55, v54, s17
  v_accvgpr_write_b32 a200, v80
  v_accvgpr_write_b32 a201, v81
  v_accvgpr_write_b32 a202, v82
  v_accvgpr_write_b32 a203, v83
  v_accvgpr_write_b32 a204, v84
  v_accvgpr_write_b32 a205, v85
  v_accvgpr_write_b32 a206, v86
  v_accvgpr_write_b32 a207, v87
  s_waitcnt vmcnt(43)
  v_perm_b32 v80, v57, v56, s16
  s_waitcnt vmcnt(42)
  v_perm_b32 v81, v59, v58, s16
  s_waitcnt vmcnt(41)
  v_perm_b32 v82, v61, v60, s16
  s_waitcnt vmcnt(40)
  v_perm_b32 v83, v63, v62, s16
  v_perm_b32 v84, v57, v56, s17
  v_perm_b32 v85, v59, v58, s17
  v_perm_b32 v86, v61, v60, s17
  v_perm_b32 v87, v63, v62, s17
  v_accvgpr_write_b32 a208, v80
  v_accvgpr_write_b32 a209, v81
  v_accvgpr_write_b32 a210, v82
  v_accvgpr_write_b32 a211, v83
  v_accvgpr_write_b32 a212, v84
  v_accvgpr_write_b32 a213, v85
  v_accvgpr_write_b32 a214, v86
  v_accvgpr_write_b32 a215, v87
  s_waitcnt vmcnt(35)
  v_perm_b32 v80, v65, v64, s16
  s_waitcnt vmcnt(34)
  v_perm_b32 v81, v67, v66, s16
  s_waitcnt vmcnt(33)
  v_perm_b32 v82, v69, v68, s16
  s_waitcnt vmcnt(32)
  v_perm_b32 v83, v71, v70, s16
  v_perm_b32 v84, v65, v64, s17
  v_perm_b32 v85, v67, v66, s17
  v_perm_b32 v86, v69, v68, s17
  v_perm_b32 v87, v71, v70, s17
  v_accvgpr_write_b32 a216, v80
  v_accvgpr_write_b32 a217, v81
  v_accvgpr_write_b32 a218, v82
  v_accvgpr_write_b32 a219, v83
  v_accvgpr_write_b32 a220, v84
  v_accvgpr_write_b32 a221, v85
  v_accvgpr_write_b32 a222, v86
  v_accvgpr_write_b32 a223, v87
  s_waitcnt vmcnt(27)
  v_perm_b32 v80, v17, v16, s16
  s_waitcnt vmcnt(26)
  v_perm_b32 v81, v19, v18, s16
  s_waitcnt vmcnt(25)
  v_perm_b32 v82, v21, v20, s16
  s_waitcnt vmcnt(24)
  v_perm_b32 v83, v23, v22, s16
  v_perm_b32 v84, v17, v16, s17
  v_perm_b32 v85, v19, v18, s17
  v_perm_b32 v86, v21, v20, s17
  v_perm_b32 v87, v23, v22, s17
  v_accvgpr_write_b32 a224, v80
  v_accvgpr_write_b32 a225, v81
  v_accvgpr_write_b32 a226, v82
  v_accvgpr_write_b32 a227, v83
  v_accvgpr_write_b32 a228, v84
  v_accvgpr_write_b32 a229, v85
  v_accvgpr_write_b32 a230, v86
  v_accvgpr_write_b32 a231, v87
  s_waitcnt vmcnt(19)
  v_perm_b32 v80, v25, v24, s16
  s_waitcnt vmcnt(18)
  v_perm_b32 v81, v27, v26, s16
  s_waitcnt vmcnt(17)
  v_perm_b32 v82, v29, v28, s16
  s_waitcnt vmcnt(16)
  v_perm_b32 v83, v31, v30, s16
  v_perm_b32 v84, v25, v24, s17
  v_perm_b32 v85, v27, v26, s17
  v_perm_b32 v86, v29, v28, s17
  v_perm_b32 v87, v31, v30, s17
  v_accvgpr_write_b32 a232, v80
  v_accvgpr_write_b32 a233, v81
  v_accvgpr_write_b32 a234, v82
  v_accvgpr_write_b32 a235, v83
  v_accvgpr_write_b32 a236, v84
  v_accvgpr_write_b32 a237, v85
  v_accvgpr_write_b32 a238, v86
  v_accvgpr_write_b32 a239, v87
  s_waitcnt vmcnt(11)
  v_perm_b32 v80, v33, v32, s16
  s_waitcnt vmcnt(10)
  v_perm_b32 v81, v35, v34, s16
  s_waitcnt vmcnt(9)
  v_perm_b32 v82, v37, v36, s16
  s_waitcnt vmcnt(8)
  v_perm_b32 v83, v39, v38, s16
  v_perm_b32 v84, v33, v32, s17
  v_perm_b32 v85, v35, v34, s17
  v_perm_b32 v86, v37, v36, s17
  v_perm_b32 v87, v39, v38, s17
  v_accvgpr_write_b32 a240, v80
  v_accvgpr_write_b32 a241, v81
  v_accvgpr_write_b32 a242, v82
  v_accvgpr_write_b32 a243, v83
  v_accvgpr_write_b32 a244, v84
  v_accvgpr_write_b32 a245, v85
  v_accvgpr_write_b32 a246, v86
  v_accvgpr_write_b32 a247, v87
  s_waitcnt vmcnt(3)
  v_perm_b32 v80, v41, v40, s16
  s_waitcnt vmcnt(2)
  v_perm_b32 v81, v43, v42, s16
  s_waitcnt vmcnt(1)
  v_perm_b32 v82, v45, v44, s16
  s_waitcnt vmcnt(0)
  v_perm_b32 v83, v47, v46, s16
  v_perm_b32 v84, v41, v40, s17
  v_perm_b32 v85, v43, v42, s17
  v_perm_b32 v86, v45, v44, s17
  v_perm_b32 v87, v47, v46, s17
  v_accvgpr_write_b32 a248, v80
  v_accvgpr_write_b32 a249, v81
  v_accvgpr_write_b32 a250, v82
  v_accvgpr_write_b32 a251, v83
  v_accvgpr_write_b32 a252, v84
  v_accvgpr_write_b32 a253, v85
  v_accvgpr_write_b32 a254, v86
  v_accvgpr_write_b32 a255, v87
  s_mov_b32 s48, s28
  s_mov_b32 s49, s29
  s_mov_b32 s50, 0x200000
  s_mov_b32 s51, 0x20000
  s_lshl_b32 s18, s66, 4
  s_add_u32 s18, s18, s34
  s_lshl_b32 s18, s18, 10
  s_add_u32 s18, s18, s68
  v_lshlrev_b32 v3, 12, v1
  v_lshl_add_u32 v3, v2, 2, v3
  v_add_u32 v3, s18, v3
  v_and_b32 v128, 31, v0
  v_min_u32 v129, 6, v128
  s_mul_i32 s18, s34, 28
  s_add_u32 s18, s18, 1024
  v_lshl_add_u32 v129, v129, 2, s18
  v_or_b32 v138, 7, v128
  v_lshlrev_b32 v138, 10, v138
  v_add_u32 v138, 1008, v138
  v_and_b32 v128, 7, v0
  s_lshl_b32 s18, s34, 5
  s_add_u32 s18, s18, 0
  v_lshl_add_u32 v128, v128, 2, s18
  v_add_u32 v130, 4096, v129
  v_cmp_gt_u32 vcc, 32, v0
  s_nop 1
  v_cndmask_b32 v4, v130, v128, vcc
  v_cndmask_b32 v7, v129, v128, vcc
  s_lshl_b32 s18, s34, 12
  v_add_u32 v8, s18, v6
  v_add_u32 v9, 1024, v8
  v_add_u32 v10, 2048, v8
  v_add_u32 v11, 3072, v8
  s_lshl_b32 s18, s34, 10
  v_add_u32 v136, s18, v6
  s_and_b32 s64, s67, 63
  s_mov_b32 s75, 0xbfb8aa3b
  s_bfe_u32 s18, s77, 0x1000f
  v_bfe_u32 v128, v0, 3, 1
  v_xor_b32 v128, s18, v128
  v_lshlrev_b32 v143, 10, v128
  v_lshl_add_u32 v143, v1, 8, v143
  v_and_b32 v128, 7, v0
  v_lshl_add_u32 v143, v128, 4, v143
  s_cmp_eq_u32 s60, 5
  s_cselect_b32 s18, 0x80, 0
  s_cselect_b32 s80, 0, -1
  s_cselect_b32 s81, -1, 0
  v_add_u32 v143, s18, v143
  v_mov_b32 v1, v129
  s_lshl_b32 s18, s34, 10
  s_add_u32 s18, s18, 0x8000
  v_add_u32 v2, s18, v6
  s_cmp_eq_u32 s60, 6
  s_cselect_b32 s79, 62, 59
L_spin_143:
  buffer_load_dword v5, off, s[40:43], 0 offset:0 sc1
  s_waitcnt vmcnt(0)
  v_cmp_ne_u32 vcc, 64, v5
  s_cbranch_vccz L_ok_144
  s_sub_u32 s3, s3, 1
  s_cbranch_scc1 L_end
  s_sleep 8
  s_branch L_spin_143
L_ok_144:
L_final_seg:
  s_lshl_b32 s69, s64, 15
  s_lshl_b32 s70, s64, 11
  s_add_u32 s70, s70, 0x580000
  s_lshl_b32 s71, s64, 1
  s_add_u32 s71, s71, s66
  s_mul_i32 s72, s71, 56
  s_mul_i32 s73, s34, 14
  s_add_u32 s72, s72, s73
  s_lshl_b32 s72, s72, 10
  s_add_u32 s72, s72, 0x600000
  s_lshl_b32 s73, s71, 2
  s_add_u32 s73, s73, s34
  s_lshl_b32 s73, s73, 15
  s_add_u32 s73, s73, 0x1000000
  s_cmp_lt_u32 s64, s79
  s_cbranch_scc1 L_more_145
  v_mov_b32 v4, v7
L_more_145:
L_spin_146:
  buffer_load_dword v5, v1, s[36:39], s70 offen sc1
  s_waitcnt vmcnt(0)
  v_cmp_ne_u32 vcc, 1, v5
  s_cbranch_vccz L_ok_147
  s_sub_u32 s3, s3, 1
  s_cbranch_scc1 L_end
  s_sleep 4
  s_branch L_spin_146
L_ok_147:
  buffer_load_dword v137, v3, s[44:47], s69 offen
  s_add_u32 s74, s72, 0
  buffer_load_dwordx4 v[16:19], v6, s[36:39], s74 offen sc1
  s_add_u32 s74, s72, 1024
  buffer_load_dwordx4 v[20:23], v6, s[36:39], s74 offen sc1
  s_add_u32 s74, s72, 2048
  buffer_load_dwordx4 v[24:27], v6, s[36:39], s74 offen sc1
  s_add_u32 s74, s72, 3072
  buffer_load_dwordx4 v[28:31], v6, s[36:39], s74 offen sc1
  s_add_u32 s74, s72, 4096
  buffer_load_dwordx4 v[32:35], v6, s[36:39], s74 offen sc1
  s_add_u32 s74, s72, 5120
  buffer_load_dwordx4 v[36:39], v6, s[36:39], s74 offen sc1
  s_add_u32 s74, s72, 6144
  buffer_load_dwordx4 v[40:43], v6, s[36:39], s74 offen sc1
  s_add_u32 s74, s72, 7168
  buffer_load_dwordx4 v[44:47], v6, s[36:39], s74 offen sc1
  s_add_u32 s74, s72, 8192
  buffer_load_dwordx4 v[48:51], v6, s[36:39], s74 offen sc1
  s_add_u32 s74, s72, 9216
  buffer_load_dwordx4 v[52:55], v6, s[36:39], s74 offen sc1
  s_add_u32 s74, s72, 10240
  buffer_load_dwordx4 v[56:59], v6, s[36:39], s74 offen sc1
  s_add_u32 s74, s72, 11264
  buffer_load_dwordx4 v[60:63], v6, s[36:39], s74 offen sc1
  s_add_u32 s74, s72, 12288
  buffer_load_dwordx4 v[64:67], v6, s[36:39], s74 offen sc1
  s_add_u32 s74, s72, 13312
  buffer_load_dwordx4 v[68:71], v6, s[36:39], s74 offen sc1
  buffer_load_dword v5, v4, s[36:39], s70 offen sc1
  s_waitcnt vmcnt(14)
  v_mfma_f32_16x16x32_bf16 v[120:123], v[16:19], v[144:147], 0
  v_mfma_f32_16x16x32_bf16 v[124:127], v[16:19], v[148:151], 0
  s_waitcnt vmcnt(13)
  v_mfma_f32_16x16x32_bf16 v[120:123], v[20:23], v[152:155], v[120:123]
  v_mfma_f32_16x16x32_bf16 v[124:127], v[20:23], v[156:159], v[124:127]
  s_waitcnt vmcnt(12)
  v_mfma_f32_16x16x32_bf16 v[120:123], v[24:27], v[160:163], v[120:123]
  v_mfma_f32_16x16x32_bf16 v[124:127], v[24:27], v[164:167], v[124:127]
  s_waitcnt vmcnt(11)
  v_mfma_f32_16x16x32_bf16 v[120:123], v[28:31], v[168:171], v[120:123]
  v_mfma_f32_16x16x32_bf16 v[124:127], v[28:31], v[172:175], v[124:127]
  s_waitcnt vmcnt(10)
  v_mfma_f32_16x16x32_bf16 v[120:123], v[32:35], v[176:179], v[120:123]
  v_mfma_f32_16x16x32_bf16 v[124:127], v[32:35], v[180:183], v[124:127]
  s_waitcnt vmcnt(9)
  v_mfma_f32_16x16x32_bf16 v[120:123], v[36:39], v[184:187], v[120:123]
  v_mfma_f32_16x16x32_bf16 v[124:127], v[36:39], v[188:191], v[124:127]
  s_waitcnt vmcnt(8)
  v_mfma_f32_16x16x32_bf16 v[120:123], v[40:43], v[192:195], v[120:123]
  v_mfma_f32_16x16x32_bf16 v[124:127], v[40:43], v[196:199], v[124:127]
  s_waitcnt vmcnt(7)
  v_mfma_f32_16x16x32_bf16 v[120:123], v[44:47], v[200:203], v[120:123]
  v_mfma_f32_16x16x32_bf16 v[124:127], v[44:47], v[204:207], v[124:127]
  s_waitcnt vmcnt(6)
  v_mfma_f32_16x16x32_bf16 v[120:123], v[48:51], v[208:211], v[120:123]
  v_mfma_f32_16x16x32_bf16 v[124:127], v[48:51], v[212:215], v[124:127]
  s_waitcnt vmcnt(5)
  v_mfma_f32_16x16x32_bf16 v[120:123], v[52:55], v[216:219], v[120:123]
  v_mfma_f32_16x16x32_bf16 v[124:127], v[52:55], v[220:223], v[124:127]
  s_waitcnt vmcnt(4)
  v_mfma_f32_16x16x32_bf16 v[120:123], v[56:59], v[224:227], v[120:123]
  v_mfma_f32_16x16x32_bf16 v[124:127], v[56:59], v[228:231], v[124:127]
  s_waitcnt vmcnt(3)
  v_mfma_f32_16x16x32_bf16 v[120:123], v[60:63], v[232:235], v[120:123]
  v_mfma_f32_16x16x32_bf16 v[124:127], v[60:63], v[236:239], v[124:127]
  s_waitcnt vmcnt(2)
  v_mfma_f32_16x16x32_bf16 v[120:123], v[64:67], v[240:243], v[120:123]
  v_mfma_f32_16x16x32_bf16 v[124:127], v[64:67], v[244:247], v[124:127]
  s_waitcnt vmcnt(1)
  v_mfma_f32_16x16x32_bf16 v[120:123], v[68:71], v[248:251], v[120:123]
  v_mfma_f32_16x16x32_bf16 v[124:127], v[68:71], v[252:255], v[124:127]
  s_nop 7
  ds_write2_b32 v8, v120, v124 offset0:2 offset1:3
  ds_write2_b32 v9, v121, v125 offset0:2 offset1:3
  ds_write2_b32 v10, v122, v126 offset0:2 offset1:3
  ds_write2_b32 v11, v123, v127 offset0:2 offset1:3
  v_xor_b32 v8, 0x4000, v8
  v_xor_b32 v9, 0x4000, v9
  v_xor_b32 v10, 0x4000, v10
  v_xor_b32 v11, 0x4000, v11
  s_waitcnt lgkmcnt(0)
  s_barrier
  ds_read_b64 v[112:113], v136 offset:8
  ds_read_b64 v[114:115], v136 offset:4104
  ds_read_b64 v[116:117], v136 offset:8200
  ds_read_b64 v[118:119], v136 offset:12296
  v_xor_b32 v136, 0x4000, v136
  s_waitcnt lgkmcnt(2)
  v_add_f32 v112, v112, v114
  v_add_f32 v113, v113, v115
  s_waitcnt lgkmcnt(0)
  v_add_f32 v116, v116, v118
  v_add_f32 v117, v117, v119
  v_add_f32 v112, v112, v116
  v_add_f32 v113, v113, v117
  v_add_f32 v112, v112, v14
  v_mul_f32 v140, s75, v112
  v_exp_f32 v140, v140
  s_nop 0
  v_add_f32 v140, 1.0, v140
  v_rcp_f32 v140, v140
  s_nop 0
  v_mul_f32 v140, v140, v112
  v_add_f32 v113, v113, v15
  v_mul_f32 v141, s75, v113
  v_exp_f32 v141, v141
  s_nop 0
  v_add_f32 v141, 1.0, v141
  v_rcp_f32 v141, v141
  s_nop 0
  v_mul_f32 v141, v141, v113
  v_lshlrev_b32 v12, 16, v137
  v_and_b32 v13, 0xffff0000, v137
  s_cmp_lg_u32 s60, 5
  s_cbranch_scc1 L_final_redo2
  s_cmp_lg_u32 s64, 63
  s_cbranch_scc1 L_final_redo2
  ds_write_b64 v2, v[140:141]
  ds_write_b64 v2, v[12:13] offset:8
  s_mov_b32 s64, 61
  s_waitcnt vmcnt(0) lgkmcnt(0)
  s_branch L_final_seg
L_final_redo2:
  s_waitcnt vmcnt(0)
  v_mov_b32 v142, -1
L_final_loop:
  s_waitcnt vmcnt(1)
  v_cmp_ne_u32 vcc, 1, v5
  s_cbranch_vccz L_fl_148
L_spin_150:
  buffer_load_dword v5, v4, s[36:39], s70 offen sc1
  s_waitcnt vmcnt(0)
  v_cmp_ne_u32 vcc, 1, v5
  s_cbranch_vccz L_ok_151
  s_sub_u32 s3, s3, 1
  s_cbranch_scc1 L_end
  s_sleep 4
  s_branch L_spin_150
L_ok_151:
L_fl_148:
  v_cmp_eq_u32 vcc, -1, v142
  s_cbranch_vccz L_ogo_149
L_spin_152:
  buffer_load_dword v142, v138, s[36:39], s73 offen sc1
  s_waitcnt vmcnt(0)
  v_cmp_eq_u32 vcc, -1, v142
  s_cbranch_vccz L_ok_153
  s_sub_u32 s3, s3, 1
  s_cbranch_scc1 L_end
  s_branch L_spin_152
L_ok_153:
L_ogo_149:
  s_lshr_b32 s78, s77, 5
  s_add_u32 s78, s78, s73
  s_cmp_eq_u32 s64, 63
  s_cbranch_scc1 L_final_half
  s_xor_b32 s74, s78, 0
  buffer_load_dwordx4 v[72:75], v6, s[36:39], s74 offen sc1
  s_xor_b32 s74, s78, 1024
  buffer_load_dwordx4 v[76:79], v6, s[36:39], s74 offen sc1
  s_xor_b32 s74, s78, 2048
  buffer_load_dwordx4 v[80:83], v6, s[36:39], s74 offen sc1
  s_xor_b32 s74, s78, 3072
  buffer_load_dwordx4 v[84:87], v6, s[36:39], s74 offen sc1
  s_xor_b32 s74, s78, 4096
  buffer_load_dwordx4 v[88:91], v6, s[36:39], s74 offen sc1
  s_xor_b32 s74, s78, 5120
  buffer_load_dwordx4 v[92:95], v6, s[36:39], s74 offen sc1
  s_xor_b32 s74, s78, 6144
  buffer_load_dwordx4 v[96:99], v6, s[36:39], s74 offen sc1
  s_xor_b32 s74, s78, 7168
  buffer_load_dwordx4 v[100:103], v6, s[36:39], s74 offen sc1
  s_xor_b32 s74, s78, 8192
  buffer_load_dwordx4 v[104:107], v6, s[36:39], s74 offen sc1
  s_xor_b32 s74, s78, 9216
  buffer_load_dwordx4 v[108:111], v6, s[36:39], s74 offen sc1
  s_xor_b32 s74, s78, 10240
  buffer_load_dwordx4 v[16:19], v6, s[36:39], s74 offen sc1
  s_xor_b32 s74, s78, 11264
  buffer_load_dwordx4 v[20:23], v6, s[36:39], s74 offen sc1
  s_xor_b32 s74, s78, 12288
  buffer_load_dwordx4 v[24:27], v6, s[36:39], s74 offen sc1
  s_xor_b32 s74, s78, 13312
  buffer_load_dwordx4 v[28:31], v6, s[36:39], s74 offen sc1
  s_xor_b32 s74, s78, 14336
  buffer_load_dwordx4 v[32:35], v6, s[36:39], s74 offen sc1
  s_xor_b32 s74, s78, 15360
  buffer_load_dwordx4 v[36:39], v6, s[36:39], s74 offen sc1
L_final_proj:
  s_mov_b32 s76, s69
  s_cmp_ge_u32 s64, s79
  s_cbranch_scc1 L_final_last
  v_mov_b32 v139, 0
  s_waitcnt vmcnt(15)
  v_mfma_f32_16x16x32_bf16 v[112:115], v[72:75], a[0:3], 0
  v_mfma_f32_16x16x32_bf16 v[116:119], v[72:75], a[4:7], 0
  v_max_u32 v139, v139, v72
  s_xor_b32 s74, s78, 16384
  buffer_load_dwordx4 v[40:43], v6, s[36:39], s74 offen sc1
  s_waitcnt vmcnt(15)
  v_mfma_f32_16x16x32_bf16 v[112:115], v[76:79], a[8:11], v[112:115]
  v_mfma_f32_16x16x32_bf16 v[116:119], v[76:79], a[12:15], v[116:119]
  v_max_u32 v139, v139, v76
  s_xor_b32 s74, s78, 17408
  buffer_load_dwordx4 v[44:47], v6, s[36:39], s74 offen sc1
  s_waitcnt vmcnt(15)
  v_mfma_f32_16x16x32_bf16 v[112:115], v[80:83], a[16:19], v[112:115]
  v_mfma_f32_16x16x32_bf16 v[116:119], v[80:83], a[20:23], v[116:119]
  v_max_u32 v139, v139, v80
  s_xor_b32 s74, s78, 18432
  buffer_load_dwordx4 v[48:51], v6, s[36:39], s74 offen sc1
  s_waitcnt vmcnt(15)
  v_mfma_f32_16x16x32_bf16 v[112:115], v[84:87], a[24:27], v[112:115]
  v_mfma_f32_16x16x32_bf16 v[116:119], v[84:87], a[28:31], v[116:119]
  v_max_u32 v139, v139, v84
  s_xor_b32 s74, s78, 19456
  buffer_load_dwordx4 v[52:55], v6, s[36:39], s74 offen sc1
  s_waitcnt vmcnt(15)
  v_mfma_f32_16x16x32_bf16 v[112:115], v[88:91], a[32:35], v[112:115]
  v_mfma_f32_16x16x32_bf16 v[116:119], v[88:91], a[36:39], v[116:119]
  v_max_u32 v139, v139, v88
  s_xor_b32 s74, s78, 20480
  buffer_load_dwordx4 v[56:59], v6, s[36:39], s74 offen sc1
  s_waitcnt vmcnt(15)
  v_mfma_f32_16x16x32_bf16 v[112:115], v[92:95], a[40:43], v[112:115]
  v_mfma_f32_16x16x32_bf16 v[116:119], v[92:95], a[44:47], v[116:119]
  v_max_u32 v139, v139, v92
  s_xor_b32 s74, s78, 21504
  buffer_load_dwordx4 v[60:63], v6, s[36:39], s74 offen sc1
  s_waitcnt vmcnt(15)
  v_mfma_f32_16x16x32_bf16 v[112:115], v[96:99], a[48:51], v[112:115]
  v_mfma_f32_16x16x32_bf16 v[116:119], v[96:99], a[52:55], v[116:119]
  v_max_u32 v139, v139, v96
  s_xor_b32 s74, s78, 22528
  buffer_load_dwordx4 v[64:67], v6, s[36:39], s74 offen sc1
  s_waitcnt vmcnt(15)
  v_mfma_f32_16x16x32_bf16 v[112:115], v[100:103], a[56:59], v[112:115]
  v_mfma_f32_16x16x32_bf16 v[116:119], v[100:103], a[60:63], v[116:119]
  v_max_u32 v139, v139, v100
  s_xor_b32 s74, s78, 23552
  buffer_load_dwordx4 v[68:71], v6, s[36:39], s74 offen sc1
  s_waitcnt vmcnt(15)
  v_mfma_f32_16x16x32_bf16 v[112:115], v[104:107], a[64:67], v[112:115]
  v_mfma_f32_16x16x32_bf16 v[116:119], v[104:107], a[68:71], v[116:119]
  v_max_u32 v139, v139, v104
  s_xor_b32 s74, s78, 24576
  buffer_load_dwordx4 v[72:75], v6, s[36:39], s74 offen sc1
  s_waitcnt vmcnt(15)
  v_mfma_f32_16x16x32_bf16 v[112:115], v[108:111], a[72:75], v[112:115]
  v_mfma_f32_16x16x32_bf16 v[116:119], v[108:111], a[76:79], v[116:119]
  v_max_u32 v139, v139, v108
  s_xor_b32 s74, s78, 25600
  buffer_load_dwordx4 v[76:79], v6, s[36:39], s74 offen sc1
  s_waitcnt vmcnt(15)
  v_mfma_f32_16x16x32_bf16 v[112:115], v[16:19], a[80:83], v[112:115]
  v_mfma_f32_16x16x32_bf16 v[116:119], v[16:19], a[84:87], v[116:119]
  v_max_u32 v139, v139, v16
  s_xor_b32 s74, s78, 26624
  buffer_load_dwordx4 v[80:83], v6, s[36:39], s74 offen sc1
  s_waitcnt vmcnt(15)
  v_mfma_f32_16x16x32_bf16 v[112:115], v[20:23], a[88:91], v[112:115]
  v_mfma_f32_16x16x32_bf16 v[116:119], v[20:23], a[92:95], v[116:119]
  v_max_u32 v139, v139, v20
  s_xor_b32 s74, s78, 27648
  buffer_load_dwordx4 v[84:87], v6, s[36:39], s74 offen sc1
  s_waitcnt vmcnt(15)
  v_mfma_f32_16x16x32_bf16 v[112:115], v[24:27], a[96:99], v[112:115]
  v_mfma_f32_16x16x32_bf16 v[116:119], v[24:27], a[100:103], v[116:119]
  v_max_u32 v139, v139, v24
  s_xor_b32 s74, s78, 28672
  buffer_load_dwordx4 v[88:91], v6, s[36:39], s74 offen sc1
  s_waitcnt vmcnt(15)
  v_mfma_f32_16x16x32_bf16 v[112:115], v[28:31], a[104:107], v[112:115]
  v_mfma_f32_16x16x32_bf16 v[116:119], v[28:31], a[108:111], v[116:119]
  v_max_u32 v139, v139, v28
  s_xor_b32 s74, s78, 29696
  buffer_load_dwordx4 v[92:95], v6, s[36:39], s74 offen sc1
  s_waitcnt vmcnt(15)
  v_mfma_f32_16x16x32_bf16 v[112:115], v[32:35], a[112:115], v[112:115]
  v_mfma_f32_16x16x32_bf16 v[116:119], v[32:35], a[116:119], v[116:119]
  v_max_u32 v139, v139, v32
  s_xor_b32 s74, s78, 30720
  buffer_load_dwordx4 v[96:99], v6, s[36:39], s74 offen sc1
  s_waitcnt vmcnt(15)
  v_mfma_f32_16x16x32_bf16 v[112:115], v[36:39], a[120:123], v[112:115]
  v_mfma_f32_16x16x32_bf16 v[116:119], v[36:39], a[124:127], v[116:119]
  v_max_u32 v139, v139, v36
  s_xor_b32 s74, s78, 31744
  buffer_load_dwordx4 v[100:103], v6, s[36:39], s74 offen sc1
  s_waitcnt vmcnt(15)
  v_mfma_f32_16x16x32_bf16 v[112:115], v[40:43], a[128:131], v[112:115]
  v_mfma_f32_16x16x32_bf16 v[116:119], v[40:43], a[132:135], v[116:119]
  v_max_u32 v139, v139, v40
  s_add_u32 s74, s69, 65536
  buffer_load_dword v137, v3, s[44:47], s74 offen
  s_waitcnt vmcnt(15)
  v_mfma_f32_16x16x32_bf16 v[112:115], v[44:47], a[136:139], v[112:115]
  v_mfma_f32_16x16x32_bf16 v[116:119], v[44:47], a[140:143], v[116:119]
  v_max_u32 v139, v139, v44
  s_add_u32 s74, s72, 229376
  buffer_load_dwordx4 v[16:19], v6, s[36:39], s74 offen sc1
  s_waitcnt vmcnt(15)
  v_mfma_f32_16x16x32_bf16 v[112:115], v[48:51], a[144:147], v[112:115]
  v_mfma_f32_16x16x32_bf16 v[116:119], v[48:51], a[148:151], v[116:119]
  v_max_u32 v139, v139, v48
  s_add_u32 s74, s72, 230400
  buffer_load_dwordx4 v[20:23], v6, s[36:39], s74 offen sc1
  s_waitcnt vmcnt(15)
  v_mfma_f32_16x16x32_bf16 v[112:115], v[52:55], a[152:155], v[112:115]
  v_mfma_f32_16x16x32_bf16 v[116:119], v[52:55], a[156:159], v[116:119]
  v_max_u32 v139, v139, v52
  s_add_u32 s74, s72, 231424
  buffer_load_dwordx4 v[24:27], v6, s[36:39], s74 offen sc1
  s_waitcnt vmcnt(15)
  v_mfma_f32_16x16x32_bf16 v[112:115], v[56:59], a[160:163], v[112:115]
  v_mfma_f32_16x16x32_bf16 v[116:119], v[56:59], a[164:167], v[116:119]
  v_max_u32 v139, v139, v56
  s_add_u32 s74, s72, 232448
  buffer_load_dwordx4 v[28:31], v6, s[36:39], s74 offen sc1
  s_waitcnt vmcnt(15)
  v_mfma_f32_16x16x32_bf16 v[112:115], v[60:63], a[168:171], v[112:115]
  v_mfma_f32_16x16x32_bf16 v[116:119], v[60:63], a[172:175], v[116:119]
  v_max_u32 v139, v139, v60
  s_add_u32 s74, s72, 233472
  buffer_load_dwordx4 v[32:35], v6, s[36:39], s74 offen sc1
  s_waitcnt vmcnt(15)
  v_mfma_f32_16x16x32_bf16 v[112:115], v[64:67], a[176:179], v[112:115]
  v_mfma_f32_16x16x32_bf16 v[116:119], v[64:67], a[180:183], v[116:119]
  v_max_u32 v139, v139, v64
  s_add_u32 s74, s72, 234496
  buffer_load_dwordx4 v[36:39], v6, s[36:39], s74 offen sc1
  s_waitcnt vmcnt(15)
  v_mfma_f32_16x16x32_bf16 v[112:115], v[68:71], a[184:187], v[112:115]
  v_mfma_f32_16x16x32_bf16 v[116:119], v[68:71], a[188:191], v[116:119]
  v_max_u32 v139, v139, v68
  s_add_u32 s74, s72, 235520
  buffer_load_dwordx4 v[40:43], v6, s[36:39], s74 offen sc1
  s_waitcnt vmcnt(15)
  v_mfma_f32_16x16x32_bf16 v[112:115], v[72:75], a[192:195], v[112:115]
  v_mfma_f32_16x16x32_bf16 v[116:119], v[72:75], a[196:199], v[116:119]
  v_max_u32 v139, v139, v72
  s_add_u32 s74, s72, 236544
  buffer_load_dwordx4 v[44:47], v6, s[36:39], s74 offen sc1
  s_waitcnt vmcnt(15)
  v_mfma_f32_16x16x32_bf16 v[112:115], v[76:79], a[200:203], v[112:115]
  v_mfma_f32_16x16x32_bf16 v[116:119], v[76:79], a[204:207], v[116:119]
  v_max_u32 v139, v139, v76
  s_add_u32 s74, s72, 237568
  buffer_load_dwordx4 v[48:51], v6, s[36:39], s74 offen sc1
  s_waitcnt vmcnt(15)
  v_mfma_f32_16x16x32_bf16 v[112:115], v[80:83], a[208:211], v[112:115]
  v_mfma_f32_16x16x32_bf16 v[116:119], v[80:83], a[212:215], v[116:119]
  v_max_u32 v139, v139, v80
  s_add_u32 s74, s72, 238592
  buffer_load_dwordx4 v[52:55], v6, s[36:39], s74 offen sc1
  s_waitcnt vmcnt(15)
  v_mfma_f32_16x16x32_bf16 v[112:115], v[84:87], a[216:219], v[112:115]
  v_mfma_f32_16x16x32_bf16 v[116:119], v[84:87], a[220:223], v[116:119]
  v_max_u32 v139, v139, v84
  s_add_u32 s74, s72, 239616
  buffer_load_dwordx4 v[56:59], v6, s[36:39], s74 offen sc1
  s_waitcnt vmcnt(15)
  v_mfma_f32_16x16x32_bf16 v[112:115], v[88:91], a[224:227], v[112:115]
  v_mfma_f32_16x16x32_bf16 v[116:119], v[88:91], a[228:231], v[116:119]
  v_max_u32 v139, v139, v88
  s_add_u32 s74, s72, 240640
  buffer_load_dwordx4 v[60:63], v6, s[36:39], s74 offen sc1
  s_waitcnt vmcnt(15)
  v_mfma_f32_16x16x32_bf16 v[112:115], v[92:95], a[232:235], v[112:115]
  v_mfma_f32_16x16x32_bf16 v[116:119], v[92:95], a[236:239], v[116:119]
  v_max_u32 v139, v139, v92
  s_add_u32 s74, s72, 241664
  buffer_load_dwordx4 v[64:67], v6, s[36:39], s74 offen sc1
  s_waitcnt vmcnt(15)
  v_mfma_f32_16x16x32_bf16 v[112:115], v[96:99], a[240:243], v[112:115]
  v_mfma_f32_16x16x32_bf16 v[116:119], v[96:99], a[244:247], v[116:119]
  v_max_u32 v139, v139, v96
  s_add_u32 s74, s72, 242688
  buffer_load_dwordx4 v[68:71], v6, s[36:39], s74 offen sc1
  s_waitcnt vmcnt(15)
  v_mfma_f32_16x16x32_bf16 v[112:115], v[100:103], a[248:251], v[112:115]
  v_mfma_f32_16x16x32_bf16 v[116:119], v[100:103], a[252:255], v[116:119]
  v_max_u32 v139, v139, v100
  v_cmp_eq_u32 vcc, -1, v139
  s_cbranch_vccnz L_final_redo
  s_add_u32 s64, s64, 2
  s_add_u32 s69, s69, 65536
  s_add_u32 s70, s70, 4096
  s_add_u32 s72, s72, 229376
  s_add_u32 s73, s73, 524288
  s_cmp_lt_u32 s64, s79
  s_cbranch_scc1 L_notlast_154
  v_mov_b32 v4, v7
L_notlast_154:
  buffer_load_dword v5, v4, s[36:39], s70 offen sc1
  buffer_load_dword v142, v138, s[36:39], s73 offen sc1
  s_waitcnt vmcnt(15)
  v_mfma_f32_16x16x32_bf16 v[120:123], v[16:19], v[144:147], 0
  v_mfma_f32_16x16x32_bf16 v[124:127], v[16:19], v[148:151], 0
  s_waitcnt vmcnt(14)
  v_mfma_f32_16x16x32_bf16 v[120:123], v[20:23], v[152:155], v[120:123]
  v_mfma_f32_16x16x32_bf16 v[124:127], v[20:23], v[156:159], v[124:127]
  s_waitcnt vmcnt(13)
  v_mfma_f32_16x16x32_bf16 v[120:123], v[24:27], v[160:163], v[120:123]
  v_mfma_f32_16x16x32_bf16 v[124:127], v[24:27], v[164:167], v[124:127]
  s_waitcnt vmcnt(12)
  v_mfma_f32_16x16x32_bf16 v[120:123], v[28:31], v[168:171], v[120:123]
  v_mfma_f32_16x16x32_bf16 v[124:127], v[28:31], v[172:175], v[124:127]
  s_waitcnt vmcnt(11)
  v_mfma_f32_16x16x32_bf16 v[120:123], v[32:35], v[176:179], v[120:123]
  v_mfma_f32_16x16x32_bf16 v[124:127], v[32:35], v[180:183], v[124:127]
  s_waitcnt vmcnt(10)
  v_mfma_f32_16x16x32_bf16 v[120:123], v[36:39], v[184:187], v[120:123]
  v_mfma_f32_16x16x32_bf16 v[124:127], v[36:39], v[188:191], v[124:127]
  s_waitcnt vmcnt(9)
  v_mfma_f32_16x16x32_bf16 v[120:123], v[40:43], v[192:195], v[120:123]
  v_mfma_f32_16x16x32_bf16 v[124:127], v[40:43], v[196:199], v[124:127]
  s_waitcnt vmcnt(8)
  v_mfma_f32_16x16x32_bf16 v[120:123], v[44:47], v[200:203], v[120:123]
  v_mfma_f32_16x16x32_bf16 v[124:127], v[44:47], v[204:207], v[124:127]
  s_waitcnt vmcnt(7)
  v_mfma_f32_16x16x32_bf16 v[120:123], v[48:51], v[208:211], v[120:123]
  v_mfma_f32_16x16x32_bf16 v[124:127], v[48:51], v[212:215], v[124:127]
  s_waitcnt vmcnt(6)
  v_mfma_f32_16x16x32_bf16 v[120:123], v[52:55], v[216:219], v[120:123]
  v_mfma_f32_16x16x32_bf16 v[124:127], v[52:55], v[220:223], v[124:127]
  s_waitcnt vmcnt(5)
  v_mfma_f32_16x16x32_bf16 v[120:123], v[56:59], v[224:227], v[120:123]
  v_mfma_f32_16x16x32_bf16 v[124:127], v[56:59], v[228:231], v[124:127]
  s_waitcnt vmcnt(4)
  v_mfma_f32_16x16x32_bf16 v[120:123], v[60:63], v[232:235], v[120:123]
  v_mfma_f32_16x16x32_bf16 v[124:127], v[60:63], v[236:239], v[124:127]
  s_waitcnt vmcnt(3)
  v_mfma_f32_16x16x32_bf16 v[120:123], v[64:67], v[240:243], v[120:123]
  v_mfma_f32_16x16x32_bf16 v[124:127], v[64:67], v[244:247], v[124:127]
  s_waitcnt vmcnt(2)
  v_mfma_f32_16x16x32_bf16 v[120:123], v[68:71], v[248:251], v[120:123]
  v_mfma_f32_16x16x32_bf16 v[124:127], v[68:71], v[252:255], v[124:127]
  s_waitcnt vmcnt(1)
  v_cmp_ne_u32 s[82:83], 1, v5
  s_waitcnt vmcnt(0)
  v_cmp_eq_u32 vcc, -1, v142
  s_or_b64 vcc, vcc, s[82:83]
  s_cbranch_vccz L_final_ahead
  buffer_load_dword v142, v138, s[36:39], s73 offen sc1
  ds_write2_b32 v8, v112, v116 offset0:0 offset1:1
  ds_write2_b32 v9, v113, v117 offset0:0 offset1:1
  ds_write2_b32 v10, v114, v118 offset0:0 offset1:1
  ds_write2_b32 v11, v115, v119 offset0:0 offset1:1
  ds_write2_b32 v8, v120, v124 offset0:2 offset1:3
  ds_write2_b32 v9, v121, v125 offset0:2 offset1:3
  ds_write2_b32 v10, v122, v126 offset0:2 offset1:3
  ds_write2_b32 v11, v123, v127 offset0:2 offset1:3
  v_xor_b32 v8, 0x4000, v8
  v_xor_b32 v9, 0x4000, v9
  v_xor_b32 v10, 0x4000, v10
  v_xor_b32 v11, 0x4000, v11
  s_waitcnt lgkmcnt(0)
  s_barrier
  ds_read_b64 v[128:129], v136 offset:0
  ds_read_b64 v[130:131], v136 offset:4096
  ds_read_b64 v[132:133], v136 offset:8192
  ds_read_b64 v[134:135], v136 offset:12288
  ds_read_b64 v[112:113], v136 offset:8
  ds_read_b64 v[114:115], v136 offset:4104
  ds_read_b64 v[116:117], v136 offset:8200
  ds_read_b64 v[118:119], v136 offset:12296
  v_xor_b32 v136, 0x4000, v136
  s_waitcnt lgkmcnt(6)
  v_add_f32 v128, v128, v130
  v_add_f32 v129, v129, v131
  s_waitcnt lgkmcnt(4)
  v_add_f32 v132, v132, v134
  v_add_f32 v133, v133, v135
  v_add_f32 v128, v128, v132
  v_add_f32 v129, v129, v133
  v_fma_f32 v128, v128, v140, v12
  v_fma_f32 v129, v129, v141, v13
  v_cvt_pk_bf16_f32 v128, v128, v129
  buffer_store_dword v128, v3, s[48:51], s76 offen
  s_waitcnt lgkmcnt(2)
  v_add_f32 v112, v112, v114
  v_add_f32 v113, v113, v115
  s_waitcnt lgkmcnt(0)
  v_add_f32 v116, v116, v118
  v_add_f32 v117, v117, v119
  v_add_f32 v112, v112, v116
  v_add_f32 v113, v113, v117
  v_add_f32 v112, v112, v14
  v_mul_f32 v140, s75, v112
  v_exp_f32 v140, v140
  s_nop 0
  v_add_f32 v140, 1.0, v140
  v_rcp_f32 v140, v140
  s_nop 0
  v_mul_f32 v140, v140, v112
  v_add_f32 v113, v113, v15
  v_mul_f32 v141, s75, v113
  v_exp_f32 v141, v141
  s_nop 0
  v_add_f32 v141, 1.0, v141
  v_rcp_f32 v141, v141
  s_nop 0
  v_mul_f32 v141, v141, v113
  v_lshlrev_b32 v12, 16, v137
  v_and_b32 v13, 0xffff0000, v137
  s_branch L_final_loop
L_final_ahead:
  s_lshr_b32 s78, s77, 5
  s_add_u32 s78, s78, s73
  s_xor_b32 s74, s78, 0
  buffer_load_dwordx4 v[72:75], v6, s[36:39], s74 offen sc1
  s_xor_b32 s74, s78, 1024
  buffer_load_dwordx4 v[76:79], v6, s[36:39], s74 offen sc1
  s_xor_b32 s74, s78, 2048
  buffer_load_dwordx4 v[80:83], v6, s[36:39], s74 offen sc1
  s_xor_b32 s74, s78, 3072
  buffer_load_dwordx4 v[84:87], v6, s[36:39], s74 offen sc1
  s_xor_b32 s74, s78, 4096
  buffer_load_dwordx4 v[88:91], v6, s[36:39], s74 offen sc1
  s_xor_b32 s74, s78, 5120
  buffer_load_dwordx4 v[92:95], v6, s[36:39], s74 offen sc1
  s_xor_b32 s74, s78, 6144
  buffer_load_dwordx4 v[96:99], v6, s[36:39], s74 offen sc1
  s_xor_b32 s74, s78, 7168
  buffer_load_dwordx4 v[100:103], v6, s[36:39], s74 offen sc1
  s_xor_b32 s74, s78, 8192
  buffer_load_dwordx4 v[104:107], v6, s[36:39], s74 offen sc1
  s_xor_b32 s74, s78, 9216
  buffer_load_dwordx4 v[108:111], v6, s[36:39], s74 offen sc1
  s_xor_b32 s74, s78, 10240
  buffer_load_dwordx4 v[16:19], v6, s[36:39], s74 offen sc1
  s_xor_b32 s74, s78, 11264
  buffer_load_dwordx4 v[20:23], v6, s[36:39], s74 offen sc1
  s_xor_b32 s74, s78, 12288
  buffer_load_dwordx4 v[24:27], v6, s[36:39], s74 offen sc1
  s_xor_b32 s74, s78, 13312
  buffer_load_dwordx4 v[28:31], v6, s[36:39], s74 offen sc1
  s_xor_b32 s74, s78, 14336
  buffer_load_dwordx4 v[32:35], v6, s[36:39], s74 offen sc1
  s_xor_b32 s74, s78, 15360
  buffer_load_dwordx4 v[36:39], v6, s[36:39], s74 offen sc1
  ds_write2_b32 v8, v112, v116 offset0:0 offset1:1
  ds_write2_b32 v9, v113, v117 offset0:0 offset1:1
  ds_write2_b32 v10, v114, v118 offset0:0 offset1:1
  ds_write2_b32 v11, v115, v119 offset0:0 offset1:1
  ds_write2_b32 v8, v120, v124 offset0:2 offset1:3
  ds_write2_b32 v9, v121, v125 offset0:2 offset1:3
  ds_write2_b32 v10, v122, v126 offset0:2 offset1:3
  ds_write2_b32 v11, v123, v127 offset0:2 offset1:3
  v_xor_b32 v8, 0x4000, v8
  v_xor_b32 v9, 0x4000, v9
  v_xor_b32 v10, 0x4000, v10
  v_xor_b32 v11, 0x4000, v11
  s_waitcnt lgkmcnt(0)
  s_barrier
  ds_read_b64 v[128:129], v136 offset:0
  ds_read_b64 v[130:131], v136 offset:4096
  ds_read_b64 v[132:133], v136 offset:8192
  ds_read_b64 v[134:135], v136 offset:12288
  ds_read_b64 v[112:113], v136 offset:8
  ds_read_b64 v[114:115], v136 offset:4104
  ds_read_b64 v[116:117], v136 offset:8200
  ds_read_b64 v[118:119], v136 offset:12296
  v_xor_b32 v136, 0x4000, v136
  s_waitcnt lgkmcnt(6)
  v_add_f32 v128, v128, v130
  v_add_f32 v129, v129, v131
  s_waitcnt lgkmcnt(4)
  v_add_f32 v132, v132, v134
  v_add_f32 v133, v133, v135
  v_add_f32 v128, v128, v132
  v_add_f32 v129, v129, v133
  v_fma_f32 v128, v128, v140, v12
  v_fma_f32 v129, v129, v141, v13
  v_cvt_pk_bf16_f32 v128, v128, v129
  buffer_store_dword v128, v3, s[48:51], s76 offen
  s_waitcnt lgkmcnt(2)
  v_add_f32 v112, v112, v114
  v_add_f32 v113, v113, v115
  s_waitcnt lgkmcnt(0)
  v_add_f32 v116, v116, v118
  v_add_f32 v117, v117, v119
  v_add_f32 v112, v112, v116
  v_add_f32 v113, v113, v117
  v_add_f32 v112, v112, v14
  v_mul_f32 v140, s75, v112
  v_exp_f32 v140, v140
  s_nop 0
  v_add_f32 v140, 1.0, v140
  v_rcp_f32 v140, v140
  s_nop 0
  v_mul_f32 v140, v140, v112
  v_add_f32 v113, v113, v15
  v_mul_f32 v141, s75, v113
  v_exp_f32 v141, v141
  s_nop 0
  v_add_f32 v141, 1.0, v141
  v_rcp_f32 v141, v141
  s_nop 0
  v_mul_f32 v141, v141, v113
  v_lshlrev_b32 v12, 16, v137
  v_and_b32 v13, 0xffff0000, v137
  s_branch L_final_proj
L_final_redo:
  s_sub_u32 s3, s3, 1
  s_cbranch_scc1 L_end
  s_branch L_final_redo2
L_final_last:
  v_mov_b32 v139, 0
  s_waitcnt vmcnt(15)
  v_mfma_f32_16x16x32_bf16 v[112:115], v[72:75], a[0:3], 0
  v_mfma_f32_16x16x32_bf16 v[116:119], v[72:75], a[4:7], 0
  v_max_u32 v139, v139, v72
  s_xor_b32 s74, s78, 16384
  buffer_load_dwordx4 v[40:43], v6, s[36:39], s74 offen sc1
  s_waitcnt vmcnt(15)
  v_mfma_f32_16x16x32_bf16 v[112:115], v[76:79], a[8:11], v[112:115]
  v_mfma_f32_16x16x32_bf16 v[116:119], v[76:79], a[12:15], v[116:119]
  v_max_u32 v139, v139, v76
  s_xor_b32 s74, s78, 17408
  buffer_load_dwordx4 v[44:47], v6, s[36:39], s74 offen sc1
  s_waitcnt vmcnt(15)
  v_mfma_f32_16x16x32_bf16 v[112:115], v[80:83], a[16:19], v[112:115]
  v_mfma_f32_16x16x32_bf16 v[116:119], v[80:83], a[20:23], v[116:119]
  v_max_u32 v139, v139, v80
  s_xor_b32 s74, s78, 18432
  buffer_load_dwordx4 v[48:51], v6, s[36:39], s74 offen sc1
  s_waitcnt vmcnt(15)
  v_mfma_f32_16x16x32_bf16 v[112:115], v[84:87], a[24:27], v[112:115]
  v_mfma_f32_16x16x32_bf16 v[116:119], v[84:87], a[28:31], v[116:119]
  v_max_u32 v139, v139, v84
  s_xor_b32 s74, s78, 19456
  buffer_load_dwordx4 v[52:55], v6, s[36:39], s74 offen sc1
  s_waitcnt vmcnt(15)
  v_mfma_f32_16x16x32_bf16 v[112:115], v[88:91], a[32:35], v[112:115]
  v_mfma_f32_16x16x32_bf16 v[116:119], v[88:91], a[36:39], v[116:119]
  v_max_u32 v139, v139, v88
  s_xor_b32 s74, s78, 20480
  buffer_load_dwordx4 v[56:59], v6, s[36:39], s74 offen sc1
  s_waitcnt vmcnt(15)
  v_mfma_f32_16x16x32_bf16 v[112:115], v[92:95], a[40:43], v[112:115]
  v_mfma_f32_16x16x32_bf16 v[116:119], v[92:95], a[44:47], v[116:119]
  v_max_u32 v139, v139, v92
  s_xor_b32 s74, s78, 21504
  buffer_load_dwordx4 v[60:63], v6, s[36:39], s74 offen sc1
  s_waitcnt vmcnt(15)
  v_mfma_f32_16x16x32_bf16 v[112:115], v[96:99], a[48:51], v[112:115]
  v_mfma_f32_16x16x32_bf16 v[116:119], v[96:99], a[52:55], v[116:119]
  v_max_u32 v139, v139, v96
  s_xor_b32 s74, s78, 22528
  buffer_load_dwordx4 v[64:67], v6, s[36:39], s74 offen sc1
  s_waitcnt vmcnt(15)
  v_mfma_f32_16x16x32_bf16 v[112:115], v[100:103], a[56:59], v[112:115]
  v_mfma_f32_16x16x32_bf16 v[116:119], v[100:103], a[60:63], v[116:119]
  v_max_u32 v139, v139, v100
  s_xor_b32 s74, s78, 23552
  buffer_load_dwordx4 v[68:71], v6, s[36:39], s74 offen sc1
  s_waitcnt vmcnt(15)
  v_mfma_f32_16x16x32_bf16 v[112:115], v[104:107], a[64:67], v[112:115]
  v_mfma_f32_16x16x32_bf16 v[116:119], v[104:107], a[68:71], v[116:119]
  v_max_u32 v139, v139, v104
  s_xor_b32 s74, s78, 24576
  buffer_load_dwordx4 v[72:75], v6, s[36:39], s74 offen sc1
  s_waitcnt vmcnt(15)
  v_mfma_f32_16x16x32_bf16 v[112:115], v[108:111], a[72:75], v[112:115]
  v_mfma_f32_16x16x32_bf16 v[116:119], v[108:111], a[76:79], v[116:119]
  v_max_u32 v139, v139, v108
  s_xor_b32 s74, s78, 25600
  buffer_load_dwordx4 v[76:79], v6, s[36:39], s74 offen sc1
  s_waitcnt vmcnt(15)
  v_mfma_f32_16x16x32_bf16 v[112:115], v[16:19], a[80:83], v[112:115]
  v_mfma_f32_16x16x32_bf16 v[116:119], v[16:19], a[84:87], v[116:119]
  v_max_u32 v139, v139, v16
  s_xor_b32 s74, s78, 26624
  buffer_load_dwordx4 v[80:83], v6, s[36:39], s74 offen sc1
  s_waitcnt vmcnt(15)
  v_mfma_f32_16x16x32_bf16 v[112:115], v[20:23], a[88:91], v[112:115]
  v_mfma_f32_16x16x32_bf16 v[116:119], v[20:23], a[92:95], v[116:119]
  v_max_u32 v139, v139, v20
  s_xor_b32 s74, s78, 27648
  buffer_load_dwordx4 v[84:87], v6, s[36:39], s74 offen sc1
  s_waitcnt vmcnt(15)
  v_mfma_f32_16x16x32_bf16 v[112:115], v[24:27], a[96:99], v[112:115]
  v_mfma_f32_16x16x32_bf16 v[116:119], v[24:27], a[100:103], v[116:119]
  v_max_u32 v139, v139, v24
  s_xor_b32 s74, s78, 28672
  buffer_load_dwordx4 v[88:91], v6, s[36:39], s74 offen sc1
  s_waitcnt vmcnt(15)
  v_mfma_f32_16x16x32_bf16 v[112:115], v[28:31], a[104:107], v[112:115]
  v_mfma_f32_16x16x32_bf16 v[116:119], v[28:31], a[108:111], v[116:119]
  v_max_u32 v139, v139, v28
  s_xor_b32 s74, s78, 29696
  buffer_load_dwordx4 v[92:95], v6, s[36:39], s74 offen sc1
  s_waitcnt vmcnt(15)
  v_mfma_f32_16x16x32_bf16 v[112:115], v[32:35], a[112:115], v[112:115]
  v_mfma_f32_16x16x32_bf16 v[116:119], v[32:35], a[116:119], v[116:119]
  v_max_u32 v139, v139, v32
  s_xor_b32 s74, s78, 30720
  buffer_load_dwordx4 v[96:99], v6, s[36:39], s74 offen sc1
  s_waitcnt vmcnt(15)
  v_mfma_f32_16x16x32_bf16 v[112:115], v[36:39], a[120:123], v[112:115]
  v_mfma_f32_16x16x32_bf16 v[116:119], v[36:39], a[124:127], v[116:119]
  v_max_u32 v139, v139, v36
  s_xor_b32 s74, s78, 31744
  buffer_load_dwordx4 v[100:103], v6, s[36:39], s74 offen sc1
  s_waitcnt vmcnt(15)
  v_mfma_f32_16x16x32_bf16 v[112:115], v[40:43], a[128:131], v[112:115]
  v_mfma_f32_16x16x32_bf16 v[116:119], v[40:43], a[132:135], v[116:119]
  v_max_u32 v139, v139, v40
  s_waitcnt vmcnt(14)
  v_mfma_f32_16x16x32_bf16 v[112:115], v[44:47], a[136:139], v[112:115]
  v_mfma_f32_16x16x32_bf16 v[116:119], v[44:47], a[140:143], v[116:119]
  v_max_u32 v139, v139, v44
  s_waitcnt vmcnt(13)
  v_mfma_f32_16x16x32_bf16 v[112:115], v[48:51], a[144:147], v[112:115]
  v_mfma_f32_16x16x32_bf16 v[116:119], v[48:51], a[148:151], v[116:119]
  v_max_u32 v139, v139, v48
  s_waitcnt vmcnt(12)
  v_mfma_f32_16x16x32_bf16 v[112:115], v[52:55], a[152:155], v[112:115]
  v_mfma_f32_16x16x32_bf16 v[116:119], v[52:55], a[156:159], v[116:119]
  v_max_u32 v139, v139, v52
  s_waitcnt vmcnt(11)
  v_mfma_f32_16x16x32_bf16 v[112:115], v[56:59], a[160:163], v[112:115]
  v_mfma_f32_16x16x32_bf16 v[116:119], v[56:59], a[164:167], v[116:119]
  v_max_u32 v139, v139, v56
  s_waitcnt vmcnt(10)
  v_mfma_f32_16x16x32_bf16 v[112:115], v[60:63], a[168:171], v[112:115]
  v_mfma_f32_16x16x32_bf16 v[116:119], v[60:63], a[172:175], v[116:119]
  v_max_u32 v139, v139, v60
  s_waitcnt vmcnt(9)
  v_mfma_f32_16x16x32_bf16 v[112:115], v[64:67], a[176:179], v[112:115]
  v_mfma_f32_16x16x32_bf16 v[116:119], v[64:67], a[180:183], v[116:119]
  v_max_u32 v139, v139, v64
  s_waitcnt vmcnt(8)
  v_mfma_f32_16x16x32_bf16 v[112:115], v[68:71], a[184:187], v[112:115]
  v_mfma_f32_16x16x32_bf16 v[116:119], v[68:71], a[188:191], v[116:119]
  v_max_u32 v139, v139, v68
  s_waitcnt vmcnt(7)
  v_mfma_f32_16x16x32_bf16 v[112:115], v[72:75], a[192:195], v[112:115]
  v_mfma_f32_16x16x32_bf16 v[116:119], v[72:75], a[196:199], v[116:119]
  v_max_u32 v139, v139, v72
  s_waitcnt vmcnt(6)
  v_mfma_f32_16x16x32_bf16 v[112:115], v[76:79], a[200:203], v[112:115]
  v_mfma_f32_16x16x32_bf16 v[116:119], v[76:79], a[204:207], v[116:119]
  v_max_u32 v139, v139, v76
  s_waitcnt vmcnt(5)
  v_mfma_f32_16x16x32_bf16 v[112:115], v[80:83], a[208:211], v[112:115]
  v_mfma_f32_16x16x32_bf16 v[116:119], v[80:83], a[212:215], v[116:119]
  v_max_u32 v139, v139, v80
  s_waitcnt vmcnt(4)
  v_mfma_f32_16x16x32_bf16 v[112:115], v[84:87], a[216:219], v[112:115]
  v_mfma_f32_16x16x32_bf16 v[116:119], v[84:87], a[220:223], v[116:119]
  v_max_u32 v139, v139, v84
  s_waitcnt vmcnt(3)
  v_mfma_f32_16x16x32_bf16 v[112:115], v[88:91], a[224:227], v[112:115]
  v_mfma_f32_16x16x32_bf16 v[116:119], v[88:91], a[228:231], v[116:119]
  v_max_u32 v139, v139, v88
  s_waitcnt vmcnt(2)
  v_mfma_f32_16x16x32_bf16 v[112:115], v[92:95], a[232:235], v[112:115]
  v_mfma_f32_16x16x32_bf16 v[116:119], v[92:95], a[236:239], v[116:119]
  v_max_u32 v139, v139, v92
  s_waitcnt vmcnt(1)
  v_mfma_f32_16x16x32_bf16 v[112:115], v[96:99], a[240:243], v[112:115]
  v_mfma_f32_16x16x32_bf16 v[116:119], v[96:99], a[244:247], v[116:119]
  v_max_u32 v139, v139, v96
  s_waitcnt vmcnt(0)
  v_mfma_f32_16x16x32_bf16 v[112:115], v[100:103], a[248:251], v[112:115]
  v_mfma_f32_16x16x32_bf16 v[116:119], v[100:103], a[252:255], v[116:119]
  v_max_u32 v139, v139, v100
  v_cmp_eq_u32 vcc, -1, v139
  s_cbranch_vccnz L_final_redo
  s_nop 3
  ds_write2_b32 v8, v112, v116 offset0:0 offset1:1
  ds_write2_b32 v9, v113, v117 offset0:0 offset1:1
  ds_write2_b32 v10, v114, v118 offset0:0 offset1:1
  ds_write2_b32 v11, v115, v119 offset0:0 offset1:1
  v_xor_b32 v8, 0x4000, v8
  v_xor_b32 v9, 0x4000, v9
  v_xor_b32 v10, 0x4000, v10
  v_xor_b32 v11, 0x4000, v11
  s_waitcnt lgkmcnt(0)
  s_barrier
  ds_read_b64 v[128:129], v136 offset:0
  ds_read_b64 v[130:131], v136 offset:4096
  ds_read_b64 v[132:133], v136 offset:8192
  ds_read_b64 v[134:135], v136 offset:12288
  v_xor_b32 v136, 0x4000, v136
  s_waitcnt lgkmcnt(2)
  v_add_f32 v128, v128, v130
  v_add_f32 v129, v129, v131
  s_waitcnt lgkmcnt(0)
  v_add_f32 v132, v132, v134
  v_add_f32 v133, v133, v135
  v_add_f32 v128, v128, v132
  v_add_f32 v129, v129, v133
  v_fma_f32 v128, v128, v140, v12
  v_fma_f32 v129, v129, v141, v13
  v_cvt_pk_bf16_f32 v128, v128, v129
  buffer_store_dword v128, v3, s[48:51], s76 offen
  s_cmp_eq_u32 s60, 6
  s_cbranch_scc1 L_final_end
  s_mov_b32 s64, 63
  s_cmp_eq_u32 s60, 7
  s_cbranch_scc1 L_final_seg
  ds_read_b64 v[140:141], v2
  ds_read_b64 v[12:13], v2 offset:8
  s_add_u32 s69, s69, 65536
  s_add_u32 s70, s70, 4096
  s_add_u32 s73, s73, 524288
  buffer_load_dword v5, v4, s[36:39], s70 offen sc1
  s_waitcnt lgkmcnt(0)
  s_branch L_final_redo2
L_final_half:
  s_andn2_b32 s78, s78, 0x400
  s_mov_b32 s76, s69
  v_mov_b32 v139, 0
  s_xor_b32 s74, s78, 0
  buffer_load_dwordx4 v[16:19], v143, s[36:39], s74 offen sc1
  s_xor_b32 s74, s78, 2048
  buffer_load_dwordx4 v[20:23], v143, s[36:39], s74 offen sc1
  s_xor_b32 s74, s78, 4096
  buffer_load_dwordx4 v[24:27], v143, s[36:39], s74 offen sc1
  s_xor_b32 s74, s78, 6144
  buffer_load_dwordx4 v[28:31], v143, s[36:39], s74 offen sc1
  s_xor_b32 s74, s78, 8192
  buffer_load_dwordx4 v[32:35], v143, s[36:39], s74 offen sc1
  s_xor_b32 s74, s78, 10240
  buffer_load_dwordx4 v[36:39], v143, s[36:39], s74 offen sc1
  s_xor_b32 s74, s78, 12288
  buffer_load_dwordx4 v[40:43], v143, s[36:39], s74 offen sc1
  s_xor_b32 s74, s78, 14336
  buffer_load_dwordx4 v[44:47], v143, s[36:39], s74 offen sc1
  s_waitcnt vmcnt(7)
  v_mfma_f32_16x16x32_bf16 v[112:115], v[16:19], a[0:3], 0
  v_mfma_f32_16x16x32_bf16 v[116:119], v[16:19], a[4:7], 0
  v_max_u32 v139, v139, v16
  v_mfma_f32_16x16x32_bf16 v[120:123], v[16:19], a[8:11], 0
  v_mfma_f32_16x16x32_bf16 v[124:127], v[16:19], a[12:15], 0
  s_xor_b32 s74, s78, 16384
  buffer_load_dwordx4 v[48:51], v143, s[36:39], s74 offen sc1
  s_waitcnt vmcnt(7)
  v_mfma_f32_16x16x32_bf16 v[112:115], v[20:23], a[16:19], v[112:115]
  v_mfma_f32_16x16x32_bf16 v[116:119], v[20:23], a[20:23], v[116:119]
  v_max_u32 v139, v139, v20
  v_mfma_f32_16x16x32_bf16 v[120:123], v[20:23], a[24:27], v[120:123]
  v_mfma_f32_16x16x32_bf16 v[124:127], v[20:23], a[28:31], v[124:127]
  s_xor_b32 s74, s78, 18432
  buffer_load_dwordx4 v[52:55], v143, s[36:39], s74 offen sc1
  s_waitcnt vmcnt(7)
  v_mfma_f32_16x16x32_bf16 v[112:115], v[24:27], a[32:35], v[112:115]
  v_mfma_f32_16x16x32_bf16 v[116:119], v[24:27], a[36:39], v[116:119]
  v_max_u32 v139, v139, v24
  v_mfma_f32_16x16x32_bf16 v[120:123], v[24:27], a[40:43], v[120:123]
  v_mfma_f32_16x16x32_bf16 v[124:127], v[24:27], a[44:47], v[124:127]
  s_xor_b32 s74, s78, 20480
  buffer_load_dwordx4 v[56:59], v143, s[36:39], s74 offen sc1
  s_waitcnt vmcnt(7)
  v_mfma_f32_16x16x32_bf16 v[112:115], v[28:31], a[48:51], v[112:115]
  v_mfma_f32_16x16x32_bf16 v[116:119], v[28:31], a[52:55], v[116:119]
  v_max_u32 v139, v139, v28
  v_mfma_f32_16x16x32_bf16 v[120:123], v[28:31], a[56:59], v[120:123]
  v_mfma_f32_16x16x32_bf16 v[124:127], v[28:31], a[60:63], v[124:127]
  s_xor_b32 s74, s78, 22528
  buffer_load_dwordx4 v[60:63], v143, s[36:39], s74 offen sc1
  s_waitcnt vmcnt(7)
  v_mfma_f32_16x16x32_bf16 v[112:115], v[32:35], a[64:67], v[112:115]
  v_mfma_f32_16x16x32_bf16 v[116:119], v[32:35], a[68:71], v[116:119]
  v_max_u32 v139, v139, v32
  v_mfma_f32_16x16x32_bf16 v[120:123], v[32:35], a[72:75], v[120:123]
  v_mfma_f32_16x16x32_bf16 v[124:127], v[32:35], a[76:79], v[124:127]
  s_xor_b32 s74, s78, 24576
  buffer_load_dwordx4 v[64:67], v143, s[36:39], s74 offen sc1
  s_waitcnt vmcnt(7)
  v_mfma_f32_16x16x32_bf16 v[112:115], v[36:39], a[80:83], v[112:115]
  v_mfma_f32_16x16x32_bf16 v[116:119], v[36:39], a[84:87], v[116:119]
  v_max_u32 v139, v139, v36
  v_mfma_f32_16x16x32_bf16 v[120:123], v[36:39], a[88:91], v[120:123]
  v_mfma_f32_16x16x32_bf16 v[124:127], v[36:39], a[92:95], v[124:127]
  s_xor_b32 s74, s78, 26624
  buffer_load_dwordx4 v[68:71], v143, s[36:39], s74 offen sc1
  s_waitcnt vmcnt(7)
  v_mfma_f32_16x16x32_bf16 v[112:115], v[40:43], a[96:99], v[112:115]
  v_mfma_f32_16x16x32_bf16 v[116:119], v[40:43], a[100:103], v[116:119]
  v_max_u32 v139, v139, v40
  v_mfma_f32_16x16x32_bf16 v[120:123], v[40:43], a[104:107], v[120:123]
  v_mfma_f32_16x16x32_bf16 v[124:127], v[40:43], a[108:111], v[124:127]
  s_xor_b32 s74, s78, 28672
  buffer_load_dwordx4 v[72:75], v143, s[36:39], s74 offen sc1
  s_waitcnt vmcnt(7)
  v_mfma_f32_16x16x32_bf16 v[112:115], v[44:47], a[112:115], v[112:115]
  v_mfma_f32_16x16x32_bf16 v[116:119], v[44:47], a[116:119], v[116:119]
  v_max_u32 v139, v139, v44
  v_mfma_f32_16x16x32_bf16 v[120:123], v[44:47], a[120:123], v[120:123]
  v_mfma_f32_16x16x32_bf16 v[124:127], v[44:47], a[124:127], v[124:127]
  s_xor_b32 s74, s78, 30720
  buffer_load_dwordx4 v[76:79], v143, s[36:39], s74 offen sc1
  s_waitcnt vmcnt(7)
  v_mfma_f32_16x16x32_bf16 v[112:115], v[48:51], a[128:131], v[112:115]
  v_mfma_f32_16x16x32_bf16 v[116:119], v[48:51], a[132:135], v[116:119]
  v_max_u32 v139, v139, v48
  v_mfma_f32_16x16x32_bf16 v[120:123], v[48:51], a[136:139], v[120:123]
  v_mfma_f32_16x16x32_bf16 v[124:127], v[48:51], a[140:143], v[124:127]
  s_waitcnt vmcnt(6)
  v_mfma_f32_16x16x32_bf16 v[112:115], v[52:55], a[144:147], v[112:115]
  v_mfma_f32_16x16x32_bf16 v[116:119], v[52:55], a[148:151], v[116:119]
  v_max_u32 v139, v139, v52
  v_mfma_f32_16x16x32_bf16 v[120:123], v[52:55], a[152:155], v[120:123]
  v_mfma_f32_16x16x32_bf16 v[124:127], v[52:55], a[156:159], v[124:127]
  s_waitcnt vmcnt(5)
  v_mfma_f32_16x16x32_bf16 v[112:115], v[56:59], a[160:163], v[112:115]
  v_mfma_f32_16x16x32_bf16 v[116:119], v[56:59], a[164:167], v[116:119]
  v_max_u32 v139, v139, v56
  v_mfma_f32_16x16x32_bf16 v[120:123], v[56:59], a[168:171], v[120:123]
  v_mfma_f32_16x16x32_bf16 v[124:127], v[56:59], a[172:175], v[124:127]
  s_waitcnt vmcnt(4)
  v_mfma_f32_16x16x32_bf16 v[112:115], v[60:63], a[176:179], v[112:115]
  v_mfma_f32_16x16x32_bf16 v[116:119], v[60:63], a[180:183], v[116:119]
  v_max_u32 v139, v139, v60
  v_mfma_f32_16x16x32_bf16 v[120:123], v[60:63], a[184:187], v[120:123]
  v_mfma_f32_16x16x32_bf16 v[124:127], v[60:63], a[188:191], v[124:127]
  s_waitcnt vmcnt(3)
  v_mfma_f32_16x16x32_bf16 v[112:115], v[64:67], a[192:195], v[112:115]
  v_mfma_f32_16x16x32_bf16 v[116:119], v[64:67], a[196:199], v[116:119]
  v_max_u32 v139, v139, v64
  v_mfma_f32_16x16x32_bf16 v[120:123], v[64:67], a[200:203], v[120:123]
  v_mfma_f32_16x16x32_bf16 v[124:127], v[64:67], a[204:207], v[124:127]
  s_waitcnt vmcnt(2)
  v_mfma_f32_16x16x32_bf16 v[112:115], v[68:71], a[208:211], v[112:115]
  v_mfma_f32_16x16x32_bf16 v[116:119], v[68:71], a[212:215], v[116:119]
  v_max_u32 v139, v139, v68
  v_mfma_f32_16x16x32_bf16 v[120:123], v[68:71], a[216:219], v[120:123]
  v_mfma_f32_16x16x32_bf16 v[124:127], v[68:71], a[220:223], v[124:127]
  s_waitcnt vmcnt(1)
  v_mfma_f32_16x16x32_bf16 v[112:115], v[72:75], a[224:227], v[112:115]
  v_mfma_f32_16x16x32_bf16 v[116:119], v[72:75], a[228:231], v[116:119]
  v_max_u32 v139, v139, v72
  v_mfma_f32_16x16x32_bf16 v[120:123], v[72:75], a[232:235], v[120:123]
  v_mfma_f32_16x16x32_bf16 v[124:127], v[72:75], a[236:239], v[124:127]
  s_waitcnt vmcnt(0)
  v_mfma_f32_16x16x32_bf16 v[112:115], v[76:79], a[240:243], v[112:115]
  v_mfma_f32_16x16x32_bf16 v[116:119], v[76:79], a[244:247], v[116:119]
  v_max_u32 v139, v139, v76
  v_mfma_f32_16x16x32_bf16 v[120:123], v[76:79], a[248:251], v[120:123]
  v_mfma_f32_16x16x32_bf16 v[124:127], v[76:79], a[252:255], v[124:127]
  v_cmp_eq_u32 vcc, -1, v139
  s_cbranch_vccnz L_final_redo
  v_cmp_gt_u32 vcc, 32, v0
  s_nop 1
  v_cndmask_b32 v112, v120, v112, vcc
  v_cndmask_b32 v113, v121, v113, vcc
  v_cndmask_b32 v114, v122, v114, vcc
  v_cndmask_b32 v115, v123, v115, vcc
  v_cndmask_b32 v116, v124, v116, vcc
  v_cndmask_b32 v117, v125, v117, vcc
  v_cndmask_b32 v118, v126, v118, vcc
  v_cndmask_b32 v119, v127, v119, vcc
  ds_write2_b32 v8, v112, v116 offset0:0 offset1:1
  ds_write2_b32 v9, v113, v117 offset0:0 offset1:1
  ds_write2_b32 v10, v114, v118 offset0:0 offset1:1
  ds_write2_b32 v11, v115, v119 offset0:0 offset1:1
  v_xor_b32 v8, 0x4000, v8
  v_xor_b32 v9, 0x4000, v9
  v_xor_b32 v10, 0x4000, v10
  v_xor_b32 v11, 0x4000, v11
  s_waitcnt lgkmcnt(0)
  s_barrier
  ds_read_b64 v[128:129], v136 offset:0
  ds_read_b64 v[130:131], v136 offset:4096
  ds_read_b64 v[132:133], v136 offset:8192
  ds_read_b64 v[134:135], v136 offset:12288
  v_xor_b32 v136, 0x4000, v136
  s_waitcnt lgkmcnt(2)
  v_add_f32 v128, v128, v130
  v_add_f32 v129, v129, v131
  s_waitcnt lgkmcnt(0)
  v_add_f32 v132, v132, v134
  v_add_f32 v133, v133, v135
  v_add_f32 v128, v128, v132
  v_add_f32 v129, v129, v133
  v_mov_b32 v130, v128
  v_mov_b32 v131, v129
  s_nop 0
  v_permlane32_swap_b32 v128, v130
  v_permlane32_swap_b32 v129, v131
  v_add_f32 v128, v128, v130
  v_add_f32 v129, v129, v131
  s_mov_b64 exec, s[80:81]
  v_fma_f32 v128, v128, v140, v12
  v_fma_f32 v129, v129, v141, v13
  v_cvt_pk_bf16_f32 v128, v128, v129
  buffer_store_dword v128, v3, s[48:51], s76 offen
  s_mov_b64 exec, -1
L_final_end:
  s_waitcnt vmcnt(0)
  s_endpgm
L_last:
.section .rodata,"a"
.p2align 6
.amdhsa_kernel recurrent_scan__memory_aug_recurrent_mem_tr__mixer_channel_mlp__prompt_kernel
  .amdhsa_next_free_vgpr 512
  .amdhsa_next_free_sgpr 102
  .amdhsa_accum_offset 256
  .amdhsa_group_segment_fixed_size 0
  .amdhsa_kernarg_size 120
  .amdhsa_user_sgpr_count 2
  .amdhsa_user_sgpr_kernarg_segment_ptr 1
  .amdhsa_system_sgpr_workgroup_id_x 1
.end_amdhsa_kernel
```
